```python
import torch

def _softmax(x, axis=-1):
    return torch.softmax(x, dim=axis)
def _gelu(x):
    return torch.nn.functional.gelu(x, approximate="tanh")
def _silu(x):
    return torch.nn.functional.silu(x)
def _sigmoid(x):
    return torch.sigmoid(x)
def _layernorm(x, axis=-1, eps=1e-5):
    m = x.mean(dim=axis, keepdim=True)
    v = x.var(dim=axis, keepdim=True, unbiased=False)
    return (x - m) / torch.sqrt(v + eps)
def _scatter_add(tgt, idx, src, axis=0):
    return tgt.clone().index_add_(axis, idx, src)
def _segment_sum(src, seg, n):
    out = torch.zeros((n,) + src.shape[1:], dtype=src.dtype)
    return out.index_add_(0, seg, src)
def _pad(x, pw):
    flat = tuple(v for pair in reversed(pw) for v in pair)
    return torch.nn.functional.pad(x, flat)

kernel_name = 'interleave_layers__linear_attn_block__dense_activation_silu__prompt'

def setup_inputs():

    _w = (lambda a: (lambda t: t.to(torch.bfloat16) if t.is_floating_point() else t)(torch.as_tensor(a)))
    def _A_setup():
        B, S, D = 1, 2048, 448
        return {
            "x": _w((lambda *s: torch.randn(*s, dtype=torch.bfloat16) * 0.05)(B, S, D)),
            "wqkv": _w((lambda *s: torch.randn(*s, dtype=torch.bfloat16) * 0.1)(D, 3 * D)),
            "wo": _w((lambda *s: torch.randn(*s, dtype=torch.bfloat16) * 0.05)(D, D)),
        }
    _A_in = _A_setup()

    def _B_setup():
        B, S, D, F = 1, 2048, 448, 1792
        return {
            "x": _w((lambda *s: torch.randn(*s, dtype=torch.bfloat16) * 0.05)(B, S, D)),
            "w1": _w((lambda *s: torch.randn(*s, dtype=torch.bfloat16) * 3.2)(D, F) * (D ** -0.5)),
            "w2": _w((lambda *s: torch.randn(*s, dtype=torch.bfloat16) * 0.8)(F, D) * (F ** -0.5)),
        }
    _B_in = _B_setup()

    return {
        "A_x": _A_in["x"],
        "A_wqkv": _A_in["wqkv"],
        "A_wo": _A_in["wo"],
        "B_x": _B_in["x"],
        "B_w1": _B_in["w1"],
        "B_w2": _B_in["w2"],
    }

def reference(A_x, A_wqkv, A_wo, B_x, B_w1, B_w2):
    def _A_ref(x, wqkv, wo):
        B, S, D = x.shape
        H = 16; Dh = D // H
        qkv = (lambda x, *d: x.permute(*d))((x @ wqkv).reshape(B, S, 3, H, Dh), 2, 0, 3, 1, 4)
        q, k, v = qkv[0], qkv[1], qkv[2]
        phi = lambda t: torch.where(t > 0, t + 1, torch.exp(t)) + 1e-6
        pq, pk = phi(q), phi(k)
        kv = torch.einsum("bhsd,bhse->bhde", pk, v)
        z = torch.einsum("bhsd->bhd", pk)
        num = torch.einsum("bhqd,bhde->bhqe", pq, kv)
        den = torch.einsum("bhqd,bhd->bhq", pq, z)[..., None] + 1e-6
        o = num / den
        return (lambda x, *d: x.permute(*d))(o, 0, 2, 1, 3).reshape(B, S, D) @ wo

    def _B_ref(x, w1, w2):
        h = torch.einsum("bsd,df->bsf", x, w1)
        h = _silu(h)
        out = torch.einsum("bsf,fd->bsd", h, w2)
        return out

    x = A_x
    x = x + _A_ref(_layernorm(x, axis=-1), A_wqkv, A_wo)
    x = x + _B_ref(_layernorm(x, axis=-1), B_w1, B_w2)
    x = x + _A_ref(_layernorm(x, axis=-1), A_wqkv, A_wo)
    x = x + _B_ref(_layernorm(x, axis=-1), B_w1, B_w2)
    return x
```

```asm
; @launch grid=(256,1,1) block=(256,1,1) lds=163840
.amdgcn_target "amdgcn-amd-amdhsa--gfx950"
.text
.globl interleave_layers__linear_attn_block__dense_activation_silu__prompt_kernel
.p2align 8
.type interleave_layers__linear_attn_block__dense_activation_silu__prompt_kernel,@function
interleave_layers__linear_attn_block__dense_activation_silu__prompt_kernel:
    s_cmp_lt_u32 s2, 256
    s_cbranch_scc1 L_start
    s_endpgm
L_start:
    s_load_dwordx4 s[40:43], s[0:1], 0
    s_load_dwordx2 s[52:53], s[0:1], 64
    s_load_dwordx2 s[44:45], s[0:1], 16
    s_load_dwordx4 s[48:51], s[0:1], 32
    s_load_dwordx2 s[46:47], s[0:1], 48
    s_getpc_b64 s[6:7]
L_pc:
    v_lshrrev_b32 v13, 6, v0
    v_and_b32 v0, 63, v0
    v_readfirstlane_b32 s60, v13
    s_and_b32 s57, s2, 7
    s_lshr_b32 s3, s2, 3
    s_lshl_b32 s4, s3, 2
    s_add_u32 s4, s4, s60
    s_lshl_b32 s4, s4, 9
    v_lshlrev_b32 v9, 7, v0
    v_add_u32 v13, s4, v9
    v_min_u32 v13, L_fastend-L_pc-4, v13
    s_mov_b64 exec, 0xf
    global_load_dword v10, v13, s[6:7]
    s_mov_b64 exec, -1
    s_and_b32 s58, s3, 15
    s_lshr_b32 s59, s3, 4
    s_lshl_b32 s2, s57, 1
    s_add_u32 s2, s2, s59
    s_lshl_b32 s3, s2, 2
    s_add_u32 s3, s3, s60
    s_min_u32 s5, s3, 55
    s_cmp_ge_u32 s5, 28
    s_cselect_b32 s4, 1, 0
    s_cselect_b32 s6, 28, 0
    s_sub_u32 s5, s5, s6
    v_lshrrev_b32 v13, 2, v0
    v_and_b32 v15, 3, v0
    v_lshlrev_b32 v15, 4, v15
    v_mul_u32_u24 v14, 2688, v13
    v_add_u32 v6, v14, v15
    v_mul_u32_u24 v14, 896, v13
    v_add_u32 v7, v14, v15
    v_mul_u32_u24 v14, 3584, v13
    v_add_u32 v8, v14, v15
    s_cmp_ge_u32 s58, 7
    s_cselect_b32 s6, 1, 0
    s_cselect_b32 s7, 7, 0
    s_lshl_b32 s62, s59, 1
    s_add_u32 s62, s62, s6
    s_sub_u32 s63, s58, s7
    s_lshl_b32 s64, s59, 2
    s_and_b32 s6, s60, 1
    s_lshl_b32 s6, s6, 1
    s_lshr_b32 s7, s60, 1
    s_or_b32 s6, s6, s7
    s_add_u32 s65, s64, s6
    s_add_u32 s64, s64, s60
    v_lshlrev_b32 v1, 4, v0
    v_lshrrev_b32 v13, 3, v0
    v_mul_u32_u24 v14, 896, v13
    v_lshrrev_b32 v13, 1, v13
    v_and_b32 v15, 7, v0
    v_xor_b32 v13, v13, v15
    v_lshl_add_u32 v16, v13, 4, v14
    v_xor_b32 v13, 4, v13
    v_lshl_add_u32 v17, v13, 4, v14
    s_lshl_b32 s70, s57, 3
    s_add_u32 s70, s70, s64
    s_mul_i32 s70, s70, 28672
    s_mul_i32 s71, s60, 28672
    s_add_u32 s71, s71, 49152
    s_cmp_ge_u32 s58, 14
    s_cselect_b32 s72, 7, 0
    s_sub_u32 s72, s63, s72
    s_mul_i32 s77, s2, 37
    s_lshr_b32 s77, s77, 8
    s_mul_i32 s77, s77, 7
    s_sub_u32 s76, s2, s77
    s_sub_i32 s77, s72, s76
    s_cmp_lt_i32 s77, 0
    s_cselect_b32 s6, 7, 0
    s_add_i32 s77, s77, s6
    s_mov_b32 s10, 1835008
    s_mov_b32 s11, 0x00020000
    s_mov_b32 s14, 1204224
    s_mov_b32 s15, 0x00020000
    s_waitcnt lgkmcnt(0)
    s_mov_b32 s12, s42
    s_mov_b32 s13, s43
    s_mov_b32 s8, s40
    s_mov_b32 s9, s41
    s_load_dword s56, s[52:53], 0
    s_lshl_b32 s73, s72, 7
    s_add_u32 s73, s73, s70
    s_lshl_b32 s74, s77, 12
    s_add_u32 s74, s74, s71
    s_add_u32 m0, s74, 0
    s_add_u32 s75, s73, 0
    buffer_load_dwordx4 v16, s[8:11], s75 offen lds
    s_add_u32 m0, s74, 1024
    s_add_u32 s75, s73, 7168
    buffer_load_dwordx4 v17, s[8:11], s75 offen lds
    s_add_u32 m0, s74, 2048
    s_add_u32 s75, s73, 14336
    buffer_load_dwordx4 v16, s[8:11], s75 offen lds
    s_add_u32 m0, s74, 3072
    s_add_u32 s75, s73, 21504
    buffer_load_dwordx4 v17, s[8:11], s75 offen lds
    s_mul_i32 s67, s64, 28672
    s_add_u32 s67, s67, 917504
    s_mul_i32 s68, s65, 28672
    s_add_u32 s68, s68, 1146880
    s_mul_i32 s69, s64, 7168
    s_add_u32 s69, s69, 1376256
    s_mov_b32 s66, 40000
    v_add_u32 v12, 114688, v1
    v_and_b32 v13, 3, v0
    v_lshlrev_b32 v13, 3, v13
    v_bfe_u32 v14, v0, 4, 1
    v_lshl_add_u32 v13, v14, 5, v13
    v_bfe_u32 v14, v0, 2, 2
    v_lshl_add_u32 v13, v14, 6, v13
    v_lshrrev_b32 v14, 5, v0
    v_lshl_add_u32 v2, v14, 8, v13
    v_add_u32 v3, 57344, v2
    v_lshl_add_u32 v62, v14, 9, v13
    v_add_u32 v63, 57344, v62
    v_and_b32 v13, 31, v0
    v_lshrrev_b32 v14, 3, v13
    v_lshlrev_b32 v14, 10, v14
    v_and_b32 v15, 7, v13
    v_lshl_add_u32 v14, v15, 7, v14
    v_add_u32 v14, s71, v14
    v_bfe_u32 v13, v13, 1, 3
    v_lshrrev_b32 v15, 5, v0
    v_xor_b32 v13, v13, v15
    v_xor_b32 v15, 0, v13
    v_lshl_add_u32 v20, v15, 4, v14
    v_xor_b32 v15, 2, v13
    v_lshl_add_u32 v21, v15, 4, v14
    v_xor_b32 v15, 4, v13
    v_lshl_add_u32 v22, v15, 4, v14
    v_xor_b32 v15, 6, v13
    v_lshl_add_u32 v23, v15, 4, v14
    v_lshrrev_b32 v15, 5, v0
    v_xor_b32 v13, v13, v15
    v_lshl_add_u32 v14, v15, 3, v14
    s_min_u32 s6, s58, 13
    s_lshr_b32 s7, s6, 1
    s_sub_i32 s7, s7, s76
    s_cmp_lt_i32 s7, 0
    s_cselect_b32 s78, 7, 0
    s_add_i32 s7, s7, s78
    s_lshl_b32 s7, s7, 12
    v_add_u32 v14, s7, v14
    s_and_b32 s6, s6, 1
    s_lshl_b32 s6, s6, 2
    v_xor_b32 v13, s6, v13
    v_xor_b32 v15, 0, v13
    v_lshl_add_u32 v24, v15, 4, v14
    v_xor_b32 v15, 1, v13
    v_lshl_add_u32 v25, v15, 4, v14
    v_xor_b32 v15, 2, v13
    v_lshl_add_u32 v26, v15, 4, v14
    v_xor_b32 v15, 3, v13
    v_lshl_add_u32 v27, v15, 4, v14
    s_cmp_lt_u32 s58, 14
    s_cselect_b32 s18, 401408, 0
    s_cselect_b32 s22, 1605632, 0
    s_cselect_b32 s26, 1605632, 0
    s_mov_b32 s16, s44
    s_mov_b32 s17, s45
    s_mov_b32 s19, 0x00020000
    s_mov_b32 s20, s48
    s_mov_b32 s21, s49
    s_mov_b32 s23, 0x00020000
    s_mov_b32 s24, s50
    s_mov_b32 s25, s51
    s_mov_b32 s27, 0x00020000
    s_mov_b32 s28, s46
    s_mov_b32 s29, s47
    s_mov_b32 s30, 1835008
    s_mov_b32 s31, 0x00020000
    s_mov_b32 s32, s52
    s_mov_b32 s33, s53
    s_mov_b32 s34, 18350080
    s_mov_b32 s35, 0x00020000
    s_mul_i32 s6, s57, 1441792
    s_add_u32 s6, s6, 6815744
    s_add_u32 s36, s52, s6
    s_addc_u32 s37, s53, 0
    s_mov_b32 s38, 1441792
    s_mov_b32 s39, 0x00020000
    s_add_u32 s72, s72, 1
    s_cmp_eq_u32 s72, 7
    s_cselect_b32 s72, 0, s72
    s_add_u32 s77, s77, 1
    s_cmp_eq_u32 s77, 7
    s_cselect_b32 s77, 0, s77
    s_lshl_b32 s73, s72, 7
    s_add_u32 s73, s73, s70
    s_lshl_b32 s74, s77, 12
    s_add_u32 s74, s74, s71
    s_add_u32 m0, s74, 0
    s_add_u32 s75, s73, 0
    buffer_load_dwordx4 v16, s[8:11], s75 offen lds
    s_add_u32 m0, s74, 1024
    s_add_u32 s75, s73, 7168
    buffer_load_dwordx4 v17, s[8:11], s75 offen lds
    s_add_u32 m0, s74, 2048
    s_add_u32 s75, s73, 14336
    buffer_load_dwordx4 v16, s[8:11], s75 offen lds
    s_add_u32 m0, s74, 3072
    s_add_u32 s75, s73, 21504
    buffer_load_dwordx4 v17, s[8:11], s75 offen lds
    s_add_u32 s72, s72, 1
    s_cmp_eq_u32 s72, 7
    s_cselect_b32 s72, 0, s72
    s_add_u32 s77, s77, 1
    s_cmp_eq_u32 s77, 7
    s_cselect_b32 s77, 0, s77
    s_lshl_b32 s73, s72, 7
    s_add_u32 s73, s73, s70
    s_lshl_b32 s74, s77, 12
    s_add_u32 s74, s74, s71
    s_add_u32 m0, s74, 0
    s_add_u32 s75, s73, 0
    buffer_load_dwordx4 v16, s[8:11], s75 offen lds
    s_add_u32 m0, s74, 1024
    s_add_u32 s75, s73, 7168
    buffer_load_dwordx4 v17, s[8:11], s75 offen lds
    s_add_u32 m0, s74, 2048
    s_add_u32 s75, s73, 14336
    buffer_load_dwordx4 v16, s[8:11], s75 offen lds
    s_add_u32 m0, s74, 3072
    s_add_u32 s75, s73, 21504
    buffer_load_dwordx4 v17, s[8:11], s75 offen lds
    s_add_u32 s72, s72, 1
    s_cmp_eq_u32 s72, 7
    s_cselect_b32 s72, 0, s72
    s_add_u32 s77, s77, 1
    s_cmp_eq_u32 s77, 7
    s_cselect_b32 s77, 0, s77
    s_lshl_b32 s73, s72, 7
    s_add_u32 s73, s73, s70
    s_lshl_b32 s74, s77, 12
    s_add_u32 s74, s74, s71
    s_add_u32 m0, s74, 0
    s_add_u32 s75, s73, 0
    buffer_load_dwordx4 v16, s[8:11], s75 offen lds
    s_add_u32 m0, s74, 1024
    s_add_u32 s75, s73, 7168
    buffer_load_dwordx4 v17, s[8:11], s75 offen lds
    s_add_u32 m0, s74, 2048
    s_add_u32 s75, s73, 14336
    buffer_load_dwordx4 v16, s[8:11], s75 offen lds
    s_add_u32 m0, s74, 3072
    s_add_u32 s75, s73, 21504
    buffer_load_dwordx4 v17, s[8:11], s75 offen lds
    s_add_u32 s72, s72, 1
    s_cmp_eq_u32 s72, 7
    s_cselect_b32 s72, 0, s72
    s_add_u32 s77, s77, 1
    s_cmp_eq_u32 s77, 7
    s_cselect_b32 s77, 0, s77
    s_lshl_b32 s73, s72, 7
    s_add_u32 s73, s73, s70
    s_lshl_b32 s74, s77, 12
    s_add_u32 s74, s74, s71
    s_add_u32 m0, s74, 0
    s_add_u32 s75, s73, 0
    buffer_load_dwordx4 v16, s[8:11], s75 offen lds
    s_add_u32 m0, s74, 1024
    s_add_u32 s75, s73, 7168
    buffer_load_dwordx4 v17, s[8:11], s75 offen lds
    s_add_u32 m0, s74, 2048
    s_add_u32 s75, s73, 14336
    buffer_load_dwordx4 v16, s[8:11], s75 offen lds
    s_add_u32 m0, s74, 3072
    s_add_u32 s75, s73, 21504
    buffer_load_dwordx4 v17, s[8:11], s75 offen lds
    s_add_u32 s72, s72, 1
    s_cmp_eq_u32 s72, 7
    s_cselect_b32 s72, 0, s72
    s_add_u32 s77, s77, 1
    s_cmp_eq_u32 s77, 7
    s_cselect_b32 s77, 0, s77
    s_lshl_b32 s73, s72, 7
    s_add_u32 s73, s73, s70
    s_lshl_b32 s74, s77, 12
    s_add_u32 s74, s74, s71
    s_add_u32 m0, s74, 0
    s_add_u32 s75, s73, 0
    buffer_load_dwordx4 v16, s[8:11], s75 offen lds
    s_add_u32 m0, s74, 1024
    s_add_u32 s75, s73, 7168
    buffer_load_dwordx4 v17, s[8:11], s75 offen lds
    s_add_u32 m0, s74, 2048
    s_add_u32 s75, s73, 14336
    buffer_load_dwordx4 v16, s[8:11], s75 offen lds
    s_add_u32 m0, s74, 3072
    s_add_u32 s75, s73, 21504
    buffer_load_dwordx4 v17, s[8:11], s75 offen lds
    s_add_u32 s72, s72, 1
    s_cmp_eq_u32 s72, 7
    s_cselect_b32 s72, 0, s72
    s_add_u32 s77, s77, 1
    s_cmp_eq_u32 s77, 7
    s_cselect_b32 s77, 0, s77
    s_lshl_b32 s73, s72, 7
    s_add_u32 s73, s73, s70
    s_lshl_b32 s74, s77, 12
    s_add_u32 s74, s74, s71
    s_add_u32 m0, s74, 0
    s_add_u32 s75, s73, 0
    buffer_load_dwordx4 v16, s[8:11], s75 offen lds
    s_add_u32 m0, s74, 1024
    s_add_u32 s75, s73, 7168
    buffer_load_dwordx4 v17, s[8:11], s75 offen lds
    s_add_u32 m0, s74, 2048
    s_add_u32 s75, s73, 14336
    buffer_load_dwordx4 v16, s[8:11], s75 offen lds
    s_add_u32 m0, s74, 3072
    s_add_u32 s75, s73, 21504
    buffer_load_dwordx4 v17, s[8:11], s75 offen lds
    s_getreg_b32 s61, hwreg(HW_REG_XCC_ID, 0, 4)
    s_mul_i32 s0, s58, 56
    s_mul_i32 s1, s60, 43008
    s_add_u32 s0, s0, s1
    s_lshl_b32 s1, s60, 10
    s_mov_b32 s78, s76
    s_mov_b32 s74, s76
    s_mul_i32 s40, s5, 57344
    s_lshl_b32 s41, s58, 8
    s_add_u32 s40, s40, s41
    s_lshl_b32 s41, s4, 7
    s_add_u32 s40, s40, s41
    buffer_load_dwordx4 a[40:43], v8, s[20:23], s40 offen
    buffer_load_dwordx4 a[44:47], v8, s[20:23], s40 offen offset:64
    s_mul_i32 s71, s58, 112
    s_mul_i32 s41, s4, 56
    s_add_u32 s71, s71, s41
    s_add_u32 s71, s71, s5
    s_lshl_b32 s71, s71, 10
    s_add_u32 s71, s71, 2433024
    s_cmp_lt_u32 s58, 14
    s_cselect_b32 s22, 18350080, 0
    s_mov_b32 s20, s32
    s_mov_b32 s21, s33
    s_lshl_b32 s40, s60, 10
    s_add_u32 s40, s40, 159744
    v_add_u32 v4, s40, v1
    v_add_u32 v5, s40, v2
    s_and_b32 s75, s62, 1
    s_lshl_b32 s75, s75, 6
    s_add_u32 s75, s75, s3
    s_mul_i32 s70, s75, 14336
    s_lshl_b32 s72, s63, 7
    s_add_u32 s70, s70, s72
    s_mul_i32 s72, s63, 112
    s_add_u32 s72, s72, s75
    s_lshl_b32 s72, s72, 11
    s_add_u32 s72, s72, 4038656
    s_cmp_lt_u32 s75, 112
    s_cselect_b32 s70, s70, 1073741824
    s_cselect_b32 s72, s72, 1073741824
    buffer_load_dwordx4 a[48:51], v7, s[24:27], s70 offen
    buffer_load_dwordx4 a[52:55], v7, s[24:27], s70 offen offset:64
    s_mul_i32 s42, s5, 14336
    s_lshl_b32 s41, s58, 6
    s_add_u32 s42, s42, s41
    s_mul_i32 s41, s58, 28
    s_add_u32 s41, s41, s5
    s_lshl_b32 s41, s41, 10
    s_add_u32 s79, s41, 2031616
    s_cmp_eq_u32 s4, 0
    s_cselect_b32 s42, 1073741824, s42
    s_cselect_b32 s79, 1073741824, s79
    buffer_load_dwordx4 v[32:35], v7, s[16:19], s42 offen
    s_lshl_b32 s40, s58, 6
    s_add_u32 s40, s40, s3
    s_lshr_b32 s41, s40, 1
    s_mul_i32 s41, s41, 2688
    s_and_b32 s40, s40, 1
    s_mul_i32 s40, s40, 384
    s_add_u32 s40, s40, s41
    s_mov_b64 exec, 0xf
    buffer_load_dword v10, v9, s[12:15], s40 offen
    s_mov_b64 exec, -1
    s_lshl_b32 s77, s76, 12
    s_add_u32 s77, s77, s1
    s_add_u32 m0, s77, 0
    s_mul_i32 s77, s76, 172032
    s_add_u32 s77, s77, s0
    s_add_u32 s77, s77, 896
    buffer_load_dwordx4 v6, s[12:15], s77 offen lds
    s_add_u32 s76, s76, 1
    s_cmp_eq_u32 s76, 7
    s_cselect_b32 s76, 0, s76
    s_lshl_b32 s77, s76, 12
    s_add_u32 s77, s77, s1
    s_add_u32 m0, s77, 0
    s_mul_i32 s77, s76, 172032
    s_add_u32 s77, s77, s0
    s_add_u32 s77, s77, 896
    buffer_load_dwordx4 v6, s[12:15], s77 offen lds
    s_add_u32 s76, s76, 1
    s_cmp_eq_u32 s76, 7
    s_cselect_b32 s76, 0, s76
    s_waitcnt vmcnt(8)
    s_waitcnt lgkmcnt(0)
    s_mov_b32 s48, 0x3f803f80
    s_mov_b32 s49, 0x3fb8aa3b
    s_mov_b32 s50, 0x358637bd
    s_mov_b32 s51, 0xffff0000
    s_mov_b32 s52, 0x10000000
    s_mov_b32 s53, 0x10000000
    s_mov_b32 s54, 0
    s_mov_b32 s55, -1
    ds_read_b128 v[64:67], v20 offset:0
    ds_read_b128 v[68:71], v21 offset:0
    ds_read_b128 v[72:75], v22 offset:0
    ds_read_b128 v[76:79], v23 offset:0
    ds_read_b128 v[80:83], v20 offset:4096
    ds_read_b128 v[84:87], v21 offset:4096
    ds_read_b128 v[88:91], v22 offset:4096
    ds_read_b128 v[92:95], v23 offset:4096
    ds_read_b128 v[96:99], v20 offset:8192
    ds_read_b128 v[100:103], v21 offset:8192
    ds_read_b128 v[104:107], v22 offset:8192
    ds_read_b128 v[108:111], v23 offset:8192
    ds_read_b128 v[112:115], v20 offset:12288
    ds_read_b128 v[116:119], v21 offset:12288
    ds_read_b128 v[120:123], v22 offset:12288
    ds_read_b128 v[124:127], v23 offset:12288
    ds_read_b128 v[128:131], v20 offset:16384
    ds_read_b128 v[132:135], v21 offset:16384
    ds_read_b128 v[136:139], v22 offset:16384
    ds_read_b128 v[140:143], v23 offset:16384
    ds_read_b128 v[144:147], v20 offset:20480
    ds_read_b128 v[148:151], v21 offset:20480
    ds_read_b128 v[152:155], v22 offset:20480
    ds_read_b128 v[156:159], v23 offset:20480
    ds_read_b128 v[160:163], v20 offset:24576
    ds_read_b128 v[164:167], v21 offset:24576
    ds_read_b128 v[168:171], v22 offset:24576
    ds_read_b128 v[172:175], v23 offset:24576
    ds_read_b64 a[56:57], v24
    ds_read_b64 a[58:59], v25
    ds_read_b64 a[60:61], v26
    ds_read_b64 a[62:63], v27
    v_mov_b32 v52, 0
    v_mov_b32 v53, 0
    v_mov_b32 v54, 0
    v_mov_b32 v55, 0
    s_waitcnt lgkmcnt(15)
    v_dot2c_f32_bf16 v52, s48, v64
    v_dot2c_f32_bf16 v54, v64, v64
    v_dot2c_f32_bf16 v53, s48, v65
    v_dot2c_f32_bf16 v55, v65, v65
    v_dot2c_f32_bf16 v52, s48, v66
    v_dot2c_f32_bf16 v54, v66, v66
    v_dot2c_f32_bf16 v53, s48, v67
    v_dot2c_f32_bf16 v55, v67, v67
    s_waitcnt lgkmcnt(0)
    s_barrier
    v_dot2c_f32_bf16 v52, s48, v68
    v_dot2c_f32_bf16 v54, v68, v68
    v_dot2c_f32_bf16 v53, s48, v69
    v_dot2c_f32_bf16 v55, v69, v69
    s_lshl_b32 s77, s78, 12
    s_add_u32 s77, s77, s1
    s_add_u32 m0, s77, 28672
    s_mul_i32 s77, s78, 172032
    s_add_u32 s77, s77, s0
    s_add_u32 s77, s77, 1792
    buffer_load_dwordx4 v6, s[12:15], s77 offen lds
    s_add_u32 s78, s78, 1
    s_cmp_eq_u32 s78, 7
    s_cselect_b32 s78, 0, s78
    v_dot2c_f32_bf16 v52, s48, v70
    v_dot2c_f32_bf16 v54, v70, v70
    v_dot2c_f32_bf16 v53, s48, v71
    v_dot2c_f32_bf16 v55, v71, v71
    v_dot2c_f32_bf16 v52, s48, v72
    v_dot2c_f32_bf16 v54, v72, v72
    v_dot2c_f32_bf16 v53, s48, v73
    v_dot2c_f32_bf16 v55, v73, v73
    v_dot2c_f32_bf16 v52, s48, v74
    v_dot2c_f32_bf16 v54, v74, v74
    v_dot2c_f32_bf16 v53, s48, v75
    v_dot2c_f32_bf16 v55, v75, v75
    v_dot2c_f32_bf16 v52, s48, v76
    v_dot2c_f32_bf16 v54, v76, v76
    v_dot2c_f32_bf16 v53, s48, v77
    v_dot2c_f32_bf16 v55, v77, v77
    v_dot2c_f32_bf16 v52, s48, v78
    v_dot2c_f32_bf16 v54, v78, v78
    v_dot2c_f32_bf16 v53, s48, v79
    v_dot2c_f32_bf16 v55, v79, v79
    v_dot2c_f32_bf16 v52, s48, v80
    v_dot2c_f32_bf16 v54, v80, v80
    v_dot2c_f32_bf16 v53, s48, v81
    v_dot2c_f32_bf16 v55, v81, v81
    v_dot2c_f32_bf16 v52, s48, v82
    v_dot2c_f32_bf16 v54, v82, v82
    v_dot2c_f32_bf16 v53, s48, v83
    v_dot2c_f32_bf16 v55, v83, v83
    v_dot2c_f32_bf16 v52, s48, v84
    v_dot2c_f32_bf16 v54, v84, v84
    v_dot2c_f32_bf16 v53, s48, v85
    v_dot2c_f32_bf16 v55, v85, v85
    v_dot2c_f32_bf16 v52, s48, v86
    v_dot2c_f32_bf16 v54, v86, v86
    v_dot2c_f32_bf16 v53, s48, v87
    v_dot2c_f32_bf16 v55, v87, v87
    v_dot2c_f32_bf16 v52, s48, v88
    v_dot2c_f32_bf16 v54, v88, v88
    v_dot2c_f32_bf16 v53, s48, v89
    v_dot2c_f32_bf16 v55, v89, v89
    v_dot2c_f32_bf16 v52, s48, v90
    v_dot2c_f32_bf16 v54, v90, v90
    v_dot2c_f32_bf16 v53, s48, v91
    v_dot2c_f32_bf16 v55, v91, v91
    v_dot2c_f32_bf16 v52, s48, v92
    v_dot2c_f32_bf16 v54, v92, v92
    v_dot2c_f32_bf16 v53, s48, v93
    v_dot2c_f32_bf16 v55, v93, v93
    v_dot2c_f32_bf16 v52, s48, v94
    v_dot2c_f32_bf16 v54, v94, v94
    v_dot2c_f32_bf16 v53, s48, v95
    v_dot2c_f32_bf16 v55, v95, v95
    v_dot2c_f32_bf16 v52, s48, v96
    v_dot2c_f32_bf16 v54, v96, v96
    v_dot2c_f32_bf16 v53, s48, v97
    v_dot2c_f32_bf16 v55, v97, v97
    v_dot2c_f32_bf16 v52, s48, v98
    v_dot2c_f32_bf16 v54, v98, v98
    v_dot2c_f32_bf16 v53, s48, v99
    v_dot2c_f32_bf16 v55, v99, v99
    v_dot2c_f32_bf16 v52, s48, v100
    v_dot2c_f32_bf16 v54, v100, v100
    v_dot2c_f32_bf16 v53, s48, v101
    v_dot2c_f32_bf16 v55, v101, v101
    v_dot2c_f32_bf16 v52, s48, v102
    v_dot2c_f32_bf16 v54, v102, v102
    v_dot2c_f32_bf16 v53, s48, v103
    v_dot2c_f32_bf16 v55, v103, v103
    v_dot2c_f32_bf16 v52, s48, v104
    v_dot2c_f32_bf16 v54, v104, v104
    v_dot2c_f32_bf16 v53, s48, v105
    v_dot2c_f32_bf16 v55, v105, v105
    v_dot2c_f32_bf16 v52, s48, v106
    v_dot2c_f32_bf16 v54, v106, v106
    v_dot2c_f32_bf16 v53, s48, v107
    v_dot2c_f32_bf16 v55, v107, v107
    v_dot2c_f32_bf16 v52, s48, v108
    v_dot2c_f32_bf16 v54, v108, v108
    v_dot2c_f32_bf16 v53, s48, v109
    v_dot2c_f32_bf16 v55, v109, v109
    s_lshl_b32 s77, s78, 12
    s_add_u32 s77, s77, s1
    s_add_u32 m0, s77, 28672
    s_mul_i32 s77, s78, 172032
    s_add_u32 s77, s77, s0
    s_add_u32 s77, s77, 1792
    buffer_load_dwordx4 v6, s[12:15], s77 offen lds
    s_add_u32 s78, s78, 1
    s_cmp_eq_u32 s78, 7
    s_cselect_b32 s78, 0, s78
    v_dot2c_f32_bf16 v52, s48, v110
    v_dot2c_f32_bf16 v54, v110, v110
    v_dot2c_f32_bf16 v53, s48, v111
    v_dot2c_f32_bf16 v55, v111, v111
    v_dot2c_f32_bf16 v52, s48, v112
    v_dot2c_f32_bf16 v54, v112, v112
    v_dot2c_f32_bf16 v53, s48, v113
    v_dot2c_f32_bf16 v55, v113, v113
    v_dot2c_f32_bf16 v52, s48, v114
    v_dot2c_f32_bf16 v54, v114, v114
    v_dot2c_f32_bf16 v53, s48, v115
    v_dot2c_f32_bf16 v55, v115, v115
    v_dot2c_f32_bf16 v52, s48, v116
    v_dot2c_f32_bf16 v54, v116, v116
    v_dot2c_f32_bf16 v53, s48, v117
    v_dot2c_f32_bf16 v55, v117, v117
    v_dot2c_f32_bf16 v52, s48, v118
    v_dot2c_f32_bf16 v54, v118, v118
    v_dot2c_f32_bf16 v53, s48, v119
    v_dot2c_f32_bf16 v55, v119, v119
    v_dot2c_f32_bf16 v52, s48, v120
    v_dot2c_f32_bf16 v54, v120, v120
    v_dot2c_f32_bf16 v53, s48, v121
    v_dot2c_f32_bf16 v55, v121, v121
    v_dot2c_f32_bf16 v52, s48, v122
    v_dot2c_f32_bf16 v54, v122, v122
    v_dot2c_f32_bf16 v53, s48, v123
    v_dot2c_f32_bf16 v55, v123, v123
    v_dot2c_f32_bf16 v52, s48, v124
    v_dot2c_f32_bf16 v54, v124, v124
    v_dot2c_f32_bf16 v53, s48, v125
    v_dot2c_f32_bf16 v55, v125, v125
    v_dot2c_f32_bf16 v52, s48, v126
    v_dot2c_f32_bf16 v54, v126, v126
    v_dot2c_f32_bf16 v53, s48, v127
    v_dot2c_f32_bf16 v55, v127, v127
    v_dot2c_f32_bf16 v52, s48, v128
    v_dot2c_f32_bf16 v54, v128, v128
    v_dot2c_f32_bf16 v53, s48, v129
    v_dot2c_f32_bf16 v55, v129, v129
    v_dot2c_f32_bf16 v52, s48, v130
    v_dot2c_f32_bf16 v54, v130, v130
    v_dot2c_f32_bf16 v53, s48, v131
    v_dot2c_f32_bf16 v55, v131, v131
    v_dot2c_f32_bf16 v52, s48, v132
    v_dot2c_f32_bf16 v54, v132, v132
    v_dot2c_f32_bf16 v53, s48, v133
    v_dot2c_f32_bf16 v55, v133, v133
    v_dot2c_f32_bf16 v52, s48, v134
    v_dot2c_f32_bf16 v54, v134, v134
    v_dot2c_f32_bf16 v53, s48, v135
    v_dot2c_f32_bf16 v55, v135, v135
    v_dot2c_f32_bf16 v52, s48, v136
    v_dot2c_f32_bf16 v54, v136, v136
    v_dot2c_f32_bf16 v53, s48, v137
    v_dot2c_f32_bf16 v55, v137, v137
    v_dot2c_f32_bf16 v52, s48, v138
    v_dot2c_f32_bf16 v54, v138, v138
    v_dot2c_f32_bf16 v53, s48, v139
    v_dot2c_f32_bf16 v55, v139, v139
    v_dot2c_f32_bf16 v52, s48, v140
    v_dot2c_f32_bf16 v54, v140, v140
    v_dot2c_f32_bf16 v53, s48, v141
    v_dot2c_f32_bf16 v55, v141, v141
    v_dot2c_f32_bf16 v52, s48, v142
    v_dot2c_f32_bf16 v54, v142, v142
    v_dot2c_f32_bf16 v53, s48, v143
    v_dot2c_f32_bf16 v55, v143, v143
    v_dot2c_f32_bf16 v52, s48, v144
    v_dot2c_f32_bf16 v54, v144, v144
    v_dot2c_f32_bf16 v53, s48, v145
    v_dot2c_f32_bf16 v55, v145, v145
    v_dot2c_f32_bf16 v52, s48, v146
    v_dot2c_f32_bf16 v54, v146, v146
    v_dot2c_f32_bf16 v53, s48, v147
    v_dot2c_f32_bf16 v55, v147, v147
    v_dot2c_f32_bf16 v52, s48, v148
    v_dot2c_f32_bf16 v54, v148, v148
    v_dot2c_f32_bf16 v53, s48, v149
    v_dot2c_f32_bf16 v55, v149, v149
    v_dot2c_f32_bf16 v52, s48, v150
    v_dot2c_f32_bf16 v54, v150, v150
    v_dot2c_f32_bf16 v53, s48, v151
    v_dot2c_f32_bf16 v55, v151, v151
    s_lshl_b32 s77, s76, 12
    s_add_u32 s77, s77, s1
    s_add_u32 m0, s77, 0
    s_mul_i32 s77, s76, 172032
    s_add_u32 s77, s77, s0
    s_add_u32 s77, s77, 896
    buffer_load_dwordx4 v6, s[12:15], s77 offen lds
    s_add_u32 s76, s76, 1
    s_cmp_eq_u32 s76, 7
    s_cselect_b32 s76, 0, s76
    v_dot2c_f32_bf16 v52, s48, v152
    v_dot2c_f32_bf16 v54, v152, v152
    v_dot2c_f32_bf16 v53, s48, v153
    v_dot2c_f32_bf16 v55, v153, v153
    v_dot2c_f32_bf16 v52, s48, v154
    v_dot2c_f32_bf16 v54, v154, v154
    v_dot2c_f32_bf16 v53, s48, v155
    v_dot2c_f32_bf16 v55, v155, v155
    v_dot2c_f32_bf16 v52, s48, v156
    v_dot2c_f32_bf16 v54, v156, v156
    v_dot2c_f32_bf16 v53, s48, v157
    v_dot2c_f32_bf16 v55, v157, v157
    v_dot2c_f32_bf16 v52, s48, v158
    v_dot2c_f32_bf16 v54, v158, v158
    v_dot2c_f32_bf16 v53, s48, v159
    v_dot2c_f32_bf16 v55, v159, v159
    v_dot2c_f32_bf16 v52, s48, v160
    v_dot2c_f32_bf16 v54, v160, v160
    v_dot2c_f32_bf16 v53, s48, v161
    v_dot2c_f32_bf16 v55, v161, v161
    v_dot2c_f32_bf16 v52, s48, v162
    v_dot2c_f32_bf16 v54, v162, v162
    v_dot2c_f32_bf16 v53, s48, v163
    v_dot2c_f32_bf16 v55, v163, v163
    v_dot2c_f32_bf16 v52, s48, v164
    v_dot2c_f32_bf16 v54, v164, v164
    v_dot2c_f32_bf16 v53, s48, v165
    v_dot2c_f32_bf16 v55, v165, v165
    v_dot2c_f32_bf16 v52, s48, v166
    v_dot2c_f32_bf16 v54, v166, v166
    v_dot2c_f32_bf16 v53, s48, v167
    v_dot2c_f32_bf16 v55, v167, v167
    v_dot2c_f32_bf16 v52, s48, v168
    v_dot2c_f32_bf16 v54, v168, v168
    v_dot2c_f32_bf16 v53, s48, v169
    v_dot2c_f32_bf16 v55, v169, v169
    v_dot2c_f32_bf16 v52, s48, v170
    v_dot2c_f32_bf16 v54, v170, v170
    v_dot2c_f32_bf16 v53, s48, v171
    v_dot2c_f32_bf16 v55, v171, v171
    v_dot2c_f32_bf16 v52, s48, v172
    v_dot2c_f32_bf16 v54, v172, v172
    v_dot2c_f32_bf16 v53, s48, v173
    v_dot2c_f32_bf16 v55, v173, v173
    v_dot2c_f32_bf16 v52, s48, v174
    v_dot2c_f32_bf16 v54, v174, v174
    v_dot2c_f32_bf16 v53, s48, v175
    v_dot2c_f32_bf16 v55, v175, v175
    s_nop 1
    v_add_f32 v52, v52, v53
    v_add_f32 v54, v54, v55
    s_nop 1
    v_permlane32_swap_b32 v52, v54
    v_add_f32 v52, v52, v54
    v_mov_b32 v53, v52
    s_nop 1
    v_permlane32_swap_b32 v52, v53
    v_mul_f32 v56, 0x3b124925, v52
    v_mul_f32 v58, 0x3b124925, v53
    v_fma_f32 v58, -v56, v56, v58
    v_max_f32 v58, 0, v58
    v_add_f32 v58, 0x3727c5ac, v58
    v_rsq_f32 v58, v58
    s_nop 0
    v_mul_f32_e64 v56, -v56, v58
    v_mov_b32 v59, v58
    v_mov_b32 v57, v56
    v_lshlrev_b32 v16, 16, v64
    v_and_b32 v17, s51, v64
    v_lshlrev_b32 v18, 16, v65
    v_and_b32 v19, s51, v65
    v_pk_fma_f32 v[16:17], v[16:17], v[58:59], v[56:57]
    v_pk_fma_f32 v[18:19], v[18:19], v[58:59], v[56:57]
    v_cvt_pk_bf16_f32 v64, v16, v17
    v_cvt_pk_bf16_f32 v65, v18, v19
    v_lshlrev_b32 v20, 16, v66
    v_and_b32 v21, s51, v66
    v_lshlrev_b32 v22, 16, v67
    v_and_b32 v23, s51, v67
    v_pk_fma_f32 v[20:21], v[20:21], v[58:59], v[56:57]
    v_pk_fma_f32 v[22:23], v[22:23], v[58:59], v[56:57]
    v_cvt_pk_bf16_f32 v66, v20, v21
    v_cvt_pk_bf16_f32 v67, v22, v23
    v_lshlrev_b32 v16, 16, v68
    v_and_b32 v17, s51, v68
    v_lshlrev_b32 v18, 16, v69
    v_and_b32 v19, s51, v69
    v_pk_fma_f32 v[16:17], v[16:17], v[58:59], v[56:57]
    s_lshl_b32 s77, s78, 12
    s_add_u32 s77, s77, s1
    s_add_u32 m0, s77, 28672
    s_mul_i32 s77, s78, 172032
    s_add_u32 s77, s77, s0
    s_add_u32 s77, s77, 1792
    buffer_load_dwordx4 v6, s[12:15], s77 offen lds
    s_add_u32 s78, s78, 1
    s_cmp_eq_u32 s78, 7
    s_cselect_b32 s78, 0, s78
    v_pk_fma_f32 v[18:19], v[18:19], v[58:59], v[56:57]
    v_cvt_pk_bf16_f32 v68, v16, v17
    v_cvt_pk_bf16_f32 v69, v18, v19
    v_lshlrev_b32 v20, 16, v70
    v_and_b32 v21, s51, v70
    v_lshlrev_b32 v22, 16, v71
    v_and_b32 v23, s51, v71
    v_pk_fma_f32 v[20:21], v[20:21], v[58:59], v[56:57]
    v_pk_fma_f32 v[22:23], v[22:23], v[58:59], v[56:57]
    v_cvt_pk_bf16_f32 v70, v20, v21
    v_cvt_pk_bf16_f32 v71, v22, v23
    v_lshlrev_b32 v16, 16, v72
    v_and_b32 v17, s51, v72
    v_lshlrev_b32 v18, 16, v73
    v_and_b32 v19, s51, v73
    v_pk_fma_f32 v[16:17], v[16:17], v[58:59], v[56:57]
    s_lshl_b32 s40, s58, 15
    s_lshl_b32 s41, s3, 9
    s_add_u32 s40, s40, s41
    s_add_u32 s40, s40, 524288
    s_add_u32 s41, s40, 524288
    v_mov_b32 v36, -1
    v_mov_b32 v37, -1
    v_lshlrev_b32 v11, 3, v0
    buffer_store_dwordx2 v[36:37], v11, s[32:35], s40 offen sc1
    buffer_store_dwordx2 v[36:37], v11, s[32:35], s41 offen sc1
    v_pk_fma_f32 v[18:19], v[18:19], v[58:59], v[56:57]
    v_cvt_pk_bf16_f32 v72, v16, v17
    v_cvt_pk_bf16_f32 v73, v18, v19
    v_lshlrev_b32 v20, 16, v74
    v_and_b32 v21, s51, v74
    v_lshlrev_b32 v22, 16, v75
    v_and_b32 v23, s51, v75
    v_pk_fma_f32 v[20:21], v[20:21], v[58:59], v[56:57]
    v_pk_fma_f32 v[22:23], v[22:23], v[58:59], v[56:57]
    v_cvt_pk_bf16_f32 v74, v20, v21
    v_cvt_pk_bf16_f32 v75, v22, v23
    v_lshlrev_b32 v16, 16, v76
    v_and_b32 v17, s51, v76
    v_lshlrev_b32 v18, 16, v77
    v_and_b32 v19, s51, v77
    v_pk_fma_f32 v[16:17], v[16:17], v[58:59], v[56:57]
    s_waitcnt vmcnt(9)
    buffer_store_dwordx4 v[32:35], v1, s[20:23], s79 offen sc1
    v_pk_fma_f32 v[18:19], v[18:19], v[58:59], v[56:57]
    v_cvt_pk_bf16_f32 v76, v16, v17
    v_cvt_pk_bf16_f32 v77, v18, v19
    v_lshlrev_b32 v20, 16, v78
    v_and_b32 v21, s51, v78
    v_lshlrev_b32 v22, 16, v79
    v_and_b32 v23, s51, v79
    v_pk_fma_f32 v[20:21], v[20:21], v[58:59], v[56:57]
    v_pk_fma_f32 v[22:23], v[22:23], v[58:59], v[56:57]
    v_cvt_pk_bf16_f32 v78, v20, v21
    v_cvt_pk_bf16_f32 v79, v22, v23
    v_lshlrev_b32 v16, 16, v80
    v_and_b32 v17, s51, v80
    v_lshlrev_b32 v18, 16, v81
    v_and_b32 v19, s51, v81
    v_pk_fma_f32 v[16:17], v[16:17], v[58:59], v[56:57]
    v_pk_fma_f32 v[18:19], v[18:19], v[58:59], v[56:57]
    v_cvt_pk_bf16_f32 v80, v16, v17
    v_cvt_pk_bf16_f32 v81, v18, v19
    v_lshlrev_b32 v20, 16, v82
    ds_write_b128 v4, a[40:43]
    ds_read_b64_tr_b16 a[40:41], v5
    ds_read_b64_tr_b16 a[42:43], v5 offset:512
    v_and_b32 v21, s51, v82
    v_lshlrev_b32 v22, 16, v83
    v_and_b32 v23, s51, v83
    v_pk_fma_f32 v[20:21], v[20:21], v[58:59], v[56:57]
    v_pk_fma_f32 v[22:23], v[22:23], v[58:59], v[56:57]
    v_cvt_pk_bf16_f32 v82, v20, v21
    v_cvt_pk_bf16_f32 v83, v22, v23
    v_lshlrev_b32 v16, 16, v84
    v_and_b32 v17, s51, v84
    v_lshlrev_b32 v18, 16, v85
    v_and_b32 v19, s51, v85
    v_pk_fma_f32 v[16:17], v[16:17], v[58:59], v[56:57]
    v_pk_fma_f32 v[18:19], v[18:19], v[58:59], v[56:57]
    v_cvt_pk_bf16_f32 v84, v16, v17
    v_cvt_pk_bf16_f32 v85, v18, v19
    v_lshlrev_b32 v20, 16, v86
    v_and_b32 v21, s51, v86
    v_lshlrev_b32 v22, 16, v87
    v_and_b32 v23, s51, v87
    v_pk_fma_f32 v[20:21], v[20:21], v[58:59], v[56:57]
    ds_write_b128 v4, a[44:47]
    ds_read_b64_tr_b16 a[44:45], v5
    ds_read_b64_tr_b16 a[46:47], v5 offset:512
    v_pk_fma_f32 v[22:23], v[22:23], v[58:59], v[56:57]
    v_cvt_pk_bf16_f32 v86, v20, v21
    v_cvt_pk_bf16_f32 v87, v22, v23
    v_lshlrev_b32 v16, 16, v88
    v_and_b32 v17, s51, v88
    v_lshlrev_b32 v18, 16, v89
    v_and_b32 v19, s51, v89
    v_pk_fma_f32 v[16:17], v[16:17], v[58:59], v[56:57]
    v_pk_fma_f32 v[18:19], v[18:19], v[58:59], v[56:57]
    v_cvt_pk_bf16_f32 v88, v16, v17
    v_cvt_pk_bf16_f32 v89, v18, v19
    v_lshlrev_b32 v20, 16, v90
    s_lshl_b32 s77, s76, 12
    s_add_u32 s77, s77, s1
    s_add_u32 m0, s77, 0
    s_mul_i32 s77, s76, 172032
    s_add_u32 s77, s77, s0
    s_add_u32 s77, s77, 896
    buffer_load_dwordx4 v6, s[12:15], s77 offen lds
    s_add_u32 s76, s76, 1
    s_cmp_eq_u32 s76, 7
    s_cselect_b32 s76, 0, s76
    v_and_b32 v21, s51, v90
    v_lshlrev_b32 v22, 16, v91
    v_and_b32 v23, s51, v91
    v_pk_fma_f32 v[20:21], v[20:21], v[58:59], v[56:57]
    s_waitcnt lgkmcnt(3)
    buffer_store_dwordx4 a[40:43], v1, s[20:23], s71 offen sc1
    s_add_u32 s71, s71, 28672
    v_pk_fma_f32 v[22:23], v[22:23], v[58:59], v[56:57]
    v_cvt_pk_bf16_f32 v90, v20, v21
    v_cvt_pk_bf16_f32 v91, v22, v23
    v_lshlrev_b32 v16, 16, v92
    v_and_b32 v17, s51, v92
    v_lshlrev_b32 v18, 16, v93
    v_and_b32 v19, s51, v93
    v_pk_fma_f32 v[16:17], v[16:17], v[58:59], v[56:57]
    v_pk_fma_f32 v[18:19], v[18:19], v[58:59], v[56:57]
    v_cvt_pk_bf16_f32 v92, v16, v17
    v_cvt_pk_bf16_f32 v93, v18, v19
    v_lshlrev_b32 v20, 16, v94
    v_and_b32 v21, s51, v94
    v_lshlrev_b32 v22, 16, v95
    v_and_b32 v23, s51, v95
    v_pk_fma_f32 v[20:21], v[20:21], v[58:59], v[56:57]
    v_pk_fma_f32 v[22:23], v[22:23], v[58:59], v[56:57]
    v_cvt_pk_bf16_f32 v94, v20, v21
    v_cvt_pk_bf16_f32 v95, v22, v23
    v_lshlrev_b32 v16, 16, v96
    s_waitcnt lgkmcnt(0)
    buffer_store_dwordx4 a[44:47], v1, s[20:23], s71 offen sc1
    v_and_b32 v17, s51, v96
    v_lshlrev_b32 v18, 16, v97
    v_and_b32 v19, s51, v97
    v_pk_fma_f32 v[16:17], v[16:17], v[58:59], v[56:57]
    v_pk_fma_f32 v[18:19], v[18:19], v[58:59], v[56:57]
    v_cvt_pk_bf16_f32 v96, v16, v17
    v_cvt_pk_bf16_f32 v97, v18, v19
    v_lshlrev_b32 v20, 16, v98
    v_and_b32 v21, s51, v98
    v_lshlrev_b32 v22, 16, v99
    v_and_b32 v23, s51, v99
    v_pk_fma_f32 v[20:21], v[20:21], v[58:59], v[56:57]
    v_pk_fma_f32 v[22:23], v[22:23], v[58:59], v[56:57]
    v_cvt_pk_bf16_f32 v98, v20, v21
    v_cvt_pk_bf16_f32 v99, v22, v23
    v_lshlrev_b32 v16, 16, v100
    v_and_b32 v17, s51, v100
    v_lshlrev_b32 v18, 16, v101
    v_and_b32 v19, s51, v101
    v_pk_fma_f32 v[16:17], v[16:17], v[58:59], v[56:57]
    ds_write_b128 v4, a[48:51]
    ds_read_b64_tr_b16 a[48:49], v5
    ds_read_b64_tr_b16 a[50:51], v5 offset:512
    v_pk_fma_f32 v[18:19], v[18:19], v[58:59], v[56:57]
    v_cvt_pk_bf16_f32 v100, v16, v17
    v_cvt_pk_bf16_f32 v101, v18, v19
    v_lshlrev_b32 v20, 16, v102
    v_and_b32 v21, s51, v102
    v_lshlrev_b32 v22, 16, v103
    v_and_b32 v23, s51, v103
    v_pk_fma_f32 v[20:21], v[20:21], v[58:59], v[56:57]
    v_pk_fma_f32 v[22:23], v[22:23], v[58:59], v[56:57]
    v_cvt_pk_bf16_f32 v102, v20, v21
    v_cvt_pk_bf16_f32 v103, v22, v23
    v_lshlrev_b32 v16, 16, v104
    v_and_b32 v17, s51, v104
    v_lshlrev_b32 v18, 16, v105
    v_and_b32 v19, s51, v105
    v_pk_fma_f32 v[16:17], v[16:17], v[58:59], v[56:57]
    v_pk_fma_f32 v[18:19], v[18:19], v[58:59], v[56:57]
    v_cvt_pk_bf16_f32 v104, v16, v17
    v_cvt_pk_bf16_f32 v105, v18, v19
    v_lshlrev_b32 v20, 16, v106
    ds_write_b128 v4, a[52:55]
    ds_read_b64_tr_b16 a[52:53], v5
    ds_read_b64_tr_b16 a[54:55], v5 offset:512
    v_and_b32 v21, s51, v106
    v_lshlrev_b32 v22, 16, v107
    v_and_b32 v23, s51, v107
    v_pk_fma_f32 v[20:21], v[20:21], v[58:59], v[56:57]
    v_pk_fma_f32 v[22:23], v[22:23], v[58:59], v[56:57]
    v_cvt_pk_bf16_f32 v106, v20, v21
    v_cvt_pk_bf16_f32 v107, v22, v23
    v_lshlrev_b32 v16, 16, v108
    v_and_b32 v17, s51, v108
    v_lshlrev_b32 v18, 16, v109
    v_and_b32 v19, s51, v109
    v_pk_fma_f32 v[16:17], v[16:17], v[58:59], v[56:57]
    v_pk_fma_f32 v[18:19], v[18:19], v[58:59], v[56:57]
    v_cvt_pk_bf16_f32 v108, v16, v17
    v_cvt_pk_bf16_f32 v109, v18, v19
    v_lshlrev_b32 v20, 16, v110
    s_lshl_b32 s77, s78, 12
    s_add_u32 s77, s77, s1
    s_add_u32 m0, s77, 28672
    s_mul_i32 s77, s78, 172032
    s_add_u32 s77, s77, s0
    s_add_u32 s77, s77, 1792
    buffer_load_dwordx4 v6, s[12:15], s77 offen lds
    s_add_u32 s78, s78, 1
    s_cmp_eq_u32 s78, 7
    s_cselect_b32 s78, 0, s78
    s_waitcnt lgkmcnt(3)
    buffer_store_dwordx4 a[48:51], v1, s[20:23], s72 offen sc1
    v_and_b32 v21, s51, v110
    v_lshlrev_b32 v22, 16, v111
    v_and_b32 v23, s51, v111
    v_pk_fma_f32 v[20:21], v[20:21], v[58:59], v[56:57]
    v_pk_fma_f32 v[22:23], v[22:23], v[58:59], v[56:57]
    v_cvt_pk_bf16_f32 v110, v20, v21
    v_cvt_pk_bf16_f32 v111, v22, v23
    v_lshlrev_b32 v16, 16, v112
    v_and_b32 v17, s51, v112
    v_lshlrev_b32 v18, 16, v113
    v_and_b32 v19, s51, v113
    v_pk_fma_f32 v[16:17], v[16:17], v[58:59], v[56:57]
    v_pk_fma_f32 v[18:19], v[18:19], v[58:59], v[56:57]
    v_cvt_pk_bf16_f32 v112, v16, v17
    v_cvt_pk_bf16_f32 v113, v18, v19
    v_lshlrev_b32 v20, 16, v114
    v_and_b32 v21, s51, v114
    v_lshlrev_b32 v22, 16, v115
    v_and_b32 v23, s51, v115
    v_pk_fma_f32 v[20:21], v[20:21], v[58:59], v[56:57]
    s_waitcnt lgkmcnt(0)
    buffer_store_dwordx4 a[52:55], v1, s[20:23], s72 offen offset:1024 sc1
    v_pk_fma_f32 v[22:23], v[22:23], v[58:59], v[56:57]
    v_cvt_pk_bf16_f32 v114, v20, v21
    v_cvt_pk_bf16_f32 v115, v22, v23
    v_lshlrev_b32 v16, 16, v116
    v_and_b32 v17, s51, v116
    v_lshlrev_b32 v18, 16, v117
    v_and_b32 v19, s51, v117
    v_pk_fma_f32 v[16:17], v[16:17], v[58:59], v[56:57]
    v_pk_fma_f32 v[18:19], v[18:19], v[58:59], v[56:57]
    v_cvt_pk_bf16_f32 v116, v16, v17
    v_cvt_pk_bf16_f32 v117, v18, v19
    v_lshlrev_b32 v20, 16, v118
    v_and_b32 v21, s51, v118
    v_lshlrev_b32 v22, 16, v119
    v_and_b32 v23, s51, v119
    v_pk_fma_f32 v[20:21], v[20:21], v[58:59], v[56:57]
    v_pk_fma_f32 v[22:23], v[22:23], v[58:59], v[56:57]
    v_cvt_pk_bf16_f32 v118, v20, v21
    v_cvt_pk_bf16_f32 v119, v22, v23
    v_lshlrev_b32 v16, 16, v120
    s_mul_i32 s40, s58, 28672
    s_add_u32 s41, s40, 1945600
    v_add_u32 v8, s41, v1
    v_and_b32 v17, s51, v120
    v_lshlrev_b32 v18, 16, v121
    v_and_b32 v19, s51, v121
    v_pk_fma_f32 v[16:17], v[16:17], v[58:59], v[56:57]
    v_pk_fma_f32 v[18:19], v[18:19], v[58:59], v[56:57]
    v_cvt_pk_bf16_f32 v120, v16, v17
    v_cvt_pk_bf16_f32 v121, v18, v19
    v_lshlrev_b32 v20, 16, v122
    v_and_b32 v21, s51, v122
    v_lshlrev_b32 v22, 16, v123
    v_and_b32 v23, s51, v123
    v_pk_fma_f32 v[20:21], v[20:21], v[58:59], v[56:57]
    v_pk_fma_f32 v[22:23], v[22:23], v[58:59], v[56:57]
    v_cvt_pk_bf16_f32 v122, v20, v21
    v_cvt_pk_bf16_f32 v123, v22, v23
    v_lshlrev_b32 v16, 16, v124
    v_and_b32 v17, s51, v124
    v_lshlrev_b32 v18, 16, v125
    v_and_b32 v19, s51, v125
    v_pk_fma_f32 v[16:17], v[16:17], v[58:59], v[56:57]
    v_pk_fma_f32 v[18:19], v[18:19], v[58:59], v[56:57]
    v_cvt_pk_bf16_f32 v124, v16, v17
    v_cvt_pk_bf16_f32 v125, v18, v19
    v_lshlrev_b32 v20, 16, v126
    v_and_b32 v21, s51, v126
    v_lshlrev_b32 v22, 16, v127
    v_and_b32 v23, s51, v127
    v_pk_fma_f32 v[20:21], v[20:21], v[58:59], v[56:57]
    v_pk_fma_f32 v[22:23], v[22:23], v[58:59], v[56:57]
    v_cvt_pk_bf16_f32 v126, v20, v21
    v_cvt_pk_bf16_f32 v127, v22, v23
    v_lshlrev_b32 v16, 16, v128
    v_and_b32 v17, s51, v128
    v_lshlrev_b32 v18, 16, v129
    v_and_b32 v19, s51, v129
    v_pk_fma_f32 v[16:17], v[16:17], v[58:59], v[56:57]
    v_pk_fma_f32 v[18:19], v[18:19], v[58:59], v[56:57]
    v_cvt_pk_bf16_f32 v128, v16, v17
    v_cvt_pk_bf16_f32 v129, v18, v19
    v_lshlrev_b32 v20, 16, v130
    v_and_b32 v21, s51, v130
    v_lshlrev_b32 v22, 16, v131
    v_and_b32 v23, s51, v131
    v_pk_fma_f32 v[20:21], v[20:21], v[58:59], v[56:57]
    s_lshl_b32 s77, s76, 12
    s_add_u32 s77, s77, s1
    s_add_u32 m0, s77, 0
    s_mul_i32 s77, s76, 172032
    s_add_u32 s77, s77, s0
    s_add_u32 s77, s77, 896
    buffer_load_dwordx4 v6, s[12:15], s77 offen lds
    s_add_u32 s76, s76, 1
    s_cmp_eq_u32 s76, 7
    s_cselect_b32 s76, 0, s76
    v_pk_fma_f32 v[22:23], v[22:23], v[58:59], v[56:57]
    v_cvt_pk_bf16_f32 v130, v20, v21
    v_cvt_pk_bf16_f32 v131, v22, v23
    v_lshlrev_b32 v16, 16, v132
    v_and_b32 v17, s51, v132
    v_lshlrev_b32 v18, 16, v133
    v_and_b32 v19, s51, v133
    v_pk_fma_f32 v[16:17], v[16:17], v[58:59], v[56:57]
    v_pk_fma_f32 v[18:19], v[18:19], v[58:59], v[56:57]
    v_cvt_pk_bf16_f32 v132, v16, v17
    v_cvt_pk_bf16_f32 v133, v18, v19
    v_lshlrev_b32 v20, 16, v134
    v_and_b32 v21, s51, v134
    v_lshlrev_b32 v22, 16, v135
    v_and_b32 v23, s51, v135
    v_pk_fma_f32 v[20:21], v[20:21], v[58:59], v[56:57]
    v_pk_fma_f32 v[22:23], v[22:23], v[58:59], v[56:57]
    v_cvt_pk_bf16_f32 v134, v20, v21
    v_cvt_pk_bf16_f32 v135, v22, v23
    v_lshlrev_b32 v16, 16, v136
    v_and_b32 v17, s51, v136
    v_lshlrev_b32 v18, 16, v137
    v_and_b32 v19, s51, v137
    v_pk_fma_f32 v[16:17], v[16:17], v[58:59], v[56:57]
    v_pk_fma_f32 v[18:19], v[18:19], v[58:59], v[56:57]
    v_cvt_pk_bf16_f32 v136, v16, v17
    v_cvt_pk_bf16_f32 v137, v18, v19
    v_lshlrev_b32 v20, 16, v138
    v_and_b32 v21, s51, v138
    v_lshlrev_b32 v22, 16, v139
    v_and_b32 v23, s51, v139
    v_pk_fma_f32 v[20:21], v[20:21], v[58:59], v[56:57]
    v_pk_fma_f32 v[22:23], v[22:23], v[58:59], v[56:57]
    v_cvt_pk_bf16_f32 v138, v20, v21
    v_cvt_pk_bf16_f32 v139, v22, v23
    v_lshlrev_b32 v16, 16, v140
    v_and_b32 v17, s51, v140
    v_lshlrev_b32 v18, 16, v141
    v_and_b32 v19, s51, v141
    v_pk_fma_f32 v[16:17], v[16:17], v[58:59], v[56:57]
    v_pk_fma_f32 v[18:19], v[18:19], v[58:59], v[56:57]
    v_cvt_pk_bf16_f32 v140, v16, v17
    v_cvt_pk_bf16_f32 v141, v18, v19
    v_lshlrev_b32 v20, 16, v142
    v_and_b32 v21, s51, v142
    v_lshlrev_b32 v22, 16, v143
    v_and_b32 v23, s51, v143
    v_pk_fma_f32 v[20:21], v[20:21], v[58:59], v[56:57]
    v_pk_fma_f32 v[22:23], v[22:23], v[58:59], v[56:57]
    v_cvt_pk_bf16_f32 v142, v20, v21
    v_cvt_pk_bf16_f32 v143, v22, v23
    v_lshlrev_b32 v16, 16, v144
    v_and_b32 v17, s51, v144
    v_lshlrev_b32 v18, 16, v145
    v_and_b32 v19, s51, v145
    v_pk_fma_f32 v[16:17], v[16:17], v[58:59], v[56:57]
    v_pk_fma_f32 v[18:19], v[18:19], v[58:59], v[56:57]
    v_cvt_pk_bf16_f32 v144, v16, v17
    v_cvt_pk_bf16_f32 v145, v18, v19
    v_lshlrev_b32 v20, 16, v146
    v_and_b32 v21, s51, v146
    v_lshlrev_b32 v22, 16, v147
    v_and_b32 v23, s51, v147
    v_pk_fma_f32 v[20:21], v[20:21], v[58:59], v[56:57]
    v_pk_fma_f32 v[22:23], v[22:23], v[58:59], v[56:57]
    v_cvt_pk_bf16_f32 v146, v20, v21
    v_cvt_pk_bf16_f32 v147, v22, v23
    v_lshlrev_b32 v16, 16, v148
    v_and_b32 v17, s51, v148
    v_lshlrev_b32 v18, 16, v149
    v_and_b32 v19, s51, v149
    v_pk_fma_f32 v[16:17], v[16:17], v[58:59], v[56:57]
    v_pk_fma_f32 v[18:19], v[18:19], v[58:59], v[56:57]
    v_cvt_pk_bf16_f32 v148, v16, v17
    v_cvt_pk_bf16_f32 v149, v18, v19
    v_lshlrev_b32 v20, 16, v150
    v_and_b32 v21, s51, v150
    v_lshlrev_b32 v22, 16, v151
    v_and_b32 v23, s51, v151
    v_pk_fma_f32 v[20:21], v[20:21], v[58:59], v[56:57]
    v_pk_fma_f32 v[22:23], v[22:23], v[58:59], v[56:57]
    v_cvt_pk_bf16_f32 v150, v20, v21
    v_cvt_pk_bf16_f32 v151, v22, v23
    v_lshlrev_b32 v16, 16, v152
    s_lshl_b32 s77, s78, 12
    s_add_u32 s77, s77, s1
    s_add_u32 m0, s77, 28672
    s_mul_i32 s77, s78, 172032
    s_add_u32 s77, s77, s0
    s_add_u32 s77, s77, 1792
    buffer_load_dwordx4 v6, s[12:15], s77 offen lds
    s_add_u32 s78, s78, 1
    s_cmp_eq_u32 s78, 7
    s_cselect_b32 s78, 0, s78
    v_and_b32 v17, s51, v152
    v_lshlrev_b32 v18, 16, v153
    v_and_b32 v19, s51, v153
    v_pk_fma_f32 v[16:17], v[16:17], v[58:59], v[56:57]
    v_pk_fma_f32 v[18:19], v[18:19], v[58:59], v[56:57]
    v_cvt_pk_bf16_f32 v152, v16, v17
    v_cvt_pk_bf16_f32 v153, v18, v19
    v_lshlrev_b32 v20, 16, v154
    v_and_b32 v21, s51, v154
    v_lshlrev_b32 v22, 16, v155
    v_and_b32 v23, s51, v155
    v_pk_fma_f32 v[20:21], v[20:21], v[58:59], v[56:57]
    v_pk_fma_f32 v[22:23], v[22:23], v[58:59], v[56:57]
    v_cvt_pk_bf16_f32 v154, v20, v21
    v_cvt_pk_bf16_f32 v155, v22, v23
    v_lshlrev_b32 v16, 16, v156
    v_and_b32 v17, s51, v156
    v_lshlrev_b32 v18, 16, v157
    v_and_b32 v19, s51, v157
    v_pk_fma_f32 v[16:17], v[16:17], v[58:59], v[56:57]
    v_pk_fma_f32 v[18:19], v[18:19], v[58:59], v[56:57]
    v_cvt_pk_bf16_f32 v156, v16, v17
    v_cvt_pk_bf16_f32 v157, v18, v19
    v_lshlrev_b32 v20, 16, v158
    v_and_b32 v21, s51, v158
    v_lshlrev_b32 v22, 16, v159
    v_and_b32 v23, s51, v159
    v_pk_fma_f32 v[20:21], v[20:21], v[58:59], v[56:57]
    v_pk_fma_f32 v[22:23], v[22:23], v[58:59], v[56:57]
    v_cvt_pk_bf16_f32 v158, v20, v21
    v_cvt_pk_bf16_f32 v159, v22, v23
    v_lshlrev_b32 v16, 16, v160
    v_and_b32 v17, s51, v160
    v_lshlrev_b32 v18, 16, v161
    v_and_b32 v19, s51, v161
    v_pk_fma_f32 v[16:17], v[16:17], v[58:59], v[56:57]
    v_pk_fma_f32 v[18:19], v[18:19], v[58:59], v[56:57]
    v_cvt_pk_bf16_f32 v160, v16, v17
    v_cvt_pk_bf16_f32 v161, v18, v19
    v_lshlrev_b32 v20, 16, v162
    v_and_b32 v21, s51, v162
    v_lshlrev_b32 v22, 16, v163
    v_and_b32 v23, s51, v163
    v_pk_fma_f32 v[20:21], v[20:21], v[58:59], v[56:57]
    v_pk_fma_f32 v[22:23], v[22:23], v[58:59], v[56:57]
    v_cvt_pk_bf16_f32 v162, v20, v21
    v_cvt_pk_bf16_f32 v163, v22, v23
    v_lshlrev_b32 v16, 16, v164
    v_and_b32 v17, s51, v164
    v_lshlrev_b32 v18, 16, v165
    v_and_b32 v19, s51, v165
    v_pk_fma_f32 v[16:17], v[16:17], v[58:59], v[56:57]
    v_pk_fma_f32 v[18:19], v[18:19], v[58:59], v[56:57]
    v_cvt_pk_bf16_f32 v164, v16, v17
    v_cvt_pk_bf16_f32 v165, v18, v19
    v_lshlrev_b32 v20, 16, v166
    v_and_b32 v21, s51, v166
    v_lshlrev_b32 v22, 16, v167
    v_and_b32 v23, s51, v167
    v_pk_fma_f32 v[20:21], v[20:21], v[58:59], v[56:57]
    v_pk_fma_f32 v[22:23], v[22:23], v[58:59], v[56:57]
    v_cvt_pk_bf16_f32 v166, v20, v21
    v_cvt_pk_bf16_f32 v167, v22, v23
    v_lshlrev_b32 v16, 16, v168
    v_and_b32 v17, s51, v168
    v_lshlrev_b32 v18, 16, v169
    v_and_b32 v19, s51, v169
    v_pk_fma_f32 v[16:17], v[16:17], v[58:59], v[56:57]
    v_pk_fma_f32 v[18:19], v[18:19], v[58:59], v[56:57]
    v_cvt_pk_bf16_f32 v168, v16, v17
    v_cvt_pk_bf16_f32 v169, v18, v19
    v_lshlrev_b32 v20, 16, v170
    v_and_b32 v21, s51, v170
    v_lshlrev_b32 v22, 16, v171
    v_and_b32 v23, s51, v171
    v_pk_fma_f32 v[20:21], v[20:21], v[58:59], v[56:57]
    v_pk_fma_f32 v[22:23], v[22:23], v[58:59], v[56:57]
    v_cvt_pk_bf16_f32 v170, v20, v21
    v_cvt_pk_bf16_f32 v171, v22, v23
    v_lshlrev_b32 v16, 16, v172
    v_and_b32 v17, s51, v172
    v_lshlrev_b32 v18, 16, v173
    v_and_b32 v19, s51, v173
    v_pk_fma_f32 v[16:17], v[16:17], v[58:59], v[56:57]
    v_pk_fma_f32 v[18:19], v[18:19], v[58:59], v[56:57]
    v_cvt_pk_bf16_f32 v172, v16, v17
    v_cvt_pk_bf16_f32 v173, v18, v19
    v_lshlrev_b32 v20, 16, v174
    v_and_b32 v21, s51, v174
    v_lshlrev_b32 v22, 16, v175
    v_and_b32 v23, s51, v175
    v_pk_fma_f32 v[20:21], v[20:21], v[58:59], v[56:57]
    v_pk_fma_f32 v[22:23], v[22:23], v[58:59], v[56:57]
    v_cvt_pk_bf16_f32 v174, v20, v21
    v_cvt_pk_bf16_f32 v175, v22, v23
    s_lshl_b32 s44, s74, 12
    v_add_u32 v54, s44, v62
    s_add_u32 s74, s74, 1
    s_cmp_eq_u32 s74, 7
    s_cselect_b32 s74, 0, s74
    s_waitcnt vmcnt(14)
    s_barrier
    ds_read_b64_tr_b16 a[0:1], v54 offset:0
    ds_read_b64_tr_b16 a[2:3], v54 offset:256
    ds_read_b64_tr_b16 a[4:5], v54 offset:28672
    ds_read_b64_tr_b16 a[6:7], v54 offset:28928
    ds_read_b64_tr_b16 a[8:9], v54 offset:1024
    ds_read_b64_tr_b16 a[10:11], v54 offset:1280
    ds_read_b64_tr_b16 a[12:13], v54 offset:29696
    ds_read_b64_tr_b16 a[14:15], v54 offset:29952
    s_waitcnt lgkmcnt(6)
    v_mfma_f32_32x32x16_bf16 v[16:31], v[64:67], a[0:3], 0
    ds_read_b64_tr_b16 a[16:17], v54 offset:2048
    ds_read_b64_tr_b16 a[18:19], v54 offset:2304
    s_lshl_b32 s77, s76, 12
    s_add_u32 s77, s77, s1
    s_add_u32 m0, s77, 0
    s_mul_i32 s77, s76, 172032
    s_add_u32 s77, s77, s0
    s_add_u32 s77, s77, 896
    buffer_load_dwordx4 v6, s[12:15], s77 offen lds
    s_add_u32 s76, s76, 1
    s_cmp_eq_u32 s76, 7
    s_cselect_b32 s76, 0, s76
    s_waitcnt lgkmcnt(6)
    v_mfma_f32_32x32x16_bf16 v[32:47], v[64:67], a[4:7], 0
    ds_read_b64_tr_b16 a[20:21], v54 offset:30720
    ds_read_b64_tr_b16 a[22:23], v54 offset:30976
    s_waitcnt lgkmcnt(6)
    v_mfma_f32_32x32x16_bf16 v[16:31], v[68:71], a[8:11], v[16:31]
    ds_read_b64_tr_b16 a[0:1], v54 offset:3072
    ds_read_b64_tr_b16 a[2:3], v54 offset:3328
    s_waitcnt lgkmcnt(6)
    v_mfma_f32_32x32x16_bf16 v[32:47], v[68:71], a[12:15], v[32:47]
    ds_read_b64_tr_b16 a[4:5], v54 offset:31744
    ds_read_b64_tr_b16 a[6:7], v54 offset:32000
    s_waitcnt lgkmcnt(6)
    v_mfma_f32_32x32x16_bf16 v[16:31], v[72:75], a[16:19], v[16:31]
    s_lshl_b32 s44, s74, 12
    v_add_u32 v55, s44, v62
    s_add_u32 s74, s74, 1
    s_cmp_eq_u32 s74, 7
    s_cselect_b32 s74, 0, s74
    s_waitcnt vmcnt(14)
    s_barrier
    ds_read_b64_tr_b16 a[8:9], v55 offset:0
    ds_read_b64_tr_b16 a[10:11], v55 offset:256
    s_waitcnt lgkmcnt(6)
    v_mfma_f32_32x32x16_bf16 v[32:47], v[72:75], a[20:23], v[32:47]
    ds_read_b64_tr_b16 a[12:13], v55 offset:28672
    ds_read_b64_tr_b16 a[14:15], v55 offset:28928
    s_lshl_b32 s77, s78, 12
    s_add_u32 s77, s77, s1
    s_add_u32 m0, s77, 28672
    s_mul_i32 s77, s78, 172032
    s_add_u32 s77, s77, s0
    s_add_u32 s77, s77, 1792
    buffer_load_dwordx4 v6, s[12:15], s77 offen lds
    s_add_u32 s78, s78, 1
    s_cmp_eq_u32 s78, 7
    s_cselect_b32 s78, 0, s78
    s_waitcnt lgkmcnt(6)
    v_mfma_f32_32x32x16_bf16 v[16:31], v[76:79], a[0:3], v[16:31]
    ds_read_b64_tr_b16 a[16:17], v55 offset:1024
    ds_read_b64_tr_b16 a[18:19], v55 offset:1280
    s_waitcnt lgkmcnt(6)
    v_mfma_f32_32x32x16_bf16 v[32:47], v[76:79], a[4:7], v[32:47]
    ds_read_b64_tr_b16 a[20:21], v55 offset:29696
    ds_read_b64_tr_b16 a[22:23], v55 offset:29952
    s_waitcnt lgkmcnt(6)
    v_mfma_f32_32x32x16_bf16 v[16:31], v[80:83], a[8:11], v[16:31]
    ds_read_b64_tr_b16 a[0:1], v55 offset:2048
    ds_read_b64_tr_b16 a[2:3], v55 offset:2304
    s_waitcnt vmcnt(4)
    s_barrier
    s_lshl_b32 s42, s58, 4
    s_add_u32 s42, s42, s2
    s_lshl_b32 s42, s42, 7
    s_add_u32 s42, s42, 65536
    s_cmp_eq_u32 s60, 0
    s_cselect_b32 s42, s42, 1073741824
    s_add_u32 s45, s56, s61
    s_add_u32 s45, s45, 1
    v_mov_b32 v14, s45
    s_mov_b64 exec, 1
    buffer_store_dword v14, v1, s[32:35], s42 offen sc1
    s_mov_b64 exec, -1
    s_waitcnt lgkmcnt(6)
    v_mfma_f32_32x32x16_bf16 v[32:47], v[80:83], a[12:15], v[32:47]
    ds_read_b64_tr_b16 a[4:5], v55 offset:30720
    ds_read_b64_tr_b16 a[6:7], v55 offset:30976
    s_waitcnt lgkmcnt(6)
    v_mfma_f32_32x32x16_bf16 v[16:31], v[84:87], a[16:19], v[16:31]
    ds_read_b64_tr_b16 a[8:9], v55 offset:3072
    ds_read_b64_tr_b16 a[10:11], v55 offset:3328
    s_lshl_b32 s77, s76, 12
    s_add_u32 s77, s77, s1
    s_add_u32 m0, s77, 0
    s_mul_i32 s77, s76, 172032
    s_add_u32 s77, s77, s0
    s_add_u32 s77, s77, 896
    buffer_load_dwordx4 v6, s[12:15], s77 offen lds
    s_add_u32 s76, s76, 1
    s_cmp_eq_u32 s76, 7
    s_cselect_b32 s76, 0, s76
    s_lshl_b32 s40, s60, 10
    s_waitcnt lgkmcnt(6)
    v_mfma_f32_32x32x16_bf16 v[32:47], v[84:87], a[20:23], v[32:47]
    ds_read_b64_tr_b16 a[12:13], v55 offset:31744
    ds_read_b64_tr_b16 a[14:15], v55 offset:32000
    v_add_u32 v60, s40, v12
    s_waitcnt lgkmcnt(6)
    v_mfma_f32_32x32x16_bf16 v[16:31], v[88:91], a[0:3], v[16:31]
    s_lshl_b32 s44, s74, 12
    v_add_u32 v54, s44, v62
    s_add_u32 s74, s74, 1
    s_cmp_eq_u32 s74, 7
    s_cselect_b32 s74, 0, s74
    s_barrier
    ds_read_b64_tr_b16 a[16:17], v54 offset:0
    ds_read_b64_tr_b16 a[18:19], v54 offset:256
    s_waitcnt lgkmcnt(6)
    v_mfma_f32_32x32x16_bf16 v[32:47], v[88:91], a[4:7], v[32:47]
    ds_read_b64_tr_b16 a[20:21], v54 offset:28672
    ds_read_b64_tr_b16 a[22:23], v54 offset:28928
    s_lshl_b32 s40, s60, 12
    s_waitcnt lgkmcnt(6)
    v_mfma_f32_32x32x16_bf16 v[16:31], v[92:95], a[8:11], v[16:31]
    ds_read_b64_tr_b16 a[0:1], v54 offset:1024
    ds_read_b64_tr_b16 a[2:3], v54 offset:1280
    v_add_u32 v61, s40, v12
    s_waitcnt lgkmcnt(6)
    v_mfma_f32_32x32x16_bf16 v[32:47], v[92:95], a[12:15], v[32:47]
    ds_read_b64_tr_b16 a[4:5], v54 offset:29696
    ds_read_b64_tr_b16 a[6:7], v54 offset:29952
    s_lshl_b32 s77, s78, 12
    s_add_u32 s77, s77, s1
    s_add_u32 m0, s77, 28672
    s_mul_i32 s77, s78, 172032
    s_add_u32 s77, s77, s0
    s_add_u32 s77, s77, 1792
    buffer_load_dwordx4 v6, s[12:15], s77 offen lds
    s_add_u32 s78, s78, 1
    s_cmp_eq_u32 s78, 7
    s_cselect_b32 s78, 0, s78
    s_waitcnt lgkmcnt(6)
    v_mfma_f32_32x32x16_bf16 v[16:31], v[96:99], a[16:19], v[16:31]
    ds_read_b64_tr_b16 a[8:9], v54 offset:2048
    ds_read_b64_tr_b16 a[10:11], v54 offset:2304
    v_lshlrev_b32 v11, 3, v0
    s_waitcnt lgkmcnt(6)
    v_mfma_f32_32x32x16_bf16 v[32:47], v[96:99], a[20:23], v[32:47]
    ds_read_b64_tr_b16 a[12:13], v54 offset:30720
    ds_read_b64_tr_b16 a[14:15], v54 offset:30976
    s_lshl_b32 s40, s58, 15
    s_waitcnt lgkmcnt(6)
    v_mfma_f32_32x32x16_bf16 v[16:31], v[100:103], a[0:3], v[16:31]
    ds_read_b64_tr_b16 a[16:17], v54 offset:3072
    ds_read_b64_tr_b16 a[18:19], v54 offset:3328
    s_waitcnt lgkmcnt(6)
    v_mfma_f32_32x32x16_bf16 v[32:47], v[100:103], a[4:7], v[32:47]
    ds_read_b64_tr_b16 a[20:21], v54 offset:31744
    ds_read_b64_tr_b16 a[22:23], v54 offset:32000
    s_lshl_b32 s41, s60, 9
    s_waitcnt lgkmcnt(6)
    v_mfma_f32_32x32x16_bf16 v[16:31], v[104:107], a[8:11], v[16:31]
    s_lshl_b32 s44, s74, 12
    v_add_u32 v55, s44, v62
    s_add_u32 s74, s74, 1
    s_cmp_eq_u32 s74, 7
    s_cselect_b32 s74, 0, s74
    s_barrier
    ds_read_b64_tr_b16 a[0:1], v55 offset:0
    ds_read_b64_tr_b16 a[2:3], v55 offset:256
    s_waitcnt lgkmcnt(6)
    v_mfma_f32_32x32x16_bf16 v[32:47], v[104:107], a[12:15], v[32:47]
    ds_read_b64_tr_b16 a[4:5], v55 offset:28672
    ds_read_b64_tr_b16 a[6:7], v55 offset:28928
    s_lshl_b32 s77, s76, 12
    s_add_u32 s77, s77, s1
    s_add_u32 m0, s77, 57344
    s_mul_i32 s77, s76, 172032
    s_add_u32 s77, s77, s0
    buffer_load_dwordx4 v6, s[12:15], s77 offen lds
    s_add_u32 s76, s76, 1
    s_cmp_eq_u32 s76, 7
    s_cselect_b32 s76, 0, s76
    s_add_u32 s40, s40, s41
    s_waitcnt lgkmcnt(6)
    v_mfma_f32_32x32x16_bf16 v[16:31], v[108:111], a[16:19], v[16:31]
    ds_read_b64_tr_b16 a[8:9], v55 offset:1024
    ds_read_b64_tr_b16 a[10:11], v55 offset:1280
    s_add_u32 s6, s40, 524288
    s_waitcnt lgkmcnt(6)
    v_mfma_f32_32x32x16_bf16 v[32:47], v[108:111], a[20:23], v[32:47]
    ds_read_b64_tr_b16 a[12:13], v55 offset:29696
    ds_read_b64_tr_b16 a[14:15], v55 offset:29952
    s_waitcnt lgkmcnt(6)
    v_mfma_f32_32x32x16_bf16 v[16:31], v[112:115], a[0:3], v[16:31]
    ds_read_b64_tr_b16 a[16:17], v55 offset:2048
    ds_read_b64_tr_b16 a[18:19], v55 offset:2304
    s_lshl_b32 s41, s57, 1
    s_waitcnt lgkmcnt(6)
    v_mfma_f32_32x32x16_bf16 v[32:47], v[112:115], a[4:7], v[32:47]
    ds_read_b64_tr_b16 a[20:21], v55 offset:30720
    ds_read_b64_tr_b16 a[22:23], v55 offset:30976
    s_lshl_b32 s77, s76, 12
    s_add_u32 s77, s77, s1
    s_add_u32 m0, s77, 57344
    s_mul_i32 s77, s76, 172032
    s_add_u32 s77, s77, s0
    buffer_load_dwordx4 v6, s[12:15], s77 offen lds
    s_add_u32 s76, s76, 1
    s_cmp_eq_u32 s76, 7
    s_cselect_b32 s76, 0, s76
    s_add_u32 s41, s41, s59
    s_waitcnt lgkmcnt(6)
    v_mfma_f32_32x32x16_bf16 v[16:31], v[116:119], a[8:11], v[16:31]
    ds_read_b64_tr_b16 a[0:1], v55 offset:3072
    ds_read_b64_tr_b16 a[2:3], v55 offset:3328
    s_waitcnt lgkmcnt(6)
    v_mfma_f32_32x32x16_bf16 v[32:47], v[116:119], a[12:15], v[32:47]
    ds_read_b64_tr_b16 a[4:5], v55 offset:31744
    ds_read_b64_tr_b16 a[6:7], v55 offset:32000
    s_lshl_b32 s41, s41, 11
    s_waitcnt lgkmcnt(6)
    v_mfma_f32_32x32x16_bf16 v[16:31], v[120:123], a[16:19], v[16:31]
    s_lshl_b32 s44, s74, 12
    v_add_u32 v54, s44, v62
    s_add_u32 s74, s74, 1
    s_cmp_eq_u32 s74, 7
    s_cselect_b32 s74, 0, s74
    s_waitcnt vmcnt(7)
    s_barrier
    ds_read_b64_tr_b16 a[8:9], v54 offset:0
    ds_read_b64_tr_b16 a[10:11], v54 offset:256
    s_add_u32 s7, s41, s6
    s_waitcnt lgkmcnt(6)
    v_mfma_f32_32x32x16_bf16 v[32:47], v[120:123], a[20:23], v[32:47]
    ds_read_b64_tr_b16 a[12:13], v54 offset:28672
    ds_read_b64_tr_b16 a[14:15], v54 offset:28928
    s_waitcnt lgkmcnt(6)
    v_mfma_f32_32x32x16_bf16 v[16:31], v[124:127], a[0:3], v[16:31]
    ds_read_b64_tr_b16 a[16:17], v54 offset:1024
    ds_read_b64_tr_b16 a[18:19], v54 offset:1280
    s_lshl_b32 s77, s76, 12
    s_add_u32 s77, s77, s1
    s_add_u32 m0, s77, 57344
    s_mul_i32 s77, s76, 172032
    s_add_u32 s77, s77, s0
    buffer_load_dwordx4 v6, s[12:15], s77 offen lds
    s_add_u32 s76, s76, 1
    s_cmp_eq_u32 s76, 7
    s_cselect_b32 s76, 0, s76
    s_cmp_ge_u32 s58, 14
    s_cselect_b32 s42, s58, s63
    s_cselect_b32 s43, 0, 14336
    s_waitcnt lgkmcnt(6)
    v_mfma_f32_32x32x16_bf16 v[32:47], v[124:127], a[4:7], v[32:47]
    ds_read_b64_tr_b16 a[20:21], v54 offset:29696
    ds_read_b64_tr_b16 a[22:23], v54 offset:29952
    s_waitcnt lgkmcnt(6)
    v_mfma_f32_32x32x16_bf16 v[16:31], v[128:131], a[8:11], v[16:31]
    ds_read_b64_tr_b16 a[0:1], v54 offset:2048
    ds_read_b64_tr_b16 a[2:3], v54 offset:2304
    s_lshl_b32 s42, s42, 11
    s_waitcnt lgkmcnt(6)
    v_mfma_f32_32x32x16_bf16 v[32:47], v[128:131], a[12:15], v[32:47]
    ds_read_b64_tr_b16 a[4:5], v54 offset:30720
    ds_read_b64_tr_b16 a[6:7], v54 offset:30976
    v_and_b32 v56, 15, v0
    s_waitcnt lgkmcnt(6)
    v_mfma_f32_32x32x16_bf16 v[16:31], v[132:135], a[16:19], v[16:31]
    ds_read_b64_tr_b16 a[8:9], v54 offset:3072
    ds_read_b64_tr_b16 a[10:11], v54 offset:3328
    s_lshl_b32 s77, s76, 12
    s_add_u32 s77, s77, s1
    s_add_u32 m0, s77, 57344
    s_mul_i32 s77, s76, 172032
    s_add_u32 s77, s77, s0
    buffer_load_dwordx4 v6, s[12:15], s77 offen lds
    s_add_u32 s76, s76, 1
    s_cmp_eq_u32 s76, 7
    s_cselect_b32 s76, 0, s76
    s_waitcnt lgkmcnt(6)
    v_mfma_f32_32x32x16_bf16 v[32:47], v[132:135], a[20:23], v[32:47]
    ds_read_b64_tr_b16 a[12:13], v54 offset:31744
    ds_read_b64_tr_b16 a[14:15], v54 offset:32000
    v_bfe_u32 v57, v0, 4, 1
    s_waitcnt lgkmcnt(6)
    v_mfma_f32_32x32x16_bf16 v[16:31], v[136:139], a[0:3], v[16:31]
    s_lshl_b32 s44, s74, 12
    v_add_u32 v55, s44, v62
    s_add_u32 s74, s74, 1
    s_cmp_eq_u32 s74, 7
    s_cselect_b32 s74, 0, s74
    s_waitcnt vmcnt(7)
    s_barrier
    ds_read_b64_tr_b16 a[16:17], v55 offset:0
    ds_read_b64_tr_b16 a[18:19], v55 offset:256
    v_mul_u32_u24 v58, s43, v57
    s_waitcnt lgkmcnt(6)
    v_mfma_f32_32x32x16_bf16 v[32:47], v[136:139], a[4:7], v[32:47]
    ds_read_b64_tr_b16 a[20:21], v55 offset:28672
    ds_read_b64_tr_b16 a[22:23], v55 offset:28928
    s_waitcnt lgkmcnt(6)
    v_mfma_f32_32x32x16_bf16 v[16:31], v[140:143], a[8:11], v[16:31]
    ds_read_b64_tr_b16 a[0:1], v55 offset:1024
    ds_read_b64_tr_b16 a[2:3], v55 offset:1280
    v_lshl_add_u32 v58, v56, 7, v58
    s_waitcnt lgkmcnt(6)
    v_mfma_f32_32x32x16_bf16 v[32:47], v[140:143], a[12:15], v[32:47]
    ds_read_b64_tr_b16 a[4:5], v55 offset:29696
    ds_read_b64_tr_b16 a[6:7], v55 offset:29952
    s_lshl_b32 s77, s76, 12
    s_add_u32 s77, s77, s1
    s_add_u32 m0, s77, 57344
    s_mul_i32 s77, s76, 172032
    s_add_u32 s77, s77, s0
    buffer_load_dwordx4 v6, s[12:15], s77 offen lds
    s_add_u32 s76, s76, 1
    s_cmp_eq_u32 s76, 7
    s_cselect_b32 s76, 0, s76
    v_add_u32 v58, s42, v58
    s_waitcnt lgkmcnt(6)
    v_mfma_f32_32x32x16_bf16 v[16:31], v[144:147], a[16:19], v[16:31]
    ds_read_b64_tr_b16 a[8:9], v55 offset:2048
    ds_read_b64_tr_b16 a[10:11], v55 offset:2304
    s_waitcnt lgkmcnt(6)
    v_mfma_f32_32x32x16_bf16 v[32:47], v[144:147], a[20:23], v[32:47]
    ds_read_b64_tr_b16 a[12:13], v55 offset:30720
    ds_read_b64_tr_b16 a[14:15], v55 offset:30976
    s_lshl_b32 s42, s57, 8
    s_waitcnt lgkmcnt(6)
    v_mfma_f32_32x32x16_bf16 v[16:31], v[148:151], a[0:3], v[16:31]
    ds_read_b64_tr_b16 a[16:17], v55 offset:3072
    ds_read_b64_tr_b16 a[18:19], v55 offset:3328
    s_waitcnt lgkmcnt(6)
    v_mfma_f32_32x32x16_bf16 v[32:47], v[148:151], a[4:7], v[32:47]
    ds_read_b64_tr_b16 a[20:21], v55 offset:31744
    ds_read_b64_tr_b16 a[22:23], v55 offset:32000
    s_lshl_b32 s77, s76, 12
    s_add_u32 s77, s77, s1
    s_add_u32 m0, s77, 57344
    s_mul_i32 s77, s76, 172032
    s_add_u32 s77, s77, s0
    buffer_load_dwordx4 v6, s[12:15], s77 offen lds
    s_add_u32 s76, s76, 1
    s_cmp_eq_u32 s76, 7
    s_cselect_b32 s76, 0, s76
    v_lshlrev_b32 v56, 11, v56
    s_waitcnt lgkmcnt(6)
    v_mfma_f32_32x32x16_bf16 v[16:31], v[152:155], a[8:11], v[16:31]
    s_lshl_b32 s44, s74, 12
    v_add_u32 v54, s44, v62
    s_add_u32 s74, s74, 1
    s_cmp_eq_u32 s74, 7
    s_cselect_b32 s74, 0, s74
    s_waitcnt vmcnt(6)
    s_barrier
    ds_read_b64_tr_b16 a[0:1], v54 offset:0
    ds_read_b64_tr_b16 a[2:3], v54 offset:256
    v_lshl_add_u32 v56, v57, 7, v56
    s_waitcnt lgkmcnt(6)
    v_mfma_f32_32x32x16_bf16 v[32:47], v[152:155], a[12:15], v[32:47]
    ds_read_b64_tr_b16 a[4:5], v54 offset:28672
    ds_read_b64_tr_b16 a[6:7], v54 offset:28928
    s_waitcnt lgkmcnt(6)
    v_mfma_f32_32x32x16_bf16 v[16:31], v[156:159], a[16:19], v[16:31]
    ds_read_b64_tr_b16 a[8:9], v54 offset:1024
    ds_read_b64_tr_b16 a[10:11], v54 offset:1280
    v_add_u32 v56, s42, v56
    s_waitcnt lgkmcnt(6)
    v_mfma_f32_32x32x16_bf16 v[32:47], v[156:159], a[20:23], v[32:47]
    ds_read_b64_tr_b16 a[12:13], v54 offset:29696
    ds_read_b64_tr_b16 a[14:15], v54 offset:29952
    v_cndmask_b32 v58, v58, v56, s[54:55]
    s_waitcnt lgkmcnt(6)
    v_mfma_f32_32x32x16_bf16 v[16:31], v[160:163], a[0:3], v[16:31]
    ds_read_b64_tr_b16 a[16:17], v54 offset:2048
    ds_read_b64_tr_b16 a[18:19], v54 offset:2304
    s_lshl_b32 s77, s76, 12
    s_add_u32 s77, s77, s1
    s_add_u32 m0, s77, 57344
    s_mul_i32 s77, s76, 172032
    s_add_u32 s77, s77, s0
    buffer_load_dwordx4 v6, s[12:15], s77 offen lds
    s_add_u32 s76, s76, 1
    s_cmp_eq_u32 s76, 7
    s_cselect_b32 s76, 0, s76
    s_waitcnt lgkmcnt(6)
    v_mfma_f32_32x32x16_bf16 v[32:47], v[160:163], a[4:7], v[32:47]
    ds_read_b64_tr_b16 a[20:21], v54 offset:30720
    ds_read_b64_tr_b16 a[22:23], v54 offset:30976
    s_mov_b32 s73, 65536
    s_waitcnt lgkmcnt(6)
    v_mfma_f32_32x32x16_bf16 v[16:31], v[164:167], a[8:11], v[16:31]
    ds_read_b64_tr_b16 a[0:1], v54 offset:3072
    ds_read_b64_tr_b16 a[2:3], v54 offset:3328
    s_waitcnt lgkmcnt(6)
    v_mfma_f32_32x32x16_bf16 v[32:47], v[164:167], a[12:15], v[32:47]
    ds_read_b64_tr_b16 a[4:5], v54 offset:31744
    ds_read_b64_tr_b16 a[6:7], v54 offset:32000
    s_waitcnt lgkmcnt(6)
    v_mfma_f32_32x32x16_bf16 v[16:31], v[168:171], a[16:19], v[16:31]
    s_waitcnt lgkmcnt(4)
    v_mfma_f32_32x32x16_bf16 v[32:47], v[168:171], a[20:23], v[32:47]
    s_waitcnt lgkmcnt(2)
    v_mfma_f32_32x32x16_bf16 v[16:31], v[172:175], a[0:3], v[16:31]
    s_waitcnt lgkmcnt(0)
    v_mfma_f32_32x32x16_bf16 v[32:47], v[172:175], a[4:7], v[32:47]
    buffer_load_dword v59, v58, s[32:35], s73 offen sc1
    v_mov_b32 v52, s50
    v_mov_b32 v53, s49
    s_nop 6
    v_pk_add_f32 v[16:17], v[16:17], v[52:53] op_sel_hi:[1,0]
    v_pk_mul_f32 v[48:49], v[16:17], v[52:53] op_sel:[0,1] op_sel_hi:[1,1]
    v_exp_f32 v48, v48 clamp
    v_exp_f32 v49, v49 clamp
    v_max_f32 v16, s50, v16
    v_max_f32 v17, s50, v17
    v_pk_add_f32 v[16:17], v[16:17], v[48:49]
    v_cvt_pk_bf16_f32 v16, v16, v17
    v_pk_add_f32 v[18:19], v[18:19], v[52:53] op_sel_hi:[1,0]
    v_pk_mul_f32 v[50:51], v[18:19], v[52:53] op_sel:[0,1] op_sel_hi:[1,1]
    v_exp_f32 v50, v50 clamp
    v_exp_f32 v51, v51 clamp
    v_max_f32 v18, s50, v18
    v_max_f32 v19, s50, v19
    v_pk_add_f32 v[18:19], v[18:19], v[50:51]
    v_cvt_pk_bf16_f32 v17, v18, v19
    v_pk_add_f32 v[20:21], v[20:21], v[52:53] op_sel_hi:[1,0]
    v_pk_mul_f32 v[48:49], v[20:21], v[52:53] op_sel:[0,1] op_sel_hi:[1,1]
    v_exp_f32 v48, v48 clamp
    v_exp_f32 v49, v49 clamp
    v_max_f32 v20, s50, v20
    v_max_f32 v21, s50, v21
    v_pk_add_f32 v[20:21], v[20:21], v[48:49]
    v_cvt_pk_bf16_f32 v18, v20, v21
    v_pk_add_f32 v[22:23], v[22:23], v[52:53] op_sel_hi:[1,0]
    v_pk_mul_f32 v[50:51], v[22:23], v[52:53] op_sel:[0,1] op_sel_hi:[1,1]
    v_exp_f32 v50, v50 clamp
    v_exp_f32 v51, v51 clamp
    v_max_f32 v22, s50, v22
    v_max_f32 v23, s50, v23
    v_pk_add_f32 v[22:23], v[22:23], v[50:51]
    v_cvt_pk_bf16_f32 v19, v22, v23
    v_pk_add_f32 v[24:25], v[24:25], v[52:53] op_sel_hi:[1,0]
    v_pk_mul_f32 v[48:49], v[24:25], v[52:53] op_sel:[0,1] op_sel_hi:[1,1]
    v_exp_f32 v48, v48 clamp
    v_exp_f32 v49, v49 clamp
    v_max_f32 v24, s50, v24
    v_max_f32 v25, s50, v25
    v_pk_add_f32 v[24:25], v[24:25], v[48:49]
    v_cvt_pk_bf16_f32 v20, v24, v25
    v_pk_add_f32 v[26:27], v[26:27], v[52:53] op_sel_hi:[1,0]
    v_pk_mul_f32 v[50:51], v[26:27], v[52:53] op_sel:[0,1] op_sel_hi:[1,1]
    v_exp_f32 v50, v50 clamp
    v_exp_f32 v51, v51 clamp
    v_max_f32 v26, s50, v26
    v_max_f32 v27, s50, v27
    v_pk_add_f32 v[26:27], v[26:27], v[50:51]
    v_cvt_pk_bf16_f32 v21, v26, v27
    v_pk_add_f32 v[28:29], v[28:29], v[52:53] op_sel_hi:[1,0]
    v_pk_mul_f32 v[48:49], v[28:29], v[52:53] op_sel:[0,1] op_sel_hi:[1,1]
    v_exp_f32 v48, v48 clamp
    v_exp_f32 v49, v49 clamp
    v_max_f32 v28, s50, v28
    v_max_f32 v29, s50, v29
    v_pk_add_f32 v[28:29], v[28:29], v[48:49]
    v_cvt_pk_bf16_f32 v22, v28, v29
    v_pk_add_f32 v[30:31], v[30:31], v[52:53] op_sel_hi:[1,0]
    v_pk_mul_f32 v[50:51], v[30:31], v[52:53] op_sel:[0,1] op_sel_hi:[1,1]
    v_exp_f32 v50, v50 clamp
    v_exp_f32 v51, v51 clamp
    v_max_f32 v30, s50, v30
    v_max_f32 v31, s50, v31
    v_pk_add_f32 v[30:31], v[30:31], v[50:51]
    v_cvt_pk_bf16_f32 v23, v30, v31
    v_cvt_pk_bf16_f32 v32, v32, v33
    v_cvt_pk_bf16_f32 v33, v34, v35
    v_cvt_pk_bf16_f32 v34, v36, v37
    v_cvt_pk_bf16_f32 v35, v38, v39
    v_cvt_pk_bf16_f32 v36, v40, v41
    v_cvt_pk_bf16_f32 v37, v42, v43
    v_cvt_pk_bf16_f32 v38, v44, v45
    v_cvt_pk_bf16_f32 v39, v46, v47
    s_mov_b64 exec, s[52:53]
    v_mov_b32 v32, s48
    v_mov_b32 v33, s48
    v_mov_b32 v34, s48
    v_mov_b32 v35, s48
    v_mov_b32 v36, s48
    v_mov_b32 v37, s48
    v_mov_b32 v38, s48
    v_mov_b32 v39, s48
    s_mov_b64 exec, -1
    v_mfma_f32_32x32x16_bf16 a[24:39], v[16:19], v[32:35], 0
    v_mfma_f32_32x32x16_bf16 a[24:39], v[20:23], v[36:39], a[24:39]
    s_nop 11
    ds_write_b128 v60, a[24:27] offset:0
    ds_write_b128 v60, a[28:31] offset:4096
    ds_write_b128 v60, a[32:35] offset:8192
    ds_write_b128 v60, a[36:39] offset:12288
    s_waitcnt lgkmcnt(0)
    s_barrier
    ds_read_b128 v[32:35], v61 offset:0
    ds_read_b128 v[36:39], v61 offset:1024
    ds_read_b128 v[40:43], v61 offset:2048
    ds_read_b128 v[44:47], v61 offset:3072
    s_waitcnt lgkmcnt(2)
    v_pk_add_f32 v[32:33], v[32:33], v[36:37]
    v_pk_add_f32 v[34:35], v[34:35], v[38:39]
    s_waitcnt lgkmcnt(0)
    v_pk_add_f32 v[40:41], v[40:41], v[44:45]
    v_pk_add_f32 v[42:43], v[42:43], v[46:47]
    v_pk_add_f32 v[32:33], v[32:33], v[40:41]
    v_pk_add_f32 v[34:35], v[34:35], v[42:43]
    v_cvt_pk_bf16_f32 v28, v32, v33
    v_cvt_pk_bf16_f32 v29, v34, v35
    buffer_store_dwordx2 v[28:29], v11, s[32:35], s7 offen sc1
    v_mov_b32 v13, v63
    s_mov_b32 s8, 0
    s_mov_b32 s9, 16384
    s_mov_b32 s10, 32768
    s_mov_b32 s11, 49152
    s_mov_b32 s12, 65536
    s_mov_b32 s13, 81920
    s_mov_b32 s14, 98304
    s_waitcnt vmcnt(2)
    s_barrier
    s_add_u32 s47, s56, 1
    s_waitcnt vmcnt(1)
    v_subrev_u32 v59, s47, v59
    v_cmp_lt_u32 vcc, 15, v59
    s_cbranch_vccnz L_aspin_1
L_aback_2:
    v_cmp_ne_u32 vcc, s61, v59
    s_nop 0
    s_cmp_eq_u32 vcc_hi, 0
    s_cbranch_scc0 L_slow
    s_lshl_b32 s44, s74, 12
    v_add_u32 v14, s44, v13
    s_add_u32 s74, s74, 1
    s_cmp_eq_u32 s74, 7
    s_cselect_b32 s74, 0, s74
    ds_read_b64_tr_b16 a[0:1], v14 offset:0
    ds_read_b64_tr_b16 a[2:3], v14 offset:256
    ds_read_b64_tr_b16 a[4:5], v14 offset:1024
    ds_read_b64_tr_b16 a[6:7], v14 offset:1280
    ds_read_b64_tr_b16 a[8:9], v14 offset:2048
    ds_read_b64_tr_b16 a[10:11], v14 offset:2304
    s_waitcnt lgkmcnt(4)
    v_mfma_f32_32x32x16_bf16 v[48:63], a[0:3], v[64:67], 0
    ds_read_b64_tr_b16 a[12:13], v14 offset:3072
    ds_read_b64_tr_b16 a[14:15], v14 offset:3328
    s_mul_i32 s77, s59, 16
    s_add_u32 s77, s77, s58
    s_lshl_b32 s77, s77, 2
    s_add_u32 s77, s77, s60
    s_mul_i32 s77, s77, 1792
    s_add_u32 s77, s77, 917504
    s_mov_b64 exec, 16383
    buffer_load_dword v10, v9, s[36:39], s77 offen
    s_mov_b64 exec, -1
    s_waitcnt lgkmcnt(4)
    v_mfma_f32_32x32x16_bf16 v[48:63], a[4:7], v[68:71], v[48:63]
    s_lshl_b32 s44, s74, 12
    v_add_u32 v15, s44, v13
    s_add_u32 s74, s74, 1
    s_cmp_eq_u32 s74, 7
    s_cselect_b32 s74, 0, s74
    ds_read_b64_tr_b16 a[0:1], v15 offset:0
    ds_read_b64_tr_b16 a[2:3], v15 offset:256
    s_waitcnt lgkmcnt(4)
    v_mfma_f32_32x32x16_bf16 v[48:63], a[8:11], v[72:75], v[48:63]
    ds_read_b64_tr_b16 a[4:5], v15 offset:1024
    ds_read_b64_tr_b16 a[6:7], v15 offset:1280
    s_mul_i32 s77, s59, 16
    s_add_u32 s77, s77, s58
    s_lshl_b32 s77, s77, 2
    s_add_u32 s77, s77, s60
    s_mul_i32 s77, s77, 2304
    s_add_u32 s77, s77, 1146880
    s_mov_b64 exec, 262143
    buffer_load_dword v10, v9, s[36:39], s77 offen
    s_mov_b64 exec, -1
    s_waitcnt lgkmcnt(4)
    v_mfma_f32_32x32x16_bf16 v[48:63], a[12:15], v[76:79], v[48:63]
    ds_read_b64_tr_b16 a[8:9], v15 offset:2048
    ds_read_b64_tr_b16 a[10:11], v15 offset:2304
    s_waitcnt lgkmcnt(4)
    v_mfma_f32_32x32x16_bf16 v[48:63], a[0:3], v[80:83], v[48:63]
    ds_read_b64_tr_b16 a[12:13], v15 offset:3072
    ds_read_b64_tr_b16 a[14:15], v15 offset:3328
    s_mul_i32 s75, s60, 7168
    s_add_u32 m0, s75, 86016
    s_nop 0
    buffer_load_dwordx4 v8, s[20:23], m0 offen offset:0 sc1 lds
    s_waitcnt lgkmcnt(4)
    v_mfma_f32_32x32x16_bf16 v[48:63], a[4:7], v[84:87], v[48:63]
    s_lshl_b32 s44, s74, 12
    v_add_u32 v14, s44, v13
    s_add_u32 s74, s74, 1
    s_cmp_eq_u32 s74, 7
    s_cselect_b32 s74, 0, s74
    ds_read_b64_tr_b16 a[0:1], v14 offset:0
    ds_read_b64_tr_b16 a[2:3], v14 offset:256
    s_waitcnt lgkmcnt(4)
    v_mfma_f32_32x32x16_bf16 v[48:63], a[8:11], v[88:91], v[48:63]
    ds_read_b64_tr_b16 a[4:5], v14 offset:1024
    ds_read_b64_tr_b16 a[6:7], v14 offset:1280
    buffer_load_dwordx4 v8, s[20:23], m0 offen offset:1024 sc1 lds
    s_waitcnt lgkmcnt(4)
    v_mfma_f32_32x32x16_bf16 v[48:63], a[12:15], v[92:95], v[48:63]
    ds_read_b64_tr_b16 a[8:9], v14 offset:2048
    ds_read_b64_tr_b16 a[10:11], v14 offset:2304
    s_waitcnt lgkmcnt(4)
    v_mfma_f32_32x32x16_bf16 v[48:63], a[0:3], v[96:99], v[48:63]
    ds_read_b64_tr_b16 a[12:13], v14 offset:3072
    ds_read_b64_tr_b16 a[14:15], v14 offset:3328
    s_waitcnt lgkmcnt(4)
    v_mfma_f32_32x32x16_bf16 v[48:63], a[4:7], v[100:103], v[48:63]
    s_lshl_b32 s44, s74, 12
    v_add_u32 v15, s44, v13
    s_add_u32 s74, s74, 1
    s_cmp_eq_u32 s74, 7
    s_cselect_b32 s74, 0, s74
    ds_read_b64_tr_b16 a[0:1], v15 offset:0
    ds_read_b64_tr_b16 a[2:3], v15 offset:256
    buffer_load_dwordx4 v8, s[20:23], m0 offen offset:2048 sc1 lds
    s_waitcnt lgkmcnt(4)
    v_mfma_f32_32x32x16_bf16 v[48:63], a[8:11], v[104:107], v[48:63]
    ds_read_b64_tr_b16 a[4:5], v15 offset:1024
    ds_read_b64_tr_b16 a[6:7], v15 offset:1280
    s_waitcnt lgkmcnt(4)
    v_mfma_f32_32x32x16_bf16 v[48:63], a[12:15], v[108:111], v[48:63]
    ds_read_b64_tr_b16 a[8:9], v15 offset:2048
    ds_read_b64_tr_b16 a[10:11], v15 offset:2304
    buffer_load_dwordx4 v8, s[20:23], m0 offen offset:3072 sc1 lds
    s_waitcnt lgkmcnt(4)
    v_mfma_f32_32x32x16_bf16 v[48:63], a[0:3], v[112:115], v[48:63]
    ds_read_b64_tr_b16 a[12:13], v15 offset:3072
    ds_read_b64_tr_b16 a[14:15], v15 offset:3328
    s_waitcnt lgkmcnt(4)
    v_mfma_f32_32x32x16_bf16 v[48:63], a[4:7], v[116:119], v[48:63]
    s_lshl_b32 s44, s74, 12
    v_add_u32 v14, s44, v13
    s_add_u32 s74, s74, 1
    s_cmp_eq_u32 s74, 7
    s_cselect_b32 s74, 0, s74
    ds_read_b64_tr_b16 a[0:1], v14 offset:0
    ds_read_b64_tr_b16 a[2:3], v14 offset:256
    s_add_u32 m0, s75, 90112
    s_nop 0
    buffer_load_dwordx4 v8, s[20:23], m0 offen offset:0 sc1 lds
    s_waitcnt lgkmcnt(4)
    v_mfma_f32_32x32x16_bf16 v[48:63], a[8:11], v[120:123], v[48:63]
    ds_read_b64_tr_b16 a[4:5], v14 offset:1024
    ds_read_b64_tr_b16 a[6:7], v14 offset:1280
    s_waitcnt lgkmcnt(4)
    v_mfma_f32_32x32x16_bf16 v[48:63], a[12:15], v[124:127], v[48:63]
    ds_read_b64_tr_b16 a[8:9], v14 offset:2048
    ds_read_b64_tr_b16 a[10:11], v14 offset:2304
    buffer_load_dwordx4 v8, s[20:23], m0 offen offset:1024 sc1 lds
    s_waitcnt lgkmcnt(4)
    v_mfma_f32_32x32x16_bf16 v[48:63], a[0:3], v[128:131], v[48:63]
    ds_read_b64_tr_b16 a[12:13], v14 offset:3072
    ds_read_b64_tr_b16 a[14:15], v14 offset:3328
    s_waitcnt lgkmcnt(4)
    v_mfma_f32_32x32x16_bf16 v[48:63], a[4:7], v[132:135], v[48:63]
    s_lshl_b32 s44, s74, 12
    v_add_u32 v15, s44, v13
    s_add_u32 s74, s74, 1
    s_cmp_eq_u32 s74, 7
    s_cselect_b32 s74, 0, s74
    ds_read_b64_tr_b16 a[0:1], v15 offset:0
    ds_read_b64_tr_b16 a[2:3], v15 offset:256
    s_waitcnt lgkmcnt(4)
    v_mfma_f32_32x32x16_bf16 v[48:63], a[8:11], v[136:139], v[48:63]
    ds_read_b64_tr_b16 a[4:5], v15 offset:1024
    ds_read_b64_tr_b16 a[6:7], v15 offset:1280
    buffer_load_dwordx4 v8, s[20:23], m0 offen offset:2048 sc1 lds
    s_waitcnt lgkmcnt(4)
    v_mfma_f32_32x32x16_bf16 v[48:63], a[12:15], v[140:143], v[48:63]
    ds_read_b64_tr_b16 a[8:9], v15 offset:2048
    ds_read_b64_tr_b16 a[10:11], v15 offset:2304
    s_waitcnt lgkmcnt(4)
    v_mfma_f32_32x32x16_bf16 v[48:63], a[0:3], v[144:147], v[48:63]
    ds_read_b64_tr_b16 a[12:13], v15 offset:3072
    ds_read_b64_tr_b16 a[14:15], v15 offset:3328
    s_lshl_b32 s24, s58, 2
    s_add_u32 s24, s24, s60
    s_mul_i32 s24, s24, 28672
    s_add_u32 s24, s24, 2433024
    buffer_load_dwordx4 a[224:227], v1, s[20:23], s24 offen offset:0 sc1
    s_waitcnt lgkmcnt(4)
    v_mfma_f32_32x32x16_bf16 v[48:63], a[4:7], v[148:151], v[48:63]
    s_lshl_b32 s44, s74, 12
    v_add_u32 v14, s44, v13
    s_add_u32 s74, s74, 1
    s_cmp_eq_u32 s74, 7
    s_cselect_b32 s74, 0, s74
    ds_read_b64_tr_b16 a[0:1], v14 offset:0
    ds_read_b64_tr_b16 a[2:3], v14 offset:256
    s_waitcnt lgkmcnt(4)
    v_mfma_f32_32x32x16_bf16 v[48:63], a[8:11], v[152:155], v[48:63]
    ds_read_b64_tr_b16 a[4:5], v14 offset:1024
    ds_read_b64_tr_b16 a[6:7], v14 offset:1280
    buffer_load_dwordx4 a[228:231], v1, s[20:23], s24 offen offset:1024 sc1
    s_waitcnt lgkmcnt(4)
    v_mfma_f32_32x32x16_bf16 v[48:63], a[12:15], v[156:159], v[48:63]
    ds_read_b64_tr_b16 a[8:9], v14 offset:2048
    ds_read_b64_tr_b16 a[10:11], v14 offset:2304
    s_waitcnt lgkmcnt(4)
    v_mfma_f32_32x32x16_bf16 v[48:63], a[0:3], v[160:163], v[48:63]
    ds_read_b64_tr_b16 a[12:13], v14 offset:3072
    ds_read_b64_tr_b16 a[14:15], v14 offset:3328
    buffer_load_dwordx4 a[232:235], v1, s[20:23], s24 offen offset:2048 sc1
    s_waitcnt lgkmcnt(4)
    v_mfma_f32_32x32x16_bf16 v[48:63], a[4:7], v[164:167], v[48:63]
    s_waitcnt lgkmcnt(2)
    v_mfma_f32_32x32x16_bf16 v[48:63], a[8:11], v[168:171], v[48:63]
    s_waitcnt lgkmcnt(0)
    v_mfma_f32_32x32x16_bf16 v[48:63], a[12:15], v[172:175], v[48:63]
    buffer_load_dwordx4 a[236:239], v1, s[20:23], s24 offen offset:3072 sc1
    v_mov_b32 v32, s50
    v_mov_b32 v33, s49
    s_nop 8
    v_pk_add_f32 v[48:49], v[48:49], v[32:33] op_sel_hi:[1,0]
    v_pk_mul_f32 v[36:37], v[48:49], v[32:33] op_sel:[0,1] op_sel_hi:[1,1]
    v_exp_f32 v36, v36 clamp
    v_exp_f32 v37, v37 clamp
    v_max_f32 v48, s50, v48
    v_max_f32 v49, s50, v49
    v_pk_add_f32 v[48:49], v[48:49], v[36:37]
    v_cvt_pk_bf16_f32 v48, v48, v49
    v_pk_add_f32 v[50:51], v[50:51], v[32:33] op_sel_hi:[1,0]
    v_pk_mul_f32 v[38:39], v[50:51], v[32:33] op_sel:[0,1] op_sel_hi:[1,1]
    s_add_u32 s24, s24, 4096
    buffer_load_dwordx4 a[240:243], v1, s[20:23], s24 offen offset:0 sc1
    v_exp_f32 v38, v38 clamp
    v_exp_f32 v39, v39 clamp
    v_max_f32 v50, s50, v50
    v_max_f32 v51, s50, v51
    v_pk_add_f32 v[50:51], v[50:51], v[38:39]
    v_cvt_pk_bf16_f32 v49, v50, v51
    v_pk_add_f32 v[52:53], v[52:53], v[32:33] op_sel_hi:[1,0]
    v_pk_mul_f32 v[36:37], v[52:53], v[32:33] op_sel:[0,1] op_sel_hi:[1,1]
    v_exp_f32 v36, v36 clamp
    v_exp_f32 v37, v37 clamp
    v_max_f32 v52, s50, v52
    v_max_f32 v53, s50, v53
    buffer_load_dwordx4 a[244:247], v1, s[20:23], s24 offen offset:1024 sc1
    v_pk_add_f32 v[52:53], v[52:53], v[36:37]
    v_cvt_pk_bf16_f32 v50, v52, v53
    v_pk_add_f32 v[54:55], v[54:55], v[32:33] op_sel_hi:[1,0]
    v_pk_mul_f32 v[38:39], v[54:55], v[32:33] op_sel:[0,1] op_sel_hi:[1,1]
    v_exp_f32 v38, v38 clamp
    v_exp_f32 v39, v39 clamp
    v_max_f32 v54, s50, v54
    v_max_f32 v55, s50, v55
    v_pk_add_f32 v[54:55], v[54:55], v[38:39]
    v_cvt_pk_bf16_f32 v51, v54, v55
    v_pk_add_f32 v[56:57], v[56:57], v[32:33] op_sel_hi:[1,0]
    v_pk_mul_f32 v[36:37], v[56:57], v[32:33] op_sel:[0,1] op_sel_hi:[1,1]
    v_exp_f32 v36, v36 clamp
    v_exp_f32 v37, v37 clamp
    v_max_f32 v56, s50, v56
    v_max_f32 v57, s50, v57
    v_pk_add_f32 v[56:57], v[56:57], v[36:37]
    v_cvt_pk_bf16_f32 v52, v56, v57
    s_add_u32 s45, s57, 0
    s_and_b32 s45, s45, 7
    s_lshl_b32 s45, s45, 12
    s_add_u32 s45, s45, s6
    buffer_load_dwordx2 v[64:65], v11, s[32:35], s45 offen sc1
    buffer_load_dwordx2 v[66:67], v11, s[32:35], s45 offen offset:2048 sc1
    v_pk_add_f32 v[58:59], v[58:59], v[32:33] op_sel_hi:[1,0]
    v_pk_mul_f32 v[38:39], v[58:59], v[32:33] op_sel:[0,1] op_sel_hi:[1,1]
    v_exp_f32 v38, v38 clamp
    v_exp_f32 v39, v39 clamp
    v_max_f32 v58, s50, v58
    v_max_f32 v59, s50, v59
    s_add_u32 s45, s57, 1
    s_and_b32 s45, s45, 7
    s_lshl_b32 s45, s45, 12
    s_add_u32 s45, s45, s6
    buffer_load_dwordx2 v[68:69], v11, s[32:35], s45 offen sc1
    buffer_load_dwordx2 v[70:71], v11, s[32:35], s45 offen offset:2048 sc1
    v_pk_add_f32 v[58:59], v[58:59], v[38:39]
    v_cvt_pk_bf16_f32 v53, v58, v59
    v_pk_add_f32 v[60:61], v[60:61], v[32:33] op_sel_hi:[1,0]
    v_pk_mul_f32 v[36:37], v[60:61], v[32:33] op_sel:[0,1] op_sel_hi:[1,1]
    v_exp_f32 v36, v36 clamp
    v_exp_f32 v37, v37 clamp
    s_add_u32 s45, s57, 2
    s_and_b32 s45, s45, 7
    s_lshl_b32 s45, s45, 12
    s_add_u32 s45, s45, s6
    buffer_load_dwordx2 v[72:73], v11, s[32:35], s45 offen sc1
    buffer_load_dwordx2 v[74:75], v11, s[32:35], s45 offen offset:2048 sc1
    v_max_f32 v60, s50, v60
    v_max_f32 v61, s50, v61
    v_pk_add_f32 v[60:61], v[60:61], v[36:37]
    v_cvt_pk_bf16_f32 v54, v60, v61
    v_pk_add_f32 v[62:63], v[62:63], v[32:33] op_sel_hi:[1,0]
    v_pk_mul_f32 v[38:39], v[62:63], v[32:33] op_sel:[0,1] op_sel_hi:[1,1]
    s_add_u32 s45, s57, 3
    s_and_b32 s45, s45, 7
    s_lshl_b32 s45, s45, 12
    s_add_u32 s45, s45, s6
    buffer_load_dwordx2 v[76:77], v11, s[32:35], s45 offen sc1
    buffer_load_dwordx2 v[78:79], v11, s[32:35], s45 offen offset:2048 sc1
    v_exp_f32 v38, v38 clamp
    v_exp_f32 v39, v39 clamp
    v_max_f32 v62, s50, v62
    v_max_f32 v63, s50, v63
    v_pk_add_f32 v[62:63], v[62:63], v[38:39]
    v_cvt_pk_bf16_f32 v55, v62, v63
    s_add_u32 s45, s57, 4
    s_and_b32 s45, s45, 7
    s_lshl_b32 s45, s45, 12
    s_add_u32 s45, s45, s6
    buffer_load_dwordx2 v[80:81], v11, s[32:35], s45 offen sc1
    buffer_load_dwordx2 v[82:83], v11, s[32:35], s45 offen offset:2048 sc1
    v_cndmask_b32 v54, v54, 0, s[54:55]
    v_cndmask_b32 v55, v55, 0, s[54:55]
    s_mul_i32 s40, s58, 7
    v_lshrrev_b32 v16, 5, v0
    v_add_u32 v16, s40, v16
    v_and_b32 v17, 31, v0
    s_add_u32 s45, s57, 5
    s_and_b32 s45, s45, 7
    s_lshl_b32 s45, s45, 12
    s_add_u32 s45, s45, s6
    buffer_load_dwordx2 v[84:85], v11, s[32:35], s45 offen sc1
    buffer_load_dwordx2 v[86:87], v11, s[32:35], s45 offen offset:2048 sc1
    v_lshlrev_b32 v17, 4, v17
    v_and_b32 v18, 1, v16
    v_lshl_add_u32 v17, v18, 9, v17
    v_lshrrev_b32 v16, 1, v16
    v_add_u32 v18, 0, v16
    v_and_b32 v19, 1, v18
    s_add_u32 s45, s57, 6
    s_and_b32 s45, s45, 7
    s_lshl_b32 s45, s45, 12
    s_add_u32 s45, s45, s6
    buffer_load_dwordx2 v[88:89], v11, s[32:35], s45 offen sc1
    buffer_load_dwordx2 v[90:91], v11, s[32:35], s45 offen offset:2048 sc1
    v_lshrrev_b32 v18, 1, v18
    v_lshl_add_u32 v18, v18, 10, v17
    v_lshl_add_u32 v56, v19, 3, v18
    v_add_u32 v18, 1, v16
    v_and_b32 v19, 1, v18
    v_lshrrev_b32 v18, 1, v18
    s_add_u32 s45, s57, 7
    s_and_b32 s45, s45, 7
    s_lshl_b32 s45, s45, 12
    s_add_u32 s45, s45, s6
    buffer_load_dwordx2 v[92:93], v11, s[32:35], s45 offen sc1
    buffer_load_dwordx2 v[94:95], v11, s[32:35], s45 offen offset:2048 sc1
    v_lshl_add_u32 v18, v18, 10, v17
    v_lshl_add_u32 v57, v19, 3, v18
    v_add_u32 v18, 2, v16
    v_and_b32 v19, 1, v18
    v_lshrrev_b32 v18, 1, v18
    v_lshl_add_u32 v18, v18, 10, v17
    v_lshl_add_u32 v58, v19, 3, v18
    v_add_u32 v18, 3, v16
    v_and_b32 v19, 1, v18
    v_lshrrev_b32 v18, 1, v18
    v_lshl_add_u32 v18, v18, 10, v17
    v_lshl_add_u32 v59, v19, 3, v18
    s_lshr_b32 s40, s60, 1
    s_lshl_b32 s40, s40, 10
    s_and_b32 s41, s60, 1
    s_lshl_b32 s41, s41, 3
    s_add_u32 s40, s40, s41
    v_add_u32 v60, s40, v12
    s_lshl_b32 s40, s64, 7
    s_lshl_b32 s41, s58, 2
    s_add_u32 s40, s40, s41
    s_add_u32 s3, s40, 1434624
    buffer_load_dwordx4 a[248:251], v1, s[20:23], s24 offen offset:2048 sc1
    buffer_load_dwordx4 a[252:255], v1, s[20:23], s24 offen offset:3072 sc1
    s_add_u32 s24, s24, 4096
    buffer_load_dwordx4 v[176:179], v1, s[20:23], s24 offen offset:0 sc1
    buffer_load_dwordx4 v[180:183], v1, s[20:23], s24 offen offset:1024 sc1
    buffer_load_dwordx4 v[184:187], v1, s[20:23], s24 offen offset:2048 sc1
    buffer_load_dwordx4 v[188:191], v1, s[20:23], s24 offen offset:3072 sc1
    s_add_u32 s24, s24, 4096
    buffer_load_dwordx4 v[192:195], v1, s[20:23], s24 offen offset:0 sc1
    buffer_load_dwordx4 v[196:199], v1, s[20:23], s24 offen offset:1024 sc1
    s_mov_b32 s43, 0x3f80
    s_mov_b32 s44, 0x3f800000
    v_mov_b32 v16, 0
    v_mov_b32 v17, 0
    v_mov_b32 v18, 0
    v_mov_b32 v19, 0
    v_mov_b32 v20, 0
    s_waitcnt vmcnt(23)
    v_dot2c_f32_bf16 v16, s43, v64
    v_dot2c_f32_bf16 v17, s44, v64
    v_dot2c_f32_bf16 v18, s43, v65
    v_dot2c_f32_bf16 v19, s44, v65
    v_max3_u32 v20, v20, v64, v65
    s_waitcnt vmcnt(22)
    v_dot2c_f32_bf16 v16, s43, v66
    v_dot2c_f32_bf16 v17, s44, v66
    v_dot2c_f32_bf16 v18, s43, v67
    v_dot2c_f32_bf16 v19, s44, v67
    v_max3_u32 v20, v20, v66, v67
    s_waitcnt vmcnt(21)
    v_dot2c_f32_bf16 v16, s43, v68
    v_dot2c_f32_bf16 v17, s44, v68
    v_dot2c_f32_bf16 v18, s43, v69
    v_dot2c_f32_bf16 v19, s44, v69
    v_max3_u32 v20, v20, v68, v69
    s_waitcnt vmcnt(20)
    v_dot2c_f32_bf16 v16, s43, v70
    v_dot2c_f32_bf16 v17, s44, v70
    v_dot2c_f32_bf16 v18, s43, v71
    v_dot2c_f32_bf16 v19, s44, v71
    v_max3_u32 v20, v20, v70, v71
    s_waitcnt vmcnt(19)
    v_dot2c_f32_bf16 v16, s43, v72
    v_dot2c_f32_bf16 v17, s44, v72
    v_dot2c_f32_bf16 v18, s43, v73
    v_dot2c_f32_bf16 v19, s44, v73
    v_max3_u32 v20, v20, v72, v73
    s_waitcnt vmcnt(18)
    v_dot2c_f32_bf16 v16, s43, v74
    v_dot2c_f32_bf16 v17, s44, v74
    v_dot2c_f32_bf16 v18, s43, v75
    v_dot2c_f32_bf16 v19, s44, v75
    v_max3_u32 v20, v20, v74, v75
    s_waitcnt vmcnt(17)
    v_dot2c_f32_bf16 v16, s43, v76
    v_dot2c_f32_bf16 v17, s44, v76
    v_dot2c_f32_bf16 v18, s43, v77
    v_dot2c_f32_bf16 v19, s44, v77
    v_max3_u32 v20, v20, v76, v77
    s_waitcnt vmcnt(16)
    v_dot2c_f32_bf16 v16, s43, v78
    v_dot2c_f32_bf16 v17, s44, v78
    v_dot2c_f32_bf16 v18, s43, v79
    v_dot2c_f32_bf16 v19, s44, v79
    v_max3_u32 v20, v20, v78, v79
    s_waitcnt vmcnt(15)
    v_dot2c_f32_bf16 v16, s43, v80
    v_dot2c_f32_bf16 v17, s44, v80
    v_dot2c_f32_bf16 v18, s43, v81
    v_dot2c_f32_bf16 v19, s44, v81
    v_max3_u32 v20, v20, v80, v81
    s_waitcnt vmcnt(14)
    v_dot2c_f32_bf16 v16, s43, v82
    v_dot2c_f32_bf16 v17, s44, v82
    v_dot2c_f32_bf16 v18, s43, v83
    v_dot2c_f32_bf16 v19, s44, v83
    v_max3_u32 v20, v20, v82, v83
    s_waitcnt vmcnt(13)
    v_dot2c_f32_bf16 v16, s43, v84
    v_dot2c_f32_bf16 v17, s44, v84
    v_dot2c_f32_bf16 v18, s43, v85
    v_dot2c_f32_bf16 v19, s44, v85
    v_max3_u32 v20, v20, v84, v85
    s_waitcnt vmcnt(12)
    v_dot2c_f32_bf16 v16, s43, v86
    v_dot2c_f32_bf16 v17, s44, v86
    v_dot2c_f32_bf16 v18, s43, v87
    v_dot2c_f32_bf16 v19, s44, v87
    v_max3_u32 v20, v20, v86, v87
    s_waitcnt vmcnt(11)
    v_dot2c_f32_bf16 v16, s43, v88
    v_dot2c_f32_bf16 v17, s44, v88
    v_dot2c_f32_bf16 v18, s43, v89
    v_dot2c_f32_bf16 v19, s44, v89
    v_max3_u32 v20, v20, v88, v89
    s_waitcnt vmcnt(10)
    v_dot2c_f32_bf16 v16, s43, v90
    v_dot2c_f32_bf16 v17, s44, v90
    v_dot2c_f32_bf16 v18, s43, v91
    v_dot2c_f32_bf16 v19, s44, v91
    v_max3_u32 v20, v20, v90, v91
    s_waitcnt vmcnt(9)
    v_dot2c_f32_bf16 v16, s43, v92
    v_dot2c_f32_bf16 v17, s44, v92
    v_dot2c_f32_bf16 v18, s43, v93
    v_dot2c_f32_bf16 v19, s44, v93
    v_max3_u32 v20, v20, v92, v93
    s_waitcnt vmcnt(8)
    v_dot2c_f32_bf16 v16, s43, v94
    v_dot2c_f32_bf16 v17, s44, v94
    v_dot2c_f32_bf16 v18, s43, v95
    v_dot2c_f32_bf16 v19, s44, v95
    v_max3_u32 v20, v20, v94, v95
    v_cmp_eq_u32 vcc, -1, v20
    s_cbranch_vccnz L_kvspin_4
L_kvback_5:
    v_cvt_pk_bf16_f32 v20, v16, v17
    v_cvt_pk_bf16_f32 v21, v18, v19
    ds_write_b64 v60, v[20:21] offset:16384
    s_waitcnt lgkmcnt(0)
    s_barrier
    ds_read_b128 v[24:27], v12 offset:16384
    ds_read_b128 v[28:31], v12 offset:17408
    s_waitcnt lgkmcnt(1)
    v_mfma_f32_32x32x16_bf16 v[32:47], v[24:27], v[48:51], 0
    s_waitcnt lgkmcnt(0)
    v_mfma_f32_32x32x16_bf16 v[32:47], v[28:31], v[52:55], v[32:47]
    s_nop 11
    v_mov_b32 v16, v44
    v_mov_b32 v17, v44
    s_nop 1
    v_permlane32_swap_b32 v16, v17
    v_add_f32 v16, s50, v17
    v_rcp_f32 v16, v16
    s_nop 0
    v_pk_mul_f32 v[32:33], v[32:33], v[16:17] op_sel_hi:[1,0]
    v_pk_mul_f32 v[34:35], v[34:35], v[16:17] op_sel_hi:[1,0]
    v_pk_mul_f32 v[36:37], v[36:37], v[16:17] op_sel_hi:[1,0]
    v_pk_mul_f32 v[38:39], v[38:39], v[16:17] op_sel_hi:[1,0]
    v_pk_mul_f32 v[40:41], v[40:41], v[16:17] op_sel_hi:[1,0]
    v_pk_mul_f32 v[42:43], v[42:43], v[16:17] op_sel_hi:[1,0]
    v_pk_mul_f32 v[44:45], v[44:45], v[16:17] op_sel_hi:[1,0]
    v_pk_mul_f32 v[46:47], v[46:47], v[16:17] op_sel_hi:[1,0]
    v_cvt_pk_bf16_f32 v20, v32, v33
    v_cvt_pk_bf16_f32 v21, v34, v35
    v_cvt_pk_bf16_f32 v22, v36, v37
    v_cvt_pk_bf16_f32 v23, v38, v39
    v_cvt_pk_bf16_f32 v24, v40, v41
    v_cvt_pk_bf16_f32 v25, v42, v43
    v_cvt_pk_bf16_f32 v26, v44, v45
    v_cvt_pk_bf16_f32 v27, v46, v47
    buffer_store_dwordx2 v[20:21], v56, s[36:39], s67 offen
    buffer_store_dwordx2 v[22:23], v57, s[36:39], s67 offen
    buffer_store_dwordx2 v[24:25], v58, s[36:39], s67 offen
    s_mov_b32 exec_hi, 0
    buffer_store_dwordx2 v[26:27], v59, s[36:39], s67 offen
    s_mov_b64 exec, -1
    s_add_u32 s45, s56, 1
    v_mov_b32 v14, s45
    s_waitcnt vmcnt(0)
    s_mov_b64 exec, 1
    buffer_store_dword v14, v1, s[36:39], s3 offen
    s_mov_b64 exec, -1
    s_cmp_ge_u32 s58, 14
    s_cbranch_scc1 L_spare0
    s_lshl_b32 s5, s58, 11
    s_add_u32 s5, s5, s68
    v_accvgpr_read_b32 v104, a56
    v_accvgpr_read_b32 v105, a57
    v_accvgpr_read_b32 v106, a58
    v_accvgpr_read_b32 v107, a59
    v_accvgpr_read_b32 v108, a60
    v_accvgpr_read_b32 v109, a61
    v_accvgpr_read_b32 v110, a62
    v_accvgpr_read_b32 v111, a63
    s_lshr_b32 s41, s58, 2
    s_lshl_b32 s41, s41, 10
    s_and_b32 s42, s58, 3
    s_lshl_b32 s42, s42, 2
    s_add_u32 s41, s41, s42
    s_add_u32 s6, s41, s69
    s_lshl_b32 s40, s64, 7
    s_lshl_b32 s41, s58, 3
    s_add_u32 s41, s40, s41
    s_add_u32 s7, s41, 1433600
    s_add_u32 s40, s40, 1434624
    v_and_b32 v13, 15, v0
    v_lshlrev_b32 v13, 2, v13
    ds_read_b64_tr_b16 v[48:49], v3 offset:28672
    ds_read_b64_tr_b16 v[50:51], v3 offset:29184
    ds_read_b64_tr_b16 v[52:53], v3 offset:29696
    ds_read_b64_tr_b16 v[54:55], v3 offset:30208
    buffer_load_dwordx4 v[200:203], v1, s[20:23], s24 offen offset:2048 sc1
    buffer_load_dwordx4 v[204:207], v1, s[20:23], s24 offen offset:3072 sc1
    s_add_u32 s24, s24, 4096
    buffer_load_dwordx4 v[208:211], v1, s[20:23], s24 offen offset:0 sc1
    buffer_load_dwordx4 v[212:215], v1, s[20:23], s24 offen offset:1024 sc1
    buffer_load_dwordx4 v[216:219], v1, s[20:23], s24 offen offset:2048 sc1
    buffer_load_dwordx4 v[220:223], v1, s[20:23], s24 offen offset:3072 sc1
    s_add_u32 s24, s24, 4096
    buffer_load_dwordx4 v[224:227], v1, s[20:23], s24 offen offset:0 sc1
    buffer_load_dwordx4 v[228:231], v1, s[20:23], s24 offen offset:1024 sc1
    s_min_u32 s70, s60, 2
    s_mul_i32 s70, s70, 28672
    v_add_u32 v60, s70, v2
    ds_read_b64_tr_b16 v[32:33], v60 offset:0
    ds_read_b64_tr_b16 v[34:35], v60 offset:512
    ds_read_b64_tr_b16 v[36:37], v60 offset:1024
    ds_read_b64_tr_b16 v[38:39], v60 offset:1536
    ds_read_b64_tr_b16 v[40:41], v60 offset:2048
    ds_read_b64_tr_b16 v[42:43], v60 offset:2560
    v_mov_b32 v15, 0
    s_mov_b32 exec_lo, 0x00100001
    s_mov_b32 exec_hi, 0x00100001
    v_mov_b32 v15, s48
    s_mov_b64 exec, -1
    v_accvgpr_write_b32 a32, v15
    v_accvgpr_write_b32 a33, v15
    v_accvgpr_write_b32 a34, v15
    v_accvgpr_write_b32 a35, v15
    s_waitcnt lgkmcnt(4)
    s_nop 0
    v_mfma_f32_16x16x32_bf16 a[36:39], a[32:35], v[32:35], 0
    ds_read_b64_tr_b16 v[44:45], v60 offset:3072
    ds_read_b64_tr_b16 v[46:47], v60 offset:3584
    s_waitcnt lgkmcnt(4)
    v_mfma_f32_16x16x32_bf16 a[36:39], a[32:35], v[36:39], a[36:39]
    ds_read_b64_tr_b16 v[32:33], v60 offset:4096
    ds_read_b64_tr_b16 v[34:35], v60 offset:4608
    s_waitcnt lgkmcnt(4)
    v_mfma_f32_16x16x32_bf16 a[36:39], a[32:35], v[40:43], a[36:39]
    ds_read_b64_tr_b16 v[36:37], v60 offset:5120
    ds_read_b64_tr_b16 v[38:39], v60 offset:5632
    s_waitcnt lgkmcnt(4)
    v_mfma_f32_16x16x32_bf16 a[36:39], a[32:35], v[44:47], a[36:39]
    ds_read_b64_tr_b16 v[40:41], v60 offset:6144
    ds_read_b64_tr_b16 v[42:43], v60 offset:6656
    s_waitcnt lgkmcnt(4)
    v_mfma_f32_16x16x32_bf16 a[36:39], a[32:35], v[32:35], a[36:39]
    ds_read_b64_tr_b16 v[44:45], v60 offset:7168
    ds_read_b64_tr_b16 v[46:47], v60 offset:7680
    s_waitcnt lgkmcnt(4)
    v_mfma_f32_16x16x32_bf16 a[36:39], a[32:35], v[36:39], a[36:39]
    ds_read_b64_tr_b16 v[32:33], v60 offset:8192
    ds_read_b64_tr_b16 v[34:35], v60 offset:8704
    s_waitcnt lgkmcnt(4)
    v_mfma_f32_16x16x32_bf16 a[36:39], a[32:35], v[40:43], a[36:39]
    ds_read_b64_tr_b16 v[36:37], v60 offset:9216
    ds_read_b64_tr_b16 v[38:39], v60 offset:9728
    s_waitcnt lgkmcnt(4)
    v_mfma_f32_16x16x32_bf16 a[36:39], a[32:35], v[44:47], a[36:39]
    ds_read_b64_tr_b16 v[40:41], v60 offset:10240
    ds_read_b64_tr_b16 v[42:43], v60 offset:10752
    s_waitcnt lgkmcnt(4)
    v_mfma_f32_16x16x32_bf16 a[36:39], a[32:35], v[32:35], a[36:39]
    ds_read_b64_tr_b16 v[44:45], v60 offset:11264
    ds_read_b64_tr_b16 v[46:47], v60 offset:11776
    s_waitcnt lgkmcnt(4)
    v_mfma_f32_16x16x32_bf16 a[36:39], a[32:35], v[36:39], a[36:39]
    ds_read_b64_tr_b16 v[32:33], v60 offset:12288
    ds_read_b64_tr_b16 v[34:35], v60 offset:12800
    s_waitcnt lgkmcnt(4)
    v_mfma_f32_16x16x32_bf16 a[36:39], a[32:35], v[40:43], a[36:39]
    ds_read_b64_tr_b16 v[36:37], v60 offset:13312
    ds_read_b64_tr_b16 v[38:39], v60 offset:13824
    s_waitcnt lgkmcnt(4)
    v_mfma_f32_16x16x32_bf16 a[36:39], a[32:35], v[44:47], a[36:39]
    ds_read_b64_tr_b16 v[40:41], v60 offset:14336
    ds_read_b64_tr_b16 v[42:43], v60 offset:14848
    s_waitcnt lgkmcnt(4)
    v_mfma_f32_16x16x32_bf16 a[36:39], a[32:35], v[32:35], a[36:39]
    ds_read_b64_tr_b16 v[44:45], v60 offset:15360
    ds_read_b64_tr_b16 v[46:47], v60 offset:15872
    s_waitcnt lgkmcnt(4)
    v_mfma_f32_16x16x32_bf16 a[36:39], a[32:35], v[36:39], a[36:39]
    ds_read_b64_tr_b16 v[32:33], v60 offset:16384
    ds_read_b64_tr_b16 v[34:35], v60 offset:16896
    s_waitcnt lgkmcnt(4)
    v_mfma_f32_16x16x32_bf16 a[36:39], a[32:35], v[40:43], a[36:39]
    ds_read_b64_tr_b16 v[36:37], v60 offset:17408
    ds_read_b64_tr_b16 v[38:39], v60 offset:17920
    s_waitcnt lgkmcnt(4)
    v_mfma_f32_16x16x32_bf16 a[36:39], a[32:35], v[44:47], a[36:39]
    ds_read_b64_tr_b16 v[40:41], v60 offset:18432
    ds_read_b64_tr_b16 v[42:43], v60 offset:18944
    s_waitcnt lgkmcnt(4)
    v_mfma_f32_16x16x32_bf16 a[36:39], a[32:35], v[32:35], a[36:39]
    ds_read_b64_tr_b16 v[44:45], v60 offset:19456
    ds_read_b64_tr_b16 v[46:47], v60 offset:19968
    s_waitcnt lgkmcnt(4)
    v_mfma_f32_16x16x32_bf16 a[36:39], a[32:35], v[36:39], a[36:39]
    ds_read_b64_tr_b16 v[32:33], v60 offset:20480
    ds_read_b64_tr_b16 v[34:35], v60 offset:20992
    s_waitcnt lgkmcnt(4)
    v_mfma_f32_16x16x32_bf16 a[36:39], a[32:35], v[40:43], a[36:39]
    ds_read_b64_tr_b16 v[36:37], v60 offset:21504
    ds_read_b64_tr_b16 v[38:39], v60 offset:22016
    s_waitcnt lgkmcnt(4)
    v_mfma_f32_16x16x32_bf16 a[36:39], a[32:35], v[44:47], a[36:39]
    ds_read_b64_tr_b16 v[40:41], v60 offset:22528
    ds_read_b64_tr_b16 v[42:43], v60 offset:23040
    s_waitcnt lgkmcnt(4)
    v_mfma_f32_16x16x32_bf16 a[36:39], a[32:35], v[32:35], a[36:39]
    ds_read_b64_tr_b16 v[44:45], v60 offset:23552
    ds_read_b64_tr_b16 v[46:47], v60 offset:24064
    s_waitcnt lgkmcnt(4)
    v_mfma_f32_16x16x32_bf16 a[36:39], a[32:35], v[36:39], a[36:39]
    ds_read_b64_tr_b16 v[32:33], v60 offset:24576
    ds_read_b64_tr_b16 v[34:35], v60 offset:25088
    s_waitcnt lgkmcnt(4)
    v_mfma_f32_16x16x32_bf16 a[36:39], a[32:35], v[40:43], a[36:39]
    ds_read_b64_tr_b16 v[36:37], v60 offset:25600
    ds_read_b64_tr_b16 v[38:39], v60 offset:26112
    s_waitcnt lgkmcnt(4)
    v_mfma_f32_16x16x32_bf16 a[36:39], a[32:35], v[44:47], a[36:39]
    ds_read_b64_tr_b16 v[40:41], v60 offset:26624
    ds_read_b64_tr_b16 v[42:43], v60 offset:27136
    s_waitcnt lgkmcnt(4)
    v_mfma_f32_16x16x32_bf16 a[36:39], a[32:35], v[32:35], a[36:39]
    ds_read_b64_tr_b16 v[44:45], v60 offset:27648
    ds_read_b64_tr_b16 v[46:47], v60 offset:28160
    s_waitcnt lgkmcnt(4)
    v_mfma_f32_16x16x32_bf16 a[36:39], a[32:35], v[36:39], a[36:39]
    s_waitcnt lgkmcnt(2)
    v_mfma_f32_16x16x32_bf16 a[36:39], a[32:35], v[40:43], a[36:39]
    s_waitcnt lgkmcnt(0)
    v_mfma_f32_16x16x32_bf16 a[36:39], a[32:35], v[44:47], a[36:39]
    s_lshl_b32 s70, s60, 9
    v_lshlrev_b32 v60, 3, v0
    v_add_u32 v60, 159744, v60
    v_add_u32 v61, s70, v60
    s_nop 3
    v_accvgpr_read_b32 v40, a36
    v_cvt_pk_bf16_f32 v42, v40, v40
    v_and_b32 v41, s51, v42
    v_sub_f32 v41, v40, v41
    v_cvt_pk_bf16_f32 v43, v41, 0
    ds_write_b64 v61, v[42:43]
    s_add_u32 s47, s56, 1
    s_mov_b32 s46, s66
L_poll_8:
    buffer_load_dword v14, v13, s[36:39], s40 offen sc1
    s_waitcnt vmcnt(0)
    v_subrev_u32 v14, s47, v14
    v_cmp_lt_u32 vcc, 3, v14
    s_cbranch_vccz L_polled_7
    s_sub_u32 s46, s46, 1
    s_cmp_lg_u32 s46, 0
    s_cbranch_scc1 L_poll_8
    s_mov_b32 s66, 1
L_polled_7:
    s_add_u32 s4, s67, 0
    buffer_load_dwordx4 v[64:67], v1, s[36:39], s4 offen offset:0 sc1
    v_lshlrev_b32 v16, 16, v104
    v_and_b32 v17, s51, v104
    buffer_load_dwordx4 v[68:71], v1, s[36:39], s4 offen offset:1024 sc1
    v_lshlrev_b32 v18, 16, v105
    v_and_b32 v19, s51, v105
    buffer_load_dwordx4 v[72:75], v1, s[36:39], s4 offen offset:2048 sc1
    v_lshlrev_b32 v20, 16, v106
    v_and_b32 v21, s51, v106
    buffer_load_dwordx4 v[76:79], v1, s[36:39], s4 offen offset:3072 sc1
    v_lshlrev_b32 v22, 16, v107
    v_and_b32 v23, s51, v107
    s_add_u32 s4, s67, 4096
    buffer_load_dwordx4 v[80:83], v1, s[36:39], s4 offen offset:0 sc1
    v_lshlrev_b32 v24, 16, v108
    v_and_b32 v25, s51, v108
    buffer_load_dwordx4 v[84:87], v1, s[36:39], s4 offen offset:1024 sc1
    v_lshlrev_b32 v26, 16, v109
    v_and_b32 v27, s51, v109
    buffer_load_dwordx4 v[88:91], v1, s[36:39], s4 offen offset:2048 sc1
    v_lshlrev_b32 v28, 16, v110
    v_and_b32 v29, s51, v110
    buffer_load_dwordx4 v[92:95], v1, s[36:39], s4 offen offset:3072 sc1
    v_lshlrev_b32 v30, 16, v111
    v_and_b32 v31, s51, v111
    s_waitcnt vmcnt(7)
    s_nop 0
    v_mfma_f32_32x32x16_bf16 v[16:31], v[48:51], v[64:67], v[16:31]
    s_add_u32 s4, s67, 8192
    buffer_load_dwordx4 v[96:99], v1, s[36:39], s4 offen offset:0 sc1
    ds_read_b64_tr_b16 v[56:57], v3 offset:30720
    ds_read_b64_tr_b16 v[58:59], v3 offset:31232
    v_mfma_f32_16x16x32_bf16 a[36:39], a[32:35], a[224:227], 0
    s_waitcnt vmcnt(7)
    v_mfma_f32_32x32x16_bf16 v[16:31], v[52:55], v[68:71], v[16:31]
    buffer_load_dwordx4 v[100:103], v1, s[36:39], s4 offen offset:1024 sc1
    ds_read_b64_tr_b16 v[48:49], v3 offset:31744
    ds_read_b64_tr_b16 v[50:51], v3 offset:32256
    v_mfma_f32_16x16x32_bf16 a[36:39], a[32:35], a[228:231], a[36:39]
    s_waitcnt vmcnt(7) lgkmcnt(2)
    v_mfma_f32_32x32x16_bf16 v[16:31], v[56:59], v[72:75], v[16:31]
    buffer_load_dwordx4 v[104:107], v1, s[36:39], s4 offen offset:2048 sc1
    ds_read_b64_tr_b16 v[52:53], v3 offset:32768
    ds_read_b64_tr_b16 v[54:55], v3 offset:33280
    v_mfma_f32_16x16x32_bf16 a[36:39], a[32:35], a[232:235], a[36:39]
    s_waitcnt vmcnt(7) lgkmcnt(2)
    v_mfma_f32_32x32x16_bf16 v[16:31], v[48:51], v[76:79], v[16:31]
    buffer_load_dwordx4 v[108:111], v1, s[36:39], s4 offen offset:3072 sc1
    ds_read_b64_tr_b16 v[56:57], v3 offset:33792
    ds_read_b64_tr_b16 v[58:59], v3 offset:34304
    v_mfma_f32_16x16x32_bf16 a[36:39], a[32:35], a[236:239], a[36:39]
    s_waitcnt vmcnt(7) lgkmcnt(2)
    v_mfma_f32_32x32x16_bf16 v[16:31], v[52:55], v[80:83], v[16:31]
    s_add_u32 s4, s67, 12288
    buffer_load_dwordx4 v[112:115], v1, s[36:39], s4 offen offset:0 sc1
    ds_read_b64_tr_b16 v[48:49], v3 offset:34816
    ds_read_b64_tr_b16 v[50:51], v3 offset:35328
    v_mfma_f32_16x16x32_bf16 a[36:39], a[32:35], a[240:243], a[36:39]
    s_waitcnt vmcnt(7) lgkmcnt(2)
    v_mfma_f32_32x32x16_bf16 v[16:31], v[56:59], v[84:87], v[16:31]
    buffer_load_dwordx4 v[116:119], v1, s[36:39], s4 offen offset:1024 sc1
    ds_read_b64_tr_b16 v[52:53], v3 offset:35840
    ds_read_b64_tr_b16 v[54:55], v3 offset:36352
    s_waitcnt vmcnt(7) lgkmcnt(2)
    v_mfma_f32_32x32x16_bf16 v[16:31], v[48:51], v[88:91], v[16:31]
    buffer_load_dwordx4 v[120:123], v1, s[36:39], s4 offen offset:2048 sc1
    ds_read_b64_tr_b16 v[56:57], v3 offset:36864
    ds_read_b64_tr_b16 v[58:59], v3 offset:37376
    v_mfma_f32_16x16x32_bf16 a[36:39], a[32:35], a[244:247], a[36:39]
    s_waitcnt vmcnt(7) lgkmcnt(2)
    v_mfma_f32_32x32x16_bf16 v[16:31], v[52:55], v[92:95], v[16:31]
    buffer_load_dwordx4 v[124:127], v1, s[36:39], s4 offen offset:3072 sc1
    ds_read_b64_tr_b16 v[48:49], v3 offset:37888
    ds_read_b64_tr_b16 v[50:51], v3 offset:38400
    v_mfma_f32_16x16x32_bf16 a[36:39], a[32:35], a[248:251], a[36:39]
    s_waitcnt vmcnt(7) lgkmcnt(2)
    v_mfma_f32_32x32x16_bf16 v[16:31], v[56:59], v[96:99], v[16:31]
    s_add_u32 s4, s67, 16384
    buffer_load_dwordx4 v[128:131], v1, s[36:39], s4 offen offset:0 sc1
    ds_read_b64_tr_b16 v[52:53], v3 offset:38912
    ds_read_b64_tr_b16 v[54:55], v3 offset:39424
    v_mfma_f32_16x16x32_bf16 a[36:39], a[32:35], a[252:255], a[36:39]
    s_waitcnt vmcnt(7) lgkmcnt(2)
    v_mfma_f32_32x32x16_bf16 v[16:31], v[48:51], v[100:103], v[16:31]
    buffer_load_dwordx4 v[132:135], v1, s[36:39], s4 offen offset:1024 sc1
    ds_read_b64_tr_b16 v[56:57], v3 offset:39936
    ds_read_b64_tr_b16 v[58:59], v3 offset:40448
    v_mfma_f32_16x16x32_bf16 a[36:39], a[32:35], v[176:179], a[36:39]
    s_waitcnt vmcnt(7) lgkmcnt(2)
    v_mfma_f32_32x32x16_bf16 v[16:31], v[52:55], v[104:107], v[16:31]
    buffer_load_dwordx4 v[136:139], v1, s[36:39], s4 offen offset:2048 sc1
    ds_read_b64_tr_b16 v[48:49], v3 offset:40960
    ds_read_b64_tr_b16 v[50:51], v3 offset:41472
    s_waitcnt vmcnt(7) lgkmcnt(2)
    v_mfma_f32_32x32x16_bf16 v[16:31], v[56:59], v[108:111], v[16:31]
    buffer_load_dwordx4 v[140:143], v1, s[36:39], s4 offen offset:3072 sc1
    ds_read_b64_tr_b16 v[52:53], v3 offset:41984
    ds_read_b64_tr_b16 v[54:55], v3 offset:42496
    v_mfma_f32_16x16x32_bf16 a[36:39], a[32:35], v[180:183], a[36:39]
    s_waitcnt vmcnt(7) lgkmcnt(2)
    v_mfma_f32_32x32x16_bf16 v[16:31], v[48:51], v[112:115], v[16:31]
    s_add_u32 s4, s67, 20480
    buffer_load_dwordx4 v[144:147], v1, s[36:39], s4 offen offset:0 sc1
    ds_read_b64_tr_b16 v[56:57], v3 offset:43008
    ds_read_b64_tr_b16 v[58:59], v3 offset:43520
    v_mfma_f32_16x16x32_bf16 a[36:39], a[32:35], v[184:187], a[36:39]
    s_waitcnt vmcnt(7) lgkmcnt(2)
    v_mfma_f32_32x32x16_bf16 v[16:31], v[52:55], v[116:119], v[16:31]
    buffer_load_dwordx4 v[148:151], v1, s[36:39], s4 offen offset:1024 sc1
    ds_read_b64_tr_b16 v[48:49], v3 offset:44032
    ds_read_b64_tr_b16 v[50:51], v3 offset:44544
    v_mfma_f32_16x16x32_bf16 a[36:39], a[32:35], v[188:191], a[36:39]
    v_and_b32 v13, 15, v0
    v_min_u32 v13, 13, v13
    v_lshlrev_b32 v13, 3, v13
    v_lshrrev_b32 v14, 4, v0
    v_lshl_add_u32 v107, v14, 7, v13
    s_mul_i32 s40, s59, 114688
    s_add_u32 s40, s40, 1032192
    s_and_b32 s0, s58, 1
    s_waitcnt vmcnt(7) lgkmcnt(2)
    v_mfma_f32_32x32x16_bf16 v[16:31], v[56:59], v[120:123], v[16:31]
    buffer_load_dwordx4 v[152:155], v1, s[36:39], s4 offen offset:2048 sc1
    ds_read_b64_tr_b16 v[52:53], v3 offset:45056
    ds_read_b64_tr_b16 v[54:55], v3 offset:45568
    v_mfma_f32_16x16x32_bf16 a[36:39], a[32:35], v[192:195], a[36:39]
    s_mul_i32 s16, s0, 28672
    s_add_u32 s40, s40, s16
    s_lshl_b32 s16, s16, 1
    v_add_u32 v110, s40, v1
    s_lshl_b32 s15, s60, 10
    s_add_u32 s15, s15, 114688
    s_lshl_b32 s40, s58, 13
    s_waitcnt vmcnt(7) lgkmcnt(2)
    v_mfma_f32_32x32x16_bf16 v[16:31], v[48:51], v[124:127], v[16:31]
    buffer_load_dwordx4 v[156:159], v1, s[36:39], s4 offen offset:3072 sc1
    ds_read_b64_tr_b16 v[56:57], v3 offset:46080
    ds_read_b64_tr_b16 v[58:59], v3 offset:46592
    v_mfma_f32_16x16x32_bf16 a[36:39], a[32:35], v[196:199], a[36:39]
    s_lshl_b32 s41, s60, 11
    s_add_u32 s3, s40, s41
    s_mul_i32 s40, s59, 458752
    s_add_u32 s3, s3, s40
    s_lshl_b32 s40, s59, 10
    s_lshl_b32 s41, s60, 6
    s_add_u32 s40, s40, s41
    s_lshl_b32 s41, s58, 2
    s_waitcnt vmcnt(7) lgkmcnt(2)
    v_mfma_f32_32x32x16_bf16 v[16:31], v[52:55], v[128:131], v[16:31]
    s_add_u32 s4, s67, 24576
    buffer_load_dwordx4 v[160:163], v1, s[36:39], s4 offen offset:0 sc1
    ds_read_b64_tr_b16 v[48:49], v3 offset:47104
    ds_read_b64_tr_b16 v[50:51], v3 offset:47616
    s_add_u32 s40, s40, s41
    s_add_u32 s2, s40, 1435648
    s_mul_i32 s40, s0, 229376
    s_sub_u32 s17, s3, s40
    s_add_u32 s3, s3, s40
    s_lshl_b32 s40, s0, 9
    s_sub_u32 s1, s2, s40
    s_waitcnt vmcnt(7) lgkmcnt(2)
    v_mfma_f32_32x32x16_bf16 v[16:31], v[56:59], v[132:135], v[16:31]
    buffer_load_dwordx4 v[164:167], v1, s[36:39], s4 offen offset:1024 sc1
    ds_read_b64_tr_b16 v[52:53], v3 offset:48128
    ds_read_b64_tr_b16 v[54:55], v3 offset:48640
    v_mfma_f32_16x16x32_bf16 a[36:39], a[32:35], v[200:203], a[36:39]
    s_add_u32 s2, s2, s40
    v_mov_b32 v84, v4
    v_mov_b32 v85, v5
    v_mov_b32 v86, 0
    v_mov_b32 v87, 0
    v_mov_b32 v90, 0
    v_mov_b32 v91, 0
    s_waitcnt vmcnt(7) lgkmcnt(2)
    v_mfma_f32_32x32x16_bf16 v[16:31], v[48:51], v[136:139], v[16:31]
    buffer_load_dwordx4 v[168:171], v1, s[36:39], s4 offen offset:2048 sc1
    ds_read_b64_tr_b16 v[56:57], v3 offset:49152
    ds_read_b64_tr_b16 v[58:59], v3 offset:49664
    v_mfma_f32_16x16x32_bf16 a[36:39], a[32:35], v[204:207], a[36:39]
    v_and_b32 v108, 31, v0
    v_lshlrev_b32 v108, 4, v108
    v_add_u32 v108, 159744, v108
    s_and_b32 s40, s65, 3
    s_lshl_b32 s40, s40, 9
    s_lshl_b32 s41, s0, 9
    s_xor_b32 s40, s40, s41
    v_add_u32 v109, s40, v108
    s_waitcnt vmcnt(7) lgkmcnt(2)
    v_mfma_f32_32x32x16_bf16 v[16:31], v[52:55], v[140:143], v[16:31]
    buffer_load_dwordx4 v[172:175], v1, s[36:39], s4 offen offset:3072 sc1
    ds_read_b64_tr_b16 v[48:49], v3 offset:50176
    ds_read_b64_tr_b16 v[50:51], v3 offset:50688
    v_mfma_f32_16x16x32_bf16 a[36:39], a[32:35], v[208:211], a[36:39]
    s_mul_i32 s73, s62, 229376
    s_lshl_b32 s43, s60, 11
    s_add_u32 s73, s73, s43
    s_lshl_b32 s74, s62, 9
    s_lshl_b32 s43, s60, 6
    s_add_u32 s74, s74, s43
    s_add_u32 s74, s74, 1435648
    s_waitcnt vmcnt(7) lgkmcnt(2)
    v_mfma_f32_32x32x16_bf16 v[16:31], v[56:59], v[144:147], v[16:31]
    ds_read_b64_tr_b16 v[52:53], v3 offset:51200
    ds_read_b64_tr_b16 v[54:55], v3 offset:51712
    v_mfma_f32_16x16x32_bf16 a[36:39], a[32:35], v[212:215], a[36:39]
    buffer_load_dwordx4 v[232:235], v1, s[20:23], s24 offen offset:2048 sc1
    buffer_load_dwordx4 v[236:239], v1, s[20:23], s24 offen offset:3072 sc1
    v_min_u32 v104, 6, v0
    v_lshlrev_b32 v104, 3, v104
    s_and_b32 s43, s62, 1
    s_lshl_b32 s44, s43, 2
    s_add_u32 s74, s74, s44
    s_lshl_b32 s44, s43, 13
    s_sub_u32 s78, s73, s44
    s_waitcnt vmcnt(8) lgkmcnt(2)
    v_mfma_f32_32x32x16_bf16 v[16:31], v[48:51], v[148:151], v[16:31]
    ds_read_b64_tr_b16 v[56:57], v3 offset:52224
    ds_read_b64_tr_b16 v[58:59], v3 offset:52736
    s_add_u32 s24, s24, 4096
    buffer_load_dwordx4 v[240:243], v1, s[20:23], s24 offen offset:0 sc1
    s_add_u32 s78, s78, 8192
    s_add_u32 s73, s73, s44
    s_lshr_b32 s43, s62, 1
    s_lshl_b32 s43, s43, 2
    s_and_b32 s44, s62, 1
    s_add_u32 s43, s43, s44
    s_mul_i32 s75, s43, 28672
    s_lshl_b32 s43, s63, 12
    s_waitcnt vmcnt(8) lgkmcnt(2)
    v_mfma_f32_32x32x16_bf16 v[16:31], v[52:55], v[152:155], v[16:31]
    ds_read_b64_tr_b16 v[48:49], v3 offset:53248
    ds_read_b64_tr_b16 v[50:51], v3 offset:53760
    v_mfma_f32_16x16x32_bf16 a[36:39], a[32:35], v[216:219], a[36:39]
    buffer_load_dwordx4 v[244:247], v1, s[20:23], s24 offen offset:1024 sc1
    s_lshl_b32 s44, s60, 7
    s_add_u32 s43, s43, s44
    s_add_u32 s75, s75, s43
    s_add_u32 s75, s75, 1146880
    s_mul_i32 s76, s62, 14336
    s_lshr_b32 s43, s63, 2
    s_lshl_b32 s43, s43, 10
    s_waitcnt vmcnt(8) lgkmcnt(2)
    v_mfma_f32_32x32x16_bf16 v[16:31], v[56:59], v[156:159], v[16:31]
    ds_read_b64_tr_b16 v[52:53], v3 offset:54272
    ds_read_b64_tr_b16 v[54:55], v3 offset:54784
    v_mfma_f32_16x16x32_bf16 a[36:39], a[32:35], v[220:223], a[36:39]
    buffer_load_dwordx4 v[248:251], v1, s[20:23], s24 offen offset:2048 sc1
    s_add_u32 s76, s76, s43
    s_and_b32 s43, s63, 3
    s_lshl_b32 s43, s43, 2
    s_add_u32 s43, s43, s44
    s_add_u32 s76, s76, s43
    s_add_u32 s76, s76, 1376256
    s_lshl_b32 s43, s62, 8
    s_waitcnt vmcnt(8) lgkmcnt(2)
    v_mfma_f32_32x32x16_bf16 v[16:31], v[48:51], v[160:163], v[16:31]
    ds_read_b64_tr_b16 v[56:57], v3 offset:55296
    ds_read_b64_tr_b16 v[58:59], v3 offset:55808
    v_mfma_f32_16x16x32_bf16 a[36:39], a[32:35], v[224:227], a[36:39]
    buffer_load_dwordx4 v[252:255], v1, s[20:23], s24 offen offset:3072 sc1
    s_mul_i32 s25, s63, 229376
    s_lshl_b32 s26, s60, 12
    s_add_u32 s25, s25, s26
    s_add_u32 s25, s25, 4038656
    s_and_b32 s26, s62, 1
    s_lshl_b32 s26, s26, 14
    s_sub_u32 s27, s25, s26
    s_add_u32 s27, s27, 16384
    s_add_u32 s25, s25, s26
    s_lshl_b32 s26, s12, 1
    s_add_u32 s26, s26, s25
    buffer_load_dwordx4 a[64:67], v1, s[20:23], s26 offen offset:0 sc1
    s_lshl_b32 s44, s63, 4
    s_add_u32 s43, s43, s44
    s_lshl_b32 s44, s60, 2
    s_add_u32 s43, s43, s44
    s_add_u32 s77, s43, 1433600
    s_lshl_b32 s43, s60, 13
    v_add_u32 v105, s43, v12
    v_lshrrev_b32 v14, 5, v0
    s_waitcnt vmcnt(9) lgkmcnt(2)
    v_mfma_f32_32x32x16_bf16 v[16:31], v[52:55], v[164:167], v[16:31]
    ds_read_b64_tr_b16 v[48:49], v3 offset:56320
    ds_read_b64_tr_b16 v[50:51], v3 offset:56832
    v_mfma_f32_16x16x32_bf16 a[36:39], a[32:35], v[228:231], a[36:39]
    buffer_load_dwordx4 a[68:71], v1, s[20:23], s26 offen offset:1024 sc1
    v_lshlrev_b32 v14, 7, v14
    v_xor_b32 v105, v105, v14
    v_mov_b32 v106, v105
    v_and_b32 v13, 7, v0
    v_lshlrev_b32 v13, 4, v13
    s_lshl_b32 s43, s60, 7
    v_add_u32 v13, s43, v13
    s_waitcnt vmcnt(9) lgkmcnt(2)
    v_mfma_f32_32x32x16_bf16 v[16:31], v[56:59], v[168:171], v[16:31]
    buffer_load_dwordx4 a[72:75], v1, s[20:23], s26 offen offset:2048 sc1
    v_bfe_u32 v14, v0, 3, 1
    v_lshlrev_b32 v15, 7, v14
    v_xor_b32 v13, v13, v15
    v_lshl_add_u32 v13, v14, 9, v13
    v_lshrrev_b32 v14, 4, v0
    v_lshl_add_u32 v13, v14, 11, v13
    v_add_u32 v111, 114688, v13
    s_waitcnt vmcnt(9) lgkmcnt(0)
    v_mfma_f32_32x32x16_bf16 v[16:31], v[48:51], v[172:175], v[16:31]
    buffer_load_dwordx4 a[76:79], v1, s[20:23], s26 offen offset:3072 sc1
    s_nop 10
    v_cvt_pk_bf16_f32 v32, v16, v17
    v_cvt_pk_bf16_f32 v33, v18, v19
    v_cvt_pk_bf16_f32 v34, v20, v21
    v_cvt_pk_bf16_f32 v35, v22, v23
    v_cvt_pk_bf16_f32 v36, v24, v25
    v_cvt_pk_bf16_f32 v37, v26, v27
    v_cvt_pk_bf16_f32 v38, v28, v29
    v_cvt_pk_bf16_f32 v39, v30, v31
    buffer_store_dwordx4 v[32:35], v1, s[36:39], s5 offen
    buffer_store_dwordx4 v[36:39], v1, s[36:39], s5 offen offset:1024
    v_pk_mul_f32 v[42:43], v[16:17], v[16:17]
    v_pk_fma_f32 v[42:43], v[18:19], v[18:19], v[42:43]
    v_pk_add_f32 v[16:17], v[16:17], v[18:19]
    v_pk_fma_f32 v[42:43], v[20:21], v[20:21], v[42:43]
    v_pk_add_f32 v[16:17], v[16:17], v[20:21]
    v_pk_fma_f32 v[42:43], v[22:23], v[22:23], v[42:43]
    v_pk_add_f32 v[16:17], v[16:17], v[22:23]
    v_pk_fma_f32 v[42:43], v[24:25], v[24:25], v[42:43]
    v_pk_add_f32 v[16:17], v[16:17], v[24:25]
    v_pk_fma_f32 v[42:43], v[26:27], v[26:27], v[42:43]
    v_pk_add_f32 v[16:17], v[16:17], v[26:27]
    v_pk_fma_f32 v[42:43], v[28:29], v[28:29], v[42:43]
    v_pk_add_f32 v[16:17], v[16:17], v[28:29]
    v_pk_fma_f32 v[42:43], v[30:31], v[30:31], v[42:43]
    v_pk_add_f32 v[16:17], v[16:17], v[30:31]
    v_add_f32 v40, v16, v17
    v_add_f32 v42, v42, v43
    s_nop 1
    v_permlane32_swap_b32 v40, v42
    v_add_f32 v40, v40, v42
    buffer_store_dword v40, v1, s[36:39], s6 offen
    s_add_u32 s45, s56, 1
    v_mov_b32 v14, s45
    v_mov_b32 v15, s45
    s_waitcnt vmcnt(0)
    s_mov_b64 exec, 1
    buffer_store_dwordx2 v[14:15], v1, s[36:39], s7 offen
    s_mov_b64 exec, -1
    s_barrier
    v_lshlrev_b32 v13, 3, v0
    v_add_u32 v13, 159744, v13
    ds_read_b64 v[8:9], v13
    ds_read_b64 v[10:11], v13 offset:512
    ds_read_b64 v[6:7], v13 offset:1024
    v_mfma_f32_16x16x32_bf16 a[36:39], a[32:35], v[232:235], a[36:39]
    v_mfma_f32_16x16x32_bf16 a[36:39], a[32:35], v[236:239], a[36:39]
    v_mfma_f32_16x16x32_bf16 a[36:39], a[32:35], v[240:243], a[36:39]
    v_mfma_f32_16x16x32_bf16 a[36:39], a[32:35], v[244:247], a[36:39]
    v_mfma_f32_16x16x32_bf16 a[36:39], a[32:35], v[248:251], a[36:39]
    v_mfma_f32_16x16x32_bf16 a[36:39], a[32:35], v[252:255], a[36:39]
    s_nop 7
    v_accvgpr_read_b32 v62, a36
    v_cvt_pk_bf16_f32 v4, v62, v62
    v_and_b32 v63, s51, v4
    v_sub_f32 v63, v62, v63
    v_cvt_pk_bf16_f32 v5, v63, 0
    v_mov_b32 v84, v4
    v_mov_b32 v85, v5
    s_waitcnt lgkmcnt(0)
    s_barrier
    s_lshl_b32 s40, s59, 9
    s_add_u32 s40, s40, 1433600
    s_add_u32 s47, s56, 1
    s_mov_b32 s46, s66
L_poll_10:
    buffer_load_dwordx2 v[14:15], v107, s[36:39], s40 offen sc1
    s_waitcnt vmcnt(0)
    v_subrev_u32 v14, s47, v14
    v_subrev_u32 v15, s47, v15
    v_or_b32 v14, v14, v15
    v_cmp_lt_u32 vcc, 3, v14
    s_cbranch_vccz L_polled_9
    s_sub_u32 s46, s46, 1
    s_cmp_lg_u32 s46, 0
    s_cbranch_scc1 L_poll_10
    s_mov_b32 s66, 1
L_polled_9:
    s_mov_b32 m0, s15
    s_nop 0
    buffer_load_dwordx4 v110, s[36:39], m0 offen sc1 lds
    s_add_u32 m0, m0, 4096
    s_nop 0
    buffer_load_dwordx4 v110, s[36:39], m0 offen sc1 lds
    s_add_u32 m0, m0, 4096
    s_nop 0
    buffer_load_dwordx4 v110, s[36:39], m0 offen sc1 lds
    s_add_u32 m0, m0, 4096
    s_nop 0
    buffer_load_dwordx4 v110, s[36:39], m0 offen sc1 lds
    s_add_u32 m0, m0, 4096
    s_nop 0
    buffer_load_dwordx4 v110, s[36:39], m0 offen sc1 lds
    s_add_u32 m0, m0, 4096
    s_nop 0
    buffer_load_dwordx4 v110, s[36:39], m0 offen sc1 lds
    s_waitcnt vmcnt(4)
    s_barrier
    ds_read_b128 v[48:51], v12 offset:0
    ds_read_b128 v[52:55], v12 offset:1024
    ds_read_b128 v[56:59], v12 offset:2048
    ds_read_b128 v[60:63], v12 offset:3072
    s_waitcnt lgkmcnt(2)
    v_mfma_f32_32x32x16_bf16 v[16:31], a[224:227], v[48:51], 0
    ds_read_b128 v[64:67], v12 offset:4096
    s_add_u32 m0, m0, 4096
    s_nop 0
    buffer_load_dwordx4 v110, s[36:39], m0 offen sc1 lds
    s_lshl_b32 s26, s13, 1
    s_add_u32 s26, s26, s25
    buffer_load_dwordx4 a[80:83], v1, s[20:23], s26 offen offset:0 sc1
    v_mfma_f32_32x32x16_bf16 v[16:31], a[228:231], v[52:55], v[16:31]
    ds_read_b128 v[48:51], v12 offset:5120
    buffer_load_dwordx4 v[112:115], v1, s[36:39], s69 offen offset:0 sc1
    s_waitcnt lgkmcnt(2)
    v_mfma_f32_32x32x16_bf16 v[16:31], a[232:235], v[56:59], v[16:31]
    ds_read_b128 v[52:55], v12 offset:6144
    s_add_u32 m0, m0, 4096
    v_subrev_u32 v110, s16, v110
    buffer_load_dwordx4 v110, s[36:39], m0 offen sc1 lds
    buffer_load_dwordx4 a[84:87], v1, s[20:23], s26 offen offset:1024 sc1
    v_mfma_f32_32x32x16_bf16 v[16:31], a[236:239], v[60:63], v[16:31]
    ds_read_b128 v[56:59], v12 offset:7168
    buffer_load_dwordx4 v[116:119], v1, s[36:39], s69 offen offset:1024 sc1
    s_waitcnt lgkmcnt(2)
    v_mfma_f32_32x32x16_bf16 v[16:31], a[240:243], v[64:67], v[16:31]
    s_waitcnt vmcnt(8)
    s_barrier
    ds_read_b128 v[60:63], v12 offset:8192
    buffer_load_dwordx4 a[88:91], v1, s[20:23], s26 offen offset:2048 sc1
    v_mfma_f32_32x32x16_bf16 v[16:31], a[244:247], v[48:51], v[16:31]
    s_add_u32 m0, m0, 4096
    ds_read_b128 v[64:67], v12 offset:9216
    buffer_load_dwordx4 v110, s[36:39], m0 offen sc1 lds
    s_waitcnt lgkmcnt(2)
    v_mfma_f32_32x32x16_bf16 v[16:31], a[248:251], v[52:55], v[16:31]
    ds_read_b128 v[48:51], v12 offset:10240
    buffer_load_dwordx4 v[120:123], v1, s[36:39], s69 offen offset:2048 sc1
    buffer_load_dwordx4 a[92:95], v1, s[20:23], s26 offen offset:3072 sc1
    v_mfma_f32_32x32x16_bf16 v[16:31], a[252:255], v[56:59], v[16:31]
    ds_read_b128 v[52:55], v12 offset:11264
    buffer_load_dwordx4 v[124:127], v1, s[36:39], s69 offen offset:3072 sc1
    s_waitcnt lgkmcnt(2)
    v_mfma_f32_32x32x16_bf16 v[16:31], v[176:179], v[60:63], v[16:31]
    ds_read_b128 v[56:59], v12 offset:12288
    s_lshl_b32 s26, s14, 1
    s_add_u32 s26, s26, s25
    buffer_load_dwordx4 a[96:99], v1, s[20:23], s26 offen offset:0 sc1
    v_mfma_f32_32x32x16_bf16 v[16:31], v[180:183], v[64:67], v[16:31]
    s_add_u32 m0, m0, 4096
    ds_read_b128 v[60:63], v12 offset:13312
    buffer_load_dwordx4 v110, s[36:39], m0 offen sc1 lds
    s_waitcnt lgkmcnt(2)
    v_mfma_f32_32x32x16_bf16 v[16:31], v[184:187], v[48:51], v[16:31]
    ds_read_b128 v[64:67], v12 offset:14336
    buffer_load_dwordx4 a[100:103], v1, s[20:23], s26 offen offset:1024 sc1
    v_mfma_f32_32x32x16_bf16 v[16:31], v[188:191], v[52:55], v[16:31]
    ds_read_b128 v[48:51], v12 offset:15360
    s_waitcnt vmcnt(11)
    v_add_f32 v112, v112, v114
    v_add_f32 v113, v113, v115
    s_waitcnt vmcnt(8)
    v_add_f32 v112, v112, v116
    v_add_f32 v113, v113, v117
    v_add_f32 v112, v112, v118
    v_add_f32 v113, v113, v119
    s_waitcnt vmcnt(5)
    v_add_f32 v112, v112, v120
    v_add_f32 v113, v113, v121
    s_waitcnt lgkmcnt(2)
    v_mfma_f32_32x32x16_bf16 v[16:31], v[192:195], v[56:59], v[16:31]
    s_barrier
    ds_read_b128 v[52:55], v12 offset:16384
    buffer_load_dwordx4 a[104:107], v1, s[20:23], s26 offen offset:2048 sc1
    v_add_f32 v112, v112, v122
    v_mfma_f32_32x32x16_bf16 v[16:31], v[196:199], v[60:63], v[16:31]
    s_mov_b32 m0, s15
    v_add_u32 v110, 40960, v110
    ds_read_b128 v[56:59], v12 offset:17408
    buffer_load_dwordx4 v110, s[36:39], m0 offen sc1 lds
    v_add_f32 v113, v113, v123
    s_waitcnt vmcnt(5)
    v_add_f32 v112, v112, v124
    s_waitcnt lgkmcnt(2)
    v_mfma_f32_32x32x16_bf16 v[16:31], v[200:203], v[64:67], v[16:31]
    ds_read_b128 v[60:63], v12 offset:18432
    v_add_f32 v113, v113, v125
    v_add_f32 v112, v112, v113
    v_mov_b32 v113, v112
    s_nop 1
    v_permlane32_swap_b32 v112, v113
    v_mul_f32 v114, 0x3b124925, v112
    v_mul_f32 v115, 0x3b124925, v113
    v_fma_f32 v115, -v114, v114, v115
    v_mfma_f32_32x32x16_bf16 v[16:31], v[204:207], v[48:51], v[16:31]
    ds_read_b128 v[64:67], v12 offset:19456
    buffer_load_dwordx4 a[108:111], v1, s[20:23], s26 offen offset:3072 sc1
    v_max_f32 v115, 0, v115
    v_add_f32 v115, 0x3727c5ac, v115
    v_cvt_pk_bf16_f32 v116, -v114, -v114
    v_and_b32 v113, s51, v116
    v_sub_f32_e64 v113, -v114, v113
    s_waitcnt lgkmcnt(2)
    v_mfma_f32_32x32x16_bf16 v[16:31], v[208:211], v[52:55], v[16:31]
    ds_read_b128 v[48:51], v12 offset:20480
    v_and_b32 v117, 0xffff, v116
    v_cvt_pk_bf16_f32 v113, v113, v113
    v_and_or_b32 v116, v113, s51, v117
    v_rsq_f32 v118, v115
    v_sqrt_f32 v119, v115
    v_mfma_f32_32x32x16_bf16 v[16:31], v[212:215], v[56:59], v[16:31]
    s_add_u32 m0, m0, 4096
    ds_read_b128 v[52:55], v12 offset:21504
    buffer_load_dwordx4 v110, s[36:39], m0 offen sc1 lds
    s_lshl_b32 s26, s8, 1
    s_add_u32 s26, s26, s27
    buffer_load_dwordx4 a[112:115], v1, s[20:23], s26 offen offset:0 sc1
    s_waitcnt lgkmcnt(2)
    v_mfma_f32_32x32x16_bf16 v[16:31], v[216:219], v[60:63], v[16:31]
    ds_read_b128 v[56:59], v12 offset:22528
    v_mul_f32_e64 v118, -v118, s49
    ds_write_b128 v109, v[116:119]
    v_mfma_f32_32x32x16_bf16 v[16:31], v[220:223], v[64:67], v[16:31]
    ds_read_b128 v[60:63], v12 offset:23552
    buffer_load_dwordx4 a[116:119], v1, s[20:23], s26 offen offset:1024 sc1
    s_waitcnt lgkmcnt(3)
    v_mfma_f32_32x32x16_bf16 v[16:31], v[224:227], v[48:51], v[16:31]
    s_waitcnt lgkmcnt(1)
    s_barrier
    ds_read_b128 v[64:67], v12 offset:24576
    ds_read_b128 v[68:71], v108 offset:0
    ds_read_b128 v[72:75], v108 offset:512
    ds_read_b128 v[76:79], v108 offset:1024
    ds_read_b128 v[80:83], v108 offset:1536
    v_mfma_f32_32x32x16_bf16 v[16:31], v[228:231], v[52:55], v[16:31]
    s_add_u32 m0, m0, 4096
    ds_read_b128 v[48:51], v12 offset:25600
    buffer_load_dwordx4 v110, s[36:39], m0 offen sc1 lds
    buffer_load_dwordx4 a[120:123], v1, s[20:23], s26 offen offset:2048 sc1
    s_waitcnt lgkmcnt(6)
    v_mfma_f32_32x32x16_bf16 v[16:31], v[232:235], v[56:59], v[16:31]
    ds_read_b128 v[52:55], v12 offset:26624
    v_mfma_f32_32x32x16_bf16 v[16:31], v[236:239], v[60:63], v[16:31]
    ds_read_b128 v[56:59], v12 offset:27648
    buffer_load_dwordx4 a[124:127], v1, s[20:23], s26 offen offset:3072 sc1
    s_waitcnt lgkmcnt(2)
    v_mfma_f32_32x32x16_bf16 v[16:31], v[240:243], v[64:67], v[16:31]
    ds_read_b128 v[60:63], v12 offset:28672
    v_mov_b32 v88, v68
    v_mov_b32 v89, v69
    v_mfma_f32_32x32x16_bf16 v[16:31], v[244:247], v[48:51], v[16:31]
    s_add_u32 m0, m0, 4096
    ds_read_b128 v[64:67], v12 offset:29696
    buffer_load_dwordx4 v110, s[36:39], m0 offen sc1 lds
    s_lshl_b32 s26, s9, 1
    s_add_u32 s26, s26, s27
    buffer_load_dwordx4 a[128:131], v1, s[20:23], s26 offen offset:0 sc1
    s_waitcnt lgkmcnt(2)
    v_mfma_f32_32x32x16_bf16 v[16:31], v[248:251], v[52:55], v[16:31]
    ds_read_b128 v[48:51], v12 offset:30720
    v_mfma_f32_32x32x16_bf16 v[16:31], v[252:255], v[56:59], v[16:31]
    ds_read_b128 v[52:55], v12 offset:31744
    v_mfma_f32_32x32x16_bf16 v[16:31], v[84:87], v[88:91], v[16:31]
    buffer_load_dwordx4 a[132:135], v1, s[20:23], s26 offen offset:1024 sc1
    s_waitcnt lgkmcnt(2)
    v_mfma_f32_32x32x16_bf16 v[32:47], a[224:227], v[60:63], 0
    s_waitcnt vmcnt(13)
    s_barrier
    ds_read_b128 v[56:59], v12 offset:32768
    v_mfma_f32_32x32x16_bf16 v[32:47], a[228:231], v[64:67], v[32:47]
    s_add_u32 m0, m0, 4096
    v_add_u32 v110, s16, v110
    ds_read_b128 v[60:63], v12 offset:33792
    buffer_load_dwordx4 v110, s[36:39], m0 offen sc1 lds
    buffer_load_dwordx4 a[136:139], v1, s[20:23], s26 offen offset:2048 sc1
    s_waitcnt lgkmcnt(2)
    v_mfma_f32_32x32x16_bf16 v[32:47], a[232:235], v[48:51], v[32:47]
    ds_read_b128 v[64:67], v12 offset:34816
    v_mul_f32 v92, v16, v70
    v_mul_f32 v93, v17, v70
    v_exp_f32 v92, v92
    v_exp_f32 v93, v93
    v_fma_f32 v92, v92, v71, v71
    v_fma_f32 v93, v93, v71, v71
    v_mfma_f32_32x32x16_bf16 v[32:47], a[236:239], v[52:55], v[32:47]
    ds_read_b128 v[48:51], v12 offset:35840
    buffer_load_dwordx4 a[140:143], v1, s[20:23], s26 offen offset:3072 sc1
    v_rcp_f32 v92, v92
    v_rcp_f32 v93, v93
    v_mul_f32 v16, v16, v92
    s_waitcnt lgkmcnt(2)
    v_mfma_f32_32x32x16_bf16 v[32:47], a[240:243], v[56:59], v[32:47]
    ds_read_b128 v[52:55], v12 offset:36864
    v_mul_f32 v17, v17, v93
    v_cvt_pk_bf16_f32 v96, v16, v17
    v_mul_f32 v94, v18, v70
    v_mul_f32 v95, v19, v70
    v_exp_f32 v94, v94
    v_exp_f32 v95, v95
    v_mfma_f32_32x32x16_bf16 v[32:47], a[244:247], v[60:63], v[32:47]
    s_add_u32 m0, m0, 4096
    ds_read_b128 v[56:59], v12 offset:37888
    buffer_load_dwordx4 v110, s[36:39], m0 offen sc1 lds
    s_lshl_b32 s26, s10, 1
    s_add_u32 s26, s26, s27
    buffer_load_dwordx4 a[144:147], v1, s[20:23], s26 offen offset:0 sc1
    s_waitcnt lgkmcnt(2)
    v_mfma_f32_32x32x16_bf16 v[32:47], a[248:251], v[64:67], v[32:47]
    ds_read_b128 v[60:63], v12 offset:38912
    v_fma_f32 v94, v94, v71, v71
    v_fma_f32 v95, v95, v71, v71
    v_rcp_f32 v94, v94
    v_rcp_f32 v95, v95
    v_mul_f32 v18, v18, v94
    v_mfma_f32_32x32x16_bf16 v[32:47], a[252:255], v[48:51], v[32:47]
    ds_read_b128 v[64:67], v12 offset:39936
    buffer_load_dwordx4 a[148:151], v1, s[20:23], s26 offen offset:1024 sc1
    v_mul_f32 v19, v19, v95
    v_cvt_pk_bf16_f32 v97, v18, v19
    v_mul_f32 v92, v20, v70
    v_mul_f32 v93, v21, v70
    v_exp_f32 v92, v92
    s_waitcnt lgkmcnt(2)
    v_mfma_f32_32x32x16_bf16 v[32:47], v[176:179], v[52:55], v[32:47]
    s_waitcnt vmcnt(14)
    s_barrier
    ds_read_b128 v[48:51], v12 offset:0
    v_exp_f32 v93, v93
    v_fma_f32 v92, v92, v71, v71
    v_fma_f32 v93, v93, v71, v71
    v_mfma_f32_32x32x16_bf16 v[32:47], v[180:183], v[56:59], v[32:47]
    s_add_u32 m0, m0, 4096
    ds_read_b128 v[52:55], v12 offset:1024
    buffer_load_dwordx4 v110, s[36:39], m0 offen sc1 lds
    buffer_load_dwordx4 a[152:155], v1, s[20:23], s26 offen offset:2048 sc1
    s_waitcnt lgkmcnt(2)
    v_mfma_f32_32x32x16_bf16 v[32:47], v[184:187], v[60:63], v[32:47]
    ds_read_b128 v[56:59], v12 offset:2048
    v_rcp_f32 v92, v92
    v_rcp_f32 v93, v93
    v_mul_f32 v20, v20, v92
    v_mul_f32 v21, v21, v93
    v_cvt_pk_bf16_f32 v98, v20, v21
    v_mul_f32 v94, v22, v70
    v_mfma_f32_32x32x16_bf16 v[32:47], v[188:191], v[64:67], v[32:47]
    ds_read_b128 v[60:63], v12 offset:3072
    buffer_load_dwordx4 a[156:159], v1, s[20:23], s26 offen offset:3072 sc1
    v_mul_f32 v95, v23, v70
    v_exp_f32 v94, v94
    v_exp_f32 v95, v95
    v_fma_f32 v94, v94, v71, v71
    s_waitcnt lgkmcnt(2)
    v_mfma_f32_32x32x16_bf16 v[32:47], v[192:195], v[48:51], v[32:47]
    ds_read_b128 v[64:67], v12 offset:4096
    v_fma_f32 v95, v95, v71, v71
    v_rcp_f32 v94, v94
    v_rcp_f32 v95, v95
    v_mul_f32 v22, v22, v94
    v_mul_f32 v23, v23, v95
    v_mfma_f32_32x32x16_bf16 v[32:47], v[196:199], v[52:55], v[32:47]
    s_add_u32 m0, m0, 4096
    ds_read_b128 v[48:51], v12 offset:5120
    buffer_load_dwordx4 v110, s[36:39], m0 offen sc1 lds
    v_cvt_pk_bf16_f32 v99, v22, v23
    v_mul_f32 v92, v24, v70
    v_mul_f32 v93, v25, v70
    v_exp_f32 v92, v92
    s_waitcnt lgkmcnt(2)
    v_mfma_f32_32x32x16_bf16 v[32:47], v[200:203], v[56:59], v[32:47]
    ds_read_b128 v[52:55], v12 offset:6144
    s_lshl_b32 s26, s11, 1
    s_add_u32 s26, s26, s27
    buffer_load_dwordx4 a[160:163], v1, s[20:23], s26 offen offset:0 sc1
    v_exp_f32 v93, v93
    v_mfma_f32_32x32x16_bf16 v[32:47], v[204:207], v[60:63], v[32:47]
    ds_read_b128 v[56:59], v12 offset:7168
    v_fma_f32 v92, v92, v71, v71
    v_fma_f32 v93, v93, v71, v71
    v_rcp_f32 v92, v92
    v_rcp_f32 v93, v93
    v_mul_f32 v24, v24, v92
    v_mul_f32 v25, v25, v93
    s_waitcnt lgkmcnt(2)
    v_mfma_f32_32x32x16_bf16 v[32:47], v[208:211], v[64:67], v[32:47]
    s_waitcnt vmcnt(13)
    s_barrier
    ds_read_b128 v[60:63], v12 offset:8192
    buffer_load_dwordx4 a[164:167], v1, s[20:23], s26 offen offset:1024 sc1
    v_cvt_pk_bf16_f32 v100, v24, v25
    v_mfma_f32_32x32x16_bf16 v[32:47], v[212:215], v[48:51], v[32:47]
    s_add_u32 m0, m0, 4096
    ds_read_b128 v[64:67], v12 offset:9216
    buffer_load_dwordx4 v110, s[36:39], m0 offen sc1 lds
    v_mul_f32 v94, v26, v70
    v_mul_f32 v95, v27, v70
    v_exp_f32 v94, v94
    s_waitcnt lgkmcnt(2)
    v_mfma_f32_32x32x16_bf16 v[32:47], v[216:219], v[52:55], v[32:47]
    ds_read_b128 v[48:51], v12 offset:10240
    buffer_load_dwordx4 a[168:171], v1, s[20:23], s26 offen offset:2048 sc1
    v_exp_f32 v95, v95
    v_fma_f32 v94, v94, v71, v71
    v_fma_f32 v95, v95, v71, v71
    v_mfma_f32_32x32x16_bf16 v[32:47], v[220:223], v[56:59], v[32:47]
    ds_read_b128 v[52:55], v12 offset:11264
    v_rcp_f32 v94, v94
    v_rcp_f32 v95, v95
    v_mul_f32 v26, v26, v94
    v_mul_f32 v27, v27, v95
    v_cvt_pk_bf16_f32 v101, v26, v27
    v_mul_f32 v92, v28, v70
    v_mul_f32 v93, v29, v70
    s_waitcnt lgkmcnt(2)
    v_mfma_f32_32x32x16_bf16 v[32:47], v[224:227], v[60:63], v[32:47]
    ds_read_b128 v[56:59], v12 offset:12288
    buffer_load_dwordx4 a[172:175], v1, s[20:23], s26 offen offset:3072 sc1
    v_exp_f32 v92, v92
    v_exp_f32 v93, v93
    v_fma_f32 v92, v92, v71, v71
    v_mfma_f32_32x32x16_bf16 v[32:47], v[228:231], v[64:67], v[32:47]
    s_add_u32 m0, m0, 4096
    ds_read_b128 v[60:63], v12 offset:13312
    buffer_load_dwordx4 v110, s[36:39], m0 offen sc1 lds
    v_fma_f32 v93, v93, v71, v71
    v_rcp_f32 v92, v92
    v_rcp_f32 v93, v93
    s_waitcnt lgkmcnt(2)
    v_mfma_f32_32x32x16_bf16 v[32:47], v[232:235], v[48:51], v[32:47]
    ds_read_b128 v[64:67], v12 offset:14336
    s_lshl_b32 s26, s12, 1
    s_add_u32 s26, s26, s27
    buffer_load_dwordx4 a[176:179], v1, s[20:23], s26 offen offset:0 sc1
    v_mul_f32 v28, v28, v92
    v_mul_f32 v29, v29, v93
    v_mfma_f32_32x32x16_bf16 v[32:47], v[236:239], v[52:55], v[32:47]
    ds_read_b128 v[48:51], v12 offset:15360
    v_cvt_pk_bf16_f32 v102, v28, v29
    v_mul_f32 v94, v30, v70
    v_mul_f32 v95, v31, v70
    v_exp_f32 v94, v94
    v_exp_f32 v95, v95
    v_fma_f32 v94, v94, v71, v71
    s_waitcnt lgkmcnt(2)
    v_mfma_f32_32x32x16_bf16 v[32:47], v[240:243], v[56:59], v[32:47]
    s_waitcnt vmcnt(13)
    s_barrier
    ds_read_b128 v[52:55], v12 offset:16384
    v_mov_b32 v88, v72
    v_mov_b32 v89, v73
    buffer_load_dwordx4 a[180:183], v1, s[20:23], s26 offen offset:1024 sc1
    v_mfma_f32_32x32x16_bf16 v[32:47], v[244:247], v[60:63], v[32:47]
    s_mov_b32 m0, s15
    v_add_u32 v110, 40960, v110
    ds_read_b128 v[56:59], v12 offset:17408
    buffer_load_dwordx4 v110, s[36:39], m0 offen sc1 lds
    v_fma_f32 v95, v95, v71, v71
    v_rcp_f32 v94, v94
    s_waitcnt lgkmcnt(2)
    v_mfma_f32_32x32x16_bf16 v[32:47], v[248:251], v[64:67], v[32:47]
    ds_read_b128 v[60:63], v12 offset:18432
    v_rcp_f32 v95, v95
    v_mul_f32 v30, v30, v94
    v_mul_f32 v31, v31, v95
    v_cvt_pk_bf16_f32 v103, v30, v31
    v_mfma_f32_32x32x16_bf16 v[32:47], v[252:255], v[48:51], v[32:47]
    ds_read_b128 v[64:67], v12 offset:19456
    buffer_load_dwordx4 a[184:187], v1, s[20:23], s26 offen offset:2048 sc1
    s_add_u32 s40, s3, 0
    buffer_store_dwordx4 v[96:99], v1, s[36:39], s40 offen sc1
    buffer_store_dwordx4 v[100:103], v1, s[36:39], s40 offen offset:1024 sc1
    v_mfma_f32_32x32x16_bf16 v[32:47], v[84:87], v[88:91], v[32:47]
    s_waitcnt lgkmcnt(2)
    v_mfma_f32_32x32x16_bf16 v[16:31], a[224:227], v[52:55], 0
    ds_read_b128 v[48:51], v12 offset:20480
    buffer_load_dwordx4 a[188:191], v1, s[20:23], s26 offen offset:3072 sc1
    v_mfma_f32_32x32x16_bf16 v[16:31], a[228:231], v[56:59], v[16:31]
    s_add_u32 m0, m0, 4096
    v_subrev_u32 v110, s16, v110
    ds_read_b128 v[52:55], v12 offset:21504
    buffer_load_dwordx4 v110, s[36:39], m0 offen sc1 lds
    s_waitcnt lgkmcnt(2)
    v_mfma_f32_32x32x16_bf16 v[16:31], a[232:235], v[60:63], v[16:31]
    ds_read_b128 v[56:59], v12 offset:22528
    s_lshl_b32 s26, s13, 1
    s_add_u32 s26, s26, s27
    buffer_load_dwordx4 a[192:195], v1, s[20:23], s26 offen offset:0 sc1
    v_mul_f32 v92, v32, v74
    v_mul_f32 v93, v33, v74
    v_exp_f32 v92, v92
    v_mfma_f32_32x32x16_bf16 v[16:31], a[236:239], v[64:67], v[16:31]
    ds_read_b128 v[60:63], v12 offset:23552
    v_exp_f32 v93, v93
    v_fma_f32 v92, v92, v75, v75
    v_fma_f32 v93, v93, v75, v75
    v_rcp_f32 v92, v92
    v_rcp_f32 v93, v93
    v_mul_f32 v32, v32, v92
    s_waitcnt lgkmcnt(2)
    v_mfma_f32_32x32x16_bf16 v[16:31], a[240:243], v[48:51], v[16:31]
    s_waitcnt vmcnt(15)
    s_barrier
    ds_read_b128 v[64:67], v12 offset:24576
    buffer_load_dwordx4 a[196:199], v1, s[20:23], s26 offen offset:1024 sc1
    v_mul_f32 v33, v33, v93
    v_mfma_f32_32x32x16_bf16 v[16:31], a[244:247], v[52:55], v[16:31]
    s_add_u32 m0, m0, 4096
    ds_read_b128 v[48:51], v12 offset:25600
    buffer_load_dwordx4 v110, s[36:39], m0 offen sc1 lds
    v_cvt_pk_bf16_f32 v96, v32, v33
    v_mul_f32 v94, v34, v74
    v_mul_f32 v95, v35, v74
    v_exp_f32 v94, v94
    s_waitcnt lgkmcnt(2)
    v_mfma_f32_32x32x16_bf16 v[16:31], a[248:251], v[56:59], v[16:31]
    ds_read_b128 v[52:55], v12 offset:26624
    buffer_load_dwordx4 a[200:203], v1, s[20:23], s26 offen offset:2048 sc1
    v_exp_f32 v95, v95
    v_fma_f32 v94, v94, v75, v75
    v_fma_f32 v95, v95, v75, v75
    v_rcp_f32 v94, v94
    v_mfma_f32_32x32x16_bf16 v[16:31], a[252:255], v[60:63], v[16:31]
    ds_read_b128 v[56:59], v12 offset:27648
    v_rcp_f32 v95, v95
    v_mul_f32 v34, v34, v94
    v_mul_f32 v35, v35, v95
    v_cvt_pk_bf16_f32 v97, v34, v35
    v_mul_f32 v92, v36, v74
    v_mul_f32 v93, v37, v74
    v_exp_f32 v92, v92
    s_waitcnt lgkmcnt(2)
    v_mfma_f32_32x32x16_bf16 v[16:31], v[176:179], v[64:67], v[16:31]
    ds_read_b128 v[60:63], v12 offset:28672
    buffer_load_dwordx4 a[204:207], v1, s[20:23], s26 offen offset:3072 sc1
    v_exp_f32 v93, v93
    v_fma_f32 v92, v92, v75, v75
    v_fma_f32 v93, v93, v75, v75
    v_mfma_f32_32x32x16_bf16 v[16:31], v[180:183], v[48:51], v[16:31]
    s_add_u32 m0, m0, 4096
    ds_read_b128 v[64:67], v12 offset:29696
    buffer_load_dwordx4 v110, s[36:39], m0 offen sc1 lds
    v_rcp_f32 v92, v92
    v_rcp_f32 v93, v93
    v_mul_f32 v36, v36, v92
    v_mul_f32 v37, v37, v93
    s_waitcnt lgkmcnt(2)
    v_mfma_f32_32x32x16_bf16 v[16:31], v[184:187], v[52:55], v[16:31]
    ds_read_b128 v[48:51], v12 offset:30720
    s_lshl_b32 s26, s14, 1
    s_add_u32 s26, s26, s27
    buffer_load_dwordx4 a[208:211], v1, s[20:23], s26 offen offset:0 sc1
    v_cvt_pk_bf16_f32 v98, v36, v37
    v_mul_f32 v94, v38, v74
    v_mul_f32 v95, v39, v74
    v_mfma_f32_32x32x16_bf16 v[16:31], v[188:191], v[56:59], v[16:31]
    ds_read_b128 v[52:55], v12 offset:31744
    v_exp_f32 v94, v94
    v_exp_f32 v95, v95
    v_fma_f32 v94, v94, v75, v75
    v_fma_f32 v95, v95, v75, v75
    v_rcp_f32 v94, v94
    s_waitcnt lgkmcnt(2)
    v_mfma_f32_32x32x16_bf16 v[16:31], v[192:195], v[60:63], v[16:31]
    s_waitcnt vmcnt(15)
    s_barrier
    ds_read_b128 v[56:59], v12 offset:32768
    v_rcp_f32 v95, v95
    v_mul_f32 v38, v38, v94
    v_mul_f32 v39, v39, v95
    v_cvt_pk_bf16_f32 v99, v38, v39
    v_mul_f32 v92, v40, v74
    v_mfma_f32_32x32x16_bf16 v[16:31], v[196:199], v[64:67], v[16:31]
    s_add_u32 m0, m0, 4096
    ds_read_b128 v[60:63], v12 offset:33792
    buffer_load_dwordx4 v110, s[36:39], m0 offen sc1 lds
    buffer_load_dwordx4 a[212:215], v1, s[20:23], s26 offen offset:1024 sc1
    v_mul_f32 v93, v41, v74
    s_waitcnt lgkmcnt(2)
    v_mfma_f32_32x32x16_bf16 v[16:31], v[200:203], v[48:51], v[16:31]
    ds_read_b128 v[64:67], v12 offset:34816
    s_add_u32 s41, s2, 0
    s_add_u32 s42, s56, 1
    v_mov_b32 v14, s42
    s_waitcnt vmcnt(11)
    s_mov_b64 exec, 1
    buffer_store_dword v14, v1, s[36:39], s41 offen
    s_mov_b64 exec, -1
    v_mfma_f32_32x32x16_bf16 v[16:31], v[204:207], v[52:55], v[16:31]
    ds_read_b128 v[48:51], v12 offset:35840
    buffer_load_dwordx4 a[216:219], v1, s[20:23], s26 offen offset:2048 sc1
    v_exp_f32 v92, v92
    v_exp_f32 v93, v93
    v_fma_f32 v92, v92, v75, v75
    v_fma_f32 v93, v93, v75, v75
    s_waitcnt lgkmcnt(2)
    v_mfma_f32_32x32x16_bf16 v[16:31], v[208:211], v[56:59], v[16:31]
    ds_read_b128 v[52:55], v12 offset:36864
    v_rcp_f32 v92, v92
    v_rcp_f32 v93, v93
    v_mul_f32 v40, v40, v92
    v_mul_f32 v41, v41, v93
    v_cvt_pk_bf16_f32 v100, v40, v41
    v_mul_f32 v94, v42, v74
    v_mul_f32 v95, v43, v74
    v_mfma_f32_32x32x16_bf16 v[16:31], v[212:215], v[60:63], v[16:31]
    s_add_u32 m0, m0, 4096
    ds_read_b128 v[56:59], v12 offset:37888
    buffer_load_dwordx4 v110, s[36:39], m0 offen sc1 lds
    buffer_load_dwordx4 a[220:223], v1, s[20:23], s26 offen offset:3072 sc1
    v_exp_f32 v94, v94
    s_waitcnt lgkmcnt(2)
    v_mfma_f32_32x32x16_bf16 v[16:31], v[216:219], v[64:67], v[16:31]
    ds_read_b128 v[60:63], v12 offset:38912
    v_exp_f32 v95, v95
    v_fma_f32 v94, v94, v75, v75
    v_fma_f32 v95, v95, v75, v75
    v_rcp_f32 v94, v94
    v_rcp_f32 v95, v95
    v_mfma_f32_32x32x16_bf16 v[16:31], v[220:223], v[48:51], v[16:31]
    ds_read_b128 v[64:67], v12 offset:39936
    s_lshl_b32 s26, s8, 1
    s_add_u32 s26, s26, s25
    buffer_load_dwordx4 a[0:3], v1, s[20:23], s26 offen offset:0 sc1
    v_mul_f32 v42, v42, v94
    v_mul_f32 v43, v43, v95
    v_cvt_pk_bf16_f32 v101, v42, v43
    v_mul_f32 v92, v44, v74
    s_waitcnt lgkmcnt(2)
    v_mfma_f32_32x32x16_bf16 v[16:31], v[224:227], v[52:55], v[16:31]
    s_waitcnt vmcnt(14)
    s_barrier
    ds_read_b128 v[48:51], v12 offset:0
    v_mul_f32 v93, v45, v74
    v_exp_f32 v92, v92
    v_exp_f32 v93, v93
    v_mfma_f32_32x32x16_bf16 v[16:31], v[228:231], v[56:59], v[16:31]
    s_add_u32 m0, m0, 4096
    ds_read_b128 v[52:55], v12 offset:1024
    buffer_load_dwordx4 v110, s[36:39], m0 offen sc1 lds
    buffer_load_dwordx4 a[4:7], v1, s[20:23], s26 offen offset:1024 sc1
    v_fma_f32 v92, v92, v75, v75
    s_waitcnt lgkmcnt(2)
    v_mfma_f32_32x32x16_bf16 v[16:31], v[232:235], v[60:63], v[16:31]
    ds_read_b128 v[56:59], v12 offset:2048
    v_fma_f32 v93, v93, v75, v75
    v_rcp_f32 v92, v92
    v_rcp_f32 v93, v93
    v_mul_f32 v44, v44, v92
    v_mul_f32 v45, v45, v93
    v_cvt_pk_bf16_f32 v102, v44, v45
    v_mul_f32 v94, v46, v74
    v_mfma_f32_32x32x16_bf16 v[16:31], v[236:239], v[64:67], v[16:31]
    ds_read_b128 v[60:63], v12 offset:3072
    buffer_load_dwordx4 a[8:11], v1, s[20:23], s26 offen offset:2048 sc1
    v_mul_f32 v95, v47, v74
    v_exp_f32 v94, v94
    v_exp_f32 v95, v95
    v_fma_f32 v94, v94, v75, v75
    s_waitcnt lgkmcnt(2)
    v_mfma_f32_32x32x16_bf16 v[16:31], v[240:243], v[48:51], v[16:31]
    ds_read_b128 v[64:67], v12 offset:4096
    v_mov_b32 v88, v76
    v_mov_b32 v89, v77
    v_fma_f32 v95, v95, v75, v75
    v_rcp_f32 v94, v94
    v_rcp_f32 v95, v95
    v_mul_f32 v46, v46, v94
    v_mfma_f32_32x32x16_bf16 v[16:31], v[244:247], v[52:55], v[16:31]
    s_add_u32 m0, m0, 4096
    ds_read_b128 v[48:51], v12 offset:5120
    buffer_load_dwordx4 v110, s[36:39], m0 offen sc1 lds
    v_mul_f32 v47, v47, v95
    v_cvt_pk_bf16_f32 v103, v46, v47
    s_waitcnt lgkmcnt(2)
    v_mfma_f32_32x32x16_bf16 v[16:31], v[248:251], v[56:59], v[16:31]
    ds_read_b128 v[52:55], v12 offset:6144
    s_add_u32 s70, s74, 0
    buffer_load_dword v109, v104, s[36:39], s70 offen sc1
    buffer_load_dwordx4 a[12:15], v1, s[20:23], s26 offen offset:3072 sc1
    s_add_u32 s40, s17, 229376
    buffer_store_dwordx4 v[96:99], v1, s[36:39], s40 offen sc1
    buffer_store_dwordx4 v[100:103], v1, s[36:39], s40 offen offset:1024 sc1
    v_mfma_f32_32x32x16_bf16 v[16:31], v[252:255], v[60:63], v[16:31]
    ds_read_b128 v[56:59], v12 offset:7168
    v_mfma_f32_32x32x16_bf16 v[16:31], v[84:87], v[88:91], v[16:31]
    s_lshl_b32 s26, s9, 1
    s_add_u32 s26, s26, s25
    buffer_load_dwordx4 a[16:19], v1, s[20:23], s26 offen offset:0 sc1
    s_waitcnt lgkmcnt(2)
    v_mfma_f32_32x32x16_bf16 v[32:47], a[224:227], v[64:67], 0
    s_waitcnt vmcnt(17)
    s_barrier
    ds_read_b128 v[60:63], v12 offset:8192
    v_mfma_f32_32x32x16_bf16 v[32:47], a[228:231], v[48:51], v[32:47]
    ds_read_b128 v[64:67], v12 offset:9216
    buffer_load_dwordx4 a[20:23], v1, s[20:23], s26 offen offset:1024 sc1
    s_waitcnt lgkmcnt(2)
    v_mfma_f32_32x32x16_bf16 v[32:47], a[232:235], v[52:55], v[32:47]
    ds_read_b128 v[48:51], v12 offset:10240
    v_mul_f32 v92, v16, v78
    v_mul_f32 v93, v17, v78
    v_exp_f32 v92, v92
    v_exp_f32 v93, v93
    v_fma_f32 v92, v92, v79, v79
    v_fma_f32 v93, v93, v79, v79
    v_mfma_f32_32x32x16_bf16 v[32:47], a[236:239], v[56:59], v[32:47]
    ds_read_b128 v[52:55], v12 offset:11264
    buffer_load_dwordx4 a[24:27], v1, s[20:23], s26 offen offset:2048 sc1
    v_rcp_f32 v92, v92
    v_rcp_f32 v93, v93
    v_mul_f32 v16, v16, v92
    v_mul_f32 v17, v17, v93
    s_waitcnt lgkmcnt(2)
    v_mfma_f32_32x32x16_bf16 v[32:47], a[240:243], v[60:63], v[32:47]
    ds_read_b128 v[56:59], v12 offset:12288
    s_add_u32 s47, s56, 1
    s_waitcnt vmcnt(6)
    v_subrev_u32 v109, s47, v109
    v_cmp_lt_u32 vcc, 3, v109
    s_cbranch_vccnz L_aspin_11
L_aback_12:
    v_cvt_pk_bf16_f32 v96, v16, v17
    v_mul_f32 v94, v18, v78
    v_mul_f32 v95, v19, v78
    v_mfma_f32_32x32x16_bf16 v[32:47], a[244:247], v[64:67], v[32:47]
    ds_read_b128 v[60:63], v12 offset:13312
    s_add_u32 s79, s73, 0
    v_add_u32 v15, s79, v1
    buffer_load_dwordx4 v[112:115], v15, s[36:39], s8 offen offset:0 sc1
    buffer_load_dwordx4 a[28:31], v1, s[20:23], s26 offen offset:3072 sc1
    s_waitcnt lgkmcnt(2)
    v_mfma_f32_32x32x16_bf16 v[32:47], a[248:251], v[48:51], v[32:47]
    ds_read_b128 v[64:67], v12 offset:14336
    buffer_load_dwordx4 v[116:119], v15, s[36:39], s8 offen offset:1024 sc1
    v_exp_f32 v94, v94
    v_exp_f32 v95, v95
    v_fma_f32 v94, v94, v79, v79
    v_mfma_f32_32x32x16_bf16 v[32:47], a[252:255], v[52:55], v[32:47]
    ds_read_b128 v[48:51], v12 offset:15360
    s_lshl_b32 s26, s10, 1
    s_add_u32 s26, s26, s25
    buffer_load_dwordx4 a[32:35], v1, s[20:23], s26 offen offset:0 sc1
    v_fma_f32 v95, v95, v79, v79
    v_rcp_f32 v94, v94
    s_waitcnt lgkmcnt(2)
    v_mfma_f32_32x32x16_bf16 v[32:47], v[176:179], v[56:59], v[32:47]
    s_barrier
    ds_read_b128 v[52:55], v12 offset:16384
    buffer_load_dwordx4 v[120:123], v15, s[36:39], s9 offen offset:0 sc1
    v_rcp_f32 v95, v95
    v_mfma_f32_32x32x16_bf16 v[32:47], v[180:183], v[60:63], v[32:47]
    ds_read_b128 v[56:59], v12 offset:17408
    buffer_load_dwordx4 a[36:39], v1, s[20:23], s26 offen offset:1024 sc1
    v_mul_f32 v18, v18, v94
    v_mul_f32 v19, v19, v95
    v_cvt_pk_bf16_f32 v97, v18, v19
    v_mul_f32 v92, v20, v78
    v_mul_f32 v93, v21, v78
    s_waitcnt lgkmcnt(2)
    v_mfma_f32_32x32x16_bf16 v[32:47], v[184:187], v[64:67], v[32:47]
    ds_read_b128 v[60:63], v12 offset:18432
    buffer_load_dwordx4 v[124:127], v15, s[36:39], s9 offen offset:1024 sc1
    v_exp_f32 v92, v92
    v_exp_f32 v93, v93
    v_fma_f32 v92, v92, v79, v79
    v_mfma_f32_32x32x16_bf16 v[32:47], v[188:191], v[48:51], v[32:47]
    ds_read_b128 v[64:67], v12 offset:19456
    v_fma_f32 v93, v93, v79, v79
    v_rcp_f32 v92, v92
    v_rcp_f32 v93, v93
    v_mul_f32 v20, v20, v92
    v_mul_f32 v21, v21, v93
    v_cvt_pk_bf16_f32 v98, v20, v21
    v_mul_f32 v94, v22, v78
    s_waitcnt lgkmcnt(2)
    v_mfma_f32_32x32x16_bf16 v[32:47], v[192:195], v[52:55], v[32:47]
    ds_read_b128 v[48:51], v12 offset:20480
    buffer_load_dwordx4 v[128:131], v15, s[36:39], s10 offen offset:0 sc1
    buffer_load_dwordx4 a[40:43], v1, s[20:23], s26 offen offset:2048 sc1
    v_mul_f32 v95, v23, v78
    v_mfma_f32_32x32x16_bf16 v[32:47], v[196:199], v[56:59], v[32:47]
    ds_read_b128 v[52:55], v12 offset:21504
    v_exp_f32 v94, v94
    v_exp_f32 v95, v95
    v_fma_f32 v94, v94, v79, v79
    v_fma_f32 v95, v95, v79, v79
    v_rcp_f32 v94, v94
    s_waitcnt lgkmcnt(2)
    v_mfma_f32_32x32x16_bf16 v[32:47], v[200:203], v[60:63], v[32:47]
    ds_read_b128 v[56:59], v12 offset:22528
    s_add_u32 s41, s1, 512
    s_add_u32 s42, s56, 1
    v_mov_b32 v14, s42
    s_waitcnt vmcnt(12)
    s_mov_b64 exec, 1
    buffer_store_dword v14, v1, s[36:39], s41 offen
    s_mov_b64 exec, -1
    buffer_load_dwordx4 v[132:135], v15, s[36:39], s10 offen offset:1024 sc1
    buffer_load_dwordx4 a[44:47], v1, s[20:23], s26 offen offset:3072 sc1
    v_mfma_f32_32x32x16_bf16 v[32:47], v[204:207], v[64:67], v[32:47]
    ds_read_b128 v[60:63], v12 offset:23552
    v_rcp_f32 v95, v95
    v_mul_f32 v22, v22, v94
    v_mul_f32 v23, v23, v95
    v_cvt_pk_bf16_f32 v99, v22, v23
    v_mul_f32 v92, v24, v78
    v_mul_f32 v93, v25, v78
    v_exp_f32 v92, v92
    s_waitcnt lgkmcnt(2)
    v_mfma_f32_32x32x16_bf16 v[32:47], v[208:211], v[48:51], v[32:47]
    s_barrier
    ds_read_b128 v[64:67], v12 offset:24576
    buffer_load_dwordx4 v[136:139], v15, s[36:39], s11 offen offset:0 sc1
    s_lshl_b32 s26, s11, 1
    s_add_u32 s26, s26, s25
    buffer_load_dwordx4 a[48:51], v1, s[20:23], s26 offen offset:0 sc1
    v_mfma_f32_32x32x16_bf16 v[32:47], v[212:215], v[52:55], v[32:47]
    ds_read_b128 v[48:51], v12 offset:25600
    buffer_load_dwordx4 v[140:143], v15, s[36:39], s11 offen offset:1024 sc1
    v_exp_f32 v93, v93
    v_fma_f32 v92, v92, v79, v79
    v_fma_f32 v93, v93, v79, v79
    v_rcp_f32 v92, v92
    s_waitcnt lgkmcnt(2)
    v_mfma_f32_32x32x16_bf16 v[32:47], v[216:219], v[56:59], v[32:47]
    ds_read_b128 v[52:55], v12 offset:26624
    buffer_load_dwordx4 a[52:55], v1, s[20:23], s26 offen offset:1024 sc1
    v_rcp_f32 v93, v93
    v_mul_f32 v24, v24, v92
    v_mul_f32 v25, v25, v93
    v_cvt_pk_bf16_f32 v100, v24, v25
    v_mfma_f32_32x32x16_bf16 v[32:47], v[220:223], v[60:63], v[32:47]
    ds_read_b128 v[56:59], v12 offset:27648
    buffer_load_dwordx4 v[144:147], v15, s[36:39], s12 offen offset:0 sc1
    v_mul_f32 v94, v26, v78
    v_mul_f32 v95, v27, v78
    v_exp_f32 v94, v94
    v_exp_f32 v95, v95
    s_waitcnt lgkmcnt(2)
    v_mfma_f32_32x32x16_bf16 v[32:47], v[224:227], v[64:67], v[32:47]
    ds_read_b128 v[60:63], v12 offset:28672
    buffer_load_dwordx4 a[56:59], v1, s[20:23], s26 offen offset:2048 sc1
    v_fma_f32 v94, v94, v79, v79
    v_fma_f32 v95, v95, v79, v79
    v_rcp_f32 v94, v94
    v_mfma_f32_32x32x16_bf16 v[32:47], v[228:231], v[48:51], v[32:47]
    ds_read_b128 v[64:67], v12 offset:29696
    buffer_load_dwordx4 v[148:151], v15, s[36:39], s12 offen offset:1024 sc1
    v_rcp_f32 v95, v95
    v_mul_f32 v26, v26, v94
    v_mul_f32 v27, v27, v95
    v_cvt_pk_bf16_f32 v101, v26, v27
    s_waitcnt lgkmcnt(2)
    v_mfma_f32_32x32x16_bf16 v[32:47], v[232:235], v[52:55], v[32:47]
    ds_read_b128 v[48:51], v12 offset:30720
    buffer_load_dwordx4 a[60:63], v1, s[20:23], s26 offen offset:3072 sc1
    v_mul_f32 v92, v28, v78
    v_mul_f32 v93, v29, v78
    v_exp_f32 v92, v92
    v_mfma_f32_32x32x16_bf16 v[32:47], v[236:239], v[56:59], v[32:47]
    ds_read_b128 v[52:55], v12 offset:31744
    buffer_load_dwordx4 v[152:155], v15, s[36:39], s13 offen offset:0 sc1
    v_exp_f32 v93, v93
    v_fma_f32 v92, v92, v79, v79
    v_fma_f32 v93, v93, v79, v79
    v_rcp_f32 v92, v92
    s_waitcnt lgkmcnt(2)
    v_mfma_f32_32x32x16_bf16 v[32:47], v[240:243], v[60:63], v[32:47]
    v_mov_b32 v88, v80
    v_mov_b32 v89, v81
    v_rcp_f32 v93, v93
    v_mul_f32 v28, v28, v92
    v_mul_f32 v29, v29, v93
    v_cvt_pk_bf16_f32 v102, v28, v29
    v_mul_f32 v94, v30, v78
    v_mul_f32 v95, v31, v78
    v_mfma_f32_32x32x16_bf16 v[32:47], v[244:247], v[64:67], v[32:47]
    buffer_load_dwordx4 v[156:159], v15, s[36:39], s13 offen offset:1024 sc1
    v_exp_f32 v94, v94
    v_exp_f32 v95, v95
    v_fma_f32 v94, v94, v79, v79
    v_fma_f32 v95, v95, v79, v79
    s_waitcnt lgkmcnt(0)
    v_mfma_f32_32x32x16_bf16 v[32:47], v[248:251], v[48:51], v[32:47]
    v_rcp_f32 v94, v94
    v_rcp_f32 v95, v95
    v_mul_f32 v30, v30, v94
    v_mul_f32 v31, v31, v95
    v_cvt_pk_bf16_f32 v103, v30, v31
    v_mfma_f32_32x32x16_bf16 v[32:47], v[252:255], v[52:55], v[32:47]
    s_add_u32 s40, s3, 114688
    buffer_store_dwordx4 v[96:99], v1, s[36:39], s40 offen sc1
    buffer_store_dwordx4 v[100:103], v1, s[36:39], s40 offen offset:1024 sc1
    v_mfma_f32_32x32x16_bf16 v[32:47], v[84:87], v[88:91], v[32:47]
    s_nop 11
    v_pk_mul_f32 v[92:93], v[32:33], v[82:83] op_sel_hi:[1,0]
    s_xor_b32 s71, s74, 4
    buffer_load_dword v13, v104, s[36:39], s71 offen sc1
    v_pk_mul_f32 v[94:95], v[34:35], v[82:83] op_sel_hi:[1,0]
    v_exp_f32 v92, v92
    v_exp_f32 v93, v93
    v_exp_f32 v94, v94
    v_exp_f32 v95, v95
    v_pk_fma_f32 v[92:93], v[92:93], v[82:83], v[82:83] op_sel:[0,1,1] op_sel_hi:[1,1,1]
    v_pk_fma_f32 v[94:95], v[94:95], v[82:83], v[82:83] op_sel:[0,1,1] op_sel_hi:[1,1,1]
    v_rcp_f32 v92, v92
    v_rcp_f32 v93, v93
    v_rcp_f32 v94, v94
    v_rcp_f32 v95, v95
    v_pk_mul_f32 v[32:33], v[32:33], v[92:93]
    v_pk_mul_f32 v[34:35], v[34:35], v[94:95]
    v_cvt_pk_bf16_f32 v96, v32, v33
    v_cvt_pk_bf16_f32 v97, v34, v35
    v_pk_mul_f32 v[92:93], v[36:37], v[82:83] op_sel_hi:[1,0]
    v_pk_mul_f32 v[94:95], v[38:39], v[82:83] op_sel_hi:[1,0]
    v_exp_f32 v92, v92
    v_exp_f32 v93, v93
    v_exp_f32 v94, v94
    buffer_load_dwordx4 v[160:163], v15, s[36:39], s14 offen offset:0 sc1
    v_exp_f32 v95, v95
    v_pk_fma_f32 v[92:93], v[92:93], v[82:83], v[82:83] op_sel:[0,1,1] op_sel_hi:[1,1,1]
    v_pk_fma_f32 v[94:95], v[94:95], v[82:83], v[82:83] op_sel:[0,1,1] op_sel_hi:[1,1,1]
    v_rcp_f32 v92, v92
    v_rcp_f32 v93, v93
    v_rcp_f32 v94, v94
    v_rcp_f32 v95, v95
    v_pk_mul_f32 v[36:37], v[36:37], v[92:93]
    v_pk_mul_f32 v[38:39], v[38:39], v[94:95]
    v_cvt_pk_bf16_f32 v98, v36, v37
    v_cvt_pk_bf16_f32 v99, v38, v39
    v_pk_mul_f32 v[92:93], v[40:41], v[82:83] op_sel_hi:[1,0]
    v_pk_mul_f32 v[94:95], v[42:43], v[82:83] op_sel_hi:[1,0]
    v_exp_f32 v92, v92
    v_exp_f32 v93, v93
    v_exp_f32 v94, v94
    v_exp_f32 v95, v95
    v_pk_fma_f32 v[92:93], v[92:93], v[82:83], v[82:83] op_sel:[0,1,1] op_sel_hi:[1,1,1]
    v_pk_fma_f32 v[94:95], v[94:95], v[82:83], v[82:83] op_sel:[0,1,1] op_sel_hi:[1,1,1]
    v_rcp_f32 v92, v92
    v_rcp_f32 v93, v93
    buffer_load_dwordx4 v[164:167], v15, s[36:39], s14 offen offset:1024 sc1
    v_rcp_f32 v94, v94
    v_rcp_f32 v95, v95
    v_pk_mul_f32 v[40:41], v[40:41], v[92:93]
    v_pk_mul_f32 v[42:43], v[42:43], v[94:95]
    v_cvt_pk_bf16_f32 v100, v40, v41
    v_cvt_pk_bf16_f32 v101, v42, v43
    v_pk_mul_f32 v[92:93], v[44:45], v[82:83] op_sel_hi:[1,0]
    v_pk_mul_f32 v[94:95], v[46:47], v[82:83] op_sel_hi:[1,0]
    v_exp_f32 v92, v92
    v_exp_f32 v93, v93
    v_exp_f32 v94, v94
    v_exp_f32 v95, v95
    v_pk_fma_f32 v[92:93], v[92:93], v[82:83], v[82:83] op_sel:[0,1,1] op_sel_hi:[1,1,1]
    v_pk_fma_f32 v[94:95], v[94:95], v[82:83], v[82:83] op_sel:[0,1,1] op_sel_hi:[1,1,1]
    v_rcp_f32 v92, v92
    v_rcp_f32 v93, v93
    v_rcp_f32 v94, v94
    v_rcp_f32 v95, v95
    v_pk_mul_f32 v[44:45], v[44:45], v[92:93]
    v_pk_mul_f32 v[46:47], v[46:47], v[94:95]
    v_cvt_pk_bf16_f32 v102, v44, v45
    v_cvt_pk_bf16_f32 v103, v46, v47
    s_add_u32 s40, s17, 344064
    buffer_store_dwordx4 v[96:99], v1, s[36:39], s40 offen sc1
    buffer_store_dwordx4 v[100:103], v1, s[36:39], s40 offen offset:1024 sc1
    s_waitcnt vmcnt(28)
    v_mfma_f32_32x32x16_bf16 v[16:31], a[0:3], v[112:115], 0
    s_barrier
    v_mfma_f32_32x32x16_bf16 v[48:63], a[4:7], v[112:115], 0
    s_waitcnt vmcnt(26)
    v_mfma_f32_32x32x16_bf16 v[16:31], a[8:11], v[116:119], v[16:31]
    v_mfma_f32_32x32x16_bf16 v[48:63], a[12:15], v[116:119], v[48:63]
    s_waitcnt vmcnt(24)
    v_mfma_f32_32x32x16_bf16 v[16:31], a[16:19], v[120:123], v[16:31]
    s_add_u32 s41, s2, 256
    s_add_u32 s42, s56, 1
    v_mov_b32 v14, s42
    s_waitcnt vmcnt(5)
    s_mov_b64 exec, 1
    buffer_store_dword v14, v1, s[36:39], s41 offen
    s_mov_b64 exec, -1
    v_mfma_f32_32x32x16_bf16 v[48:63], a[20:23], v[120:123], v[48:63]
    v_and_b32 v107, 7, v0
    v_mfma_f32_32x32x16_bf16 v[16:31], a[24:27], v[124:127], v[16:31]
    s_add_u32 s47, s56, 1
    s_waitcnt vmcnt(5)
    v_subrev_u32 v13, s47, v13
    v_cmp_lt_u32 vcc, 3, v13
    s_cbranch_vccnz L_aspin_14
L_aback_15:
    s_add_u32 s79, s78, 0
    v_add_u32 v15, s79, v1
    buffer_load_dwordx4 v[168:171], v15, s[36:39], s8 offen offset:0 sc1
    v_bfe_u32 v110, v0, 3, 1
    v_mfma_f32_32x32x16_bf16 v[48:63], a[28:31], v[124:127], v[48:63]
    v_mfma_f32_32x32x16_bf16 v[16:31], a[32:35], v[128:131], v[16:31]
    buffer_load_dwordx4 v[172:175], v15, s[36:39], s8 offen offset:1024 sc1
    v_lshrrev_b32 v108, 4, v0
    v_mfma_f32_32x32x16_bf16 v[48:63], a[36:39], v[128:131], v[48:63]
    v_lshlrev_b32 v108, 9, v108
    v_mfma_f32_32x32x16_bf16 v[16:31], a[40:43], v[132:135], v[16:31]
    buffer_load_dwordx4 v[112:115], v15, s[36:39], s9 offen offset:0 sc1
    v_mfma_f32_32x32x16_bf16 v[48:63], a[44:47], v[132:135], v[48:63]
    v_lshl_add_u32 v108, v107, 4, v108
    v_mfma_f32_32x32x16_bf16 v[16:31], a[48:51], v[136:139], v[16:31]
    buffer_load_dwordx4 v[116:119], v15, s[36:39], s9 offen offset:1024 sc1
    v_mfma_f32_32x32x16_bf16 v[48:63], a[52:55], v[136:139], v[48:63]
    v_lshlrev_b32 v107, 4, v107
    v_mfma_f32_32x32x16_bf16 v[16:31], a[56:59], v[140:143], v[16:31]
    buffer_load_dwordx4 v[120:123], v15, s[36:39], s10 offen offset:0 sc1
    v_lshl_add_u32 v107, v110, 9, v107
    v_mfma_f32_32x32x16_bf16 v[48:63], a[60:63], v[140:143], v[48:63]
    v_mfma_f32_32x32x16_bf16 v[16:31], a[64:67], v[144:147], v[16:31]
    buffer_load_dwordx4 v[124:127], v15, s[36:39], s10 offen offset:1024 sc1
    v_lshrrev_b32 v110, 4, v0
    v_mfma_f32_32x32x16_bf16 v[48:63], a[68:71], v[144:147], v[48:63]
    v_lshl_add_u32 v107, v110, 10, v107
    v_mfma_f32_32x32x16_bf16 v[16:31], a[72:75], v[148:151], v[16:31]
    buffer_load_dwordx4 v[128:131], v15, s[36:39], s11 offen offset:0 sc1
    v_mfma_f32_32x32x16_bf16 v[48:63], a[76:79], v[148:151], v[48:63]
    s_add_u32 s43, s75, 0
    buffer_load_dwordx4 v[88:91], v107, s[36:39], s43 offen sc1
    v_mfma_f32_32x32x16_bf16 v[16:31], a[80:83], v[152:155], v[16:31]
    buffer_load_dwordx4 v[132:135], v15, s[36:39], s11 offen offset:1024 sc1
    v_mfma_f32_32x32x16_bf16 v[48:63], a[84:87], v[152:155], v[48:63]
    v_mfma_f32_32x32x16_bf16 v[16:31], a[88:91], v[156:159], v[16:31]
    s_add_u32 s70, s74, 256
    buffer_load_dword v109, v104, s[36:39], s70 offen sc1
    buffer_load_dwordx4 v[136:139], v15, s[36:39], s12 offen offset:0 sc1
    v_mfma_f32_32x32x16_bf16 v[48:63], a[92:95], v[156:159], v[48:63]
    s_waitcnt vmcnt(15)
    v_mfma_f32_32x32x16_bf16 v[16:31], a[96:99], v[160:163], v[16:31]
    buffer_load_dwordx4 v[140:143], v15, s[36:39], s12 offen offset:1024 sc1
    s_add_u32 s41, s1, 768
    s_add_u32 s42, s56, 1
    v_mov_b32 v14, s42
    s_waitcnt vmcnt(13)
    s_mov_b64 exec, 1
    buffer_store_dword v14, v1, s[36:39], s41 offen
    s_mov_b64 exec, -1
    v_mfma_f32_32x32x16_bf16 v[48:63], a[100:103], v[160:163], v[48:63]
    v_mfma_f32_32x32x16_bf16 v[16:31], a[104:107], v[164:167], v[16:31]
    v_mfma_f32_32x32x16_bf16 v[48:63], a[108:111], v[164:167], v[48:63]
    buffer_load_dwordx4 v[144:147], v15, s[36:39], s13 offen offset:0 sc1
    s_waitcnt vmcnt(13)
    v_mfma_f32_32x32x16_bf16 v[16:31], a[112:115], v[168:171], v[16:31]
    v_mfma_f32_32x32x16_bf16 v[48:63], a[116:119], v[168:171], v[48:63]
    buffer_load_dwordx4 v[148:151], v15, s[36:39], s13 offen offset:1024 sc1
    s_waitcnt vmcnt(13)
    v_mfma_f32_32x32x16_bf16 v[16:31], a[120:123], v[172:175], v[16:31]
    v_mfma_f32_32x32x16_bf16 v[48:63], a[124:127], v[172:175], v[48:63]
    buffer_load_dwordx4 v[152:155], v15, s[36:39], s14 offen offset:0 sc1
    s_waitcnt vmcnt(13)
    v_mfma_f32_32x32x16_bf16 v[16:31], a[128:131], v[112:115], v[16:31]
    v_mfma_f32_32x32x16_bf16 v[48:63], a[132:135], v[112:115], v[48:63]
    buffer_load_dwordx4 v[156:159], v15, s[36:39], s14 offen offset:1024 sc1
    s_waitcnt vmcnt(13)
    v_mfma_f32_32x32x16_bf16 v[16:31], a[136:139], v[116:119], v[16:31]
    v_mfma_f32_32x32x16_bf16 v[48:63], a[140:143], v[116:119], v[48:63]
    s_waitcnt vmcnt(12)
    v_mfma_f32_32x32x16_bf16 v[16:31], a[144:147], v[120:123], v[16:31]
    s_add_u32 s47, s56, 1
    s_waitcnt vmcnt(7)
    v_subrev_u32 v109, s47, v109
    v_cmp_lt_u32 vcc, 3, v109
    s_cbranch_vccnz L_aspin_17
L_aback_18:
    s_add_u32 s79, s73, 114688
    v_add_u32 v15, s79, v1
    buffer_load_dwordx4 v[160:163], v15, s[36:39], s8 offen offset:0 sc1
    v_mfma_f32_32x32x16_bf16 v[48:63], a[148:151], v[120:123], v[48:63]
    v_mfma_f32_32x32x16_bf16 v[16:31], a[152:155], v[124:127], v[16:31]
    buffer_load_dwordx4 v[164:167], v15, s[36:39], s8 offen offset:1024 sc1
    v_mfma_f32_32x32x16_bf16 v[48:63], a[156:159], v[124:127], v[48:63]
    v_mfma_f32_32x32x16_bf16 v[16:31], a[160:163], v[128:131], v[16:31]
    buffer_load_dwordx4 v[168:171], v15, s[36:39], s9 offen offset:0 sc1
    v_mfma_f32_32x32x16_bf16 v[48:63], a[164:167], v[128:131], v[48:63]
    v_mfma_f32_32x32x16_bf16 v[16:31], a[168:171], v[132:135], v[16:31]
    s_xor_b32 s71, s74, 4
    s_add_u32 s71, s71, 256
    buffer_load_dword v13, v104, s[36:39], s71 offen sc1
    buffer_load_dwordx4 v[172:175], v15, s[36:39], s9 offen offset:1024 sc1
    v_mfma_f32_32x32x16_bf16 v[48:63], a[172:175], v[132:135], v[48:63]
    s_waitcnt vmcnt(11)
    v_mfma_f32_32x32x16_bf16 v[16:31], a[176:179], v[136:139], v[16:31]
    buffer_load_dwordx4 v[112:115], v15, s[36:39], s10 offen offset:0 sc1
    v_mfma_f32_32x32x16_bf16 v[48:63], a[180:183], v[136:139], v[48:63]
    s_waitcnt vmcnt(11)
    v_mfma_f32_32x32x16_bf16 v[16:31], a[184:187], v[140:143], v[16:31]
    buffer_load_dwordx4 v[116:119], v15, s[36:39], s10 offen offset:1024 sc1
    v_mfma_f32_32x32x16_bf16 v[48:63], a[188:191], v[140:143], v[48:63]
    s_waitcnt vmcnt(10)
    v_mfma_f32_32x32x16_bf16 v[16:31], a[192:195], v[144:147], v[16:31]
    buffer_load_dwordx4 v[120:123], v15, s[36:39], s11 offen offset:0 sc1
    v_mfma_f32_32x32x16_bf16 v[48:63], a[196:199], v[144:147], v[48:63]
    s_waitcnt vmcnt(10)
    v_mfma_f32_32x32x16_bf16 v[16:31], a[200:203], v[148:151], v[16:31]
    buffer_load_dwordx4 v[124:127], v15, s[36:39], s11 offen offset:1024 sc1
    v_mfma_f32_32x32x16_bf16 v[48:63], a[204:207], v[148:151], v[48:63]
    s_waitcnt vmcnt(10)
    v_mfma_f32_32x32x16_bf16 v[16:31], a[208:211], v[152:155], v[16:31]
    buffer_load_dwordx4 v[128:131], v15, s[36:39], s12 offen offset:0 sc1
    v_mfma_f32_32x32x16_bf16 v[48:63], a[212:215], v[152:155], v[48:63]
    s_waitcnt vmcnt(10)
    v_mfma_f32_32x32x16_bf16 v[16:31], a[216:219], v[156:159], v[16:31]
    buffer_load_dwordx4 v[132:135], v15, s[36:39], s12 offen offset:1024 sc1
    v_mfma_f32_32x32x16_bf16 v[48:63], a[220:223], v[156:159], v[48:63]
    s_waitcnt vmcnt(10)
    v_mfma_f32_32x32x16_bf16 v[32:47], a[0:3], v[160:163], 0
    s_add_u32 s47, s56, 1
    s_waitcnt vmcnt(7)
    v_subrev_u32 v13, s47, v13
    v_cmp_lt_u32 vcc, 3, v13
    s_cbranch_vccnz L_aspin_20
L_aback_21:
    s_add_u32 s43, s75, 57344
    buffer_load_dwordx4 v[84:87], v107, s[36:39], s43 offen sc1
    v_mfma_f32_32x32x16_bf16 v[64:79], a[4:7], v[160:163], 0
    buffer_load_dwordx4 v[136:139], v15, s[36:39], s13 offen offset:0 sc1
    v_mfma_f32_32x32x16_bf16 v[32:47], a[8:11], v[164:167], v[32:47]
    ds_write_b128 v105, v[16:19] offset:0
    v_mfma_f32_32x32x16_bf16 v[64:79], a[12:15], v[164:167], v[64:79]
    buffer_load_dwordx4 v[140:143], v15, s[36:39], s13 offen offset:1024 sc1
    ds_write_b128 v106, v[20:23] offset:1024
    v_lshlrev_b32 v92, 16, v88
    v_mfma_f32_32x32x16_bf16 v[32:47], a[16:19], v[168:171], v[32:47]
    v_and_b32 v93, s51, v88
    v_mfma_f32_32x32x16_bf16 v[64:79], a[20:23], v[168:171], v[64:79]
    buffer_load_dwordx4 v[144:147], v15, s[36:39], s14 offen offset:0 sc1
    ds_write_b128 v105, v[24:27] offset:2048
    s_waitcnt vmcnt(10)
    v_mfma_f32_32x32x16_bf16 v[32:47], a[24:27], v[172:175], v[32:47]
    v_lshlrev_b32 v94, 16, v89
    v_mfma_f32_32x32x16_bf16 v[64:79], a[28:31], v[172:175], v[64:79]
    buffer_load_dwordx4 v[148:151], v15, s[36:39], s14 offen offset:1024 sc1
    ds_write_b128 v106, v[28:31] offset:3072
    v_and_b32 v95, s51, v89
    s_waitcnt vmcnt(10)
    v_mfma_f32_32x32x16_bf16 v[32:47], a[32:35], v[112:115], v[32:47]
    v_mfma_f32_32x32x16_bf16 v[64:79], a[36:39], v[112:115], v[64:79]
    s_add_u32 s79, s78, 114688
    v_add_u32 v15, s79, v1
    buffer_load_dwordx4 v[152:155], v15, s[36:39], s8 offen offset:0 sc1
    ds_write_b128 v105, v[48:51] offset:4096
    v_lshlrev_b32 v96, 16, v90
    s_waitcnt vmcnt(10)
    v_mfma_f32_32x32x16_bf16 v[32:47], a[40:43], v[116:119], v[32:47]
    ds_write_b128 v106, v[52:55] offset:5120
    v_mfma_f32_32x32x16_bf16 v[64:79], a[44:47], v[116:119], v[64:79]
    buffer_load_dwordx4 v[156:159], v15, s[36:39], s8 offen offset:1024 sc1
    v_and_b32 v97, s51, v90
    s_waitcnt vmcnt(10)
    v_mfma_f32_32x32x16_bf16 v[32:47], a[48:51], v[120:123], v[32:47]
    ds_write_b128 v105, v[56:59] offset:6144
    v_lshlrev_b32 v98, 16, v91
    v_mfma_f32_32x32x16_bf16 v[64:79], a[52:55], v[120:123], v[64:79]
    buffer_load_dwordx4 v[160:163], v15, s[36:39], s9 offen offset:0 sc1
    s_waitcnt vmcnt(10)
    v_mfma_f32_32x32x16_bf16 v[32:47], a[56:59], v[124:127], v[32:47]
    ds_write_b128 v106, v[60:63] offset:7168
    v_and_b32 v99, s51, v91
    v_mfma_f32_32x32x16_bf16 v[64:79], a[60:63], v[124:127], v[64:79]
    buffer_load_dwordx4 v[164:167], v15, s[36:39], s9 offen offset:1024 sc1
    s_waitcnt vmcnt(10)
    v_mfma_f32_32x32x16_bf16 v[32:47], a[64:67], v[128:131], v[32:47]
    v_mfma_f32_32x32x16_bf16 v[64:79], a[68:71], v[128:131], v[64:79]
    buffer_load_dwordx4 v[168:171], v15, s[36:39], s10 offen offset:0 sc1
    s_waitcnt lgkmcnt(0)
    s_barrier
    ds_read_b128 v[16:19], v111 offset:0
    s_waitcnt vmcnt(10)
    v_mfma_f32_32x32x16_bf16 v[32:47], a[72:75], v[132:135], v[32:47]
    ds_read_b128 v[20:23], v111 offset:1024
    v_mfma_f32_32x32x16_bf16 v[64:79], a[76:79], v[132:135], v[64:79]
    buffer_load_dwordx4 v[172:175], v15, s[36:39], s10 offen offset:1024 sc1
    ds_read_b128 v[24:27], v111 offset:8192
    s_waitcnt vmcnt(9)
    v_mfma_f32_32x32x16_bf16 v[32:47], a[80:83], v[136:139], v[32:47]
    ds_read_b128 v[28:31], v111 offset:9216
    v_mfma_f32_32x32x16_bf16 v[64:79], a[84:87], v[136:139], v[64:79]
    buffer_load_dwordx4 v[112:115], v15, s[36:39], s11 offen offset:0 sc1
    ds_read_b128 v[48:51], v111 offset:16384
    s_waitcnt vmcnt(9)
    v_mfma_f32_32x32x16_bf16 v[32:47], a[88:91], v[140:143], v[32:47]
    ds_read_b128 v[52:55], v111 offset:17408
    v_mfma_f32_32x32x16_bf16 v[64:79], a[92:95], v[140:143], v[64:79]
    ds_read_b128 v[56:59], v111 offset:24576
    s_waitcnt vmcnt(8)
    v_mfma_f32_32x32x16_bf16 v[32:47], a[96:99], v[144:147], v[32:47]
    buffer_load_dwordx4 v[116:119], v15, s[36:39], s11 offen offset:1024 sc1
    ds_read_b128 v[60:63], v111 offset:25600
    v_mfma_f32_32x32x16_bf16 v[64:79], a[100:103], v[144:147], v[64:79]
    s_waitcnt lgkmcnt(7)
    v_add_f32 v92, v92, v16
    v_add_f32 v93, v93, v17
    v_add_f32 v94, v94, v18
    v_add_f32 v95, v95, v19
    s_waitcnt vmcnt(8)
    v_mfma_f32_32x32x16_bf16 v[32:47], a[104:107], v[148:151], v[32:47]
    buffer_load_dwordx4 v[120:123], v15, s[36:39], s12 offen offset:0 sc1
    s_waitcnt lgkmcnt(6)
    v_add_f32 v96, v96, v20
    v_add_f32 v97, v97, v21
    v_add_f32 v98, v98, v22
    v_add_f32 v99, v99, v23
    v_mfma_f32_32x32x16_bf16 v[64:79], a[108:111], v[148:151], v[64:79]
    s_waitcnt lgkmcnt(5)
    v_add_f32 v92, v92, v24
    v_add_f32 v93, v93, v25
    v_add_f32 v94, v94, v26
    s_waitcnt vmcnt(8)
    v_mfma_f32_32x32x16_bf16 v[32:47], a[112:115], v[152:155], v[32:47]
    buffer_load_dwordx4 v[124:127], v15, s[36:39], s12 offen offset:1024 sc1
    v_add_f32 v95, v95, v27
    s_waitcnt lgkmcnt(4)
    v_add_f32 v96, v96, v28
    v_add_f32 v97, v97, v29
    v_add_f32 v98, v98, v30
    v_mfma_f32_32x32x16_bf16 v[64:79], a[116:119], v[152:155], v[64:79]
    v_add_f32 v99, v99, v31
    s_waitcnt lgkmcnt(3)
    v_add_f32 v92, v92, v48
    v_add_f32 v93, v93, v49
    s_waitcnt vmcnt(8)
    v_mfma_f32_32x32x16_bf16 v[32:47], a[120:123], v[156:159], v[32:47]
    buffer_load_dwordx4 v[128:131], v15, s[36:39], s13 offen offset:0 sc1
    v_add_f32 v94, v94, v50
    v_add_f32 v95, v95, v51
    s_waitcnt lgkmcnt(2)
    v_add_f32 v96, v96, v52
    v_add_f32 v97, v97, v53
    v_mfma_f32_32x32x16_bf16 v[64:79], a[124:127], v[156:159], v[64:79]
    v_add_f32 v98, v98, v54
    v_add_f32 v99, v99, v55
    s_waitcnt lgkmcnt(1)
    v_add_f32 v92, v92, v56
    s_waitcnt vmcnt(8)
    v_mfma_f32_32x32x16_bf16 v[32:47], a[128:131], v[160:163], v[32:47]
    buffer_load_dwordx4 v[132:135], v15, s[36:39], s13 offen offset:1024 sc1
    v_add_f32 v93, v93, v57
    v_add_f32 v94, v94, v58
    v_add_f32 v95, v95, v59
    s_waitcnt lgkmcnt(0)
    v_add_f32 v96, v96, v60
    v_mfma_f32_32x32x16_bf16 v[64:79], a[132:135], v[160:163], v[64:79]
    v_add_f32 v97, v97, v61
    v_add_f32 v98, v98, v62
    v_add_f32 v99, v99, v63
    s_waitcnt vmcnt(8)
    v_mfma_f32_32x32x16_bf16 v[32:47], a[136:139], v[164:167], v[32:47]
    buffer_load_dwordx4 v[136:139], v15, s[36:39], s14 offen offset:0 sc1
    v_cvt_pk_bf16_f32 v80, v92, v93
    v_cvt_pk_bf16_f32 v81, v94, v95
    v_cvt_pk_bf16_f32 v82, v96, v97
    v_cvt_pk_bf16_f32 v83, v98, v99
    v_mfma_f32_32x32x16_bf16 v[64:79], a[140:143], v[164:167], v[64:79]
    s_add_u32 s44, s75, 0
    buffer_store_dwordx4 v[80:83], v107, s[36:39], s44 offen
    v_add_f32 v100, v92, v93
    v_mul_f32 v101, v92, v92
    s_waitcnt vmcnt(9)
    v_mfma_f32_32x32x16_bf16 v[32:47], a[144:147], v[168:171], v[32:47]
    buffer_load_dwordx4 v[140:143], v15, s[36:39], s14 offen offset:1024 sc1
    v_fmac_f32 v101, v93, v93
    v_add_f32 v100, v100, v94
    v_fmac_f32 v101, v94, v94
    v_add_f32 v100, v100, v95
    s_waitcnt vmcnt(9)
    v_mfma_f32_32x32x16_bf16 v[32:47], a[152:155], v[172:175], v[32:47]
    v_fmac_f32 v101, v95, v95
    v_add_f32 v100, v100, v96
    v_fmac_f32 v101, v96, v96
    s_waitcnt vmcnt(8)
    v_mfma_f32_32x32x16_bf16 v[32:47], a[160:163], v[112:115], v[32:47]
    v_add_f32 v100, v100, v97
    v_fmac_f32 v101, v97, v97
    v_add_f32 v100, v100, v98
    v_fmac_f32 v101, v98, v98
    s_waitcnt vmcnt(7)
    v_mfma_f32_32x32x16_bf16 v[32:47], a[168:171], v[116:119], v[32:47]
    v_add_f32 v100, v100, v99
    v_fmac_f32 v101, v99, v99
    s_nop 0
    v_add_f32_dpp v100, v100, v100 row_ror:8 row_mask:0xf bank_mask:0xf
    s_waitcnt vmcnt(6)
    v_mfma_f32_32x32x16_bf16 v[32:47], a[176:179], v[120:123], v[32:47]
    s_barrier
    v_add_f32_dpp v101, v101, v101 row_ror:8 row_mask:0xf bank_mask:0xf
    s_nop 1
    v_permlane16_swap_b32 v100, v101
    v_add_f32 v100, v100, v101
    v_mov_b32 v101, v100
    s_waitcnt vmcnt(5)
    v_mfma_f32_32x32x16_bf16 v[32:47], a[184:187], v[124:127], v[32:47]
    v_permlane32_swap_b32 v100, v101
    v_add_f32 v100, v100, v101
    s_add_u32 s43, s76, 0
    s_mov_b64 exec, 0x00ff00ff
    buffer_store_dword v100, v108, s[36:39], s43 offen
    s_mov_b64 exec, -1
    s_waitcnt vmcnt(5)
    v_mfma_f32_32x32x16_bf16 v[32:47], a[192:195], v[128:131], v[32:47]
    v_lshlrev_b32 v92, 16, v84
    v_and_b32 v93, s51, v84
    s_waitcnt vmcnt(4)
    v_mfma_f32_32x32x16_bf16 v[32:47], a[200:203], v[132:135], v[32:47]
    v_lshlrev_b32 v94, 16, v85
    v_and_b32 v95, s51, v85
    s_waitcnt vmcnt(3)
    v_mfma_f32_32x32x16_bf16 v[32:47], a[208:211], v[136:139], v[32:47]
    v_lshlrev_b32 v96, 16, v86
    v_and_b32 v97, s51, v86
    s_waitcnt vmcnt(1)
    v_mfma_f32_32x32x16_bf16 v[32:47], a[216:219], v[140:143], v[32:47]
    v_lshlrev_b32 v98, 16, v87
    v_and_b32 v99, s51, v87
    v_mfma_f32_32x32x16_bf16 v[64:79], a[148:151], v[168:171], v[64:79]
    v_mfma_f32_32x32x16_bf16 v[64:79], a[156:159], v[172:175], v[64:79]
    v_mfma_f32_32x32x16_bf16 v[64:79], a[164:167], v[112:115], v[64:79]
    s_nop 6
    ds_write_b128 v105, v[32:35] offset:16384
    v_mfma_f32_32x32x16_bf16 v[64:79], a[172:175], v[116:119], v[64:79]
    v_mfma_f32_32x32x16_bf16 v[64:79], a[180:183], v[120:123], v[64:79]
    ds_write_b128 v106, v[36:39] offset:17408
    v_mfma_f32_32x32x16_bf16 v[64:79], a[188:191], v[124:127], v[64:79]
    v_mfma_f32_32x32x16_bf16 v[64:79], a[196:199], v[128:131], v[64:79]
    ds_write_b128 v105, v[40:43] offset:18432
    s_add_u32 s43, s77, 0
    s_add_u32 s44, s56, 2
    v_mov_b32 v102, s44
    s_waitcnt vmcnt(0)
    s_mov_b64 exec, 1
    buffer_store_dword v102, v1, s[36:39], s43 offen
    s_mov_b64 exec, -1
    v_mfma_f32_32x32x16_bf16 v[64:79], a[204:207], v[132:135], v[64:79]
    v_mfma_f32_32x32x16_bf16 v[64:79], a[212:215], v[136:139], v[64:79]
    ds_write_b128 v106, v[44:47] offset:19456
    v_mfma_f32_32x32x16_bf16 v[64:79], a[220:223], v[140:143], v[64:79]
    s_nop 11
    ds_write_b128 v105, v[64:67] offset:20480
    ds_write_b128 v106, v[68:71] offset:21504
    ds_write_b128 v105, v[72:75] offset:22528
    ds_write_b128 v106, v[76:79] offset:23552
    s_waitcnt lgkmcnt(0)
    s_barrier
    ds_read_b128 v[32:35], v111 offset:16384
    ds_read_b128 v[36:39], v111 offset:17408
    ds_read_b128 v[40:43], v111 offset:24576
    ds_read_b128 v[44:47], v111 offset:25600
    ds_read_b128 v[64:67], v111 offset:32768
    ds_read_b128 v[68:71], v111 offset:33792
    ds_read_b128 v[72:75], v111 offset:40960
    ds_read_b128 v[76:79], v111 offset:41984
    s_waitcnt lgkmcnt(7)
    v_pk_add_f32 v[92:93], v[92:93], v[32:33]
    v_pk_add_f32 v[94:95], v[94:95], v[34:35]
    s_waitcnt lgkmcnt(6)
    v_pk_add_f32 v[96:97], v[96:97], v[36:37]
    v_pk_add_f32 v[98:99], v[98:99], v[38:39]
    s_waitcnt lgkmcnt(5)
    v_pk_add_f32 v[92:93], v[92:93], v[40:41]
    v_pk_add_f32 v[94:95], v[94:95], v[42:43]
    s_waitcnt lgkmcnt(4)
    v_pk_add_f32 v[96:97], v[96:97], v[44:45]
    v_pk_add_f32 v[98:99], v[98:99], v[46:47]
    s_waitcnt lgkmcnt(3)
    v_pk_add_f32 v[92:93], v[92:93], v[64:65]
    v_pk_add_f32 v[94:95], v[94:95], v[66:67]
    s_waitcnt lgkmcnt(2)
    v_pk_add_f32 v[96:97], v[96:97], v[68:69]
    v_pk_add_f32 v[98:99], v[98:99], v[70:71]
    s_waitcnt lgkmcnt(1)
    v_pk_add_f32 v[92:93], v[92:93], v[72:73]
    v_pk_add_f32 v[94:95], v[94:95], v[74:75]
    s_waitcnt lgkmcnt(0)
    v_pk_add_f32 v[96:97], v[96:97], v[76:77]
    v_pk_add_f32 v[98:99], v[98:99], v[78:79]
    v_cvt_pk_bf16_f32 v80, v92, v93
    v_cvt_pk_bf16_f32 v81, v94, v95
    v_cvt_pk_bf16_f32 v82, v96, v97
    v_cvt_pk_bf16_f32 v83, v98, v99
    s_add_u32 s44, s75, 57344
    buffer_store_dwordx4 v[80:83], v107, s[36:39], s44 offen
    v_add_f32 v100, v92, v93
    v_mul_f32 v101, v92, v92
    v_fmac_f32 v101, v93, v93
    v_add_f32 v100, v100, v94
    v_fmac_f32 v101, v94, v94
    v_add_f32 v100, v100, v95
    v_fmac_f32 v101, v95, v95
    v_add_f32 v100, v100, v96
    v_fmac_f32 v101, v96, v96
    v_add_f32 v100, v100, v97
    v_fmac_f32 v101, v97, v97
    v_add_f32 v100, v100, v98
    v_fmac_f32 v101, v98, v98
    v_add_f32 v100, v100, v99
    v_fmac_f32 v101, v99, v99
    s_nop 0
    v_add_f32_dpp v100, v100, v100 row_ror:8 row_mask:0xf bank_mask:0xf
    v_add_f32_dpp v101, v101, v101 row_ror:8 row_mask:0xf bank_mask:0xf
    s_nop 1
    v_permlane16_swap_b32 v100, v101
    v_add_f32 v100, v100, v101
    v_mov_b32 v101, v100
    s_nop 1
    v_permlane32_swap_b32 v100, v101
    v_add_f32 v100, v100, v101
    s_add_u32 s43, s76, 7168
    s_mov_b64 exec, 0x00ff00ff
    buffer_store_dword v100, v108, s[36:39], s43 offen
    s_mov_b64 exec, -1
    s_add_u32 s43, s77, 128
    s_add_u32 s44, s56, 2
    v_mov_b32 v102, s44
    s_waitcnt vmcnt(0)
    s_mov_b64 exec, 1
    buffer_store_dword v102, v1, s[36:39], s43 offen
    s_mov_b64 exec, -1
L_layer1:
    s_waitcnt lgkmcnt(0)
    v_min_u32 v13, 27, v0
    v_lshlrev_b32 v13, 2, v13
    s_lshl_b32 s40, s64, 7
    s_add_u32 s40, s40, 1433600
    ds_read_b64_tr_b16 v[152:153], v2 offset:0
    ds_read_b64_tr_b16 v[154:155], v2 offset:512
    ds_read_b64_tr_b16 v[156:157], v2 offset:28672
    ds_read_b64_tr_b16 v[158:159], v2 offset:29184
    ds_read_b64_tr_b16 v[160:161], v3 offset:0
    ds_read_b64_tr_b16 v[162:163], v3 offset:512
    s_add_u32 s47, s56, 2
    s_mov_b32 s46, s66
L_poll_24:
    buffer_load_dword v14, v13, s[36:39], s40 offen sc1
    s_waitcnt vmcnt(0)
    v_subrev_u32 v14, s47, v14
    v_cmp_lt_u32 vcc, 3, v14
    s_cbranch_vccz L_polled_23
    s_sub_u32 s46, s46, 1
    s_cmp_lg_u32 s46, 0
    s_cbranch_scc1 L_poll_24
    s_mov_b32 s66, 1
L_polled_23:
    s_add_u32 s4, s68, 0
    buffer_load_dwordx4 v[96:99], v1, s[36:39], s4 offen offset:0 sc1
    buffer_load_dwordx4 v[100:103], v1, s[36:39], s4 offen offset:1024 sc1
    buffer_load_dwordx4 v[104:107], v1, s[36:39], s4 offen offset:2048 sc1
    buffer_load_dwordx4 v[108:111], v1, s[36:39], s4 offen offset:3072 sc1
    s_add_u32 s4, s68, 4096
    buffer_load_dwordx4 v[112:115], v1, s[36:39], s4 offen offset:0 sc1
    buffer_load_dwordx4 v[116:119], v1, s[36:39], s4 offen offset:1024 sc1
    s_waitcnt vmcnt(5) lgkmcnt(4)
    v_mfma_f32_32x32x16_bf16 v[16:31], v[96:99], v[152:155], 0
    ds_read_b64_tr_b16 v[164:165], v2 offset:1024
    ds_read_b64_tr_b16 v[166:167], v2 offset:1536
    buffer_load_dwordx4 v[120:123], v1, s[36:39], s4 offen offset:2048 sc1
    s_waitcnt lgkmcnt(4)
    v_mfma_f32_32x32x16_bf16 v[32:47], v[96:99], v[156:159], 0
    ds_read_b64_tr_b16 v[168:169], v2 offset:29696
    ds_read_b64_tr_b16 v[170:171], v2 offset:30208
    s_waitcnt lgkmcnt(4)
    v_mfma_f32_32x32x16_bf16 v[48:63], v[160:163], v[96:99], 0
    ds_read_b64_tr_b16 v[172:173], v3 offset:1024
    ds_read_b64_tr_b16 v[174:175], v3 offset:1536
    buffer_load_dwordx4 v[124:127], v1, s[36:39], s4 offen offset:3072 sc1
    s_waitcnt vmcnt(6) lgkmcnt(4)
    v_mfma_f32_32x32x16_bf16 v[16:31], v[100:103], v[164:167], v[16:31]
    ds_read_b64_tr_b16 v[152:153], v2 offset:2048
    ds_read_b64_tr_b16 v[154:155], v2 offset:2560
    s_waitcnt lgkmcnt(4)
    v_mfma_f32_32x32x16_bf16 v[32:47], v[100:103], v[168:171], v[32:47]
    ds_read_b64_tr_b16 v[156:157], v2 offset:30720
    ds_read_b64_tr_b16 v[158:159], v2 offset:31232
    s_add_u32 s4, s68, 8192
    buffer_load_dwordx4 v[128:131], v1, s[36:39], s4 offen offset:0 sc1
    s_waitcnt lgkmcnt(4)
    v_mfma_f32_32x32x16_bf16 v[48:63], v[172:175], v[100:103], v[48:63]
    ds_read_b64_tr_b16 v[160:161], v3 offset:2048
    ds_read_b64_tr_b16 v[162:163], v3 offset:2560
    s_waitcnt vmcnt(6) lgkmcnt(4)
    v_mfma_f32_32x32x16_bf16 v[16:31], v[104:107], v[152:155], v[16:31]
    ds_read_b64_tr_b16 v[164:165], v2 offset:3072
    ds_read_b64_tr_b16 v[166:167], v2 offset:3584
    buffer_load_dwordx4 v[132:135], v1, s[36:39], s4 offen offset:1024 sc1
    s_waitcnt lgkmcnt(4)
    v_mfma_f32_32x32x16_bf16 v[32:47], v[104:107], v[156:159], v[32:47]
    ds_read_b64_tr_b16 v[168:169], v2 offset:31744
    ds_read_b64_tr_b16 v[170:171], v2 offset:32256
    s_waitcnt lgkmcnt(4)
    v_mfma_f32_32x32x16_bf16 v[48:63], v[160:163], v[104:107], v[48:63]
    ds_read_b64_tr_b16 v[172:173], v3 offset:3072
    ds_read_b64_tr_b16 v[174:175], v3 offset:3584
    buffer_load_dwordx4 v[136:139], v1, s[36:39], s4 offen offset:2048 sc1
    s_waitcnt vmcnt(7) lgkmcnt(4)
    v_mfma_f32_32x32x16_bf16 v[16:31], v[108:111], v[164:167], v[16:31]
    ds_read_b64_tr_b16 v[152:153], v2 offset:4096
    ds_read_b64_tr_b16 v[154:155], v2 offset:4608
    s_waitcnt lgkmcnt(4)
    v_mfma_f32_32x32x16_bf16 v[32:47], v[108:111], v[168:171], v[32:47]
    ds_read_b64_tr_b16 v[156:157], v2 offset:32768
    ds_read_b64_tr_b16 v[158:159], v2 offset:33280
    buffer_load_dwordx4 v[140:143], v1, s[36:39], s4 offen offset:3072 sc1
    s_waitcnt lgkmcnt(4)
    v_mfma_f32_32x32x16_bf16 v[48:63], v[172:175], v[108:111], v[48:63]
    ds_read_b64_tr_b16 v[160:161], v3 offset:4096
    ds_read_b64_tr_b16 v[162:163], v3 offset:4608
    s_waitcnt vmcnt(7) lgkmcnt(4)
    v_mfma_f32_32x32x16_bf16 v[16:31], v[112:115], v[152:155], v[16:31]
    ds_read_b64_tr_b16 v[164:165], v2 offset:5120
    ds_read_b64_tr_b16 v[166:167], v2 offset:5632
    s_add_u32 s4, s68, 12288
    buffer_load_dwordx4 v[144:147], v1, s[36:39], s4 offen offset:0 sc1
    s_waitcnt lgkmcnt(4)
    v_mfma_f32_32x32x16_bf16 v[32:47], v[112:115], v[156:159], v[32:47]
    ds_read_b64_tr_b16 v[168:169], v2 offset:33792
    ds_read_b64_tr_b16 v[170:171], v2 offset:34304
    s_waitcnt lgkmcnt(4)
    v_mfma_f32_32x32x16_bf16 v[48:63], v[160:163], v[112:115], v[48:63]
    ds_read_b64_tr_b16 v[172:173], v3 offset:5120
    ds_read_b64_tr_b16 v[174:175], v3 offset:5632
    buffer_load_dwordx4 v[148:151], v1, s[36:39], s4 offen offset:1024 sc1
    s_waitcnt vmcnt(8) lgkmcnt(4)
    v_mfma_f32_32x32x16_bf16 v[16:31], v[116:119], v[164:167], v[16:31]
    ds_read_b64_tr_b16 v[152:153], v2 offset:6144
    ds_read_b64_tr_b16 v[154:155], v2 offset:6656
    s_waitcnt lgkmcnt(4)
    v_mfma_f32_32x32x16_bf16 v[32:47], v[116:119], v[168:171], v[32:47]
    ds_read_b64_tr_b16 v[156:157], v2 offset:34816
    ds_read_b64_tr_b16 v[158:159], v2 offset:35328
    buffer_load_dwordx4 v[64:67], v1, s[36:39], s69 offen offset:0 sc1
    s_waitcnt lgkmcnt(4)
    v_mfma_f32_32x32x16_bf16 v[48:63], v[172:175], v[116:119], v[48:63]
    ds_read_b64_tr_b16 v[160:161], v3 offset:6144
    ds_read_b64_tr_b16 v[162:163], v3 offset:6656
    s_waitcnt vmcnt(8) lgkmcnt(4)
    v_mfma_f32_32x32x16_bf16 v[16:31], v[120:123], v[152:155], v[16:31]
    ds_read_b64_tr_b16 v[164:165], v2 offset:7168
    ds_read_b64_tr_b16 v[166:167], v2 offset:7680
    buffer_load_dwordx4 v[68:71], v1, s[36:39], s69 offen offset:1024 sc1
    s_waitcnt lgkmcnt(4)
    v_mfma_f32_32x32x16_bf16 v[32:47], v[120:123], v[156:159], v[32:47]
    ds_read_b64_tr_b16 v[168:169], v2 offset:35840
    ds_read_b64_tr_b16 v[170:171], v2 offset:36352
    s_waitcnt lgkmcnt(4)
    v_mfma_f32_32x32x16_bf16 v[48:63], v[160:163], v[120:123], v[48:63]
    ds_read_b64_tr_b16 v[172:173], v3 offset:7168
    ds_read_b64_tr_b16 v[174:175], v3 offset:7680
    buffer_load_dwordx4 v[96:99], v1, s[36:39], s4 offen offset:2048 sc1
    s_waitcnt vmcnt(9) lgkmcnt(4)
    v_mfma_f32_32x32x16_bf16 v[16:31], v[124:127], v[164:167], v[16:31]
    ds_read_b64_tr_b16 v[152:153], v2 offset:8192
    ds_read_b64_tr_b16 v[154:155], v2 offset:8704
    s_waitcnt lgkmcnt(4)
    v_mfma_f32_32x32x16_bf16 v[32:47], v[124:127], v[168:171], v[32:47]
    ds_read_b64_tr_b16 v[156:157], v2 offset:36864
    ds_read_b64_tr_b16 v[158:159], v2 offset:37376
    buffer_load_dwordx4 v[100:103], v1, s[36:39], s4 offen offset:3072 sc1
    s_waitcnt lgkmcnt(4)
    v_mfma_f32_32x32x16_bf16 v[48:63], v[172:175], v[124:127], v[48:63]
    ds_read_b64_tr_b16 v[160:161], v3 offset:8192
    ds_read_b64_tr_b16 v[162:163], v3 offset:8704
    s_waitcnt vmcnt(9) lgkmcnt(4)
    v_mfma_f32_32x32x16_bf16 v[16:31], v[128:131], v[152:155], v[16:31]
    ds_read_b64_tr_b16 v[164:165], v2 offset:9216
    ds_read_b64_tr_b16 v[166:167], v2 offset:9728
    s_add_u32 s4, s68, 16384
    buffer_load_dwordx4 v[104:107], v1, s[36:39], s4 offen offset:0 sc1
    s_waitcnt lgkmcnt(4)
    v_mfma_f32_32x32x16_bf16 v[32:47], v[128:131], v[156:159], v[32:47]
    ds_read_b64_tr_b16 v[168:169], v2 offset:37888
    ds_read_b64_tr_b16 v[170:171], v2 offset:38400
    s_waitcnt lgkmcnt(4)
    v_mfma_f32_32x32x16_bf16 v[48:63], v[160:163], v[128:131], v[48:63]
    ds_read_b64_tr_b16 v[172:173], v3 offset:9216
    ds_read_b64_tr_b16 v[174:175], v3 offset:9728
    buffer_load_dwordx4 v[108:111], v1, s[36:39], s4 offen offset:1024 sc1
    s_waitcnt vmcnt(10) lgkmcnt(4)
    v_mfma_f32_32x32x16_bf16 v[16:31], v[132:135], v[164:167], v[16:31]
    ds_read_b64_tr_b16 v[152:153], v2 offset:10240
    ds_read_b64_tr_b16 v[154:155], v2 offset:10752
    s_waitcnt lgkmcnt(4)
    v_mfma_f32_32x32x16_bf16 v[32:47], v[132:135], v[168:171], v[32:47]
    ds_read_b64_tr_b16 v[156:157], v2 offset:38912
    ds_read_b64_tr_b16 v[158:159], v2 offset:39424
    buffer_load_dwordx4 v[112:115], v1, s[36:39], s4 offen offset:2048 sc1
    s_waitcnt lgkmcnt(4)
    v_mfma_f32_32x32x16_bf16 v[48:63], v[172:175], v[132:135], v[48:63]
    ds_read_b64_tr_b16 v[160:161], v3 offset:10240
    ds_read_b64_tr_b16 v[162:163], v3 offset:10752
    s_waitcnt vmcnt(10) lgkmcnt(4)
    v_mfma_f32_32x32x16_bf16 v[16:31], v[136:139], v[152:155], v[16:31]
    ds_read_b64_tr_b16 v[164:165], v2 offset:11264
    ds_read_b64_tr_b16 v[166:167], v2 offset:11776
    buffer_load_dwordx4 v[116:119], v1, s[36:39], s4 offen offset:3072 sc1
    s_waitcnt vmcnt(7)
    v_add_f32 v64, v64, v66
    v_add_f32 v65, v65, v67
    s_waitcnt lgkmcnt(4)
    v_mfma_f32_32x32x16_bf16 v[32:47], v[136:139], v[156:159], v[32:47]
    ds_read_b64_tr_b16 v[168:169], v2 offset:39936
    ds_read_b64_tr_b16 v[170:171], v2 offset:40448
    s_waitcnt vmcnt(6)
    v_add_f32 v64, v64, v68
    s_waitcnt lgkmcnt(4)
    v_mfma_f32_32x32x16_bf16 v[48:63], v[160:163], v[136:139], v[48:63]
    ds_read_b64_tr_b16 v[172:173], v3 offset:11264
    ds_read_b64_tr_b16 v[174:175], v3 offset:11776
    s_add_u32 s4, s68, 20480
    buffer_load_dwordx4 v[120:123], v1, s[36:39], s4 offen offset:0 sc1
    v_add_f32 v65, v65, v69
    v_add_f32 v64, v64, v70
    s_waitcnt lgkmcnt(4)
    v_mfma_f32_32x32x16_bf16 v[16:31], v[140:143], v[164:167], v[16:31]
    ds_read_b64_tr_b16 v[152:153], v2 offset:12288
    ds_read_b64_tr_b16 v[154:155], v2 offset:12800
    v_add_f32 v64, v64, v65
    s_waitcnt lgkmcnt(4)
    v_mfma_f32_32x32x16_bf16 v[32:47], v[140:143], v[168:171], v[32:47]
    ds_read_b64_tr_b16 v[156:157], v2 offset:40960
    ds_read_b64_tr_b16 v[158:159], v2 offset:41472
    buffer_load_dwordx4 v[124:127], v1, s[36:39], s4 offen offset:1024 sc1
    v_mov_b32 v65, v64
    s_nop 1
    v_permlane32_swap_b32 v64, v65
    s_waitcnt lgkmcnt(4)
    v_mfma_f32_32x32x16_bf16 v[48:63], v[172:175], v[140:143], v[48:63]
    ds_read_b64_tr_b16 v[160:161], v3 offset:12288
    ds_read_b64_tr_b16 v[162:163], v3 offset:12800
    v_mul_f32 v66, 0x3b124925, v64
    s_waitcnt lgkmcnt(4)
    v_mfma_f32_32x32x16_bf16 v[16:31], v[144:147], v[152:155], v[16:31]
    ds_read_b64_tr_b16 v[164:165], v2 offset:13312
    ds_read_b64_tr_b16 v[166:167], v2 offset:13824
    buffer_load_dwordx4 v[128:131], v1, s[36:39], s4 offen offset:2048 sc1
    v_mul_f32 v67, 0x3b124925, v65
    v_fma_f32 v67, -v66, v66, v67
    s_waitcnt lgkmcnt(4)
    v_mfma_f32_32x32x16_bf16 v[32:47], v[144:147], v[156:159], v[32:47]
    ds_read_b64_tr_b16 v[168:169], v2 offset:41984
    ds_read_b64_tr_b16 v[170:171], v2 offset:42496
    v_max_f32 v67, 0, v67
    s_waitcnt lgkmcnt(4)
    v_mfma_f32_32x32x16_bf16 v[48:63], v[160:163], v[144:147], v[48:63]
    ds_read_b64_tr_b16 v[172:173], v3 offset:13312
    ds_read_b64_tr_b16 v[174:175], v3 offset:13824
    buffer_load_dwordx4 v[132:135], v1, s[36:39], s4 offen offset:3072 sc1
    v_add_f32 v67, 0x3727c5ac, v67
    s_waitcnt lgkmcnt(4)
    v_mfma_f32_32x32x16_bf16 v[16:31], v[148:151], v[164:167], v[16:31]
    ds_read_b64_tr_b16 v[152:153], v2 offset:14336
    ds_read_b64_tr_b16 v[154:155], v2 offset:14848
    v_rsq_f32 v88, v67
    v_cvt_pk_bf16_f32 v92, -v66, -v66
    s_waitcnt lgkmcnt(4)
    v_mfma_f32_32x32x16_bf16 v[32:47], v[148:151], v[168:171], v[32:47]
    ds_read_b64_tr_b16 v[156:157], v2 offset:43008
    ds_read_b64_tr_b16 v[158:159], v2 offset:43520
    s_add_u32 s4, s68, 24576
    buffer_load_dwordx4 v[136:139], v1, s[36:39], s4 offen offset:0 sc1
    v_and_b32 v65, s51, v92
    s_waitcnt lgkmcnt(4)
    v_mfma_f32_32x32x16_bf16 v[48:63], v[172:175], v[148:151], v[48:63]
    v_sub_f32_e64 v65, -v66, v65
    v_and_b32 v93, 0xffff, v92
    s_waitcnt vmcnt(10) lgkmcnt(2)
    v_mfma_f32_32x32x16_bf16 v[16:31], v[96:99], v[152:155], v[16:31]
    ds_read_b64_tr_b16 v[164:165], v2 offset:15360
    ds_read_b64_tr_b16 v[166:167], v2 offset:15872
    buffer_load_dwordx4 v[140:143], v1, s[36:39], s4 offen offset:1024 sc1
    v_cvt_pk_bf16_f32 v65, v65, v65
    s_waitcnt lgkmcnt(2)
    v_mfma_f32_32x32x16_bf16 v[32:47], v[96:99], v[156:159], v[32:47]
    ds_read_b64_tr_b16 v[168:169], v2 offset:44032
    ds_read_b64_tr_b16 v[170:171], v2 offset:44544
    v_and_or_b32 v92, v65, s51, v93
    v_mov_b32 v94, 0
    s_waitcnt vmcnt(10) lgkmcnt(2)
    v_mfma_f32_32x32x16_bf16 v[16:31], v[100:103], v[164:167], v[16:31]
    ds_read_b64_tr_b16 v[152:153], v2 offset:16384
    ds_read_b64_tr_b16 v[154:155], v2 offset:16896
    buffer_load_dwordx4 v[144:147], v1, s[36:39], s4 offen offset:2048 sc1
    v_mov_b32 v95, 0
    s_waitcnt lgkmcnt(2)
    v_mfma_f32_32x32x16_bf16 v[32:47], v[100:103], v[168:171], v[32:47]
    ds_read_b64_tr_b16 v[156:157], v2 offset:45056
    ds_read_b64_tr_b16 v[158:159], v2 offset:45568
    v_cvt_pk_bf16_f32 v80, v88, v88
    s_waitcnt vmcnt(10) lgkmcnt(2)
    v_mfma_f32_32x32x16_bf16 v[16:31], v[104:107], v[152:155], v[16:31]
    ds_read_b64_tr_b16 v[164:165], v2 offset:17408
    ds_read_b64_tr_b16 v[166:167], v2 offset:17920
    buffer_load_dwordx4 v[148:151], v1, s[36:39], s4 offen offset:3072 sc1
    v_and_b32 v64, s51, v80
    v_sub_f32 v64, v88, v64
    s_waitcnt lgkmcnt(2)
    v_mfma_f32_32x32x16_bf16 v[32:47], v[104:107], v[156:159], v[32:47]
    ds_read_b64_tr_b16 v[168:169], v2 offset:46080
    ds_read_b64_tr_b16 v[170:171], v2 offset:46592
    v_cvt_pk_bf16_f32 v81, v64, v64
    s_waitcnt vmcnt(10) lgkmcnt(2)
    v_mfma_f32_32x32x16_bf16 v[16:31], v[108:111], v[164:167], v[16:31]
    ds_read_b64_tr_b16 v[152:153], v2 offset:18432
    ds_read_b64_tr_b16 v[154:155], v2 offset:18944
    v_and_b32 v65, s51, v81
    v_sub_f32 v65, v64, v65
    s_waitcnt lgkmcnt(2)
    v_mfma_f32_32x32x16_bf16 v[32:47], v[108:111], v[168:171], v[32:47]
    ds_read_b64_tr_b16 v[156:157], v2 offset:47104
    ds_read_b64_tr_b16 v[158:159], v2 offset:47616
    v_and_b32 v80, 0xffff, v80
    s_waitcnt vmcnt(9) lgkmcnt(2)
    v_mfma_f32_32x32x16_bf16 v[16:31], v[112:115], v[152:155], v[16:31]
    ds_read_b64_tr_b16 v[164:165], v2 offset:19456
    ds_read_b64_tr_b16 v[166:167], v2 offset:19968
    v_and_or_b32 v80, v81, s51, v80
    v_cvt_pk_bf16_f32 v81, v65, 0
    s_waitcnt lgkmcnt(2)
    v_mfma_f32_32x32x16_bf16 v[32:47], v[112:115], v[156:159], v[32:47]
    ds_read_b64_tr_b16 v[168:169], v2 offset:48128
    ds_read_b64_tr_b16 v[170:171], v2 offset:48640
    v_mov_b32 v82, 0
    s_waitcnt vmcnt(8) lgkmcnt(2)
    v_mfma_f32_32x32x16_bf16 v[16:31], v[116:119], v[164:167], v[16:31]
    ds_read_b64_tr_b16 v[152:153], v2 offset:20480
    ds_read_b64_tr_b16 v[154:155], v2 offset:20992
    v_mov_b32 v83, 0
    v_mov_b32 v84, s48
    s_waitcnt lgkmcnt(2)
    v_mfma_f32_32x32x16_bf16 v[32:47], v[116:119], v[168:171], v[32:47]
    ds_read_b64_tr_b16 v[156:157], v2 offset:49152
    ds_read_b64_tr_b16 v[158:159], v2 offset:49664
    v_cndmask_b32 v84, v84, 0, s[54:55]
    s_waitcnt vmcnt(7) lgkmcnt(2)
    v_mfma_f32_32x32x16_bf16 v[16:31], v[120:123], v[152:155], v[16:31]
    ds_read_b64_tr_b16 v[164:165], v2 offset:21504
    ds_read_b64_tr_b16 v[166:167], v2 offset:22016
    v_mov_b32 v85, v84
    s_waitcnt lgkmcnt(2)
    v_mfma_f32_32x32x16_bf16 v[32:47], v[120:123], v[156:159], v[32:47]
    ds_read_b64_tr_b16 v[168:169], v2 offset:50176
    ds_read_b64_tr_b16 v[170:171], v2 offset:50688
    v_mov_b32 v86, 0
    v_mov_b32 v87, 0
    s_waitcnt vmcnt(6) lgkmcnt(2)
    v_mfma_f32_32x32x16_bf16 v[16:31], v[124:127], v[164:167], v[16:31]
    ds_read_b64_tr_b16 v[152:153], v2 offset:22528
    ds_read_b64_tr_b16 v[154:155], v2 offset:23040
    v_mfma_f32_32x32x16_bf16 v[64:79], v[80:83], v[84:87], 0
    s_waitcnt lgkmcnt(2)
    v_mfma_f32_32x32x16_bf16 v[32:47], v[124:127], v[168:171], v[32:47]
    ds_read_b64_tr_b16 v[156:157], v2 offset:51200
    ds_read_b64_tr_b16 v[158:159], v2 offset:51712
    s_lshl_b32 s40, s60, 10
    v_add_u32 v89, s40, v12
    s_waitcnt vmcnt(5) lgkmcnt(2)
    v_mfma_f32_32x32x16_bf16 v[16:31], v[128:131], v[152:155], v[16:31]
    ds_read_b64_tr_b16 v[164:165], v2 offset:23552
    ds_read_b64_tr_b16 v[166:167], v2 offset:24064
    s_lshl_b32 s40, s60, 12
    s_waitcnt lgkmcnt(2)
    v_mfma_f32_32x32x16_bf16 v[32:47], v[128:131], v[156:159], v[32:47]
    ds_read_b64_tr_b16 v[168:169], v2 offset:52224
    ds_read_b64_tr_b16 v[170:171], v2 offset:52736
    v_add_u32 v90, s40, v12
    v_lshlrev_b32 v91, 3, v0
    s_waitcnt vmcnt(4) lgkmcnt(2)
    v_mfma_f32_32x32x16_bf16 v[16:31], v[132:135], v[164:167], v[16:31]
    ds_read_b64_tr_b16 v[152:153], v2 offset:24576
    ds_read_b64_tr_b16 v[154:155], v2 offset:25088
    s_lshl_b32 s40, s58, 15
    s_waitcnt lgkmcnt(2)
    v_mfma_f32_32x32x16_bf16 v[32:47], v[132:135], v[168:171], v[32:47]
    ds_read_b64_tr_b16 v[156:157], v2 offset:53248
    ds_read_b64_tr_b16 v[158:159], v2 offset:53760
    s_lshl_b32 s41, s60, 9
    s_waitcnt vmcnt(3) lgkmcnt(2)
    v_mfma_f32_32x32x16_bf16 v[16:31], v[136:139], v[152:155], v[16:31]
    ds_read_b64_tr_b16 v[164:165], v2 offset:25600
    ds_read_b64_tr_b16 v[166:167], v2 offset:26112
    s_add_u32 s40, s40, s41
    s_add_u32 s6, s40, 1048576
    s_waitcnt lgkmcnt(2)
    v_mfma_f32_32x32x16_bf16 v[32:47], v[136:139], v[156:159], v[32:47]
    ds_read_b64_tr_b16 v[168:169], v2 offset:54272
    ds_read_b64_tr_b16 v[170:171], v2 offset:54784
    s_lshl_b32 s41, s57, 1
    s_waitcnt vmcnt(2) lgkmcnt(2)
    v_mfma_f32_32x32x16_bf16 v[16:31], v[140:143], v[164:167], v[16:31]
    ds_read_b64_tr_b16 v[152:153], v2 offset:26624
    ds_read_b64_tr_b16 v[154:155], v2 offset:27136
    s_add_u32 s41, s41, s59
    s_lshl_b32 s41, s41, 11
    s_waitcnt lgkmcnt(2)
    v_mfma_f32_32x32x16_bf16 v[32:47], v[140:143], v[168:171], v[32:47]
    ds_read_b64_tr_b16 v[156:157], v2 offset:55296
    ds_read_b64_tr_b16 v[158:159], v2 offset:55808
    s_add_u32 s7, s41, s6
    s_waitcnt vmcnt(1) lgkmcnt(2)
    v_mfma_f32_32x32x16_bf16 v[16:31], v[144:147], v[152:155], v[16:31]
    ds_read_b64_tr_b16 v[164:165], v2 offset:27648
    ds_read_b64_tr_b16 v[166:167], v2 offset:28160
    v_mov_b32 v80, v8
    v_mov_b32 v81, v9
    s_waitcnt lgkmcnt(2)
    v_mfma_f32_32x32x16_bf16 v[32:47], v[144:147], v[156:159], v[32:47]
    ds_read_b64_tr_b16 v[168:169], v2 offset:56320
    ds_read_b64_tr_b16 v[170:171], v2 offset:56832
    v_mov_b32 v84, v10
    s_waitcnt vmcnt(0) lgkmcnt(2)
    v_mfma_f32_32x32x16_bf16 v[16:31], v[148:151], v[164:167], v[16:31]
    v_mov_b32 v85, v11
    s_waitcnt lgkmcnt(0)
    v_mfma_f32_32x32x16_bf16 v[32:47], v[148:151], v[168:171], v[32:47]
    v_mfma_f32_32x32x16_bf16 v[16:31], v[92:95], v[80:83], v[16:31]
    v_mfma_f32_32x32x16_bf16 v[32:47], v[92:95], v[84:87], v[32:47]
    ds_read_b64_tr_b16 v[160:161], v3 offset:14336
    ds_read_b64_tr_b16 v[162:163], v3 offset:14848
    ds_read_b64_tr_b16 v[164:165], v3 offset:15360
    ds_read_b64_tr_b16 v[166:167], v3 offset:15872
    ds_read_b64_tr_b16 v[152:153], v3 offset:16384
    ds_read_b64_tr_b16 v[154:155], v3 offset:16896
    v_mov_b32 v172, s50
    v_mov_b32 v173, s49
    v_mov_b32 v80, v6
    v_mov_b32 v81, v7
    s_nop 0
    v_pk_fma_f32 v[16:17], v[16:17], v[64:65], v[172:173] op_sel_hi:[1,1,0]
    v_pk_mul_f32 v[168:169], v[16:17], v[172:173] op_sel:[0,1] op_sel_hi:[1,1]
    v_exp_f32 v168, v168 clamp
    v_exp_f32 v169, v169 clamp
    v_max_f32 v16, s50, v16
    v_max_f32 v17, s50, v17
    v_pk_add_f32 v[16:17], v[16:17], v[168:169]
    v_cvt_pk_bf16_f32 v16, v16, v17
    v_pk_fma_f32 v[18:19], v[18:19], v[66:67], v[172:173] op_sel_hi:[1,1,0]
    v_pk_mul_f32 v[170:171], v[18:19], v[172:173] op_sel:[0,1] op_sel_hi:[1,1]
    v_exp_f32 v170, v170 clamp
    v_exp_f32 v171, v171 clamp
    v_max_f32 v18, s50, v18
    v_max_f32 v19, s50, v19
    v_pk_add_f32 v[18:19], v[18:19], v[170:171]
    v_cvt_pk_bf16_f32 v17, v18, v19
    v_pk_fma_f32 v[20:21], v[20:21], v[68:69], v[172:173] op_sel_hi:[1,1,0]
    v_pk_mul_f32 v[168:169], v[20:21], v[172:173] op_sel:[0,1] op_sel_hi:[1,1]
    v_exp_f32 v168, v168 clamp
    v_exp_f32 v169, v169 clamp
    v_max_f32 v20, s50, v20
    v_max_f32 v21, s50, v21
    v_pk_add_f32 v[20:21], v[20:21], v[168:169]
    v_cvt_pk_bf16_f32 v18, v20, v21
    v_pk_fma_f32 v[22:23], v[22:23], v[70:71], v[172:173] op_sel_hi:[1,1,0]
    v_pk_mul_f32 v[170:171], v[22:23], v[172:173] op_sel:[0,1] op_sel_hi:[1,1]
    v_exp_f32 v170, v170 clamp
    v_exp_f32 v171, v171 clamp
    v_max_f32 v22, s50, v22
    v_max_f32 v23, s50, v23
    v_pk_add_f32 v[22:23], v[22:23], v[170:171]
    v_cvt_pk_bf16_f32 v19, v22, v23
    v_pk_fma_f32 v[24:25], v[24:25], v[72:73], v[172:173] op_sel_hi:[1,1,0]
    v_pk_mul_f32 v[168:169], v[24:25], v[172:173] op_sel:[0,1] op_sel_hi:[1,1]
    v_exp_f32 v168, v168 clamp
    v_exp_f32 v169, v169 clamp
    v_max_f32 v24, s50, v24
    v_max_f32 v25, s50, v25
    v_pk_add_f32 v[24:25], v[24:25], v[168:169]
    v_cvt_pk_bf16_f32 v20, v24, v25
    v_pk_fma_f32 v[26:27], v[26:27], v[74:75], v[172:173] op_sel_hi:[1,1,0]
    v_pk_mul_f32 v[170:171], v[26:27], v[172:173] op_sel:[0,1] op_sel_hi:[1,1]
    v_exp_f32 v170, v170 clamp
    v_exp_f32 v171, v171 clamp
    v_max_f32 v26, s50, v26
    v_max_f32 v27, s50, v27
    v_pk_add_f32 v[26:27], v[26:27], v[170:171]
    v_cvt_pk_bf16_f32 v21, v26, v27
    v_pk_fma_f32 v[28:29], v[28:29], v[76:77], v[172:173] op_sel_hi:[1,1,0]
    v_pk_mul_f32 v[168:169], v[28:29], v[172:173] op_sel:[0,1] op_sel_hi:[1,1]
    v_exp_f32 v168, v168 clamp
    v_exp_f32 v169, v169 clamp
    v_max_f32 v28, s50, v28
    v_max_f32 v29, s50, v29
    v_pk_add_f32 v[28:29], v[28:29], v[168:169]
    v_cvt_pk_bf16_f32 v22, v28, v29
    v_pk_fma_f32 v[30:31], v[30:31], v[78:79], v[172:173] op_sel_hi:[1,1,0]
    v_pk_mul_f32 v[170:171], v[30:31], v[172:173] op_sel:[0,1] op_sel_hi:[1,1]
    v_exp_f32 v170, v170 clamp
    v_exp_f32 v171, v171 clamp
    v_max_f32 v30, s50, v30
    v_max_f32 v31, s50, v31
    v_pk_add_f32 v[30:31], v[30:31], v[170:171]
    v_cvt_pk_bf16_f32 v23, v30, v31
    v_pk_mul_f32 v[32:33], v[32:33], v[64:65]
    v_pk_mul_f32 v[34:35], v[34:35], v[66:67]
    v_pk_mul_f32 v[36:37], v[36:37], v[68:69]
    v_pk_mul_f32 v[38:39], v[38:39], v[70:71]
    v_pk_mul_f32 v[40:41], v[40:41], v[72:73]
    v_pk_mul_f32 v[42:43], v[42:43], v[74:75]
    v_pk_mul_f32 v[44:45], v[44:45], v[76:77]
    v_pk_mul_f32 v[46:47], v[46:47], v[78:79]
    v_cvt_pk_bf16_f32 v32, v32, v33
    v_cvt_pk_bf16_f32 v33, v34, v35
    v_cvt_pk_bf16_f32 v34, v36, v37
    v_cvt_pk_bf16_f32 v35, v38, v39
    v_cvt_pk_bf16_f32 v36, v40, v41
    v_cvt_pk_bf16_f32 v37, v42, v43
    v_cvt_pk_bf16_f32 v38, v44, v45
    v_cvt_pk_bf16_f32 v39, v46, v47
    s_mov_b64 exec, s[52:53]
    v_mov_b32 v32, s48
    v_mov_b32 v33, s48
    v_mov_b32 v34, s48
    v_mov_b32 v35, s48
    v_mov_b32 v36, s48
    v_mov_b32 v37, s48
    v_mov_b32 v38, s48
    v_mov_b32 v39, s48
    s_mov_b64 exec, -1
    v_mfma_f32_32x32x16_bf16 v[64:79], v[16:19], v[32:35], 0
    v_mfma_f32_32x32x16_bf16 v[64:79], v[20:23], v[36:39], v[64:79]
    s_nop 11
    ds_write_b128 v89, v[64:67] offset:0
    ds_write_b128 v89, v[68:71] offset:4096
    ds_write_b128 v89, v[72:75] offset:8192
    ds_write_b128 v89, v[76:79] offset:12288
    s_waitcnt lgkmcnt(0)
    s_barrier
    ds_read_b128 v[32:35], v90 offset:0
    ds_read_b128 v[36:39], v90 offset:1024
    ds_read_b128 v[40:43], v90 offset:2048
    ds_read_b128 v[44:47], v90 offset:3072
    s_waitcnt lgkmcnt(2)
    v_pk_add_f32 v[32:33], v[32:33], v[36:37]
    v_pk_add_f32 v[34:35], v[34:35], v[38:39]
    s_waitcnt lgkmcnt(0)
    v_pk_add_f32 v[40:41], v[40:41], v[44:45]
    v_pk_add_f32 v[42:43], v[42:43], v[46:47]
    v_pk_add_f32 v[32:33], v[32:33], v[40:41]
    v_pk_add_f32 v[34:35], v[34:35], v[42:43]
    v_cvt_pk_bf16_f32 v28, v32, v33
    v_cvt_pk_bf16_f32 v29, v34, v35
    buffer_store_dwordx2 v[28:29], v91, s[32:35], s7 offen sc1
    v_mfma_f32_32x32x16_bf16 v[48:63], v[160:163], v[96:99], v[48:63]
    ds_read_b64_tr_b16 v[156:157], v3 offset:17408
    ds_read_b64_tr_b16 v[158:159], v3 offset:17920
    v_mfma_f32_32x32x16_bf16 v[48:63], v[164:167], v[100:103], v[48:63]
    ds_read_b64_tr_b16 v[160:161], v3 offset:18432
    ds_read_b64_tr_b16 v[162:163], v3 offset:18944
    v_mfma_f32_32x32x16_bf16 v[48:63], v[152:155], v[104:107], v[48:63]
    ds_read_b64_tr_b16 v[164:165], v3 offset:19456
    ds_read_b64_tr_b16 v[166:167], v3 offset:19968
    s_waitcnt lgkmcnt(4)
    v_mfma_f32_32x32x16_bf16 v[48:63], v[156:159], v[108:111], v[48:63]
    ds_read_b64_tr_b16 v[152:153], v3 offset:20480
    ds_read_b64_tr_b16 v[154:155], v3 offset:20992
    s_waitcnt lgkmcnt(4)
    v_mfma_f32_32x32x16_bf16 v[48:63], v[160:163], v[112:115], v[48:63]
    ds_read_b64_tr_b16 v[156:157], v3 offset:21504
    ds_read_b64_tr_b16 v[158:159], v3 offset:22016
    s_waitcnt lgkmcnt(4)
    v_mfma_f32_32x32x16_bf16 v[48:63], v[164:167], v[116:119], v[48:63]
    ds_read_b64_tr_b16 v[160:161], v3 offset:22528
    ds_read_b64_tr_b16 v[162:163], v3 offset:23040
    s_waitcnt lgkmcnt(4)
    v_mfma_f32_32x32x16_bf16 v[48:63], v[152:155], v[120:123], v[48:63]
    ds_read_b64_tr_b16 v[164:165], v3 offset:23552
    ds_read_b64_tr_b16 v[166:167], v3 offset:24064
    s_waitcnt lgkmcnt(4)
    v_mfma_f32_32x32x16_bf16 v[48:63], v[156:159], v[124:127], v[48:63]
    ds_read_b64_tr_b16 v[152:153], v3 offset:24576
    ds_read_b64_tr_b16 v[154:155], v3 offset:25088
    s_waitcnt lgkmcnt(4)
    v_mfma_f32_32x32x16_bf16 v[48:63], v[160:163], v[128:131], v[48:63]
    ds_read_b64_tr_b16 v[156:157], v3 offset:25600
    ds_read_b64_tr_b16 v[158:159], v3 offset:26112
    s_waitcnt lgkmcnt(4)
    v_mfma_f32_32x32x16_bf16 v[48:63], v[164:167], v[132:135], v[48:63]
    ds_read_b64_tr_b16 v[160:161], v3 offset:26624
    ds_read_b64_tr_b16 v[162:163], v3 offset:27136
    s_waitcnt lgkmcnt(4)
    v_mfma_f32_32x32x16_bf16 v[48:63], v[152:155], v[136:139], v[48:63]
    ds_read_b64_tr_b16 v[164:165], v3 offset:27648
    ds_read_b64_tr_b16 v[166:167], v3 offset:28160
    s_waitcnt lgkmcnt(4)
    v_mfma_f32_32x32x16_bf16 v[48:63], v[156:159], v[140:143], v[48:63]
    s_waitcnt lgkmcnt(2)
    v_mfma_f32_32x32x16_bf16 v[48:63], v[160:163], v[144:147], v[48:63]
    s_waitcnt lgkmcnt(0)
    v_mfma_f32_32x32x16_bf16 v[48:63], v[164:167], v[148:151], v[48:63]
    v_mfma_f32_32x32x16_bf16 v[48:63], v[80:83], v[92:95], v[48:63]
    s_nop 11
    v_pk_fma_f32 v[48:49], v[48:49], v[88:89], v[172:173] op_sel_hi:[1,0,0]
    v_pk_mul_f32 v[168:169], v[48:49], v[172:173] op_sel:[0,1] op_sel_hi:[1,1]
    v_exp_f32 v168, v168 clamp
    v_exp_f32 v169, v169 clamp
    v_max_f32 v48, s50, v48
    v_max_f32 v49, s50, v49
    v_pk_add_f32 v[48:49], v[48:49], v[168:169]
    v_cvt_pk_bf16_f32 v48, v48, v49
    v_pk_fma_f32 v[50:51], v[50:51], v[88:89], v[172:173] op_sel_hi:[1,0,0]
    v_pk_mul_f32 v[170:171], v[50:51], v[172:173] op_sel:[0,1] op_sel_hi:[1,1]
    v_exp_f32 v170, v170 clamp
    v_exp_f32 v171, v171 clamp
    v_max_f32 v50, s50, v50
    v_max_f32 v51, s50, v51
    v_pk_add_f32 v[50:51], v[50:51], v[170:171]
    v_cvt_pk_bf16_f32 v49, v50, v51
    v_pk_fma_f32 v[52:53], v[52:53], v[88:89], v[172:173] op_sel_hi:[1,0,0]
    v_pk_mul_f32 v[168:169], v[52:53], v[172:173] op_sel:[0,1] op_sel_hi:[1,1]
    v_exp_f32 v168, v168 clamp
    v_exp_f32 v169, v169 clamp
    v_max_f32 v52, s50, v52
    v_max_f32 v53, s50, v53
    v_pk_add_f32 v[52:53], v[52:53], v[168:169]
    v_cvt_pk_bf16_f32 v50, v52, v53
    v_pk_fma_f32 v[54:55], v[54:55], v[88:89], v[172:173] op_sel_hi:[1,0,0]
    v_pk_mul_f32 v[170:171], v[54:55], v[172:173] op_sel:[0,1] op_sel_hi:[1,1]
    v_exp_f32 v170, v170 clamp
    v_exp_f32 v171, v171 clamp
    v_max_f32 v54, s50, v54
    v_max_f32 v55, s50, v55
    v_pk_add_f32 v[54:55], v[54:55], v[170:171]
    v_cvt_pk_bf16_f32 v51, v54, v55
    v_pk_fma_f32 v[56:57], v[56:57], v[88:89], v[172:173] op_sel_hi:[1,0,0]
    v_pk_mul_f32 v[168:169], v[56:57], v[172:173] op_sel:[0,1] op_sel_hi:[1,1]
    v_exp_f32 v168, v168 clamp
    v_exp_f32 v169, v169 clamp
    v_max_f32 v56, s50, v56
    v_max_f32 v57, s50, v57
    v_pk_add_f32 v[56:57], v[56:57], v[168:169]
    v_cvt_pk_bf16_f32 v52, v56, v57
    v_pk_fma_f32 v[58:59], v[58:59], v[88:89], v[172:173] op_sel_hi:[1,0,0]
    v_pk_mul_f32 v[170:171], v[58:59], v[172:173] op_sel:[0,1] op_sel_hi:[1,1]
    v_exp_f32 v170, v170 clamp
    v_exp_f32 v171, v171 clamp
    v_max_f32 v58, s50, v58
    v_max_f32 v59, s50, v59
    v_pk_add_f32 v[58:59], v[58:59], v[170:171]
    v_cvt_pk_bf16_f32 v53, v58, v59
    v_pk_fma_f32 v[60:61], v[60:61], v[88:89], v[172:173] op_sel_hi:[1,0,0]
    v_pk_mul_f32 v[168:169], v[60:61], v[172:173] op_sel:[0,1] op_sel_hi:[1,1]
    v_exp_f32 v168, v168 clamp
    v_exp_f32 v169, v169 clamp
    v_max_f32 v60, s50, v60
    v_max_f32 v61, s50, v61
    v_pk_add_f32 v[60:61], v[60:61], v[168:169]
    v_cvt_pk_bf16_f32 v54, v60, v61
    v_pk_fma_f32 v[62:63], v[62:63], v[88:89], v[172:173] op_sel_hi:[1,0,0]
    v_pk_mul_f32 v[170:171], v[62:63], v[172:173] op_sel:[0,1] op_sel_hi:[1,1]
    v_exp_f32 v170, v170 clamp
    v_exp_f32 v171, v171 clamp
    v_max_f32 v62, s50, v62
    v_max_f32 v63, s50, v63
    v_pk_add_f32 v[62:63], v[62:63], v[170:171]
    v_cvt_pk_bf16_f32 v55, v62, v63
    v_cndmask_b32 v54, v54, 0, s[54:55]
    v_cndmask_b32 v55, v55, 0, s[54:55]
    s_mul_i32 s40, s58, 7
    v_lshrrev_b32 v16, 5, v0
    v_add_u32 v16, s40, v16
    v_and_b32 v17, 31, v0
    v_lshlrev_b32 v17, 4, v17
    v_and_b32 v18, 1, v16
    v_lshl_add_u32 v17, v18, 9, v17
    v_lshrrev_b32 v16, 1, v16
    v_add_u32 v18, 0, v16
    v_and_b32 v19, 1, v18
    v_lshrrev_b32 v18, 1, v18
    v_lshl_add_u32 v18, v18, 10, v17
    v_lshl_add_u32 v56, v19, 3, v18
    v_add_u32 v18, 1, v16
    v_and_b32 v19, 1, v18
    v_lshrrev_b32 v18, 1, v18
    v_lshl_add_u32 v18, v18, 10, v17
    v_lshl_add_u32 v57, v19, 3, v18
    v_add_u32 v18, 2, v16
    v_and_b32 v19, 1, v18
    v_lshrrev_b32 v18, 1, v18
    v_lshl_add_u32 v18, v18, 10, v17
    v_lshl_add_u32 v58, v19, 3, v18
    v_add_u32 v18, 3, v16
    v_and_b32 v19, 1, v18
    v_lshrrev_b32 v18, 1, v18
    v_lshl_add_u32 v18, v18, 10, v17
    v_lshl_add_u32 v59, v19, 3, v18
    s_lshr_b32 s40, s60, 1
    s_lshl_b32 s40, s40, 10
    s_and_b32 s41, s60, 1
    s_lshl_b32 s41, s41, 3
    s_add_u32 s40, s40, s41
    v_add_u32 v60, s40, v12
    s_lshl_b32 s40, s64, 7
    s_lshl_b32 s41, s58, 2
    s_add_u32 s40, s40, s41
    s_add_u32 s3, s40, 1434624
    s_add_u32 s45, s57, 0
    s_and_b32 s45, s45, 7
    s_lshl_b32 s45, s45, 12
    s_add_u32 s45, s45, s6
    buffer_load_dwordx2 v[96:97], v91, s[32:35], s45 offen sc1
    buffer_load_dwordx2 v[98:99], v91, s[32:35], s45 offen offset:2048 sc1
    s_add_u32 s45, s57, 1
    s_and_b32 s45, s45, 7
    s_lshl_b32 s45, s45, 12
    s_add_u32 s45, s45, s6
    buffer_load_dwordx2 v[100:101], v91, s[32:35], s45 offen sc1
    buffer_load_dwordx2 v[102:103], v91, s[32:35], s45 offen offset:2048 sc1
    s_add_u32 s45, s57, 2
    s_and_b32 s45, s45, 7
    s_lshl_b32 s45, s45, 12
    s_add_u32 s45, s45, s6
    buffer_load_dwordx2 v[104:105], v91, s[32:35], s45 offen sc1
    buffer_load_dwordx2 v[106:107], v91, s[32:35], s45 offen offset:2048 sc1
    s_add_u32 s45, s57, 3
    s_and_b32 s45, s45, 7
    s_lshl_b32 s45, s45, 12
    s_add_u32 s45, s45, s6
    buffer_load_dwordx2 v[108:109], v91, s[32:35], s45 offen sc1
    buffer_load_dwordx2 v[110:111], v91, s[32:35], s45 offen offset:2048 sc1
    s_add_u32 s45, s57, 4
    s_and_b32 s45, s45, 7
    s_lshl_b32 s45, s45, 12
    s_add_u32 s45, s45, s6
    buffer_load_dwordx2 v[112:113], v91, s[32:35], s45 offen sc1
    buffer_load_dwordx2 v[114:115], v91, s[32:35], s45 offen offset:2048 sc1
    s_add_u32 s45, s57, 5
    s_and_b32 s45, s45, 7
    s_lshl_b32 s45, s45, 12
    s_add_u32 s45, s45, s6
    buffer_load_dwordx2 v[116:117], v91, s[32:35], s45 offen sc1
    buffer_load_dwordx2 v[118:119], v91, s[32:35], s45 offen offset:2048 sc1
    s_add_u32 s45, s57, 6
    s_and_b32 s45, s45, 7
    s_lshl_b32 s45, s45, 12
    s_add_u32 s45, s45, s6
    buffer_load_dwordx2 v[120:121], v91, s[32:35], s45 offen sc1
    buffer_load_dwordx2 v[122:123], v91, s[32:35], s45 offen offset:2048 sc1
    s_add_u32 s45, s57, 7
    s_and_b32 s45, s45, 7
    s_lshl_b32 s45, s45, 12
    s_add_u32 s45, s45, s6
    buffer_load_dwordx2 v[124:125], v91, s[32:35], s45 offen sc1
    buffer_load_dwordx2 v[126:127], v91, s[32:35], s45 offen offset:2048 sc1
    s_mov_b32 s43, 0x3f80
    s_mov_b32 s44, 0x3f800000
    v_mov_b32 v16, 0
    v_mov_b32 v17, 0
    v_mov_b32 v18, 0
    v_mov_b32 v19, 0
    v_mov_b32 v20, 0
    s_waitcnt vmcnt(15)
    v_dot2c_f32_bf16 v16, s43, v96
    v_dot2c_f32_bf16 v17, s44, v96
    v_dot2c_f32_bf16 v18, s43, v97
    v_dot2c_f32_bf16 v19, s44, v97
    v_max3_u32 v20, v20, v96, v97
    s_waitcnt vmcnt(14)
    v_dot2c_f32_bf16 v16, s43, v98
    v_dot2c_f32_bf16 v17, s44, v98
    v_dot2c_f32_bf16 v18, s43, v99
    v_dot2c_f32_bf16 v19, s44, v99
    v_max3_u32 v20, v20, v98, v99
    s_waitcnt vmcnt(13)
    v_dot2c_f32_bf16 v16, s43, v100
    v_dot2c_f32_bf16 v17, s44, v100
    v_dot2c_f32_bf16 v18, s43, v101
    v_dot2c_f32_bf16 v19, s44, v101
    v_max3_u32 v20, v20, v100, v101
    s_waitcnt vmcnt(12)
    v_dot2c_f32_bf16 v16, s43, v102
    v_dot2c_f32_bf16 v17, s44, v102
    v_dot2c_f32_bf16 v18, s43, v103
    v_dot2c_f32_bf16 v19, s44, v103
    v_max3_u32 v20, v20, v102, v103
    s_waitcnt vmcnt(11)
    v_dot2c_f32_bf16 v16, s43, v104
    v_dot2c_f32_bf16 v17, s44, v104
    v_dot2c_f32_bf16 v18, s43, v105
    v_dot2c_f32_bf16 v19, s44, v105
    v_max3_u32 v20, v20, v104, v105
    s_waitcnt vmcnt(10)
    v_dot2c_f32_bf16 v16, s43, v106
    v_dot2c_f32_bf16 v17, s44, v106
    v_dot2c_f32_bf16 v18, s43, v107
    v_dot2c_f32_bf16 v19, s44, v107
    v_max3_u32 v20, v20, v106, v107
    s_waitcnt vmcnt(9)
    v_dot2c_f32_bf16 v16, s43, v108
    v_dot2c_f32_bf16 v17, s44, v108
    v_dot2c_f32_bf16 v18, s43, v109
    v_dot2c_f32_bf16 v19, s44, v109
    v_max3_u32 v20, v20, v108, v109
    s_waitcnt vmcnt(8)
    v_dot2c_f32_bf16 v16, s43, v110
    v_dot2c_f32_bf16 v17, s44, v110
    v_dot2c_f32_bf16 v18, s43, v111
    v_dot2c_f32_bf16 v19, s44, v111
    v_max3_u32 v20, v20, v110, v111
    s_waitcnt vmcnt(7)
    v_dot2c_f32_bf16 v16, s43, v112
    v_dot2c_f32_bf16 v17, s44, v112
    v_dot2c_f32_bf16 v18, s43, v113
    v_dot2c_f32_bf16 v19, s44, v113
    v_max3_u32 v20, v20, v112, v113
    s_waitcnt vmcnt(6)
    v_dot2c_f32_bf16 v16, s43, v114
    v_dot2c_f32_bf16 v17, s44, v114
    v_dot2c_f32_bf16 v18, s43, v115
    v_dot2c_f32_bf16 v19, s44, v115
    v_max3_u32 v20, v20, v114, v115
    s_waitcnt vmcnt(5)
    v_dot2c_f32_bf16 v16, s43, v116
    v_dot2c_f32_bf16 v17, s44, v116
    v_dot2c_f32_bf16 v18, s43, v117
    v_dot2c_f32_bf16 v19, s44, v117
    v_max3_u32 v20, v20, v116, v117
    s_waitcnt vmcnt(4)
    v_dot2c_f32_bf16 v16, s43, v118
    v_dot2c_f32_bf16 v17, s44, v118
    v_dot2c_f32_bf16 v18, s43, v119
    v_dot2c_f32_bf16 v19, s44, v119
    v_max3_u32 v20, v20, v118, v119
    s_waitcnt vmcnt(3)
    v_dot2c_f32_bf16 v16, s43, v120
    v_dot2c_f32_bf16 v17, s44, v120
    v_dot2c_f32_bf16 v18, s43, v121
    v_dot2c_f32_bf16 v19, s44, v121
    v_max3_u32 v20, v20, v120, v121
    s_waitcnt vmcnt(2)
    v_dot2c_f32_bf16 v16, s43, v122
    v_dot2c_f32_bf16 v17, s44, v122
    v_dot2c_f32_bf16 v18, s43, v123
    v_dot2c_f32_bf16 v19, s44, v123
    v_max3_u32 v20, v20, v122, v123
    s_waitcnt vmcnt(1)
    v_dot2c_f32_bf16 v16, s43, v124
    v_dot2c_f32_bf16 v17, s44, v124
    v_dot2c_f32_bf16 v18, s43, v125
    v_dot2c_f32_bf16 v19, s44, v125
    v_max3_u32 v20, v20, v124, v125
    s_waitcnt vmcnt(0)
    v_dot2c_f32_bf16 v16, s43, v126
    v_dot2c_f32_bf16 v17, s44, v126
    v_dot2c_f32_bf16 v18, s43, v127
    v_dot2c_f32_bf16 v19, s44, v127
    v_max3_u32 v20, v20, v126, v127
    v_cmp_eq_u32 vcc, -1, v20
    s_cbranch_vccnz L_kvspin_25
L_kvback_26:
    v_cvt_pk_bf16_f32 v20, v16, v17
    v_cvt_pk_bf16_f32 v21, v18, v19
    ds_write_b64 v60, v[20:21] offset:16384
    s_waitcnt lgkmcnt(0)
    s_barrier
    ds_read_b128 v[24:27], v12 offset:16384
    ds_read_b128 v[28:31], v12 offset:17408
    s_waitcnt lgkmcnt(1)
    v_mfma_f32_32x32x16_bf16 v[32:47], v[24:27], v[48:51], 0
    s_waitcnt lgkmcnt(0)
    v_mfma_f32_32x32x16_bf16 v[32:47], v[28:31], v[52:55], v[32:47]
    s_nop 11
    v_mov_b32 v16, v44
    v_mov_b32 v17, v44
    s_nop 1
    v_permlane32_swap_b32 v16, v17
    v_add_f32 v16, s50, v17
    v_rcp_f32 v16, v16
    s_nop 0
    v_pk_mul_f32 v[32:33], v[32:33], v[16:17] op_sel_hi:[1,0]
    v_pk_mul_f32 v[34:35], v[34:35], v[16:17] op_sel_hi:[1,0]
    v_pk_mul_f32 v[36:37], v[36:37], v[16:17] op_sel_hi:[1,0]
    v_pk_mul_f32 v[38:39], v[38:39], v[16:17] op_sel_hi:[1,0]
    v_pk_mul_f32 v[40:41], v[40:41], v[16:17] op_sel_hi:[1,0]
    v_pk_mul_f32 v[42:43], v[42:43], v[16:17] op_sel_hi:[1,0]
    v_pk_mul_f32 v[44:45], v[44:45], v[16:17] op_sel_hi:[1,0]
    v_pk_mul_f32 v[46:47], v[46:47], v[16:17] op_sel_hi:[1,0]
    v_cvt_pk_bf16_f32 v20, v32, v33
    v_cvt_pk_bf16_f32 v21, v34, v35
    v_cvt_pk_bf16_f32 v22, v36, v37
    v_cvt_pk_bf16_f32 v23, v38, v39
    v_cvt_pk_bf16_f32 v24, v40, v41
    v_cvt_pk_bf16_f32 v25, v42, v43
    v_cvt_pk_bf16_f32 v26, v44, v45
    v_cvt_pk_bf16_f32 v27, v46, v47
    buffer_store_dwordx2 v[20:21], v56, s[36:39], s67 offen
    buffer_store_dwordx2 v[22:23], v57, s[36:39], s67 offen
    buffer_store_dwordx2 v[24:25], v58, s[36:39], s67 offen
    s_mov_b32 exec_hi, 0
    buffer_store_dwordx2 v[26:27], v59, s[36:39], s67 offen
    s_mov_b64 exec, -1
    s_add_u32 s45, s56, 2
    v_mov_b32 v14, s45
    s_waitcnt vmcnt(0)
    s_mov_b64 exec, 1
    buffer_store_dword v14, v1, s[36:39], s3 offen
    s_mov_b64 exec, -1
    s_cmp_ge_u32 s58, 14
    s_cbranch_scc1 L_spare1
    s_lshl_b32 s5, s58, 11
    s_add_u32 s5, s5, s68
    buffer_load_dwordx4 v[104:107], v1, s[36:39], s5 offen sc1
    buffer_load_dwordx4 v[108:111], v1, s[36:39], s5 offen offset:1024 sc1
    s_lshr_b32 s41, s58, 2
    s_lshl_b32 s41, s41, 10
    s_and_b32 s42, s58, 3
    s_lshl_b32 s42, s42, 2
    s_add_u32 s41, s41, s42
    s_add_u32 s6, s41, s69
    s_lshl_b32 s40, s64, 7
    s_lshl_b32 s41, s58, 3
    s_add_u32 s41, s40, s41
    s_add_u32 s7, s41, 1433600
    s_add_u32 s40, s40, 1434624
    v_and_b32 v13, 15, v0
    v_lshlrev_b32 v13, 2, v13
    ds_read_b64_tr_b16 v[48:49], v3 offset:28672
    ds_read_b64_tr_b16 v[50:51], v3 offset:29184
    ds_read_b64_tr_b16 v[52:53], v3 offset:29696
    ds_read_b64_tr_b16 v[54:55], v3 offset:30208
    s_add_u32 s47, s56, 2
    s_mov_b32 s46, s66
L_poll_29:
    buffer_load_dword v14, v13, s[36:39], s40 offen sc1
    s_waitcnt vmcnt(0)
    v_subrev_u32 v14, s47, v14
    v_cmp_lt_u32 vcc, 3, v14
    s_cbranch_vccz L_polled_28
    s_sub_u32 s46, s46, 1
    s_cmp_lg_u32 s46, 0
    s_cbranch_scc1 L_poll_29
    s_mov_b32 s66, 1
L_polled_28:
    s_add_u32 s4, s67, 0
    buffer_load_dwordx4 v[64:67], v1, s[36:39], s4 offen offset:0 sc1
    v_lshlrev_b32 v16, 16, v104
    v_and_b32 v17, s51, v104
    buffer_load_dwordx4 v[68:71], v1, s[36:39], s4 offen offset:1024 sc1
    v_lshlrev_b32 v18, 16, v105
    v_and_b32 v19, s51, v105
    buffer_load_dwordx4 v[72:75], v1, s[36:39], s4 offen offset:2048 sc1
    v_lshlrev_b32 v20, 16, v106
    v_and_b32 v21, s51, v106
    buffer_load_dwordx4 v[76:79], v1, s[36:39], s4 offen offset:3072 sc1
    v_lshlrev_b32 v22, 16, v107
    v_and_b32 v23, s51, v107
    s_add_u32 s4, s67, 4096
    buffer_load_dwordx4 v[80:83], v1, s[36:39], s4 offen offset:0 sc1
    v_lshlrev_b32 v24, 16, v108
    v_and_b32 v25, s51, v108
    buffer_load_dwordx4 v[84:87], v1, s[36:39], s4 offen offset:1024 sc1
    v_lshlrev_b32 v26, 16, v109
    v_and_b32 v27, s51, v109
    buffer_load_dwordx4 v[88:91], v1, s[36:39], s4 offen offset:2048 sc1
    v_lshlrev_b32 v28, 16, v110
    v_and_b32 v29, s51, v110
    buffer_load_dwordx4 v[92:95], v1, s[36:39], s4 offen offset:3072 sc1
    v_lshlrev_b32 v30, 16, v111
    v_and_b32 v31, s51, v111
    s_waitcnt vmcnt(7) lgkmcnt(2)
    s_nop 0
    v_mfma_f32_32x32x16_bf16 v[16:31], v[48:51], v[64:67], v[16:31]
    s_add_u32 s4, s67, 8192
    buffer_load_dwordx4 v[96:99], v1, s[36:39], s4 offen offset:0 sc1
    ds_read_b64_tr_b16 v[56:57], v3 offset:30720
    ds_read_b64_tr_b16 v[58:59], v3 offset:31232
    s_waitcnt vmcnt(7) lgkmcnt(2)
    v_mfma_f32_32x32x16_bf16 v[16:31], v[52:55], v[68:71], v[16:31]
    buffer_load_dwordx4 v[100:103], v1, s[36:39], s4 offen offset:1024 sc1
    ds_read_b64_tr_b16 v[48:49], v3 offset:31744
    ds_read_b64_tr_b16 v[50:51], v3 offset:32256
    s_waitcnt vmcnt(7) lgkmcnt(2)
    v_mfma_f32_32x32x16_bf16 v[16:31], v[56:59], v[72:75], v[16:31]
    buffer_load_dwordx4 v[104:107], v1, s[36:39], s4 offen offset:2048 sc1
    ds_read_b64_tr_b16 v[52:53], v3 offset:32768
    ds_read_b64_tr_b16 v[54:55], v3 offset:33280
    s_waitcnt vmcnt(7) lgkmcnt(2)
    v_mfma_f32_32x32x16_bf16 v[16:31], v[48:51], v[76:79], v[16:31]
    buffer_load_dwordx4 v[108:111], v1, s[36:39], s4 offen offset:3072 sc1
    ds_read_b64_tr_b16 v[56:57], v3 offset:33792
    ds_read_b64_tr_b16 v[58:59], v3 offset:34304
    s_waitcnt vmcnt(7) lgkmcnt(2)
    v_mfma_f32_32x32x16_bf16 v[16:31], v[52:55], v[80:83], v[16:31]
    s_add_u32 s4, s67, 12288
    buffer_load_dwordx4 v[112:115], v1, s[36:39], s4 offen offset:0 sc1
    ds_read_b64_tr_b16 v[48:49], v3 offset:34816
    ds_read_b64_tr_b16 v[50:51], v3 offset:35328
    s_waitcnt vmcnt(7) lgkmcnt(2)
    v_mfma_f32_32x32x16_bf16 v[16:31], v[56:59], v[84:87], v[16:31]
    buffer_load_dwordx4 v[116:119], v1, s[36:39], s4 offen offset:1024 sc1
    ds_read_b64_tr_b16 v[52:53], v3 offset:35840
    ds_read_b64_tr_b16 v[54:55], v3 offset:36352
    s_waitcnt vmcnt(7) lgkmcnt(2)
    v_mfma_f32_32x32x16_bf16 v[16:31], v[48:51], v[88:91], v[16:31]
    buffer_load_dwordx4 v[120:123], v1, s[36:39], s4 offen offset:2048 sc1
    ds_read_b64_tr_b16 v[56:57], v3 offset:36864
    ds_read_b64_tr_b16 v[58:59], v3 offset:37376
    s_waitcnt vmcnt(7) lgkmcnt(2)
    v_mfma_f32_32x32x16_bf16 v[16:31], v[52:55], v[92:95], v[16:31]
    buffer_load_dwordx4 v[124:127], v1, s[36:39], s4 offen offset:3072 sc1
    ds_read_b64_tr_b16 v[48:49], v3 offset:37888
    ds_read_b64_tr_b16 v[50:51], v3 offset:38400
    s_waitcnt vmcnt(7) lgkmcnt(2)
    v_mfma_f32_32x32x16_bf16 v[16:31], v[56:59], v[96:99], v[16:31]
    s_add_u32 s4, s67, 16384
    buffer_load_dwordx4 v[128:131], v1, s[36:39], s4 offen offset:0 sc1
    ds_read_b64_tr_b16 v[52:53], v3 offset:38912
    ds_read_b64_tr_b16 v[54:55], v3 offset:39424
    s_waitcnt vmcnt(7) lgkmcnt(2)
    v_mfma_f32_32x32x16_bf16 v[16:31], v[48:51], v[100:103], v[16:31]
    buffer_load_dwordx4 v[132:135], v1, s[36:39], s4 offen offset:1024 sc1
    ds_read_b64_tr_b16 v[56:57], v3 offset:39936
    ds_read_b64_tr_b16 v[58:59], v3 offset:40448
    s_waitcnt vmcnt(7) lgkmcnt(2)
    v_mfma_f32_32x32x16_bf16 v[16:31], v[52:55], v[104:107], v[16:31]
    buffer_load_dwordx4 v[136:139], v1, s[36:39], s4 offen offset:2048 sc1
    ds_read_b64_tr_b16 v[48:49], v3 offset:40960
    ds_read_b64_tr_b16 v[50:51], v3 offset:41472
    s_waitcnt vmcnt(7) lgkmcnt(2)
    v_mfma_f32_32x32x16_bf16 v[16:31], v[56:59], v[108:111], v[16:31]
    buffer_load_dwordx4 v[140:143], v1, s[36:39], s4 offen offset:3072 sc1
    ds_read_b64_tr_b16 v[52:53], v3 offset:41984
    ds_read_b64_tr_b16 v[54:55], v3 offset:42496
    s_waitcnt vmcnt(7) lgkmcnt(2)
    v_mfma_f32_32x32x16_bf16 v[16:31], v[48:51], v[112:115], v[16:31]
    s_add_u32 s4, s67, 20480
    buffer_load_dwordx4 v[144:147], v1, s[36:39], s4 offen offset:0 sc1
    ds_read_b64_tr_b16 v[56:57], v3 offset:43008
    ds_read_b64_tr_b16 v[58:59], v3 offset:43520
    s_waitcnt vmcnt(7) lgkmcnt(2)
    v_mfma_f32_32x32x16_bf16 v[16:31], v[52:55], v[116:119], v[16:31]
    buffer_load_dwordx4 v[148:151], v1, s[36:39], s4 offen offset:1024 sc1
    ds_read_b64_tr_b16 v[48:49], v3 offset:44032
    ds_read_b64_tr_b16 v[50:51], v3 offset:44544
    v_and_b32 v13, 15, v0
    v_min_u32 v13, 13, v13
    v_lshlrev_b32 v13, 3, v13
    v_lshrrev_b32 v14, 4, v0
    v_lshl_add_u32 v107, v14, 7, v13
    s_mul_i32 s40, s59, 114688
    s_add_u32 s40, s40, 1146880
    s_waitcnt vmcnt(7) lgkmcnt(2)
    v_mfma_f32_32x32x16_bf16 v[16:31], v[56:59], v[120:123], v[16:31]
    buffer_load_dwordx4 v[152:155], v1, s[36:39], s4 offen offset:2048 sc1
    ds_read_b64_tr_b16 v[52:53], v3 offset:45056
    ds_read_b64_tr_b16 v[54:55], v3 offset:45568
    s_and_b32 s0, s58, 1
    s_mul_i32 s16, s0, 28672
    s_add_u32 s40, s40, s16
    s_lshl_b32 s16, s16, 1
    v_add_u32 v110, s40, v1
    s_lshl_b32 s15, s60, 10
    s_add_u32 s15, s15, 0
    s_waitcnt vmcnt(7) lgkmcnt(2)
    v_mfma_f32_32x32x16_bf16 v[16:31], v[48:51], v[124:127], v[16:31]
    buffer_load_dwordx4 v[156:159], v1, s[36:39], s4 offen offset:3072 sc1
    ds_read_b64_tr_b16 v[56:57], v3 offset:46080
    ds_read_b64_tr_b16 v[58:59], v3 offset:46592
    s_lshl_b32 s40, s58, 13
    s_lshl_b32 s41, s60, 11
    s_add_u32 s3, s40, s41
    s_mul_i32 s40, s59, 458752
    s_add_u32 s3, s3, s40
    s_lshl_b32 s40, s59, 10
    s_waitcnt vmcnt(7) lgkmcnt(2)
    v_mfma_f32_32x32x16_bf16 v[16:31], v[52:55], v[128:131], v[16:31]
    s_add_u32 s4, s67, 24576
    buffer_load_dwordx4 v[160:163], v1, s[36:39], s4 offen offset:0 sc1
    ds_read_b64_tr_b16 v[48:49], v3 offset:47104
    ds_read_b64_tr_b16 v[50:51], v3 offset:47616
    s_lshl_b32 s41, s60, 6
    s_add_u32 s40, s40, s41
    s_lshl_b32 s41, s58, 2
    s_add_u32 s40, s40, s41
    s_add_u32 s2, s40, 1435648
    s_mul_i32 s40, s0, 229376
    s_sub_u32 s17, s3, s40
    s_waitcnt vmcnt(7) lgkmcnt(2)
    v_mfma_f32_32x32x16_bf16 v[16:31], v[56:59], v[132:135], v[16:31]
    buffer_load_dwordx4 v[164:167], v1, s[36:39], s4 offen offset:1024 sc1
    ds_read_b64_tr_b16 v[52:53], v3 offset:48128
    ds_read_b64_tr_b16 v[54:55], v3 offset:48640
    s_add_u32 s3, s3, s40
    s_lshl_b32 s40, s0, 9
    s_sub_u32 s1, s2, s40
    s_add_u32 s2, s2, s40
    v_mov_b32 v84, v4
    v_mov_b32 v85, v5
    s_waitcnt vmcnt(7) lgkmcnt(2)
    v_mfma_f32_32x32x16_bf16 v[16:31], v[48:51], v[136:139], v[16:31]
    buffer_load_dwordx4 v[168:171], v1, s[36:39], s4 offen offset:2048 sc1
    ds_read_b64_tr_b16 v[56:57], v3 offset:49152
    ds_read_b64_tr_b16 v[58:59], v3 offset:49664
    v_mov_b32 v86, 0
    v_mov_b32 v87, 0
    v_mov_b32 v90, 0
    v_mov_b32 v91, 0
    v_and_b32 v108, 31, v0
    v_lshlrev_b32 v108, 4, v108
    v_add_u32 v108, 159744, v108
    s_waitcnt vmcnt(7) lgkmcnt(2)
    v_mfma_f32_32x32x16_bf16 v[16:31], v[52:55], v[140:143], v[16:31]
    buffer_load_dwordx4 v[172:175], v1, s[36:39], s4 offen offset:3072 sc1
    ds_read_b64_tr_b16 v[48:49], v3 offset:50176
    ds_read_b64_tr_b16 v[50:51], v3 offset:50688
    s_and_b32 s40, s65, 3
    s_lshl_b32 s40, s40, 9
    s_lshl_b32 s41, s0, 9
    s_xor_b32 s40, s40, s41
    v_add_u32 v109, s40, v108
    s_mul_i32 s73, s62, 229376
    s_waitcnt vmcnt(7) lgkmcnt(2)
    v_mfma_f32_32x32x16_bf16 v[16:31], v[56:59], v[144:147], v[16:31]
    ds_read_b64_tr_b16 v[52:53], v3 offset:51200
    ds_read_b64_tr_b16 v[54:55], v3 offset:51712
    s_lshl_b32 s43, s60, 11
    s_add_u32 s73, s73, s43
    s_lshl_b32 s74, s62, 9
    s_lshl_b32 s43, s60, 6
    s_add_u32 s74, s74, s43
    s_add_u32 s74, s74, 1435648
    v_min_u32 v104, 6, v0
    s_waitcnt vmcnt(6) lgkmcnt(2)
    v_mfma_f32_32x32x16_bf16 v[16:31], v[48:51], v[148:151], v[16:31]
    ds_read_b64_tr_b16 v[56:57], v3 offset:52224
    ds_read_b64_tr_b16 v[58:59], v3 offset:52736
    v_lshlrev_b32 v104, 3, v104
    s_and_b32 s43, s62, 1
    s_lshl_b32 s44, s43, 2
    s_add_u32 s74, s74, s44
    s_lshl_b32 s44, s43, 13
    s_sub_u32 s78, s73, s44
    s_add_u32 s78, s78, 8192
    s_waitcnt vmcnt(5) lgkmcnt(2)
    v_mfma_f32_32x32x16_bf16 v[16:31], v[52:55], v[152:155], v[16:31]
    ds_read_b64_tr_b16 v[48:49], v3 offset:53248
    ds_read_b64_tr_b16 v[50:51], v3 offset:53760
    s_add_u32 s73, s73, s44
    s_lshr_b32 s43, s62, 1
    s_lshl_b32 s43, s43, 2
    s_and_b32 s44, s62, 1
    s_add_u32 s43, s43, s44
    s_mul_i32 s75, s43, 28672
    s_waitcnt vmcnt(4) lgkmcnt(2)
    v_mfma_f32_32x32x16_bf16 v[16:31], v[56:59], v[156:159], v[16:31]
    ds_read_b64_tr_b16 v[52:53], v3 offset:54272
    ds_read_b64_tr_b16 v[54:55], v3 offset:54784
    s_lshl_b32 s43, s63, 12
    s_lshl_b32 s44, s60, 7
    s_add_u32 s43, s43, s44
    s_add_u32 s75, s75, s43
    s_add_u32 s75, s75, 1146880
    s_lshl_b32 s43, s57, 2
    s_add_u32 s43, s43, s62
    s_waitcnt vmcnt(3) lgkmcnt(2)
    v_mfma_f32_32x32x16_bf16 v[16:31], v[48:51], v[160:163], v[16:31]
    ds_read_b64_tr_b16 v[56:57], v3 offset:55296
    ds_read_b64_tr_b16 v[58:59], v3 offset:55808
    s_lshl_b32 s43, s43, 3
    s_add_u32 s43, s43, s60
    s_mul_i32 s43, s43, 7168
    s_lshl_b32 s44, s63, 7
    s_add_u32 s77, s43, s44
    s_lshl_b32 s43, s60, 13
    s_waitcnt vmcnt(2) lgkmcnt(2)
    v_mfma_f32_32x32x16_bf16 v[16:31], v[52:55], v[164:167], v[16:31]
    ds_read_b64_tr_b16 v[48:49], v3 offset:56320
    ds_read_b64_tr_b16 v[50:51], v3 offset:56832
    v_add_u32 v105, s43, v12
    v_xor_b32 v106, 0x80, v105
    v_and_b32 v13, 7, v0
    v_lshlrev_b32 v13, 4, v13
    s_lshl_b32 s43, s60, 7
    v_add_u32 v13, s43, v13
    v_bfe_u32 v14, v0, 3, 1
    s_waitcnt vmcnt(1) lgkmcnt(2)
    v_mfma_f32_32x32x16_bf16 v[16:31], v[56:59], v[168:171], v[16:31]
    v_lshlrev_b32 v15, 7, v14
    v_xor_b32 v13, v13, v15
    v_lshl_add_u32 v13, v14, 10, v13
    v_lshrrev_b32 v14, 4, v0
    v_lshl_add_u32 v13, v14, 11, v13
    v_add_u32 v111, 114688, v13
    s_waitcnt vmcnt(0) lgkmcnt(0)
    v_mfma_f32_32x32x16_bf16 v[16:31], v[48:51], v[172:175], v[16:31]
    s_nop 11
    v_cvt_pk_bf16_f32 v32, v16, v17
    v_cvt_pk_bf16_f32 v33, v18, v19
    v_cvt_pk_bf16_f32 v34, v20, v21
    v_cvt_pk_bf16_f32 v35, v22, v23
    v_cvt_pk_bf16_f32 v36, v24, v25
    v_cvt_pk_bf16_f32 v37, v26, v27
    v_cvt_pk_bf16_f32 v38, v28, v29
    v_cvt_pk_bf16_f32 v39, v30, v31
    buffer_store_dwordx4 v[32:35], v1, s[36:39], s5 offen
    buffer_store_dwordx4 v[36:39], v1, s[36:39], s5 offen offset:1024
    v_pk_mul_f32 v[42:43], v[16:17], v[16:17]
    v_pk_fma_f32 v[42:43], v[18:19], v[18:19], v[42:43]
    v_pk_add_f32 v[16:17], v[16:17], v[18:19]
    v_pk_fma_f32 v[42:43], v[20:21], v[20:21], v[42:43]
    v_pk_add_f32 v[16:17], v[16:17], v[20:21]
    v_pk_fma_f32 v[42:43], v[22:23], v[22:23], v[42:43]
    v_pk_add_f32 v[16:17], v[16:17], v[22:23]
    v_pk_fma_f32 v[42:43], v[24:25], v[24:25], v[42:43]
    v_pk_add_f32 v[16:17], v[16:17], v[24:25]
    v_pk_fma_f32 v[42:43], v[26:27], v[26:27], v[42:43]
    v_pk_add_f32 v[16:17], v[16:17], v[26:27]
    v_pk_fma_f32 v[42:43], v[28:29], v[28:29], v[42:43]
    v_pk_add_f32 v[16:17], v[16:17], v[28:29]
    v_pk_fma_f32 v[42:43], v[30:31], v[30:31], v[42:43]
    v_pk_add_f32 v[16:17], v[16:17], v[30:31]
    v_add_f32 v40, v16, v17
    v_add_f32 v42, v42, v43
    s_nop 1
    v_permlane32_swap_b32 v40, v42
    v_add_f32 v40, v40, v42
    buffer_store_dword v40, v1, s[36:39], s6 offen
    s_add_u32 s45, s56, 3
    v_mov_b32 v14, s45
    v_mov_b32 v15, s45
    s_waitcnt vmcnt(0)
    s_mov_b64 exec, 1
    buffer_store_dwordx2 v[14:15], v1, s[36:39], s7 offen
    s_mov_b64 exec, -1
    v_add_u32 v3, 57344, v1
    s_barrier
    s_lshl_b32 s40, s59, 9
    s_add_u32 s40, s40, 1433600
    s_add_u32 s47, s56, 3
    s_mov_b32 s46, s66
L_poll_31:
    buffer_load_dwordx2 v[14:15], v107, s[36:39], s40 offen sc1
    s_waitcnt vmcnt(0)
    v_subrev_u32 v14, s47, v14
    v_subrev_u32 v15, s47, v15
    v_or_b32 v14, v14, v15
    v_cmp_lt_u32 vcc, 3, v14
    s_cbranch_vccz L_polled_30
    s_sub_u32 s46, s46, 1
    s_cmp_lg_u32 s46, 0
    s_cbranch_scc1 L_poll_31
    s_mov_b32 s66, 1
L_polled_30:
    s_mov_b32 m0, s15
    s_nop 0
    buffer_load_dwordx4 v110, s[36:39], m0 offen sc1 lds
    s_add_u32 m0, m0, 4096
    s_nop 0
    buffer_load_dwordx4 v110, s[36:39], m0 offen sc1 lds
    s_add_u32 m0, m0, 4096
    s_nop 0
    buffer_load_dwordx4 v110, s[36:39], m0 offen sc1 lds
    s_add_u32 m0, m0, 4096
    s_nop 0
    buffer_load_dwordx4 v110, s[36:39], m0 offen sc1 lds
    s_add_u32 m0, m0, 4096
    s_nop 0
    buffer_load_dwordx4 v110, s[36:39], m0 offen sc1 lds
    s_add_u32 m0, m0, 4096
    s_nop 0
    buffer_load_dwordx4 v110, s[36:39], m0 offen sc1 lds
    s_waitcnt vmcnt(4)
    s_barrier
    ds_read_b128 v[48:51], v1 offset:0
    ds_read_b128 v[52:55], v1 offset:1024
    ds_read_b128 v[56:59], v1 offset:2048
    ds_read_b128 v[60:63], v1 offset:3072
    s_waitcnt lgkmcnt(2)
    v_mfma_f32_32x32x16_bf16 v[16:31], a[224:227], v[48:51], 0
    ds_read_b128 v[64:67], v1 offset:4096
    s_add_u32 m0, m0, 4096
    s_nop 0
    buffer_load_dwordx4 v110, s[36:39], m0 offen sc1 lds
    v_mfma_f32_32x32x16_bf16 v[16:31], a[228:231], v[52:55], v[16:31]
    ds_read_b128 v[48:51], v1 offset:5120
    buffer_load_dwordx4 v[112:115], v1, s[36:39], s69 offen offset:0 sc1
    s_waitcnt lgkmcnt(2)
    v_mfma_f32_32x32x16_bf16 v[16:31], a[232:235], v[56:59], v[16:31]
    ds_read_b128 v[52:55], v1 offset:6144
    s_add_u32 m0, m0, 4096
    v_subrev_u32 v110, s16, v110
    buffer_load_dwordx4 v110, s[36:39], m0 offen sc1 lds
    v_mfma_f32_32x32x16_bf16 v[16:31], a[236:239], v[60:63], v[16:31]
    ds_read_b128 v[56:59], v1 offset:7168
    buffer_load_dwordx4 v[116:119], v1, s[36:39], s69 offen offset:1024 sc1
    s_waitcnt lgkmcnt(2)
    v_mfma_f32_32x32x16_bf16 v[16:31], a[240:243], v[64:67], v[16:31]
    s_waitcnt vmcnt(6)
    s_barrier
    ds_read_b128 v[60:63], v1 offset:8192
    v_mfma_f32_32x32x16_bf16 v[16:31], a[244:247], v[48:51], v[16:31]
    ds_read_b128 v[64:67], v1 offset:9216
    s_waitcnt lgkmcnt(2)
    v_mfma_f32_32x32x16_bf16 v[16:31], a[248:251], v[52:55], v[16:31]
    ds_read_b128 v[48:51], v1 offset:10240
    buffer_load_dwordx4 v[120:123], v1, s[36:39], s69 offen offset:2048 sc1
    v_mfma_f32_32x32x16_bf16 v[16:31], a[252:255], v[56:59], v[16:31]
    ds_read_b128 v[52:55], v1 offset:11264
    buffer_load_dwordx4 v[124:127], v1, s[36:39], s69 offen offset:3072 sc1
    s_waitcnt lgkmcnt(2)
    v_mfma_f32_32x32x16_bf16 v[16:31], v[176:179], v[60:63], v[16:31]
    ds_read_b128 v[56:59], v1 offset:12288
    v_mfma_f32_32x32x16_bf16 v[16:31], v[180:183], v[64:67], v[16:31]
    s_add_u32 m0, m0, 4096
    ds_read_b128 v[60:63], v1 offset:13312
    buffer_load_dwordx4 v110, s[36:39], m0 offen sc1 lds
    s_waitcnt lgkmcnt(2)
    v_mfma_f32_32x32x16_bf16 v[16:31], v[184:187], v[48:51], v[16:31]
    ds_read_b128 v[64:67], v1 offset:14336
    v_mfma_f32_32x32x16_bf16 v[16:31], v[188:191], v[52:55], v[16:31]
    s_add_u32 m0, m0, 4096
    ds_read_b128 v[48:51], v1 offset:15360
    buffer_load_dwordx4 v110, s[36:39], m0 offen sc1 lds
    s_waitcnt vmcnt(6)
    v_add_f32 v112, v112, v114
    v_add_f32 v113, v113, v115
    s_waitcnt vmcnt(4)
    v_add_f32 v112, v112, v116
    v_add_f32 v113, v113, v117
    s_waitcnt lgkmcnt(2)
    v_mfma_f32_32x32x16_bf16 v[16:31], v[192:195], v[56:59], v[16:31]
    s_barrier
    ds_read_b128 v[52:55], v1 offset:16384
    v_add_f32 v112, v112, v118
    v_add_f32 v113, v113, v119
    s_waitcnt vmcnt(3)
    v_add_f32 v112, v112, v120
    v_mfma_f32_32x32x16_bf16 v[16:31], v[196:199], v[60:63], v[16:31]
    s_add_u32 m0, m0, 4096
    ds_read_b128 v[56:59], v1 offset:17408
    buffer_load_dwordx4 v110, s[36:39], m0 offen sc1 lds
    v_add_f32 v113, v113, v121
    v_add_f32 v112, v112, v122
    v_add_f32 v113, v113, v123
    s_waitcnt vmcnt(3)
    v_add_f32 v112, v112, v124
    s_waitcnt lgkmcnt(2)
    v_mfma_f32_32x32x16_bf16 v[16:31], v[200:203], v[64:67], v[16:31]
    ds_read_b128 v[60:63], v1 offset:18432
    v_add_f32 v113, v113, v125
    v_add_f32 v112, v112, v113
    v_mov_b32 v113, v112
    s_nop 1
    v_permlane32_swap_b32 v112, v113
    v_mul_f32 v114, 0x3b124925, v112
    v_mul_f32 v115, 0x3b124925, v113
    v_mfma_f32_32x32x16_bf16 v[16:31], v[204:207], v[48:51], v[16:31]
    s_add_u32 m0, m0, 4096
    ds_read_b128 v[64:67], v1 offset:19456
    buffer_load_dwordx4 v110, s[36:39], m0 offen sc1 lds
    v_fma_f32 v115, -v114, v114, v115
    v_max_f32 v115, 0, v115
    v_add_f32 v115, 0x3727c5ac, v115
    v_cvt_pk_bf16_f32 v116, -v114, -v114
    s_waitcnt lgkmcnt(2)
    v_mfma_f32_32x32x16_bf16 v[16:31], v[208:211], v[52:55], v[16:31]
    ds_read_b128 v[48:51], v1 offset:20480
    v_and_b32 v113, s51, v116
    v_sub_f32_e64 v113, -v114, v113
    v_and_b32 v117, 0xffff, v116
    v_cvt_pk_bf16_f32 v113, v113, v113
    v_and_or_b32 v116, v113, s51, v117
    v_rsq_f32 v118, v115
    v_mfma_f32_32x32x16_bf16 v[16:31], v[212:215], v[56:59], v[16:31]
    s_add_u32 m0, m0, 4096
    ds_read_b128 v[52:55], v1 offset:21504
    buffer_load_dwordx4 v110, s[36:39], m0 offen sc1 lds
    v_sqrt_f32 v119, v115
    v_mul_f32_e64 v118, -v118, s49
    s_waitcnt lgkmcnt(2)
    v_mfma_f32_32x32x16_bf16 v[16:31], v[216:219], v[60:63], v[16:31]
    ds_read_b128 v[56:59], v1 offset:22528
    ds_write_b128 v109, v[116:119]
    v_mfma_f32_32x32x16_bf16 v[16:31], v[220:223], v[64:67], v[16:31]
    s_add_u32 m0, m0, 4096
    ds_read_b128 v[60:63], v1 offset:23552
    buffer_load_dwordx4 v110, s[36:39], m0 offen sc1 lds
    s_waitcnt lgkmcnt(3)
    v_mfma_f32_32x32x16_bf16 v[16:31], v[224:227], v[48:51], v[16:31]
    s_waitcnt vmcnt(4)
    s_waitcnt lgkmcnt(1)
    s_barrier
    ds_read_b128 v[64:67], v1 offset:24576
    ds_read_b128 v[68:71], v108 offset:0
    ds_read_b128 v[72:75], v108 offset:512
    ds_read_b128 v[76:79], v108 offset:1024
    ds_read_b128 v[80:83], v108 offset:1536
    v_mfma_f32_32x32x16_bf16 v[16:31], v[228:231], v[52:55], v[16:31]
    s_add_u32 m0, m0, 4096
    v_add_u32 v110, s16, v110
    ds_read_b128 v[48:51], v1 offset:25600
    buffer_load_dwordx4 v110, s[36:39], m0 offen sc1 lds
    s_waitcnt lgkmcnt(6)
    v_mfma_f32_32x32x16_bf16 v[16:31], v[232:235], v[56:59], v[16:31]
    ds_read_b128 v[52:55], v1 offset:26624
    v_mfma_f32_32x32x16_bf16 v[16:31], v[236:239], v[60:63], v[16:31]
    s_add_u32 m0, m0, 4096
    ds_read_b128 v[56:59], v1 offset:27648
    buffer_load_dwordx4 v110, s[36:39], m0 offen sc1 lds
    s_waitcnt lgkmcnt(2)
    v_mfma_f32_32x32x16_bf16 v[16:31], v[240:243], v[64:67], v[16:31]
    ds_read_b128 v[60:63], v1 offset:28672
    v_mov_b32 v88, v68
    v_mov_b32 v89, v69
    v_mfma_f32_32x32x16_bf16 v[16:31], v[244:247], v[48:51], v[16:31]
    s_add_u32 m0, m0, 4096
    ds_read_b128 v[64:67], v1 offset:29696
    buffer_load_dwordx4 v110, s[36:39], m0 offen sc1 lds
    s_waitcnt lgkmcnt(2)
    v_mfma_f32_32x32x16_bf16 v[16:31], v[248:251], v[52:55], v[16:31]
    ds_read_b128 v[48:51], v1 offset:30720
    v_mfma_f32_32x32x16_bf16 v[16:31], v[252:255], v[56:59], v[16:31]
    s_add_u32 m0, m0, 4096
    ds_read_b128 v[52:55], v1 offset:31744
    buffer_load_dwordx4 v110, s[36:39], m0 offen sc1 lds
    v_mfma_f32_32x32x16_bf16 v[16:31], v[84:87], v[88:91], v[16:31]
    s_waitcnt lgkmcnt(2)
    v_mfma_f32_32x32x16_bf16 v[32:47], a[224:227], v[60:63], 0
    ds_read_b128 v[56:59], v1 offset:32768
    v_mfma_f32_32x32x16_bf16 v[32:47], a[228:231], v[64:67], v[32:47]
    s_add_u32 m0, m0, 4096
    ds_read_b128 v[60:63], v1 offset:33792
    buffer_load_dwordx4 v110, s[36:39], m0 offen sc1 lds
    s_waitcnt lgkmcnt(2)
    v_mfma_f32_32x32x16_bf16 v[32:47], a[232:235], v[48:51], v[32:47]
    ds_read_b128 v[64:67], v1 offset:34816
    s_nop 1
    v_mul_f32 v92, v16, v70
    v_mul_f32 v93, v17, v70
    v_exp_f32 v92, v92
    v_exp_f32 v93, v93
    v_mfma_f32_32x32x16_bf16 v[32:47], a[236:239], v[52:55], v[32:47]
    s_add_u32 m0, m0, 4096
    ds_read_b128 v[48:51], v1 offset:35840
    buffer_load_dwordx4 v110, s[36:39], m0 offen sc1 lds
    v_fma_f32 v92, v92, v71, v71
    v_fma_f32 v93, v93, v71, v71
    v_rcp_f32 v92, v92
    s_waitcnt lgkmcnt(2)
    v_mfma_f32_32x32x16_bf16 v[32:47], a[240:243], v[56:59], v[32:47]
    ds_read_b128 v[52:55], v1 offset:36864
    v_rcp_f32 v93, v93
    v_mul_f32 v16, v16, v92
    v_mul_f32 v17, v17, v93
    v_cvt_pk_bf16_f32 v96, v16, v17
    v_mfma_f32_32x32x16_bf16 v[32:47], a[244:247], v[60:63], v[32:47]
    s_add_u32 m0, m0, 4096
    ds_read_b128 v[56:59], v1 offset:37888
    buffer_load_dwordx4 v110, s[36:39], m0 offen sc1 lds
    v_mul_f32 v94, v18, v70
    v_mul_f32 v95, v19, v70
    v_exp_f32 v94, v94
    s_waitcnt lgkmcnt(2)
    v_mfma_f32_32x32x16_bf16 v[32:47], a[248:251], v[64:67], v[32:47]
    ds_read_b128 v[60:63], v1 offset:38912
    v_exp_f32 v95, v95
    v_fma_f32 v94, v94, v71, v71
    v_fma_f32 v95, v95, v71, v71
    v_rcp_f32 v94, v94
    v_mfma_f32_32x32x16_bf16 v[32:47], a[252:255], v[48:51], v[32:47]
    s_add_u32 m0, m0, 4096
    v_subrev_u32 v110, s16, v110
    ds_read_b128 v[64:67], v1 offset:39936
    buffer_load_dwordx4 v110, s[36:39], m0 offen sc1 lds
    v_rcp_f32 v95, v95
    s_waitcnt lgkmcnt(2)
    v_mfma_f32_32x32x16_bf16 v[32:47], v[176:179], v[52:55], v[32:47]
    s_waitcnt vmcnt(6)
    s_barrier
    ds_read_b128 v[48:51], v1 offset:40960
    v_mul_f32 v18, v18, v94
    v_mul_f32 v19, v19, v95
    v_mfma_f32_32x32x16_bf16 v[32:47], v[180:183], v[56:59], v[32:47]
    s_add_u32 m0, m0, 4096
    ds_read_b128 v[52:55], v1 offset:41984
    buffer_load_dwordx4 v110, s[36:39], m0 offen sc1 lds
    v_cvt_pk_bf16_f32 v97, v18, v19
    v_mul_f32 v92, v20, v70
    v_mul_f32 v93, v21, v70
    s_waitcnt lgkmcnt(2)
    v_mfma_f32_32x32x16_bf16 v[32:47], v[184:187], v[60:63], v[32:47]
    ds_read_b128 v[56:59], v1 offset:43008
    v_exp_f32 v92, v92
    v_exp_f32 v93, v93
    v_fma_f32 v92, v92, v71, v71
    v_fma_f32 v93, v93, v71, v71
    v_mfma_f32_32x32x16_bf16 v[32:47], v[188:191], v[64:67], v[32:47]
    s_add_u32 m0, m0, 4096
    ds_read_b128 v[60:63], v1 offset:44032
    buffer_load_dwordx4 v110, s[36:39], m0 offen sc1 lds
    v_rcp_f32 v92, v92
    v_rcp_f32 v93, v93
    s_waitcnt lgkmcnt(2)
    v_mfma_f32_32x32x16_bf16 v[32:47], v[192:195], v[48:51], v[32:47]
    ds_read_b128 v[64:67], v1 offset:45056
    v_mul_f32 v20, v20, v92
    v_mul_f32 v21, v21, v93
    v_cvt_pk_bf16_f32 v98, v20, v21
    v_mul_f32 v94, v22, v70
    v_mul_f32 v95, v23, v70
    v_mfma_f32_32x32x16_bf16 v[32:47], v[196:199], v[52:55], v[32:47]
    s_add_u32 m0, m0, 4096
    ds_read_b128 v[48:51], v1 offset:46080
    buffer_load_dwordx4 v110, s[36:39], m0 offen sc1 lds
    v_exp_f32 v94, v94
    v_exp_f32 v95, v95
    s_waitcnt lgkmcnt(2)
    v_mfma_f32_32x32x16_bf16 v[32:47], v[200:203], v[56:59], v[32:47]
    ds_read_b128 v[52:55], v1 offset:47104
    v_fma_f32 v94, v94, v71, v71
    v_fma_f32 v95, v95, v71, v71
    v_rcp_f32 v94, v94
    v_rcp_f32 v95, v95
    v_mfma_f32_32x32x16_bf16 v[32:47], v[204:207], v[60:63], v[32:47]
    s_add_u32 m0, m0, 4096
    ds_read_b128 v[56:59], v1 offset:48128
    buffer_load_dwordx4 v110, s[36:39], m0 offen sc1 lds
    v_mul_f32 v22, v22, v94
    v_mul_f32 v23, v23, v95
    s_waitcnt lgkmcnt(2)
    v_mfma_f32_32x32x16_bf16 v[32:47], v[208:211], v[64:67], v[32:47]
    ds_read_b128 v[60:63], v1 offset:49152
    v_cvt_pk_bf16_f32 v99, v22, v23
    v_mul_f32 v92, v24, v70
    v_mul_f32 v93, v25, v70
    v_exp_f32 v92, v92
    v_exp_f32 v93, v93
    v_mfma_f32_32x32x16_bf16 v[32:47], v[212:215], v[48:51], v[32:47]
    s_add_u32 m0, m0, 4096
    ds_read_b128 v[64:67], v1 offset:50176
    buffer_load_dwordx4 v110, s[36:39], m0 offen sc1 lds
    v_fma_f32 v92, v92, v71, v71
    v_fma_f32 v93, v93, v71, v71
    s_waitcnt lgkmcnt(2)
    v_mfma_f32_32x32x16_bf16 v[32:47], v[216:219], v[52:55], v[32:47]
    ds_read_b128 v[48:51], v1 offset:51200
    v_rcp_f32 v92, v92
    v_rcp_f32 v93, v93
    v_mul_f32 v24, v24, v92
    v_mul_f32 v25, v25, v93
    v_mfma_f32_32x32x16_bf16 v[32:47], v[220:223], v[56:59], v[32:47]
    s_add_u32 m0, m0, 4096
    ds_read_b128 v[52:55], v1 offset:52224
    buffer_load_dwordx4 v110, s[36:39], m0 offen sc1 lds
    v_cvt_pk_bf16_f32 v100, v24, v25
    v_mul_f32 v94, v26, v70
    v_mul_f32 v95, v27, v70
    s_waitcnt lgkmcnt(2)
    v_mfma_f32_32x32x16_bf16 v[32:47], v[224:227], v[60:63], v[32:47]
    ds_read_b128 v[56:59], v1 offset:53248
    v_exp_f32 v94, v94
    v_exp_f32 v95, v95
    v_fma_f32 v94, v94, v71, v71
    v_fma_f32 v95, v95, v71, v71
    v_mfma_f32_32x32x16_bf16 v[32:47], v[228:231], v[64:67], v[32:47]
    ds_read_b128 v[60:63], v1 offset:54272
    v_rcp_f32 v94, v94
    v_rcp_f32 v95, v95
    v_mul_f32 v26, v26, v94
    v_mul_f32 v27, v27, v95
    v_cvt_pk_bf16_f32 v101, v26, v27
    v_mul_f32 v92, v28, v70
    s_waitcnt lgkmcnt(2)
    v_mfma_f32_32x32x16_bf16 v[32:47], v[232:235], v[48:51], v[32:47]
    ds_read_b128 v[64:67], v1 offset:55296
    v_mul_f32 v93, v29, v70
    v_exp_f32 v92, v92
    v_exp_f32 v93, v93
    v_fma_f32 v92, v92, v71, v71
    v_mfma_f32_32x32x16_bf16 v[32:47], v[236:239], v[52:55], v[32:47]
    ds_read_b128 v[48:51], v1 offset:56320
    v_fma_f32 v93, v93, v71, v71
    v_rcp_f32 v92, v92
    v_rcp_f32 v93, v93
    v_mul_f32 v28, v28, v92
    v_mul_f32 v29, v29, v93
    s_waitcnt lgkmcnt(2)
    v_mfma_f32_32x32x16_bf16 v[32:47], v[240:243], v[56:59], v[32:47]
    ds_read_b128 v[52:55], v3 offset:0
    v_mov_b32 v88, v72
    v_mov_b32 v89, v73
    v_cvt_pk_bf16_f32 v102, v28, v29
    v_mul_f32 v94, v30, v70
    v_mul_f32 v95, v31, v70
    v_exp_f32 v94, v94
    v_mfma_f32_32x32x16_bf16 v[32:47], v[244:247], v[60:63], v[32:47]
    ds_read_b128 v[56:59], v3 offset:1024
    v_exp_f32 v95, v95
    v_fma_f32 v94, v94, v71, v71
    v_fma_f32 v95, v95, v71, v71
    v_rcp_f32 v94, v94
    s_waitcnt lgkmcnt(2)
    v_mfma_f32_32x32x16_bf16 v[32:47], v[248:251], v[64:67], v[32:47]
    ds_read_b128 v[60:63], v3 offset:2048
    v_rcp_f32 v95, v95
    v_mul_f32 v30, v30, v94
    v_mul_f32 v31, v31, v95
    v_cvt_pk_bf16_f32 v103, v30, v31
    v_mfma_f32_32x32x16_bf16 v[32:47], v[252:255], v[48:51], v[32:47]
    ds_read_b128 v[64:67], v3 offset:3072
    s_add_u32 s40, s3, 0
    buffer_store_dwordx4 v[96:99], v1, s[36:39], s40 offen sc1
    buffer_store_dwordx4 v[100:103], v1, s[36:39], s40 offen offset:1024 sc1
    v_mfma_f32_32x32x16_bf16 v[32:47], v[84:87], v[88:91], v[32:47]
    s_waitcnt lgkmcnt(2)
    v_mfma_f32_32x32x16_bf16 v[16:31], a[224:227], v[52:55], 0
    ds_read_b128 v[48:51], v3 offset:4096
    v_mfma_f32_32x32x16_bf16 v[16:31], a[228:231], v[56:59], v[16:31]
    ds_read_b128 v[52:55], v3 offset:5120
    s_waitcnt lgkmcnt(2)
    v_mfma_f32_32x32x16_bf16 v[16:31], a[232:235], v[60:63], v[16:31]
    ds_read_b128 v[56:59], v3 offset:6144
    s_nop 3
    v_mul_f32 v92, v32, v74
    v_mul_f32 v93, v33, v74
    v_exp_f32 v92, v92
    v_exp_f32 v93, v93
    v_mfma_f32_32x32x16_bf16 v[16:31], a[236:239], v[64:67], v[16:31]
    ds_read_b128 v[60:63], v3 offset:7168
    v_fma_f32 v92, v92, v75, v75
    v_fma_f32 v93, v93, v75, v75
    v_rcp_f32 v92, v92
    v_rcp_f32 v93, v93
    s_waitcnt lgkmcnt(2)
    v_mfma_f32_32x32x16_bf16 v[16:31], a[240:243], v[48:51], v[16:31]
    s_waitcnt vmcnt(8)
    s_barrier
    ds_read_b128 v[64:67], v3 offset:8192
    v_mul_f32 v32, v32, v92
    v_mfma_f32_32x32x16_bf16 v[16:31], a[244:247], v[52:55], v[16:31]
    ds_read_b128 v[48:51], v3 offset:9216
    v_mul_f32 v33, v33, v93
    v_cvt_pk_bf16_f32 v96, v32, v33
    v_mul_f32 v94, v34, v74
    v_mul_f32 v95, v35, v74
    v_exp_f32 v94, v94
    s_waitcnt lgkmcnt(2)
    v_mfma_f32_32x32x16_bf16 v[16:31], a[248:251], v[56:59], v[16:31]
    ds_read_b128 v[52:55], v3 offset:10240
    v_exp_f32 v95, v95
    v_fma_f32 v94, v94, v75, v75
    v_fma_f32 v95, v95, v75, v75
    v_mfma_f32_32x32x16_bf16 v[16:31], a[252:255], v[60:63], v[16:31]
    ds_read_b128 v[56:59], v3 offset:11264
    v_rcp_f32 v94, v94
    v_rcp_f32 v95, v95
    v_mul_f32 v34, v34, v94
    v_mul_f32 v35, v35, v95
    v_cvt_pk_bf16_f32 v97, v34, v35
    s_waitcnt lgkmcnt(2)
    v_mfma_f32_32x32x16_bf16 v[16:31], v[176:179], v[64:67], v[16:31]
    ds_read_b128 v[60:63], v3 offset:12288
    v_mul_f32 v92, v36, v74
    v_mul_f32 v93, v37, v74
    v_exp_f32 v92, v92
    v_mfma_f32_32x32x16_bf16 v[16:31], v[180:183], v[48:51], v[16:31]
    ds_read_b128 v[64:67], v3 offset:13312
    v_exp_f32 v93, v93
    v_fma_f32 v92, v92, v75, v75
    v_fma_f32 v93, v93, v75, v75
    v_rcp_f32 v92, v92
    s_waitcnt lgkmcnt(2)
    v_mfma_f32_32x32x16_bf16 v[16:31], v[184:187], v[52:55], v[16:31]
    ds_read_b128 v[48:51], v3 offset:14336
    v_rcp_f32 v93, v93
    v_mul_f32 v36, v36, v92
    v_mul_f32 v37, v37, v93
    v_cvt_pk_bf16_f32 v98, v36, v37
    v_mul_f32 v94, v38, v74
    v_mfma_f32_32x32x16_bf16 v[16:31], v[188:191], v[56:59], v[16:31]
    ds_read_b128 v[52:55], v3 offset:15360
    v_mul_f32 v95, v39, v74
    v_exp_f32 v94, v94
    v_exp_f32 v95, v95
    v_fma_f32 v94, v94, v75, v75
    s_waitcnt lgkmcnt(2)
    v_mfma_f32_32x32x16_bf16 v[16:31], v[192:195], v[60:63], v[16:31]
    ds_read_b128 v[56:59], v3 offset:16384
    v_fma_f32 v95, v95, v75, v75
    v_rcp_f32 v94, v94
    v_rcp_f32 v95, v95
    v_mfma_f32_32x32x16_bf16 v[16:31], v[196:199], v[64:67], v[16:31]
    ds_read_b128 v[60:63], v3 offset:17408
    v_mul_f32 v38, v38, v94
    v_mul_f32 v39, v39, v95
    v_cvt_pk_bf16_f32 v99, v38, v39
    v_mul_f32 v92, v40, v74
    v_mul_f32 v93, v41, v74
    s_waitcnt lgkmcnt(2)
    v_mfma_f32_32x32x16_bf16 v[16:31], v[200:203], v[48:51], v[16:31]
    ds_read_b128 v[64:67], v3 offset:18432
    s_add_u32 s41, s2, 0
    s_add_u32 s42, s56, 2
    v_mov_b32 v14, s42
    s_waitcnt vmcnt(0)
    s_mov_b64 exec, 1
    buffer_store_dword v14, v1, s[36:39], s41 offen
    s_mov_b64 exec, -1
    v_mfma_f32_32x32x16_bf16 v[16:31], v[204:207], v[52:55], v[16:31]
    ds_read_b128 v[48:51], v3 offset:19456
    v_exp_f32 v92, v92
    v_exp_f32 v93, v93
    v_fma_f32 v92, v92, v75, v75
    v_fma_f32 v93, v93, v75, v75
    s_waitcnt lgkmcnt(2)
    v_mfma_f32_32x32x16_bf16 v[16:31], v[208:211], v[56:59], v[16:31]
    ds_read_b128 v[52:55], v3 offset:20480
    v_rcp_f32 v92, v92
    v_rcp_f32 v93, v93
    v_mul_f32 v40, v40, v92
    v_mul_f32 v41, v41, v93
    v_mfma_f32_32x32x16_bf16 v[16:31], v[212:215], v[60:63], v[16:31]
    ds_read_b128 v[56:59], v3 offset:21504
    v_cvt_pk_bf16_f32 v100, v40, v41
    v_mul_f32 v94, v42, v74
    v_mul_f32 v95, v43, v74
    v_exp_f32 v94, v94
    s_waitcnt lgkmcnt(2)
    v_mfma_f32_32x32x16_bf16 v[16:31], v[216:219], v[64:67], v[16:31]
    ds_read_b128 v[60:63], v3 offset:22528
    v_exp_f32 v95, v95
    v_fma_f32 v94, v94, v75, v75
    v_fma_f32 v95, v95, v75, v75
    v_rcp_f32 v94, v94
    v_mfma_f32_32x32x16_bf16 v[16:31], v[220:223], v[48:51], v[16:31]
    ds_read_b128 v[64:67], v3 offset:23552
    v_rcp_f32 v95, v95
    v_mul_f32 v42, v42, v94
    v_mul_f32 v43, v43, v95
    v_cvt_pk_bf16_f32 v101, v42, v43
    s_waitcnt lgkmcnt(2)
    v_mfma_f32_32x32x16_bf16 v[16:31], v[224:227], v[52:55], v[16:31]
    ds_read_b128 v[48:51], v3 offset:24576
    v_mul_f32 v92, v44, v74
    v_mul_f32 v93, v45, v74
    v_exp_f32 v92, v92
    v_exp_f32 v93, v93
    v_mfma_f32_32x32x16_bf16 v[16:31], v[228:231], v[56:59], v[16:31]
    ds_read_b128 v[52:55], v3 offset:25600
    v_fma_f32 v92, v92, v75, v75
    v_fma_f32 v93, v93, v75, v75
    v_rcp_f32 v92, v92
    v_rcp_f32 v93, v93
    s_waitcnt lgkmcnt(2)
    v_mfma_f32_32x32x16_bf16 v[16:31], v[232:235], v[60:63], v[16:31]
    ds_read_b128 v[56:59], v3 offset:26624
    v_mul_f32 v44, v44, v92
    v_mul_f32 v45, v45, v93
    v_cvt_pk_bf16_f32 v102, v44, v45
    v_mul_f32 v94, v46, v74
    v_mfma_f32_32x32x16_bf16 v[16:31], v[236:239], v[64:67], v[16:31]
    ds_read_b128 v[60:63], v3 offset:27648
    v_mul_f32 v95, v47, v74
    v_exp_f32 v94, v94
    v_exp_f32 v95, v95
    v_fma_f32 v94, v94, v75, v75
    s_waitcnt lgkmcnt(2)
    v_mfma_f32_32x32x16_bf16 v[16:31], v[240:243], v[48:51], v[16:31]
    ds_read_b128 v[64:67], v3 offset:28672
    v_mov_b32 v88, v76
    v_mov_b32 v89, v77
    v_fma_f32 v95, v95, v75, v75
    v_rcp_f32 v94, v94
    v_mfma_f32_32x32x16_bf16 v[16:31], v[244:247], v[52:55], v[16:31]
    ds_read_b128 v[48:51], v3 offset:29696
    v_rcp_f32 v95, v95
    v_mul_f32 v46, v46, v94
    v_mul_f32 v47, v47, v95
    v_cvt_pk_bf16_f32 v103, v46, v47
    s_waitcnt lgkmcnt(2)
    v_mfma_f32_32x32x16_bf16 v[16:31], v[248:251], v[56:59], v[16:31]
    ds_read_b128 v[52:55], v3 offset:30720
    s_add_u32 s70, s74, 0
    buffer_load_dword v109, v104, s[36:39], s70 offen sc1
    v_mfma_f32_32x32x16_bf16 v[16:31], v[252:255], v[60:63], v[16:31]
    ds_read_b128 v[56:59], v3 offset:31744
    s_add_u32 s40, s17, 229376
    buffer_store_dwordx4 v[96:99], v1, s[36:39], s40 offen sc1
    buffer_store_dwordx4 v[100:103], v1, s[36:39], s40 offen offset:1024 sc1
    v_mfma_f32_32x32x16_bf16 v[16:31], v[84:87], v[88:91], v[16:31]
    s_waitcnt lgkmcnt(2)
    v_mfma_f32_32x32x16_bf16 v[32:47], a[224:227], v[64:67], 0
    s_barrier
    ds_read_b128 v[60:63], v3 offset:32768
    v_mfma_f32_32x32x16_bf16 v[32:47], a[228:231], v[48:51], v[32:47]
    ds_read_b128 v[64:67], v3 offset:33792
    s_waitcnt lgkmcnt(2)
    v_mfma_f32_32x32x16_bf16 v[32:47], a[232:235], v[52:55], v[32:47]
    ds_read_b128 v[48:51], v3 offset:34816
    s_nop 2
    v_mul_f32 v92, v16, v78
    v_mul_f32 v93, v17, v78
    v_exp_f32 v92, v92
    v_exp_f32 v93, v93
    v_fma_f32 v92, v92, v79, v79
    v_mfma_f32_32x32x16_bf16 v[32:47], a[236:239], v[56:59], v[32:47]
    ds_read_b128 v[52:55], v3 offset:35840
    v_fma_f32 v93, v93, v79, v79
    v_rcp_f32 v92, v92
    v_rcp_f32 v93, v93
    v_mul_f32 v16, v16, v92
    v_mul_f32 v17, v17, v93
    s_waitcnt lgkmcnt(2)
    v_mfma_f32_32x32x16_bf16 v[32:47], a[240:243], v[60:63], v[32:47]
    ds_read_b128 v[56:59], v3 offset:36864
    s_add_u32 s47, s56, 2
    s_waitcnt vmcnt(2)
    v_subrev_u32 v109, s47, v109
    v_cmp_lt_u32 vcc, 3, v109
    s_cbranch_vccnz L_aspin_32
L_aback_33:
    v_cvt_pk_bf16_f32 v96, v16, v17
    v_mul_f32 v94, v18, v78
    v_mul_f32 v95, v19, v78
    v_mfma_f32_32x32x16_bf16 v[32:47], a[244:247], v[64:67], v[32:47]
    ds_read_b128 v[60:63], v3 offset:37888
    s_add_u32 s79, s73, 0
    v_add_u32 v15, s79, v1
    buffer_load_dwordx4 v[112:115], v15, s[36:39], s8 offen offset:0 sc1
    v_exp_f32 v94, v94
    s_waitcnt lgkmcnt(2)
    v_mfma_f32_32x32x16_bf16 v[32:47], a[248:251], v[48:51], v[32:47]
    ds_read_b128 v[64:67], v3 offset:38912
    buffer_load_dwordx4 v[116:119], v15, s[36:39], s8 offen offset:1024 sc1
    v_exp_f32 v95, v95
    v_fma_f32 v94, v94, v79, v79
    v_mfma_f32_32x32x16_bf16 v[32:47], a[252:255], v[52:55], v[32:47]
    ds_read_b128 v[48:51], v3 offset:39936
    v_fma_f32 v95, v95, v79, v79
    v_rcp_f32 v94, v94
    v_rcp_f32 v95, v95
    v_mul_f32 v18, v18, v94
    v_mul_f32 v19, v19, v95
    s_waitcnt lgkmcnt(2)
    v_mfma_f32_32x32x16_bf16 v[32:47], v[176:179], v[56:59], v[32:47]
    ds_read_b128 v[52:55], v3 offset:40960
    buffer_load_dwordx4 v[120:123], v15, s[36:39], s9 offen offset:0 sc1
    v_cvt_pk_bf16_f32 v97, v18, v19
    v_mul_f32 v92, v20, v78
    v_mul_f32 v93, v21, v78
    v_mfma_f32_32x32x16_bf16 v[32:47], v[180:183], v[60:63], v[32:47]
    ds_read_b128 v[56:59], v3 offset:41984
    v_exp_f32 v92, v92
    v_exp_f32 v93, v93
    v_fma_f32 v92, v92, v79, v79
    v_fma_f32 v93, v93, v79, v79
    v_rcp_f32 v92, v92
    s_waitcnt lgkmcnt(2)
    v_mfma_f32_32x32x16_bf16 v[32:47], v[184:187], v[64:67], v[32:47]
    ds_read_b128 v[60:63], v3 offset:43008
    buffer_load_dwordx4 v[124:127], v15, s[36:39], s9 offen offset:1024 sc1
    v_rcp_f32 v93, v93
    v_mul_f32 v20, v20, v92
    v_mfma_f32_32x32x16_bf16 v[32:47], v[188:191], v[48:51], v[32:47]
    ds_read_b128 v[64:67], v3 offset:44032
    v_mul_f32 v21, v21, v93
    v_cvt_pk_bf16_f32 v98, v20, v21
    v_mul_f32 v94, v22, v78
    v_mul_f32 v95, v23, v78
    v_exp_f32 v94, v94
    v_exp_f32 v95, v95
    s_waitcnt lgkmcnt(2)
    v_mfma_f32_32x32x16_bf16 v[32:47], v[192:195], v[52:55], v[32:47]
    ds_read_b128 v[48:51], v3 offset:45056
    buffer_load_dwordx4 v[128:131], v15, s[36:39], s10 offen offset:0 sc1
    v_fma_f32 v94, v94, v79, v79
    v_fma_f32 v95, v95, v79, v79
    v_mfma_f32_32x32x16_bf16 v[32:47], v[196:199], v[56:59], v[32:47]
    ds_read_b128 v[52:55], v3 offset:46080
    v_rcp_f32 v94, v94
    v_rcp_f32 v95, v95
    v_mul_f32 v22, v22, v94
    v_mul_f32 v23, v23, v95
    v_cvt_pk_bf16_f32 v99, v22, v23
    v_mul_f32 v92, v24, v78
    s_waitcnt lgkmcnt(2)
    v_mfma_f32_32x32x16_bf16 v[32:47], v[200:203], v[60:63], v[32:47]
    ds_read_b128 v[56:59], v3 offset:47104
    s_add_u32 s41, s1, 512
    s_add_u32 s42, s56, 2
    v_mov_b32 v14, s42
    s_waitcnt vmcnt(5)
    s_mov_b64 exec, 1
    buffer_store_dword v14, v1, s[36:39], s41 offen
    s_mov_b64 exec, -1
    buffer_load_dwordx4 v[132:135], v15, s[36:39], s10 offen offset:1024 sc1
    v_mfma_f32_32x32x16_bf16 v[32:47], v[204:207], v[64:67], v[32:47]
    ds_read_b128 v[60:63], v3 offset:48128
    v_mul_f32 v93, v25, v78
    v_exp_f32 v92, v92
    v_exp_f32 v93, v93
    v_fma_f32 v92, v92, v79, v79
    v_fma_f32 v93, v93, v79, v79
    s_waitcnt lgkmcnt(2)
    v_mfma_f32_32x32x16_bf16 v[32:47], v[208:211], v[48:51], v[32:47]
    ds_read_b128 v[64:67], v3 offset:49152
    buffer_load_dwordx4 v[136:139], v15, s[36:39], s11 offen offset:0 sc1
    v_rcp_f32 v92, v92
    v_rcp_f32 v93, v93
    v_mfma_f32_32x32x16_bf16 v[32:47], v[212:215], v[52:55], v[32:47]
    ds_read_b128 v[48:51], v3 offset:50176
    buffer_load_dwordx4 v[140:143], v15, s[36:39], s11 offen offset:1024 sc1
    v_mul_f32 v24, v24, v92
    v_mul_f32 v25, v25, v93
    v_cvt_pk_bf16_f32 v100, v24, v25
    s_waitcnt lgkmcnt(2)
    v_mfma_f32_32x32x16_bf16 v[32:47], v[216:219], v[56:59], v[32:47]
    ds_read_b128 v[52:55], v3 offset:51200
    v_mul_f32 v94, v26, v78
    v_mul_f32 v95, v27, v78
    v_exp_f32 v94, v94
    v_exp_f32 v95, v95
    v_fma_f32 v94, v94, v79, v79
    v_mfma_f32_32x32x16_bf16 v[32:47], v[220:223], v[60:63], v[32:47]
    ds_read_b128 v[56:59], v3 offset:52224
    buffer_load_dwordx4 v[144:147], v15, s[36:39], s12 offen offset:0 sc1
    v_fma_f32 v95, v95, v79, v79
    v_rcp_f32 v94, v94
    s_waitcnt lgkmcnt(2)
    v_mfma_f32_32x32x16_bf16 v[32:47], v[224:227], v[64:67], v[32:47]
    ds_read_b128 v[60:63], v3 offset:53248
    v_rcp_f32 v95, v95
    v_mul_f32 v26, v26, v94
    v_mul_f32 v27, v27, v95
    v_cvt_pk_bf16_f32 v101, v26, v27
    v_mul_f32 v92, v28, v78
    v_mul_f32 v93, v29, v78
    v_mfma_f32_32x32x16_bf16 v[32:47], v[228:231], v[48:51], v[32:47]
    ds_read_b128 v[64:67], v3 offset:54272
    buffer_load_dwordx4 v[148:151], v15, s[36:39], s12 offen offset:1024 sc1
    v_exp_f32 v92, v92
    v_exp_f32 v93, v93
    s_waitcnt lgkmcnt(2)
    v_mfma_f32_32x32x16_bf16 v[32:47], v[232:235], v[52:55], v[32:47]
    ds_read_b128 v[48:51], v3 offset:55296
    v_fma_f32 v92, v92, v79, v79
    v_fma_f32 v93, v93, v79, v79
    v_rcp_f32 v92, v92
    v_rcp_f32 v93, v93
    v_mul_f32 v28, v28, v92
    v_mfma_f32_32x32x16_bf16 v[32:47], v[236:239], v[56:59], v[32:47]
    ds_read_b128 v[52:55], v3 offset:56320
    buffer_load_dwordx4 v[152:155], v15, s[36:39], s13 offen offset:0 sc1
    v_mul_f32 v29, v29, v93
    v_cvt_pk_bf16_f32 v102, v28, v29
    v_mul_f32 v94, v30, v78
    v_mul_f32 v95, v31, v78
    s_waitcnt lgkmcnt(2)
    v_mfma_f32_32x32x16_bf16 v[32:47], v[240:243], v[60:63], v[32:47]
    v_mov_b32 v88, v80
    v_mov_b32 v89, v81
    v_exp_f32 v94, v94
    v_exp_f32 v95, v95
    v_fma_f32 v94, v94, v79, v79
    v_mfma_f32_32x32x16_bf16 v[32:47], v[244:247], v[64:67], v[32:47]
    buffer_load_dwordx4 v[156:159], v15, s[36:39], s13 offen offset:1024 sc1
    v_fma_f32 v95, v95, v79, v79
    v_rcp_f32 v94, v94
    v_rcp_f32 v95, v95
    s_waitcnt lgkmcnt(0)
    v_mfma_f32_32x32x16_bf16 v[32:47], v[248:251], v[48:51], v[32:47]
    v_mul_f32 v30, v30, v94
    v_mul_f32 v31, v31, v95
    v_cvt_pk_bf16_f32 v103, v30, v31
    s_add_u32 s40, s3, 114688
    buffer_store_dwordx4 v[96:99], v1, s[36:39], s40 offen sc1
    buffer_store_dwordx4 v[100:103], v1, s[36:39], s40 offen offset:1024 sc1
    v_mfma_f32_32x32x16_bf16 v[32:47], v[252:255], v[52:55], v[32:47]
    v_mfma_f32_32x32x16_bf16 v[32:47], v[84:87], v[88:91], v[32:47]
    s_nop 11
    v_pk_mul_f32 v[92:93], v[32:33], v[82:83] op_sel_hi:[1,0]
    s_xor_b32 s71, s74, 4
    buffer_load_dword v13, v104, s[36:39], s71 offen sc1
    v_pk_mul_f32 v[94:95], v[34:35], v[82:83] op_sel_hi:[1,0]
    v_exp_f32 v92, v92
    v_exp_f32 v93, v93
    v_exp_f32 v94, v94
    v_exp_f32 v95, v95
    v_pk_fma_f32 v[92:93], v[92:93], v[82:83], v[82:83] op_sel:[0,1,1] op_sel_hi:[1,1,1]
    v_pk_fma_f32 v[94:95], v[94:95], v[82:83], v[82:83] op_sel:[0,1,1] op_sel_hi:[1,1,1]
    v_rcp_f32 v92, v92
    v_rcp_f32 v93, v93
    v_rcp_f32 v94, v94
    v_rcp_f32 v95, v95
    v_pk_mul_f32 v[32:33], v[32:33], v[92:93]
    v_pk_mul_f32 v[34:35], v[34:35], v[94:95]
    v_cvt_pk_bf16_f32 v96, v32, v33
    v_cvt_pk_bf16_f32 v97, v34, v35
    v_pk_mul_f32 v[92:93], v[36:37], v[82:83] op_sel_hi:[1,0]
    v_pk_mul_f32 v[94:95], v[38:39], v[82:83] op_sel_hi:[1,0]
    v_exp_f32 v92, v92
    v_exp_f32 v93, v93
    v_exp_f32 v94, v94
    buffer_load_dwordx4 v[160:163], v15, s[36:39], s14 offen offset:0 sc1
    v_exp_f32 v95, v95
    v_pk_fma_f32 v[92:93], v[92:93], v[82:83], v[82:83] op_sel:[0,1,1] op_sel_hi:[1,1,1]
    v_pk_fma_f32 v[94:95], v[94:95], v[82:83], v[82:83] op_sel:[0,1,1] op_sel_hi:[1,1,1]
    v_rcp_f32 v92, v92
    v_rcp_f32 v93, v93
    v_rcp_f32 v94, v94
    v_rcp_f32 v95, v95
    v_pk_mul_f32 v[36:37], v[36:37], v[92:93]
    v_pk_mul_f32 v[38:39], v[38:39], v[94:95]
    v_cvt_pk_bf16_f32 v98, v36, v37
    v_cvt_pk_bf16_f32 v99, v38, v39
    v_pk_mul_f32 v[92:93], v[40:41], v[82:83] op_sel_hi:[1,0]
    v_pk_mul_f32 v[94:95], v[42:43], v[82:83] op_sel_hi:[1,0]
    v_exp_f32 v92, v92
    v_exp_f32 v93, v93
    v_exp_f32 v94, v94
    v_exp_f32 v95, v95
    v_pk_fma_f32 v[92:93], v[92:93], v[82:83], v[82:83] op_sel:[0,1,1] op_sel_hi:[1,1,1]
    v_pk_fma_f32 v[94:95], v[94:95], v[82:83], v[82:83] op_sel:[0,1,1] op_sel_hi:[1,1,1]
    v_rcp_f32 v92, v92
    v_rcp_f32 v93, v93
    buffer_load_dwordx4 v[164:167], v15, s[36:39], s14 offen offset:1024 sc1
    v_rcp_f32 v94, v94
    v_rcp_f32 v95, v95
    v_pk_mul_f32 v[40:41], v[40:41], v[92:93]
    v_pk_mul_f32 v[42:43], v[42:43], v[94:95]
    v_cvt_pk_bf16_f32 v100, v40, v41
    v_cvt_pk_bf16_f32 v101, v42, v43
    v_pk_mul_f32 v[92:93], v[44:45], v[82:83] op_sel_hi:[1,0]
    v_pk_mul_f32 v[94:95], v[46:47], v[82:83] op_sel_hi:[1,0]
    v_exp_f32 v92, v92
    v_exp_f32 v93, v93
    v_exp_f32 v94, v94
    v_exp_f32 v95, v95
    v_pk_fma_f32 v[92:93], v[92:93], v[82:83], v[82:83] op_sel:[0,1,1] op_sel_hi:[1,1,1]
    v_pk_fma_f32 v[94:95], v[94:95], v[82:83], v[82:83] op_sel:[0,1,1] op_sel_hi:[1,1,1]
    v_rcp_f32 v92, v92
    v_rcp_f32 v93, v93
    v_rcp_f32 v94, v94
    v_rcp_f32 v95, v95
    v_pk_mul_f32 v[44:45], v[44:45], v[92:93]
    v_pk_mul_f32 v[46:47], v[46:47], v[94:95]
    v_cvt_pk_bf16_f32 v102, v44, v45
    v_cvt_pk_bf16_f32 v103, v46, v47
    s_add_u32 s40, s17, 344064
    buffer_store_dwordx4 v[96:99], v1, s[36:39], s40 offen sc1
    buffer_store_dwordx4 v[100:103], v1, s[36:39], s40 offen offset:1024 sc1
    s_waitcnt vmcnt(19)
    v_mfma_f32_32x32x16_bf16 v[16:31], a[0:3], v[112:115], 0
    s_barrier
    v_mfma_f32_32x32x16_bf16 v[48:63], a[4:7], v[112:115], 0
    s_waitcnt vmcnt(18)
    v_mfma_f32_32x32x16_bf16 v[16:31], a[8:11], v[116:119], v[16:31]
    v_mfma_f32_32x32x16_bf16 v[48:63], a[12:15], v[116:119], v[48:63]
    s_waitcnt vmcnt(17)
    v_mfma_f32_32x32x16_bf16 v[16:31], a[16:19], v[120:123], v[16:31]
    s_add_u32 s41, s2, 256
    s_add_u32 s42, s56, 2
    v_mov_b32 v14, s42
    s_waitcnt vmcnt(5)
    s_mov_b64 exec, 1
    buffer_store_dword v14, v1, s[36:39], s41 offen
    s_mov_b64 exec, -1
    v_mfma_f32_32x32x16_bf16 v[48:63], a[20:23], v[120:123], v[48:63]
    v_and_b32 v107, 7, v0
    v_mfma_f32_32x32x16_bf16 v[16:31], a[24:27], v[124:127], v[16:31]
    s_add_u32 s47, s56, 2
    s_waitcnt vmcnt(5)
    v_subrev_u32 v13, s47, v13
    v_cmp_lt_u32 vcc, 3, v13
    s_cbranch_vccnz L_aspin_35
L_aback_36:
    s_add_u32 s79, s78, 0
    v_add_u32 v15, s79, v1
    buffer_load_dwordx4 v[168:171], v15, s[36:39], s8 offen offset:0 sc1
    v_bfe_u32 v110, v0, 3, 1
    v_mfma_f32_32x32x16_bf16 v[48:63], a[28:31], v[124:127], v[48:63]
    v_mfma_f32_32x32x16_bf16 v[16:31], a[32:35], v[128:131], v[16:31]
    buffer_load_dwordx4 v[172:175], v15, s[36:39], s8 offen offset:1024 sc1
    v_mul_u32_u24 v108, 896, v107
    v_mfma_f32_32x32x16_bf16 v[48:63], a[36:39], v[128:131], v[48:63]
    v_lshlrev_b32 v107, 4, v107
    v_mfma_f32_32x32x16_bf16 v[16:31], a[40:43], v[132:135], v[16:31]
    buffer_load_dwordx4 v[112:115], v15, s[36:39], s9 offen offset:0 sc1
    v_mfma_f32_32x32x16_bf16 v[48:63], a[44:47], v[132:135], v[48:63]
    v_lshl_add_u32 v107, v110, 3, v107
    v_mfma_f32_32x32x16_bf16 v[16:31], a[48:51], v[136:139], v[16:31]
    buffer_load_dwordx4 v[116:119], v15, s[36:39], s9 offen offset:1024 sc1
    v_mfma_f32_32x32x16_bf16 v[48:63], a[52:55], v[136:139], v[48:63]
    v_lshrrev_b32 v110, 3, v0
    v_mfma_f32_32x32x16_bf16 v[16:31], a[56:59], v[140:143], v[16:31]
    buffer_load_dwordx4 v[120:123], v15, s[36:39], s10 offen offset:0 sc1
    v_lshl_add_u32 v108, v110, 4, v108
    v_mfma_f32_32x32x16_bf16 v[48:63], a[60:63], v[140:143], v[48:63]
    v_mfma_f32_32x32x16_bf16 v[16:31], a[64:67], v[144:147], v[16:31]
    buffer_load_dwordx4 v[124:127], v15, s[36:39], s10 offen offset:1024 sc1
    v_lshrrev_b32 v110, 4, v0
    v_mfma_f32_32x32x16_bf16 v[48:63], a[68:71], v[144:147], v[48:63]
    v_lshl_add_u32 v107, v110, 10, v107
    v_mfma_f32_32x32x16_bf16 v[16:31], a[72:75], v[148:151], v[16:31]
    buffer_load_dwordx4 v[128:131], v15, s[36:39], s11 offen offset:0 sc1
    v_mfma_f32_32x32x16_bf16 v[48:63], a[76:79], v[148:151], v[48:63]
    s_add_u32 s43, s75, 0
    buffer_load_dwordx2 v[88:89], v107, s[36:39], s43 offen sc1
    buffer_load_dwordx2 v[90:91], v107, s[36:39], s43 offen offset:512 sc1
    v_mfma_f32_32x32x16_bf16 v[16:31], a[80:83], v[152:155], v[16:31]
    buffer_load_dwordx4 v[132:135], v15, s[36:39], s11 offen offset:1024 sc1
    v_mfma_f32_32x32x16_bf16 v[48:63], a[84:87], v[152:155], v[48:63]
    v_mfma_f32_32x32x16_bf16 v[16:31], a[88:91], v[156:159], v[16:31]
    s_add_u32 s70, s74, 256
    buffer_load_dword v109, v104, s[36:39], s70 offen sc1
    buffer_load_dwordx4 v[136:139], v15, s[36:39], s12 offen offset:0 sc1
    v_mfma_f32_32x32x16_bf16 v[48:63], a[92:95], v[156:159], v[48:63]
    s_waitcnt vmcnt(16)
    v_mfma_f32_32x32x16_bf16 v[16:31], a[96:99], v[160:163], v[16:31]
    buffer_load_dwordx4 v[140:143], v15, s[36:39], s12 offen offset:1024 sc1
    s_add_u32 s41, s1, 768
    s_add_u32 s42, s56, 2
    v_mov_b32 v14, s42
    s_waitcnt vmcnt(14)
    s_mov_b64 exec, 1
    buffer_store_dword v14, v1, s[36:39], s41 offen
    s_mov_b64 exec, -1
    v_mfma_f32_32x32x16_bf16 v[48:63], a[100:103], v[160:163], v[48:63]
    v_mfma_f32_32x32x16_bf16 v[16:31], a[104:107], v[164:167], v[16:31]
    v_mfma_f32_32x32x16_bf16 v[48:63], a[108:111], v[164:167], v[48:63]
    buffer_load_dwordx4 v[144:147], v15, s[36:39], s13 offen offset:0 sc1
    s_waitcnt vmcnt(14)
    v_mfma_f32_32x32x16_bf16 v[16:31], a[112:115], v[168:171], v[16:31]
    v_mfma_f32_32x32x16_bf16 v[48:63], a[116:119], v[168:171], v[48:63]
    buffer_load_dwordx4 v[148:151], v15, s[36:39], s13 offen offset:1024 sc1
    s_waitcnt vmcnt(14)
    v_mfma_f32_32x32x16_bf16 v[16:31], a[120:123], v[172:175], v[16:31]
    v_mfma_f32_32x32x16_bf16 v[48:63], a[124:127], v[172:175], v[48:63]
    buffer_load_dwordx4 v[152:155], v15, s[36:39], s14 offen offset:0 sc1
    s_waitcnt vmcnt(14)
    v_mfma_f32_32x32x16_bf16 v[16:31], a[128:131], v[112:115], v[16:31]
    v_mfma_f32_32x32x16_bf16 v[48:63], a[132:135], v[112:115], v[48:63]
    buffer_load_dwordx4 v[156:159], v15, s[36:39], s14 offen offset:1024 sc1
    s_waitcnt vmcnt(14)
    v_mfma_f32_32x32x16_bf16 v[16:31], a[136:139], v[116:119], v[16:31]
    v_mfma_f32_32x32x16_bf16 v[48:63], a[140:143], v[116:119], v[48:63]
    s_waitcnt vmcnt(13)
    v_mfma_f32_32x32x16_bf16 v[16:31], a[144:147], v[120:123], v[16:31]
    s_add_u32 s47, s56, 2
    s_waitcnt vmcnt(7)
    v_subrev_u32 v109, s47, v109
    v_cmp_lt_u32 vcc, 3, v109
    s_cbranch_vccnz L_aspin_38
L_aback_39:
    s_add_u32 s79, s73, 114688
    v_add_u32 v15, s79, v1
    buffer_load_dwordx4 v[160:163], v15, s[36:39], s8 offen offset:0 sc1
    v_mfma_f32_32x32x16_bf16 v[48:63], a[148:151], v[120:123], v[48:63]
    v_mfma_f32_32x32x16_bf16 v[16:31], a[152:155], v[124:127], v[16:31]
    buffer_load_dwordx4 v[164:167], v15, s[36:39], s8 offen offset:1024 sc1
    v_mfma_f32_32x32x16_bf16 v[48:63], a[156:159], v[124:127], v[48:63]
    v_mfma_f32_32x32x16_bf16 v[16:31], a[160:163], v[128:131], v[16:31]
    buffer_load_dwordx4 v[168:171], v15, s[36:39], s9 offen offset:0 sc1
    v_mfma_f32_32x32x16_bf16 v[48:63], a[164:167], v[128:131], v[48:63]
    v_mfma_f32_32x32x16_bf16 v[16:31], a[168:171], v[132:135], v[16:31]
    s_xor_b32 s71, s74, 4
    s_add_u32 s71, s71, 256
    buffer_load_dword v13, v104, s[36:39], s71 offen sc1
    buffer_load_dwordx4 v[172:175], v15, s[36:39], s9 offen offset:1024 sc1
    v_mfma_f32_32x32x16_bf16 v[48:63], a[172:175], v[132:135], v[48:63]
    s_waitcnt vmcnt(11)
    v_mfma_f32_32x32x16_bf16 v[16:31], a[176:179], v[136:139], v[16:31]
    buffer_load_dwordx4 v[112:115], v15, s[36:39], s10 offen offset:0 sc1
    v_mfma_f32_32x32x16_bf16 v[48:63], a[180:183], v[136:139], v[48:63]
    s_waitcnt vmcnt(11)
    v_mfma_f32_32x32x16_bf16 v[16:31], a[184:187], v[140:143], v[16:31]
    buffer_load_dwordx4 v[116:119], v15, s[36:39], s10 offen offset:1024 sc1
    v_mfma_f32_32x32x16_bf16 v[48:63], a[188:191], v[140:143], v[48:63]
    s_waitcnt vmcnt(10)
    v_mfma_f32_32x32x16_bf16 v[16:31], a[192:195], v[144:147], v[16:31]
    buffer_load_dwordx4 v[120:123], v15, s[36:39], s11 offen offset:0 sc1
    v_mfma_f32_32x32x16_bf16 v[48:63], a[196:199], v[144:147], v[48:63]
    s_waitcnt vmcnt(10)
    v_mfma_f32_32x32x16_bf16 v[16:31], a[200:203], v[148:151], v[16:31]
    buffer_load_dwordx4 v[124:127], v15, s[36:39], s11 offen offset:1024 sc1
    v_mfma_f32_32x32x16_bf16 v[48:63], a[204:207], v[148:151], v[48:63]
    s_waitcnt vmcnt(10)
    v_mfma_f32_32x32x16_bf16 v[16:31], a[208:211], v[152:155], v[16:31]
    buffer_load_dwordx4 v[128:131], v15, s[36:39], s12 offen offset:0 sc1
    v_mfma_f32_32x32x16_bf16 v[48:63], a[212:215], v[152:155], v[48:63]
    s_waitcnt vmcnt(10)
    v_mfma_f32_32x32x16_bf16 v[16:31], a[216:219], v[156:159], v[16:31]
    buffer_load_dwordx4 v[132:135], v15, s[36:39], s12 offen offset:1024 sc1
    v_mfma_f32_32x32x16_bf16 v[48:63], a[220:223], v[156:159], v[48:63]
    s_waitcnt vmcnt(10)
    v_mfma_f32_32x32x16_bf16 v[32:47], a[0:3], v[160:163], 0
    s_add_u32 s47, s56, 2
    s_waitcnt vmcnt(7)
    v_subrev_u32 v13, s47, v13
    v_cmp_lt_u32 vcc, 3, v13
    s_cbranch_vccnz L_aspin_41
L_aback_42:
    s_add_u32 s43, s75, 57344
    buffer_load_dwordx2 v[84:85], v107, s[36:39], s43 offen sc1
    buffer_load_dwordx2 v[86:87], v107, s[36:39], s43 offen offset:512 sc1
    v_mfma_f32_32x32x16_bf16 v[64:79], a[4:7], v[160:163], 0
    buffer_load_dwordx4 v[136:139], v15, s[36:39], s13 offen offset:0 sc1
    v_mfma_f32_32x32x16_bf16 v[32:47], a[8:11], v[164:167], v[32:47]
    ds_write_b128 v105, v[16:19] offset:0
    v_mfma_f32_32x32x16_bf16 v[64:79], a[12:15], v[164:167], v[64:79]
    buffer_load_dwordx4 v[140:143], v15, s[36:39], s13 offen offset:1024 sc1
    ds_write_b128 v106, v[20:23] offset:1024
    v_lshlrev_b32 v92, 16, v88
    v_mfma_f32_32x32x16_bf16 v[32:47], a[16:19], v[168:171], v[32:47]
    v_and_b32 v93, s51, v88
    v_mfma_f32_32x32x16_bf16 v[64:79], a[20:23], v[168:171], v[64:79]
    buffer_load_dwordx4 v[144:147], v15, s[36:39], s14 offen offset:0 sc1
    ds_write_b128 v105, v[24:27] offset:2048
    s_waitcnt vmcnt(11)
    v_mfma_f32_32x32x16_bf16 v[32:47], a[24:27], v[172:175], v[32:47]
    v_lshlrev_b32 v94, 16, v89
    v_mfma_f32_32x32x16_bf16 v[64:79], a[28:31], v[172:175], v[64:79]
    buffer_load_dwordx4 v[148:151], v15, s[36:39], s14 offen offset:1024 sc1
    ds_write_b128 v106, v[28:31] offset:3072
    v_and_b32 v95, s51, v89
    s_waitcnt vmcnt(11)
    v_mfma_f32_32x32x16_bf16 v[32:47], a[32:35], v[112:115], v[32:47]
    v_mfma_f32_32x32x16_bf16 v[64:79], a[36:39], v[112:115], v[64:79]
    s_add_u32 s79, s78, 114688
    v_add_u32 v15, s79, v1
    buffer_load_dwordx4 v[152:155], v15, s[36:39], s8 offen offset:0 sc1
    ds_write_b128 v105, v[48:51] offset:4096
    v_lshlrev_b32 v96, 16, v90
    s_waitcnt vmcnt(11)
    v_mfma_f32_32x32x16_bf16 v[32:47], a[40:43], v[116:119], v[32:47]
    ds_write_b128 v106, v[52:55] offset:5120
    v_mfma_f32_32x32x16_bf16 v[64:79], a[44:47], v[116:119], v[64:79]
    buffer_load_dwordx4 v[156:159], v15, s[36:39], s8 offen offset:1024 sc1
    v_and_b32 v97, s51, v90
    s_waitcnt vmcnt(11)
    v_mfma_f32_32x32x16_bf16 v[32:47], a[48:51], v[120:123], v[32:47]
    ds_write_b128 v105, v[56:59] offset:6144
    v_lshlrev_b32 v98, 16, v91
    v_mfma_f32_32x32x16_bf16 v[64:79], a[52:55], v[120:123], v[64:79]
    buffer_load_dwordx4 v[160:163], v15, s[36:39], s9 offen offset:0 sc1
    s_waitcnt vmcnt(11)
    v_mfma_f32_32x32x16_bf16 v[32:47], a[56:59], v[124:127], v[32:47]
    ds_write_b128 v106, v[60:63] offset:7168
    v_and_b32 v99, s51, v91
    v_mfma_f32_32x32x16_bf16 v[64:79], a[60:63], v[124:127], v[64:79]
    buffer_load_dwordx4 v[164:167], v15, s[36:39], s9 offen offset:1024 sc1
    s_waitcnt vmcnt(11)
    v_mfma_f32_32x32x16_bf16 v[32:47], a[64:67], v[128:131], v[32:47]
    v_mfma_f32_32x32x16_bf16 v[64:79], a[68:71], v[128:131], v[64:79]
    buffer_load_dwordx4 v[168:171], v15, s[36:39], s10 offen offset:0 sc1
    s_waitcnt lgkmcnt(0)
    s_barrier
    ds_read_b128 v[16:19], v111 offset:0
    s_waitcnt vmcnt(11)
    v_mfma_f32_32x32x16_bf16 v[32:47], a[72:75], v[132:135], v[32:47]
    ds_read_b128 v[20:23], v111 offset:512
    v_mfma_f32_32x32x16_bf16 v[64:79], a[76:79], v[132:135], v[64:79]
    buffer_load_dwordx4 v[172:175], v15, s[36:39], s10 offen offset:1024 sc1
    ds_read_b128 v[24:27], v111 offset:8192
    s_waitcnt vmcnt(9)
    v_mfma_f32_32x32x16_bf16 v[32:47], a[80:83], v[136:139], v[32:47]
    ds_read_b128 v[28:31], v111 offset:8704
    v_mfma_f32_32x32x16_bf16 v[64:79], a[84:87], v[136:139], v[64:79]
    buffer_load_dwordx4 v[112:115], v15, s[36:39], s11 offen offset:0 sc1
    ds_read_b128 v[48:51], v111 offset:16384
    s_waitcnt vmcnt(9)
    v_mfma_f32_32x32x16_bf16 v[32:47], a[88:91], v[140:143], v[32:47]
    ds_read_b128 v[52:55], v111 offset:16896
    v_mfma_f32_32x32x16_bf16 v[64:79], a[92:95], v[140:143], v[64:79]
    ds_read_b128 v[56:59], v111 offset:24576
    s_waitcnt vmcnt(8)
    v_mfma_f32_32x32x16_bf16 v[32:47], a[96:99], v[144:147], v[32:47]
    buffer_load_dwordx4 v[116:119], v15, s[36:39], s11 offen offset:1024 sc1
    ds_read_b128 v[60:63], v111 offset:25088
    v_mfma_f32_32x32x16_bf16 v[64:79], a[100:103], v[144:147], v[64:79]
    s_waitcnt lgkmcnt(7)
    v_add_f32 v92, v92, v16
    v_add_f32 v93, v93, v17
    v_add_f32 v94, v94, v18
    s_waitcnt vmcnt(8)
    v_mfma_f32_32x32x16_bf16 v[32:47], a[104:107], v[148:151], v[32:47]
    buffer_load_dwordx4 v[120:123], v15, s[36:39], s12 offen offset:0 sc1
    v_add_f32 v95, v95, v19
    s_waitcnt lgkmcnt(6)
    v_add_f32 v96, v96, v20
    v_mfma_f32_32x32x16_bf16 v[64:79], a[108:111], v[148:151], v[64:79]
    v_add_f32 v97, v97, v21
    v_add_f32 v98, v98, v22
    s_waitcnt vmcnt(8)
    v_mfma_f32_32x32x16_bf16 v[32:47], a[112:115], v[152:155], v[32:47]
    buffer_load_dwordx4 v[124:127], v15, s[36:39], s12 offen offset:1024 sc1
    v_add_f32 v99, v99, v23
    s_waitcnt lgkmcnt(5)
    v_add_f32 v92, v92, v24
    v_mfma_f32_32x32x16_bf16 v[64:79], a[116:119], v[152:155], v[64:79]
    v_add_f32 v93, v93, v25
    v_add_f32 v94, v94, v26
    s_waitcnt vmcnt(8)
    v_mfma_f32_32x32x16_bf16 v[32:47], a[120:123], v[156:159], v[32:47]
    buffer_load_dwordx4 v[128:131], v15, s[36:39], s13 offen offset:0 sc1
    v_add_f32 v95, v95, v27
    s_waitcnt lgkmcnt(4)
    v_add_f32 v96, v96, v28
    v_mfma_f32_32x32x16_bf16 v[64:79], a[124:127], v[156:159], v[64:79]
    v_add_f32 v97, v97, v29
    v_add_f32 v98, v98, v30
    s_waitcnt vmcnt(8)
    v_mfma_f32_32x32x16_bf16 v[32:47], a[128:131], v[160:163], v[32:47]
    buffer_load_dwordx4 v[132:135], v15, s[36:39], s13 offen offset:1024 sc1
    v_add_f32 v99, v99, v31
    s_waitcnt lgkmcnt(3)
    v_add_f32 v92, v92, v48
    v_mfma_f32_32x32x16_bf16 v[64:79], a[132:135], v[160:163], v[64:79]
    v_add_f32 v93, v93, v49
    v_add_f32 v94, v94, v50
    v_add_f32 v95, v95, v51
    s_waitcnt vmcnt(8)
    v_mfma_f32_32x32x16_bf16 v[32:47], a[136:139], v[164:167], v[32:47]
    buffer_load_dwordx4 v[136:139], v15, s[36:39], s14 offen offset:0 sc1
    s_waitcnt lgkmcnt(2)
    v_add_f32 v96, v96, v52
    v_add_f32 v97, v97, v53
    v_mfma_f32_32x32x16_bf16 v[64:79], a[140:143], v[164:167], v[64:79]
    v_add_f32 v98, v98, v54
    v_add_f32 v99, v99, v55
    s_waitcnt vmcnt(8)
    v_mfma_f32_32x32x16_bf16 v[32:47], a[144:147], v[168:171], v[32:47]
    buffer_load_dwordx4 v[140:143], v15, s[36:39], s14 offen offset:1024 sc1
    s_waitcnt lgkmcnt(1)
    v_add_f32 v92, v92, v56
    v_add_f32 v93, v93, v57
    s_waitcnt vmcnt(8)
    v_mfma_f32_32x32x16_bf16 v[32:47], a[152:155], v[172:175], v[32:47]
    v_add_f32 v94, v94, v58
    v_add_f32 v95, v95, v59
    s_waitcnt vmcnt(7)
    v_mfma_f32_32x32x16_bf16 v[32:47], a[160:163], v[112:115], v[32:47]
    s_waitcnt lgkmcnt(0)
    v_add_f32 v96, v96, v60
    v_add_f32 v97, v97, v61
    s_waitcnt vmcnt(6)
    v_mfma_f32_32x32x16_bf16 v[32:47], a[168:171], v[116:119], v[32:47]
    v_add_f32 v98, v98, v62
    v_add_f32 v99, v99, v63
    s_waitcnt vmcnt(5)
    v_mfma_f32_32x32x16_bf16 v[32:47], a[176:179], v[120:123], v[32:47]
    s_barrier
    v_cvt_pk_bf16_f32 v80, v92, v93
    v_cvt_pk_bf16_f32 v81, v94, v95
    s_waitcnt vmcnt(4)
    v_mfma_f32_32x32x16_bf16 v[32:47], a[184:187], v[124:127], v[32:47]
    v_cvt_pk_bf16_f32 v82, v96, v97
    v_cvt_pk_bf16_f32 v83, v98, v99
    s_waitcnt vmcnt(3)
    v_mfma_f32_32x32x16_bf16 v[32:47], a[192:195], v[128:131], v[32:47]
    v_lshlrev_b32 v92, 16, v84
    v_and_b32 v93, s51, v84
    s_waitcnt vmcnt(2)
    v_mfma_f32_32x32x16_bf16 v[32:47], a[200:203], v[132:135], v[32:47]
    v_lshlrev_b32 v94, 16, v85
    v_and_b32 v95, s51, v85
    s_waitcnt vmcnt(1)
    v_mfma_f32_32x32x16_bf16 v[32:47], a[208:211], v[136:139], v[32:47]
    v_lshlrev_b32 v96, 16, v86
    v_and_b32 v97, s51, v86
    s_waitcnt vmcnt(0)
    v_mfma_f32_32x32x16_bf16 v[32:47], a[216:219], v[140:143], v[32:47]
    v_lshlrev_b32 v98, 16, v87
    v_and_b32 v99, s51, v87
    v_mfma_f32_32x32x16_bf16 v[64:79], a[148:151], v[168:171], v[64:79]
    v_mfma_f32_32x32x16_bf16 v[64:79], a[156:159], v[172:175], v[64:79]
    v_mfma_f32_32x32x16_bf16 v[64:79], a[164:167], v[112:115], v[64:79]
    s_nop 6
    ds_write_b128 v105, v[32:35] offset:16384
    v_mfma_f32_32x32x16_bf16 v[64:79], a[172:175], v[116:119], v[64:79]
    v_mfma_f32_32x32x16_bf16 v[64:79], a[180:183], v[120:123], v[64:79]
    s_add_u32 s43, s77, 0
    buffer_store_dwordx4 v[80:83], v108, s[28:31], s43 offen sc1
    ds_write_b128 v106, v[36:39] offset:17408
    v_mfma_f32_32x32x16_bf16 v[64:79], a[188:191], v[124:127], v[64:79]
    v_mfma_f32_32x32x16_bf16 v[64:79], a[196:199], v[128:131], v[64:79]
    ds_write_b128 v105, v[40:43] offset:18432
    v_mfma_f32_32x32x16_bf16 v[64:79], a[204:207], v[132:135], v[64:79]
    v_mfma_f32_32x32x16_bf16 v[64:79], a[212:215], v[136:139], v[64:79]
    ds_write_b128 v106, v[44:47] offset:19456
    v_mfma_f32_32x32x16_bf16 v[64:79], a[220:223], v[140:143], v[64:79]
    s_nop 11
    ds_write_b128 v105, v[64:67] offset:20480
    ds_write_b128 v106, v[68:71] offset:21504
    ds_write_b128 v105, v[72:75] offset:22528
    ds_write_b128 v106, v[76:79] offset:23552
    s_waitcnt lgkmcnt(0)
    s_barrier
    ds_read_b128 v[32:35], v111 offset:16384
    ds_read_b128 v[36:39], v111 offset:16896
    ds_read_b128 v[40:43], v111 offset:24576
    ds_read_b128 v[44:47], v111 offset:25088
    ds_read_b128 v[64:67], v111 offset:32768
    ds_read_b128 v[68:71], v111 offset:33280
    ds_read_b128 v[72:75], v111 offset:40960
    ds_read_b128 v[76:79], v111 offset:41472
    s_waitcnt lgkmcnt(7)
    v_pk_add_f32 v[92:93], v[92:93], v[32:33]
    v_pk_add_f32 v[94:95], v[94:95], v[34:35]
    s_waitcnt lgkmcnt(6)
    v_pk_add_f32 v[96:97], v[96:97], v[36:37]
    v_pk_add_f32 v[98:99], v[98:99], v[38:39]
    s_waitcnt lgkmcnt(5)
    v_pk_add_f32 v[92:93], v[92:93], v[40:41]
    v_pk_add_f32 v[94:95], v[94:95], v[42:43]
    s_waitcnt lgkmcnt(4)
    v_pk_add_f32 v[96:97], v[96:97], v[44:45]
    v_pk_add_f32 v[98:99], v[98:99], v[46:47]
    s_waitcnt lgkmcnt(3)
    v_pk_add_f32 v[92:93], v[92:93], v[64:65]
    v_pk_add_f32 v[94:95], v[94:95], v[66:67]
    s_waitcnt lgkmcnt(2)
    v_pk_add_f32 v[96:97], v[96:97], v[68:69]
    v_pk_add_f32 v[98:99], v[98:99], v[70:71]
    s_waitcnt lgkmcnt(1)
    v_pk_add_f32 v[92:93], v[92:93], v[72:73]
    v_pk_add_f32 v[94:95], v[94:95], v[74:75]
    s_waitcnt lgkmcnt(0)
    v_pk_add_f32 v[96:97], v[96:97], v[76:77]
    v_pk_add_f32 v[98:99], v[98:99], v[78:79]
    v_cvt_pk_bf16_f32 v80, v92, v93
    v_cvt_pk_bf16_f32 v81, v94, v95
    v_cvt_pk_bf16_f32 v82, v96, v97
    v_cvt_pk_bf16_f32 v83, v98, v99
    s_add_u32 s43, s77, 28672
    buffer_store_dwordx4 v[80:83], v108, s[28:31], s43 offen sc1
    s_or_b32 s40, s57, s58
    s_or_b32 s40, s40, s59
    s_or_b32 s40, s40, s60
    s_cmp_lg_u32 s40, 0
    s_cbranch_scc1 L_fin
    s_add_u32 s40, s56, 64
    v_mov_b32 v14, s40
    s_mov_b64 exec, 1
    buffer_store_dword v14, v1, s[32:35], 0 offen sc1
    s_mov_b64 exec, -1
L_fin:
    s_waitcnt vmcnt(0)
    s_endpgm
L_spare0:
    s_waitcnt vmcnt(0) lgkmcnt(0)
    s_min_u32 s70, s60, 2
    s_mul_i32 s70, s70, 28672
    v_add_u32 v60, s70, v2
    ds_read_b64_tr_b16 v[32:33], v60 offset:0
    ds_read_b64_tr_b16 v[34:35], v60 offset:512
    ds_read_b64_tr_b16 v[36:37], v60 offset:1024
    ds_read_b64_tr_b16 v[38:39], v60 offset:1536
    ds_read_b64_tr_b16 v[40:41], v60 offset:2048
    ds_read_b64_tr_b16 v[42:43], v60 offset:2560
    v_mov_b32 v15, 0
    s_mov_b32 exec_lo, 0x00100001
    s_mov_b32 exec_hi, 0x00100001
    v_mov_b32 v15, s48
    s_mov_b64 exec, -1
    v_accvgpr_write_b32 a32, v15
    v_accvgpr_write_b32 a33, v15
    v_accvgpr_write_b32 a34, v15
    v_accvgpr_write_b32 a35, v15
    s_waitcnt lgkmcnt(4)
    s_nop 0
    v_mfma_f32_16x16x32_bf16 a[36:39], a[32:35], v[32:35], 0
    ds_read_b64_tr_b16 v[44:45], v60 offset:3072
    ds_read_b64_tr_b16 v[46:47], v60 offset:3584
    s_waitcnt lgkmcnt(4)
    v_mfma_f32_16x16x32_bf16 a[36:39], a[32:35], v[36:39], a[36:39]
    ds_read_b64_tr_b16 v[32:33], v60 offset:4096
    ds_read_b64_tr_b16 v[34:35], v60 offset:4608
    s_waitcnt lgkmcnt(4)
    v_mfma_f32_16x16x32_bf16 a[36:39], a[32:35], v[40:43], a[36:39]
    ds_read_b64_tr_b16 v[36:37], v60 offset:5120
    ds_read_b64_tr_b16 v[38:39], v60 offset:5632
    s_waitcnt lgkmcnt(4)
    v_mfma_f32_16x16x32_bf16 a[36:39], a[32:35], v[44:47], a[36:39]
    ds_read_b64_tr_b16 v[40:41], v60 offset:6144
    ds_read_b64_tr_b16 v[42:43], v60 offset:6656
    s_waitcnt lgkmcnt(4)
    v_mfma_f32_16x16x32_bf16 a[36:39], a[32:35], v[32:35], a[36:39]
    ds_read_b64_tr_b16 v[44:45], v60 offset:7168
    ds_read_b64_tr_b16 v[46:47], v60 offset:7680
    s_waitcnt lgkmcnt(4)
    v_mfma_f32_16x16x32_bf16 a[36:39], a[32:35], v[36:39], a[36:39]
    ds_read_b64_tr_b16 v[32:33], v60 offset:8192
    ds_read_b64_tr_b16 v[34:35], v60 offset:8704
    s_waitcnt lgkmcnt(4)
    v_mfma_f32_16x16x32_bf16 a[36:39], a[32:35], v[40:43], a[36:39]
    ds_read_b64_tr_b16 v[36:37], v60 offset:9216
    ds_read_b64_tr_b16 v[38:39], v60 offset:9728
    s_waitcnt lgkmcnt(4)
    v_mfma_f32_16x16x32_bf16 a[36:39], a[32:35], v[44:47], a[36:39]
    ds_read_b64_tr_b16 v[40:41], v60 offset:10240
    ds_read_b64_tr_b16 v[42:43], v60 offset:10752
    s_waitcnt lgkmcnt(4)
    v_mfma_f32_16x16x32_bf16 a[36:39], a[32:35], v[32:35], a[36:39]
    ds_read_b64_tr_b16 v[44:45], v60 offset:11264
    ds_read_b64_tr_b16 v[46:47], v60 offset:11776
    s_waitcnt lgkmcnt(4)
    v_mfma_f32_16x16x32_bf16 a[36:39], a[32:35], v[36:39], a[36:39]
    ds_read_b64_tr_b16 v[32:33], v60 offset:12288
    ds_read_b64_tr_b16 v[34:35], v60 offset:12800
    s_waitcnt lgkmcnt(4)
    v_mfma_f32_16x16x32_bf16 a[36:39], a[32:35], v[40:43], a[36:39]
    ds_read_b64_tr_b16 v[36:37], v60 offset:13312
    ds_read_b64_tr_b16 v[38:39], v60 offset:13824
    s_waitcnt lgkmcnt(4)
    v_mfma_f32_16x16x32_bf16 a[36:39], a[32:35], v[44:47], a[36:39]
    ds_read_b64_tr_b16 v[40:41], v60 offset:14336
    ds_read_b64_tr_b16 v[42:43], v60 offset:14848
    s_waitcnt lgkmcnt(4)
    v_mfma_f32_16x16x32_bf16 a[36:39], a[32:35], v[32:35], a[36:39]
    ds_read_b64_tr_b16 v[44:45], v60 offset:15360
    ds_read_b64_tr_b16 v[46:47], v60 offset:15872
    s_waitcnt lgkmcnt(4)
    v_mfma_f32_16x16x32_bf16 a[36:39], a[32:35], v[36:39], a[36:39]
    ds_read_b64_tr_b16 v[32:33], v60 offset:16384
    ds_read_b64_tr_b16 v[34:35], v60 offset:16896
    s_waitcnt lgkmcnt(4)
    v_mfma_f32_16x16x32_bf16 a[36:39], a[32:35], v[40:43], a[36:39]
    ds_read_b64_tr_b16 v[36:37], v60 offset:17408
    ds_read_b64_tr_b16 v[38:39], v60 offset:17920
    s_waitcnt lgkmcnt(4)
    v_mfma_f32_16x16x32_bf16 a[36:39], a[32:35], v[44:47], a[36:39]
    ds_read_b64_tr_b16 v[40:41], v60 offset:18432
    ds_read_b64_tr_b16 v[42:43], v60 offset:18944
    s_waitcnt lgkmcnt(4)
    v_mfma_f32_16x16x32_bf16 a[36:39], a[32:35], v[32:35], a[36:39]
    ds_read_b64_tr_b16 v[44:45], v60 offset:19456
    ds_read_b64_tr_b16 v[46:47], v60 offset:19968
    s_waitcnt lgkmcnt(4)
    v_mfma_f32_16x16x32_bf16 a[36:39], a[32:35], v[36:39], a[36:39]
    ds_read_b64_tr_b16 v[32:33], v60 offset:20480
    ds_read_b64_tr_b16 v[34:35], v60 offset:20992
    s_waitcnt lgkmcnt(4)
    v_mfma_f32_16x16x32_bf16 a[36:39], a[32:35], v[40:43], a[36:39]
    ds_read_b64_tr_b16 v[36:37], v60 offset:21504
    ds_read_b64_tr_b16 v[38:39], v60 offset:22016
    s_waitcnt lgkmcnt(4)
    v_mfma_f32_16x16x32_bf16 a[36:39], a[32:35], v[44:47], a[36:39]
    ds_read_b64_tr_b16 v[40:41], v60 offset:22528
    ds_read_b64_tr_b16 v[42:43], v60 offset:23040
    s_waitcnt lgkmcnt(4)
    v_mfma_f32_16x16x32_bf16 a[36:39], a[32:35], v[32:35], a[36:39]
    ds_read_b64_tr_b16 v[44:45], v60 offset:23552
    ds_read_b64_tr_b16 v[46:47], v60 offset:24064
    s_waitcnt lgkmcnt(4)
    v_mfma_f32_16x16x32_bf16 a[36:39], a[32:35], v[36:39], a[36:39]
    ds_read_b64_tr_b16 v[32:33], v60 offset:24576
    ds_read_b64_tr_b16 v[34:35], v60 offset:25088
    s_waitcnt lgkmcnt(4)
    v_mfma_f32_16x16x32_bf16 a[36:39], a[32:35], v[40:43], a[36:39]
    ds_read_b64_tr_b16 v[36:37], v60 offset:25600
    ds_read_b64_tr_b16 v[38:39], v60 offset:26112
    s_waitcnt lgkmcnt(4)
    v_mfma_f32_16x16x32_bf16 a[36:39], a[32:35], v[44:47], a[36:39]
    ds_read_b64_tr_b16 v[40:41], v60 offset:26624
    ds_read_b64_tr_b16 v[42:43], v60 offset:27136
    s_waitcnt lgkmcnt(4)
    v_mfma_f32_16x16x32_bf16 a[36:39], a[32:35], v[32:35], a[36:39]
    ds_read_b64_tr_b16 v[44:45], v60 offset:27648
    ds_read_b64_tr_b16 v[46:47], v60 offset:28160
    s_waitcnt lgkmcnt(4)
    v_mfma_f32_16x16x32_bf16 a[36:39], a[32:35], v[36:39], a[36:39]
    s_waitcnt lgkmcnt(2)
    v_mfma_f32_16x16x32_bf16 a[36:39], a[32:35], v[40:43], a[36:39]
    s_waitcnt lgkmcnt(0)
    v_mfma_f32_16x16x32_bf16 a[36:39], a[32:35], v[44:47], a[36:39]
    s_lshl_b32 s70, s60, 9
    v_lshlrev_b32 v60, 3, v0
    v_add_u32 v60, 159744, v60
    v_add_u32 v61, s70, v60
    s_nop 3
    v_accvgpr_read_b32 v40, a36
    v_cvt_pk_bf16_f32 v42, v40, v40
    v_and_b32 v41, s51, v42
    v_sub_f32 v41, v40, v41
    v_cvt_pk_bf16_f32 v43, v41, 0
    ds_write_b64 v61, v[42:43]
    s_waitcnt lgkmcnt(0)
    s_barrier
    v_lshlrev_b32 v13, 3, v0
    v_add_u32 v13, 159744, v13
    ds_read_b64 v[8:9], v13
    ds_read_b64 v[10:11], v13 offset:512
    ds_read_b64 v[6:7], v13 offset:1024
    s_and_b32 s40, s58, 1
    s_lshl_b32 s40, s40, 3
    s_add_u32 s40, s40, s64
    v_lshlrev_b32 v64, 7, v0
    s_add_u32 s41, s40, 0
    s_min_u32 s41, s41, 97
    s_mul_i32 s42, s41, 147
    s_lshr_b32 s42, s42, 10
    s_mul_i32 s43, s42, 7
    s_sub_u32 s41, s41, s43
    s_add_u32 s42, s42, 8
    s_cmp_ge_u32 s42, 14
    s_cselect_b32 s43, 14, 0
    s_sub_u32 s42, s42, s43
    s_mul_i32 s41, s41, 229376
    s_lshl_b32 s42, s42, 14
    s_add_u32 s41, s41, s42
    s_add_u32 s41, s41, 4038656
    buffer_load_dword v65, v64, s[32:35], s41 offen sc1
    s_add_u32 s41, s41, 8192
    buffer_load_dword v65, v64, s[32:35], s41 offen sc1
    s_add_u32 s41, s40, 16
    s_min_u32 s41, s41, 97
    s_mul_i32 s42, s41, 147
    s_lshr_b32 s42, s42, 10
    s_mul_i32 s43, s42, 7
    s_sub_u32 s41, s41, s43
    s_add_u32 s42, s42, 8
    s_cmp_ge_u32 s42, 14
    s_cselect_b32 s43, 14, 0
    s_sub_u32 s42, s42, s43
    s_mul_i32 s41, s41, 229376
    s_lshl_b32 s42, s42, 14
    s_add_u32 s41, s41, s42
    s_add_u32 s41, s41, 4038656
    buffer_load_dword v65, v64, s[32:35], s41 offen sc1
    s_add_u32 s41, s41, 8192
    buffer_load_dword v65, v64, s[32:35], s41 offen sc1
    s_add_u32 s41, s40, 32
    s_min_u32 s41, s41, 97
    s_mul_i32 s42, s41, 147
    s_lshr_b32 s42, s42, 10
    s_mul_i32 s43, s42, 7
    s_sub_u32 s41, s41, s43
    s_add_u32 s42, s42, 8
    s_cmp_ge_u32 s42, 14
    s_cselect_b32 s43, 14, 0
    s_sub_u32 s42, s42, s43
    s_mul_i32 s41, s41, 229376
    s_lshl_b32 s42, s42, 14
    s_add_u32 s41, s41, s42
    s_add_u32 s41, s41, 4038656
    buffer_load_dword v65, v64, s[32:35], s41 offen sc1
    s_add_u32 s41, s41, 8192
    buffer_load_dword v65, v64, s[32:35], s41 offen sc1
    s_add_u32 s41, s40, 48
    s_min_u32 s41, s41, 97
    s_mul_i32 s42, s41, 147
    s_lshr_b32 s42, s42, 10
    s_mul_i32 s43, s42, 7
    s_sub_u32 s41, s41, s43
    s_add_u32 s42, s42, 8
    s_cmp_ge_u32 s42, 14
    s_cselect_b32 s43, 14, 0
    s_sub_u32 s42, s42, s43
    s_mul_i32 s41, s41, 229376
    s_lshl_b32 s42, s42, 14
    s_add_u32 s41, s41, s42
    s_add_u32 s41, s41, 4038656
    buffer_load_dword v65, v64, s[32:35], s41 offen sc1
    s_add_u32 s41, s41, 8192
    buffer_load_dword v65, v64, s[32:35], s41 offen sc1
    s_add_u32 s41, s40, 64
    s_min_u32 s41, s41, 97
    s_mul_i32 s42, s41, 147
    s_lshr_b32 s42, s42, 10
    s_mul_i32 s43, s42, 7
    s_sub_u32 s41, s41, s43
    s_add_u32 s42, s42, 8
    s_cmp_ge_u32 s42, 14
    s_cselect_b32 s43, 14, 0
    s_sub_u32 s42, s42, s43
    s_mul_i32 s41, s41, 229376
    s_lshl_b32 s42, s42, 14
    s_add_u32 s41, s41, s42
    s_add_u32 s41, s41, 4038656
    buffer_load_dword v65, v64, s[32:35], s41 offen sc1
    s_add_u32 s41, s41, 8192
    buffer_load_dword v65, v64, s[32:35], s41 offen sc1
    s_add_u32 s41, s40, 80
    s_min_u32 s41, s41, 97
    s_mul_i32 s42, s41, 147
    s_lshr_b32 s42, s42, 10
    s_mul_i32 s43, s42, 7
    s_sub_u32 s41, s41, s43
    s_add_u32 s42, s42, 8
    s_cmp_ge_u32 s42, 14
    s_cselect_b32 s43, 14, 0
    s_sub_u32 s42, s42, s43
    s_mul_i32 s41, s41, 229376
    s_lshl_b32 s42, s42, 14
    s_add_u32 s41, s41, s42
    s_add_u32 s41, s41, 4038656
    buffer_load_dword v65, v64, s[32:35], s41 offen sc1
    s_add_u32 s41, s41, 8192
    buffer_load_dword v65, v64, s[32:35], s41 offen sc1
    s_add_u32 s41, s40, 96
    s_min_u32 s41, s41, 97
    s_mul_i32 s42, s41, 147
    s_lshr_b32 s42, s42, 10
    s_mul_i32 s43, s42, 7
    s_sub_u32 s41, s41, s43
    s_add_u32 s42, s42, 8
    s_cmp_ge_u32 s42, 14
    s_cselect_b32 s43, 14, 0
    s_sub_u32 s42, s42, s43
    s_mul_i32 s41, s41, 229376
    s_lshl_b32 s42, s42, 14
    s_add_u32 s41, s41, s42
    s_add_u32 s41, s41, 4038656
    buffer_load_dword v65, v64, s[32:35], s41 offen sc1
    s_add_u32 s41, s41, 8192
    buffer_load_dword v65, v64, s[32:35], s41 offen sc1
    s_waitcnt vmcnt(0) lgkmcnt(0)
    s_branch L_layer1
L_spare1:
    s_waitcnt vmcnt(0) lgkmcnt(0)
    s_branch L_fin
L_aspin_1:
    s_nop 4
    s_mov_b32 s46, s66
L_poll_3:
    buffer_load_dword v59, v58, s[32:35], s73 offen sc1
    s_waitcnt vmcnt(0)
    v_subrev_u32 v59, s47, v59
    v_cmp_lt_u32 vcc, 15, v59
    s_cbranch_vccz L_aback_2
    s_sub_u32 s46, s46, 1
    s_cmp_lg_u32 s46, 0
    s_cbranch_scc1 L_poll_3
    s_mov_b32 s66, 1
    s_branch L_aback_2
L_kvspin_4:
    s_mov_b32 s46, s66
L_kvloop_6:
    s_add_u32 s45, s57, 0
    s_and_b32 s45, s45, 7
    s_lshl_b32 s45, s45, 12
    s_add_u32 s45, s45, s6
    buffer_load_dwordx2 v[64:65], v11, s[32:35], s45 offen sc1
    buffer_load_dwordx2 v[66:67], v11, s[32:35], s45 offen offset:2048 sc1
    s_add_u32 s45, s57, 1
    s_and_b32 s45, s45, 7
    s_lshl_b32 s45, s45, 12
    s_add_u32 s45, s45, s6
    buffer_load_dwordx2 v[68:69], v11, s[32:35], s45 offen sc1
    buffer_load_dwordx2 v[70:71], v11, s[32:35], s45 offen offset:2048 sc1
    s_add_u32 s45, s57, 2
    s_and_b32 s45, s45, 7
    s_lshl_b32 s45, s45, 12
    s_add_u32 s45, s45, s6
    buffer_load_dwordx2 v[72:73], v11, s[32:35], s45 offen sc1
    buffer_load_dwordx2 v[74:75], v11, s[32:35], s45 offen offset:2048 sc1
    s_add_u32 s45, s57, 3
    s_and_b32 s45, s45, 7
    s_lshl_b32 s45, s45, 12
    s_add_u32 s45, s45, s6
    buffer_load_dwordx2 v[76:77], v11, s[32:35], s45 offen sc1
    buffer_load_dwordx2 v[78:79], v11, s[32:35], s45 offen offset:2048 sc1
    s_add_u32 s45, s57, 4
    s_and_b32 s45, s45, 7
    s_lshl_b32 s45, s45, 12
    s_add_u32 s45, s45, s6
    buffer_load_dwordx2 v[80:81], v11, s[32:35], s45 offen sc1
    buffer_load_dwordx2 v[82:83], v11, s[32:35], s45 offen offset:2048 sc1
    s_add_u32 s45, s57, 5
    s_and_b32 s45, s45, 7
    s_lshl_b32 s45, s45, 12
    s_add_u32 s45, s45, s6
    buffer_load_dwordx2 v[84:85], v11, s[32:35], s45 offen sc1
    buffer_load_dwordx2 v[86:87], v11, s[32:35], s45 offen offset:2048 sc1
    s_add_u32 s45, s57, 6
    s_and_b32 s45, s45, 7
    s_lshl_b32 s45, s45, 12
    s_add_u32 s45, s45, s6
    buffer_load_dwordx2 v[88:89], v11, s[32:35], s45 offen sc1
    buffer_load_dwordx2 v[90:91], v11, s[32:35], s45 offen offset:2048 sc1
    s_add_u32 s45, s57, 7
    s_and_b32 s45, s45, 7
    s_lshl_b32 s45, s45, 12
    s_add_u32 s45, s45, s6
    buffer_load_dwordx2 v[92:93], v11, s[32:35], s45 offen sc1
    buffer_load_dwordx2 v[94:95], v11, s[32:35], s45 offen offset:2048 sc1
    s_waitcnt vmcnt(0)
    v_mov_b32 v16, 0
    v_mov_b32 v17, 0
    v_mov_b32 v18, 0
    v_mov_b32 v19, 0
    v_mov_b32 v20, 0
    v_dot2c_f32_bf16 v16, s43, v64
    v_dot2c_f32_bf16 v17, s44, v64
    v_dot2c_f32_bf16 v18, s43, v65
    v_dot2c_f32_bf16 v19, s44, v65
    v_max3_u32 v20, v20, v64, v65
    v_dot2c_f32_bf16 v16, s43, v66
    v_dot2c_f32_bf16 v17, s44, v66
    v_dot2c_f32_bf16 v18, s43, v67
    v_dot2c_f32_bf16 v19, s44, v67
    v_max3_u32 v20, v20, v66, v67
    v_dot2c_f32_bf16 v16, s43, v68
    v_dot2c_f32_bf16 v17, s44, v68
    v_dot2c_f32_bf16 v18, s43, v69
    v_dot2c_f32_bf16 v19, s44, v69
    v_max3_u32 v20, v20, v68, v69
    v_dot2c_f32_bf16 v16, s43, v70
    v_dot2c_f32_bf16 v17, s44, v70
    v_dot2c_f32_bf16 v18, s43, v71
    v_dot2c_f32_bf16 v19, s44, v71
    v_max3_u32 v20, v20, v70, v71
    v_dot2c_f32_bf16 v16, s43, v72
    v_dot2c_f32_bf16 v17, s44, v72
    v_dot2c_f32_bf16 v18, s43, v73
    v_dot2c_f32_bf16 v19, s44, v73
    v_max3_u32 v20, v20, v72, v73
    v_dot2c_f32_bf16 v16, s43, v74
    v_dot2c_f32_bf16 v17, s44, v74
    v_dot2c_f32_bf16 v18, s43, v75
    v_dot2c_f32_bf16 v19, s44, v75
    v_max3_u32 v20, v20, v74, v75
    v_dot2c_f32_bf16 v16, s43, v76
    v_dot2c_f32_bf16 v17, s44, v76
    v_dot2c_f32_bf16 v18, s43, v77
    v_dot2c_f32_bf16 v19, s44, v77
    v_max3_u32 v20, v20, v76, v77
    v_dot2c_f32_bf16 v16, s43, v78
    v_dot2c_f32_bf16 v17, s44, v78
    v_dot2c_f32_bf16 v18, s43, v79
    v_dot2c_f32_bf16 v19, s44, v79
    v_max3_u32 v20, v20, v78, v79
    v_dot2c_f32_bf16 v16, s43, v80
    v_dot2c_f32_bf16 v17, s44, v80
    v_dot2c_f32_bf16 v18, s43, v81
    v_dot2c_f32_bf16 v19, s44, v81
    v_max3_u32 v20, v20, v80, v81
    v_dot2c_f32_bf16 v16, s43, v82
    v_dot2c_f32_bf16 v17, s44, v82
    v_dot2c_f32_bf16 v18, s43, v83
    v_dot2c_f32_bf16 v19, s44, v83
    v_max3_u32 v20, v20, v82, v83
    v_dot2c_f32_bf16 v16, s43, v84
    v_dot2c_f32_bf16 v17, s44, v84
    v_dot2c_f32_bf16 v18, s43, v85
    v_dot2c_f32_bf16 v19, s44, v85
    v_max3_u32 v20, v20, v84, v85
    v_dot2c_f32_bf16 v16, s43, v86
    v_dot2c_f32_bf16 v17, s44, v86
    v_dot2c_f32_bf16 v18, s43, v87
    v_dot2c_f32_bf16 v19, s44, v87
    v_max3_u32 v20, v20, v86, v87
    v_dot2c_f32_bf16 v16, s43, v88
    v_dot2c_f32_bf16 v17, s44, v88
    v_dot2c_f32_bf16 v18, s43, v89
    v_dot2c_f32_bf16 v19, s44, v89
    v_max3_u32 v20, v20, v88, v89
    v_dot2c_f32_bf16 v16, s43, v90
    v_dot2c_f32_bf16 v17, s44, v90
    v_dot2c_f32_bf16 v18, s43, v91
    v_dot2c_f32_bf16 v19, s44, v91
    v_max3_u32 v20, v20, v90, v91
    v_dot2c_f32_bf16 v16, s43, v92
    v_dot2c_f32_bf16 v17, s44, v92
    v_dot2c_f32_bf16 v18, s43, v93
    v_dot2c_f32_bf16 v19, s44, v93
    v_max3_u32 v20, v20, v92, v93
    v_dot2c_f32_bf16 v16, s43, v94
    v_dot2c_f32_bf16 v17, s44, v94
    v_dot2c_f32_bf16 v18, s43, v95
    v_dot2c_f32_bf16 v19, s44, v95
    v_max3_u32 v20, v20, v94, v95
    v_cmp_eq_u32 vcc, -1, v20
    s_cbranch_vccz L_kvback_5
    s_sub_u32 s46, s46, 1
    s_cmp_lg_u32 s46, 0
    s_cbranch_scc1 L_kvloop_6
    s_mov_b32 s66, 1
    s_branch L_kvback_5
L_aspin_11:
    s_nop 4
    s_mov_b32 s46, s66
L_poll_13:
    buffer_load_dword v109, v104, s[36:39], s70 offen sc1
    s_waitcnt vmcnt(0)
    v_subrev_u32 v109, s47, v109
    v_cmp_lt_u32 vcc, 3, v109
    s_cbranch_vccz L_aback_12
    s_sub_u32 s46, s46, 1
    s_cmp_lg_u32 s46, 0
    s_cbranch_scc1 L_poll_13
    s_mov_b32 s66, 1
    s_branch L_aback_12
L_aspin_14:
    s_nop 4
    s_mov_b32 s46, s66
L_poll_16:
    buffer_load_dword v13, v104, s[36:39], s71 offen sc1
    s_waitcnt vmcnt(0)
    v_subrev_u32 v13, s47, v13
    v_cmp_lt_u32 vcc, 3, v13
    s_cbranch_vccz L_aback_15
    s_sub_u32 s46, s46, 1
    s_cmp_lg_u32 s46, 0
    s_cbranch_scc1 L_poll_16
    s_mov_b32 s66, 1
    s_branch L_aback_15
L_aspin_17:
    s_nop 4
    s_mov_b32 s46, s66
L_poll_19:
    buffer_load_dword v109, v104, s[36:39], s70 offen sc1
    s_waitcnt vmcnt(0)
    v_subrev_u32 v109, s47, v109
    v_cmp_lt_u32 vcc, 3, v109
    s_cbranch_vccz L_aback_18
    s_sub_u32 s46, s46, 1
    s_cmp_lg_u32 s46, 0
    s_cbranch_scc1 L_poll_19
    s_mov_b32 s66, 1
    s_branch L_aback_18
L_aspin_20:
    s_nop 4
    s_mov_b32 s46, s66
L_poll_22:
    buffer_load_dword v13, v104, s[36:39], s71 offen sc1
    s_waitcnt vmcnt(0)
    v_subrev_u32 v13, s47, v13
    v_cmp_lt_u32 vcc, 3, v13
    s_cbranch_vccz L_aback_21
    s_sub_u32 s46, s46, 1
    s_cmp_lg_u32 s46, 0
    s_cbranch_scc1 L_poll_22
    s_mov_b32 s66, 1
    s_branch L_aback_21
L_kvspin_25:
    s_mov_b32 s46, s66
L_kvloop_27:
    s_add_u32 s45, s57, 0
    s_and_b32 s45, s45, 7
    s_lshl_b32 s45, s45, 12
    s_add_u32 s45, s45, s6
    buffer_load_dwordx2 v[96:97], v91, s[32:35], s45 offen sc1
    buffer_load_dwordx2 v[98:99], v91, s[32:35], s45 offen offset:2048 sc1
    s_add_u32 s45, s57, 1
    s_and_b32 s45, s45, 7
    s_lshl_b32 s45, s45, 12
    s_add_u32 s45, s45, s6
    buffer_load_dwordx2 v[100:101], v91, s[32:35], s45 offen sc1
    buffer_load_dwordx2 v[102:103], v91, s[32:35], s45 offen offset:2048 sc1
    s_add_u32 s45, s57, 2
    s_and_b32 s45, s45, 7
    s_lshl_b32 s45, s45, 12
    s_add_u32 s45, s45, s6
    buffer_load_dwordx2 v[104:105], v91, s[32:35], s45 offen sc1
    buffer_load_dwordx2 v[106:107], v91, s[32:35], s45 offen offset:2048 sc1
    s_add_u32 s45, s57, 3
    s_and_b32 s45, s45, 7
    s_lshl_b32 s45, s45, 12
    s_add_u32 s45, s45, s6
    buffer_load_dwordx2 v[108:109], v91, s[32:35], s45 offen sc1
    buffer_load_dwordx2 v[110:111], v91, s[32:35], s45 offen offset:2048 sc1
    s_add_u32 s45, s57, 4
    s_and_b32 s45, s45, 7
    s_lshl_b32 s45, s45, 12
    s_add_u32 s45, s45, s6
    buffer_load_dwordx2 v[112:113], v91, s[32:35], s45 offen sc1
    buffer_load_dwordx2 v[114:115], v91, s[32:35], s45 offen offset:2048 sc1
    s_add_u32 s45, s57, 5
    s_and_b32 s45, s45, 7
    s_lshl_b32 s45, s45, 12
    s_add_u32 s45, s45, s6
    buffer_load_dwordx2 v[116:117], v91, s[32:35], s45 offen sc1
    buffer_load_dwordx2 v[118:119], v91, s[32:35], s45 offen offset:2048 sc1
    s_add_u32 s45, s57, 6
    s_and_b32 s45, s45, 7
    s_lshl_b32 s45, s45, 12
    s_add_u32 s45, s45, s6
    buffer_load_dwordx2 v[120:121], v91, s[32:35], s45 offen sc1
    buffer_load_dwordx2 v[122:123], v91, s[32:35], s45 offen offset:2048 sc1
    s_add_u32 s45, s57, 7
    s_and_b32 s45, s45, 7
    s_lshl_b32 s45, s45, 12
    s_add_u32 s45, s45, s6
    buffer_load_dwordx2 v[124:125], v91, s[32:35], s45 offen sc1
    buffer_load_dwordx2 v[126:127], v91, s[32:35], s45 offen offset:2048 sc1
    s_waitcnt vmcnt(0)
    v_mov_b32 v16, 0
    v_mov_b32 v17, 0
    v_mov_b32 v18, 0
    v_mov_b32 v19, 0
    v_mov_b32 v20, 0
    v_dot2c_f32_bf16 v16, s43, v96
    v_dot2c_f32_bf16 v17, s44, v96
    v_dot2c_f32_bf16 v18, s43, v97
    v_dot2c_f32_bf16 v19, s44, v97
    v_max3_u32 v20, v20, v96, v97
    v_dot2c_f32_bf16 v16, s43, v98
    v_dot2c_f32_bf16 v17, s44, v98
    v_dot2c_f32_bf16 v18, s43, v99
    v_dot2c_f32_bf16 v19, s44, v99
    v_max3_u32 v20, v20, v98, v99
    v_dot2c_f32_bf16 v16, s43, v100
    v_dot2c_f32_bf16 v17, s44, v100
    v_dot2c_f32_bf16 v18, s43, v101
    v_dot2c_f32_bf16 v19, s44, v101
    v_max3_u32 v20, v20, v100, v101
    v_dot2c_f32_bf16 v16, s43, v102
    v_dot2c_f32_bf16 v17, s44, v102
    v_dot2c_f32_bf16 v18, s43, v103
    v_dot2c_f32_bf16 v19, s44, v103
    v_max3_u32 v20, v20, v102, v103
    v_dot2c_f32_bf16 v16, s43, v104
    v_dot2c_f32_bf16 v17, s44, v104
    v_dot2c_f32_bf16 v18, s43, v105
    v_dot2c_f32_bf16 v19, s44, v105
    v_max3_u32 v20, v20, v104, v105
    v_dot2c_f32_bf16 v16, s43, v106
    v_dot2c_f32_bf16 v17, s44, v106
    v_dot2c_f32_bf16 v18, s43, v107
    v_dot2c_f32_bf16 v19, s44, v107
    v_max3_u32 v20, v20, v106, v107
    v_dot2c_f32_bf16 v16, s43, v108
    v_dot2c_f32_bf16 v17, s44, v108
    v_dot2c_f32_bf16 v18, s43, v109
    v_dot2c_f32_bf16 v19, s44, v109
    v_max3_u32 v20, v20, v108, v109
    v_dot2c_f32_bf16 v16, s43, v110
    v_dot2c_f32_bf16 v17, s44, v110
    v_dot2c_f32_bf16 v18, s43, v111
    v_dot2c_f32_bf16 v19, s44, v111
    v_max3_u32 v20, v20, v110, v111
    v_dot2c_f32_bf16 v16, s43, v112
    v_dot2c_f32_bf16 v17, s44, v112
    v_dot2c_f32_bf16 v18, s43, v113
    v_dot2c_f32_bf16 v19, s44, v113
    v_max3_u32 v20, v20, v112, v113
    v_dot2c_f32_bf16 v16, s43, v114
    v_dot2c_f32_bf16 v17, s44, v114
    v_dot2c_f32_bf16 v18, s43, v115
    v_dot2c_f32_bf16 v19, s44, v115
    v_max3_u32 v20, v20, v114, v115
    v_dot2c_f32_bf16 v16, s43, v116
    v_dot2c_f32_bf16 v17, s44, v116
    v_dot2c_f32_bf16 v18, s43, v117
    v_dot2c_f32_bf16 v19, s44, v117
    v_max3_u32 v20, v20, v116, v117
    v_dot2c_f32_bf16 v16, s43, v118
    v_dot2c_f32_bf16 v17, s44, v118
    v_dot2c_f32_bf16 v18, s43, v119
    v_dot2c_f32_bf16 v19, s44, v119
    v_max3_u32 v20, v20, v118, v119
    v_dot2c_f32_bf16 v16, s43, v120
    v_dot2c_f32_bf16 v17, s44, v120
    v_dot2c_f32_bf16 v18, s43, v121
    v_dot2c_f32_bf16 v19, s44, v121
    v_max3_u32 v20, v20, v120, v121
    v_dot2c_f32_bf16 v16, s43, v122
    v_dot2c_f32_bf16 v17, s44, v122
    v_dot2c_f32_bf16 v18, s43, v123
    v_dot2c_f32_bf16 v19, s44, v123
    v_max3_u32 v20, v20, v122, v123
    v_dot2c_f32_bf16 v16, s43, v124
    v_dot2c_f32_bf16 v17, s44, v124
    v_dot2c_f32_bf16 v18, s43, v125
    v_dot2c_f32_bf16 v19, s44, v125
    v_max3_u32 v20, v20, v124, v125
    v_dot2c_f32_bf16 v16, s43, v126
    v_dot2c_f32_bf16 v17, s44, v126
    v_dot2c_f32_bf16 v18, s43, v127
    v_dot2c_f32_bf16 v19, s44, v127
    v_max3_u32 v20, v20, v126, v127
    v_cmp_eq_u32 vcc, -1, v20
    s_cbranch_vccz L_kvback_26
    s_sub_u32 s46, s46, 1
    s_cmp_lg_u32 s46, 0
    s_cbranch_scc1 L_kvloop_27
    s_mov_b32 s66, 1
    s_branch L_kvback_26
L_aspin_32:
    s_nop 4
    s_mov_b32 s46, s66
L_poll_34:
    buffer_load_dword v109, v104, s[36:39], s70 offen sc1
    s_waitcnt vmcnt(0)
    v_subrev_u32 v109, s47, v109
    v_cmp_lt_u32 vcc, 3, v109
    s_cbranch_vccz L_aback_33
    s_sub_u32 s46, s46, 1
    s_cmp_lg_u32 s46, 0
    s_cbranch_scc1 L_poll_34
    s_mov_b32 s66, 1
    s_branch L_aback_33
L_aspin_35:
    s_nop 4
    s_mov_b32 s46, s66
L_poll_37:
    buffer_load_dword v13, v104, s[36:39], s71 offen sc1
    s_waitcnt vmcnt(0)
    v_subrev_u32 v13, s47, v13
    v_cmp_lt_u32 vcc, 3, v13
    s_cbranch_vccz L_aback_36
    s_sub_u32 s46, s46, 1
    s_cmp_lg_u32 s46, 0
    s_cbranch_scc1 L_poll_37
    s_mov_b32 s66, 1
    s_branch L_aback_36
L_aspin_38:
    s_nop 4
    s_mov_b32 s46, s66
L_poll_40:
    buffer_load_dword v109, v104, s[36:39], s70 offen sc1
    s_waitcnt vmcnt(0)
    v_subrev_u32 v109, s47, v109
    v_cmp_lt_u32 vcc, 3, v109
    s_cbranch_vccz L_aback_39
    s_sub_u32 s46, s46, 1
    s_cmp_lg_u32 s46, 0
    s_cbranch_scc1 L_poll_40
    s_mov_b32 s66, 1
    s_branch L_aback_39
L_aspin_41:
    s_nop 4
    s_mov_b32 s46, s66
L_poll_43:
    buffer_load_dword v13, v104, s[36:39], s71 offen sc1
    s_waitcnt vmcnt(0)
    v_subrev_u32 v13, s47, v13
    v_cmp_lt_u32 vcc, 3, v13
    s_cbranch_vccz L_aback_42
    s_sub_u32 s46, s46, 1
    s_cmp_lg_u32 s46, 0
    s_cbranch_scc1 L_poll_43
    s_mov_b32 s66, 1
    s_branch L_aback_42
L_fastend:
L_slow:
    s_waitcnt vmcnt(0) lgkmcnt(0)
    s_nop 7
    s_lshl_b32 s44, s74, 12
    v_add_u32 v14, s44, v13
    s_add_u32 s74, s74, 1
    s_cmp_eq_u32 s74, 7
    s_cselect_b32 s74, 0, s74
    ds_read_b64_tr_b16 a[0:1], v14 offset:0
    ds_read_b64_tr_b16 a[2:3], v14 offset:256
    ds_read_b64_tr_b16 a[4:5], v14 offset:1024
    ds_read_b64_tr_b16 a[6:7], v14 offset:1280
    ds_read_b64_tr_b16 a[8:9], v14 offset:2048
    ds_read_b64_tr_b16 a[10:11], v14 offset:2304
    s_waitcnt lgkmcnt(4)
    v_mfma_f32_32x32x16_bf16 v[48:63], a[0:3], v[64:67], 0
    ds_read_b64_tr_b16 a[12:13], v14 offset:3072
    ds_read_b64_tr_b16 a[14:15], v14 offset:3328
    s_mul_i32 s77, s59, 16
    s_add_u32 s77, s77, s58
    s_lshl_b32 s77, s77, 2
    s_add_u32 s77, s77, s60
    s_mul_i32 s77, s77, 1792
    s_add_u32 s77, s77, 917504
    s_mov_b64 exec, 16383
    buffer_load_dword v10, v9, s[36:39], s77 offen
    s_mov_b64 exec, -1
    s_waitcnt lgkmcnt(4)
    v_mfma_f32_32x32x16_bf16 v[48:63], a[4:7], v[68:71], v[48:63]
    s_lshl_b32 s44, s74, 12
    v_add_u32 v15, s44, v13
    s_add_u32 s74, s74, 1
    s_cmp_eq_u32 s74, 7
    s_cselect_b32 s74, 0, s74
    ds_read_b64_tr_b16 a[0:1], v15 offset:0
    ds_read_b64_tr_b16 a[2:3], v15 offset:256
    s_waitcnt lgkmcnt(4)
    v_mfma_f32_32x32x16_bf16 v[48:63], a[8:11], v[72:75], v[48:63]
    ds_read_b64_tr_b16 a[4:5], v15 offset:1024
    ds_read_b64_tr_b16 a[6:7], v15 offset:1280
    s_mul_i32 s77, s59, 16
    s_add_u32 s77, s77, s58
    s_lshl_b32 s77, s77, 2
    s_add_u32 s77, s77, s60
    s_mul_i32 s77, s77, 2304
    s_add_u32 s77, s77, 1146880
    s_mov_b64 exec, 262143
    buffer_load_dword v10, v9, s[36:39], s77 offen
    s_mov_b64 exec, -1
    s_waitcnt lgkmcnt(4)
    v_mfma_f32_32x32x16_bf16 v[48:63], a[12:15], v[76:79], v[48:63]
    ds_read_b64_tr_b16 a[8:9], v15 offset:2048
    ds_read_b64_tr_b16 a[10:11], v15 offset:2304
    s_waitcnt lgkmcnt(4)
    v_mfma_f32_32x32x16_bf16 v[48:63], a[0:3], v[80:83], v[48:63]
    ds_read_b64_tr_b16 a[12:13], v15 offset:3072
    ds_read_b64_tr_b16 a[14:15], v15 offset:3328
    s_mul_i32 s75, s60, 7168
    s_add_u32 m0, s75, 86016
    s_nop 0
    buffer_load_dwordx4 v8, s[20:23], m0 offen offset:0 sc1 lds
    s_waitcnt lgkmcnt(4)
    v_mfma_f32_32x32x16_bf16 v[48:63], a[4:7], v[84:87], v[48:63]
    s_lshl_b32 s44, s74, 12
    v_add_u32 v14, s44, v13
    s_add_u32 s74, s74, 1
    s_cmp_eq_u32 s74, 7
    s_cselect_b32 s74, 0, s74
    ds_read_b64_tr_b16 a[0:1], v14 offset:0
    ds_read_b64_tr_b16 a[2:3], v14 offset:256
    s_waitcnt lgkmcnt(4)
    v_mfma_f32_32x32x16_bf16 v[48:63], a[8:11], v[88:91], v[48:63]
    ds_read_b64_tr_b16 a[4:5], v14 offset:1024
    ds_read_b64_tr_b16 a[6:7], v14 offset:1280
    buffer_load_dwordx4 v8, s[20:23], m0 offen offset:1024 sc1 lds
    s_waitcnt lgkmcnt(4)
    v_mfma_f32_32x32x16_bf16 v[48:63], a[12:15], v[92:95], v[48:63]
    ds_read_b64_tr_b16 a[8:9], v14 offset:2048
    ds_read_b64_tr_b16 a[10:11], v14 offset:2304
    s_waitcnt lgkmcnt(4)
    v_mfma_f32_32x32x16_bf16 v[48:63], a[0:3], v[96:99], v[48:63]
    ds_read_b64_tr_b16 a[12:13], v14 offset:3072
    ds_read_b64_tr_b16 a[14:15], v14 offset:3328
    s_waitcnt lgkmcnt(4)
    v_mfma_f32_32x32x16_bf16 v[48:63], a[4:7], v[100:103], v[48:63]
    s_lshl_b32 s44, s74, 12
    v_add_u32 v15, s44, v13
    s_add_u32 s74, s74, 1
    s_cmp_eq_u32 s74, 7
    s_cselect_b32 s74, 0, s74
    ds_read_b64_tr_b16 a[0:1], v15 offset:0
    ds_read_b64_tr_b16 a[2:3], v15 offset:256
    buffer_load_dwordx4 v8, s[20:23], m0 offen offset:2048 sc1 lds
    s_waitcnt lgkmcnt(4)
    v_mfma_f32_32x32x16_bf16 v[48:63], a[8:11], v[104:107], v[48:63]
    ds_read_b64_tr_b16 a[4:5], v15 offset:1024
    ds_read_b64_tr_b16 a[6:7], v15 offset:1280
    s_waitcnt lgkmcnt(4)
    v_mfma_f32_32x32x16_bf16 v[48:63], a[12:15], v[108:111], v[48:63]
    ds_read_b64_tr_b16 a[8:9], v15 offset:2048
    ds_read_b64_tr_b16 a[10:11], v15 offset:2304
    buffer_load_dwordx4 v8, s[20:23], m0 offen offset:3072 sc1 lds
    s_waitcnt lgkmcnt(4)
    v_mfma_f32_32x32x16_bf16 v[48:63], a[0:3], v[112:115], v[48:63]
    ds_read_b64_tr_b16 a[12:13], v15 offset:3072
    ds_read_b64_tr_b16 a[14:15], v15 offset:3328
    s_waitcnt lgkmcnt(4)
    v_mfma_f32_32x32x16_bf16 v[48:63], a[4:7], v[116:119], v[48:63]
    s_lshl_b32 s44, s74, 12
    v_add_u32 v14, s44, v13
    s_add_u32 s74, s74, 1
    s_cmp_eq_u32 s74, 7
    s_cselect_b32 s74, 0, s74
    ds_read_b64_tr_b16 a[0:1], v14 offset:0
    ds_read_b64_tr_b16 a[2:3], v14 offset:256
    s_add_u32 m0, s75, 90112
    s_nop 0
    buffer_load_dwordx4 v8, s[20:23], m0 offen offset:0 sc1 lds
    s_waitcnt lgkmcnt(4)
    v_mfma_f32_32x32x16_bf16 v[48:63], a[8:11], v[120:123], v[48:63]
    ds_read_b64_tr_b16 a[4:5], v14 offset:1024
    ds_read_b64_tr_b16 a[6:7], v14 offset:1280
    s_waitcnt lgkmcnt(4)
    v_mfma_f32_32x32x16_bf16 v[48:63], a[12:15], v[124:127], v[48:63]
    ds_read_b64_tr_b16 a[8:9], v14 offset:2048
    ds_read_b64_tr_b16 a[10:11], v14 offset:2304
    buffer_load_dwordx4 v8, s[20:23], m0 offen offset:1024 sc1 lds
    s_waitcnt lgkmcnt(4)
    v_mfma_f32_32x32x16_bf16 v[48:63], a[0:3], v[128:131], v[48:63]
    ds_read_b64_tr_b16 a[12:13], v14 offset:3072
    ds_read_b64_tr_b16 a[14:15], v14 offset:3328
    s_waitcnt lgkmcnt(4)
    v_mfma_f32_32x32x16_bf16 v[48:63], a[4:7], v[132:135], v[48:63]
    s_lshl_b32 s44, s74, 12
    v_add_u32 v15, s44, v13
    s_add_u32 s74, s74, 1
    s_cmp_eq_u32 s74, 7
    s_cselect_b32 s74, 0, s74
    ds_read_b64_tr_b16 a[0:1], v15 offset:0
    ds_read_b64_tr_b16 a[2:3], v15 offset:256
    s_waitcnt lgkmcnt(4)
    v_mfma_f32_32x32x16_bf16 v[48:63], a[8:11], v[136:139], v[48:63]
    ds_read_b64_tr_b16 a[4:5], v15 offset:1024
    ds_read_b64_tr_b16 a[6:7], v15 offset:1280
    buffer_load_dwordx4 v8, s[20:23], m0 offen offset:2048 sc1 lds
    s_waitcnt lgkmcnt(4)
    v_mfma_f32_32x32x16_bf16 v[48:63], a[12:15], v[140:143], v[48:63]
    ds_read_b64_tr_b16 a[8:9], v15 offset:2048
    ds_read_b64_tr_b16 a[10:11], v15 offset:2304
    s_waitcnt lgkmcnt(4)
    v_mfma_f32_32x32x16_bf16 v[48:63], a[0:3], v[144:147], v[48:63]
    ds_read_b64_tr_b16 a[12:13], v15 offset:3072
    ds_read_b64_tr_b16 a[14:15], v15 offset:3328
    s_lshl_b32 s24, s58, 2
    s_add_u32 s24, s24, s60
    s_mul_i32 s24, s24, 28672
    s_add_u32 s24, s24, 2433024
    buffer_load_dwordx4 a[224:227], v1, s[20:23], s24 offen offset:0 sc1
    s_waitcnt lgkmcnt(4)
    v_mfma_f32_32x32x16_bf16 v[48:63], a[4:7], v[148:151], v[48:63]
    s_lshl_b32 s44, s74, 12
    v_add_u32 v14, s44, v13
    s_add_u32 s74, s74, 1
    s_cmp_eq_u32 s74, 7
    s_cselect_b32 s74, 0, s74
    ds_read_b64_tr_b16 a[0:1], v14 offset:0
    ds_read_b64_tr_b16 a[2:3], v14 offset:256
    s_waitcnt lgkmcnt(4)
    v_mfma_f32_32x32x16_bf16 v[48:63], a[8:11], v[152:155], v[48:63]
    ds_read_b64_tr_b16 a[4:5], v14 offset:1024
    ds_read_b64_tr_b16 a[6:7], v14 offset:1280
    buffer_load_dwordx4 a[228:231], v1, s[20:23], s24 offen offset:1024 sc1
    s_waitcnt lgkmcnt(4)
    v_mfma_f32_32x32x16_bf16 v[48:63], a[12:15], v[156:159], v[48:63]
    ds_read_b64_tr_b16 a[8:9], v14 offset:2048
    ds_read_b64_tr_b16 a[10:11], v14 offset:2304
    s_waitcnt lgkmcnt(4)
    v_mfma_f32_32x32x16_bf16 v[48:63], a[0:3], v[160:163], v[48:63]
    ds_read_b64_tr_b16 a[12:13], v14 offset:3072
    ds_read_b64_tr_b16 a[14:15], v14 offset:3328
    buffer_load_dwordx4 a[232:235], v1, s[20:23], s24 offen offset:2048 sc1
    s_waitcnt lgkmcnt(4)
    v_mfma_f32_32x32x16_bf16 v[48:63], a[4:7], v[164:167], v[48:63]
    s_waitcnt lgkmcnt(2)
    v_mfma_f32_32x32x16_bf16 v[48:63], a[8:11], v[168:171], v[48:63]
    s_waitcnt lgkmcnt(0)
    v_mfma_f32_32x32x16_bf16 v[48:63], a[12:15], v[172:175], v[48:63]
    buffer_load_dwordx4 a[236:239], v1, s[20:23], s24 offen offset:3072 sc1
    v_mov_b32 v32, s50
    v_mov_b32 v33, s49
    s_nop 8
    v_pk_add_f32 v[48:49], v[48:49], v[32:33] op_sel_hi:[1,0]
    v_pk_mul_f32 v[36:37], v[48:49], v[32:33] op_sel:[0,1] op_sel_hi:[1,1]
    v_exp_f32 v36, v36 clamp
    v_exp_f32 v37, v37 clamp
    v_max_f32 v48, s50, v48
    v_max_f32 v49, s50, v49
    v_pk_add_f32 v[48:49], v[48:49], v[36:37]
    v_cvt_pk_bf16_f32 v48, v48, v49
    v_pk_add_f32 v[50:51], v[50:51], v[32:33] op_sel_hi:[1,0]
    v_pk_mul_f32 v[38:39], v[50:51], v[32:33] op_sel:[0,1] op_sel_hi:[1,1]
    s_add_u32 s24, s24, 4096
    buffer_load_dwordx4 a[240:243], v1, s[20:23], s24 offen offset:0 sc1
    v_exp_f32 v38, v38 clamp
    v_exp_f32 v39, v39 clamp
    v_max_f32 v50, s50, v50
    v_max_f32 v51, s50, v51
    v_pk_add_f32 v[50:51], v[50:51], v[38:39]
    v_cvt_pk_bf16_f32 v49, v50, v51
    v_pk_add_f32 v[52:53], v[52:53], v[32:33] op_sel_hi:[1,0]
    v_pk_mul_f32 v[36:37], v[52:53], v[32:33] op_sel:[0,1] op_sel_hi:[1,1]
    v_exp_f32 v36, v36 clamp
    v_exp_f32 v37, v37 clamp
    v_max_f32 v52, s50, v52
    v_max_f32 v53, s50, v53
    buffer_load_dwordx4 a[244:247], v1, s[20:23], s24 offen offset:1024 sc1
    v_pk_add_f32 v[52:53], v[52:53], v[36:37]
    v_cvt_pk_bf16_f32 v50, v52, v53
    v_pk_add_f32 v[54:55], v[54:55], v[32:33] op_sel_hi:[1,0]
    v_pk_mul_f32 v[38:39], v[54:55], v[32:33] op_sel:[0,1] op_sel_hi:[1,1]
    v_exp_f32 v38, v38 clamp
    v_exp_f32 v39, v39 clamp
    v_max_f32 v54, s50, v54
    v_max_f32 v55, s50, v55
    v_pk_add_f32 v[54:55], v[54:55], v[38:39]
    v_cvt_pk_bf16_f32 v51, v54, v55
    v_pk_add_f32 v[56:57], v[56:57], v[32:33] op_sel_hi:[1,0]
    v_pk_mul_f32 v[36:37], v[56:57], v[32:33] op_sel:[0,1] op_sel_hi:[1,1]
    v_exp_f32 v36, v36 clamp
    v_exp_f32 v37, v37 clamp
    v_max_f32 v56, s50, v56
    v_max_f32 v57, s50, v57
    v_pk_add_f32 v[56:57], v[56:57], v[36:37]
    v_cvt_pk_bf16_f32 v52, v56, v57
    s_add_u32 s45, s57, 0
    s_and_b32 s45, s45, 7
    s_lshl_b32 s45, s45, 12
    s_add_u32 s45, s45, s6
    buffer_load_dwordx2 v[64:65], v11, s[32:35], s45 offen sc1
    buffer_load_dwordx2 v[66:67], v11, s[32:35], s45 offen offset:2048 sc1
    v_pk_add_f32 v[58:59], v[58:59], v[32:33] op_sel_hi:[1,0]
    v_pk_mul_f32 v[38:39], v[58:59], v[32:33] op_sel:[0,1] op_sel_hi:[1,1]
    v_exp_f32 v38, v38 clamp
    v_exp_f32 v39, v39 clamp
    v_max_f32 v58, s50, v58
    v_max_f32 v59, s50, v59
    s_add_u32 s45, s57, 1
    s_and_b32 s45, s45, 7
    s_lshl_b32 s45, s45, 12
    s_add_u32 s45, s45, s6
    buffer_load_dwordx2 v[68:69], v11, s[32:35], s45 offen sc1
    buffer_load_dwordx2 v[70:71], v11, s[32:35], s45 offen offset:2048 sc1
    v_pk_add_f32 v[58:59], v[58:59], v[38:39]
    v_cvt_pk_bf16_f32 v53, v58, v59
    v_pk_add_f32 v[60:61], v[60:61], v[32:33] op_sel_hi:[1,0]
    v_pk_mul_f32 v[36:37], v[60:61], v[32:33] op_sel:[0,1] op_sel_hi:[1,1]
    v_exp_f32 v36, v36 clamp
    v_exp_f32 v37, v37 clamp
    s_add_u32 s45, s57, 2
    s_and_b32 s45, s45, 7
    s_lshl_b32 s45, s45, 12
    s_add_u32 s45, s45, s6
    buffer_load_dwordx2 v[72:73], v11, s[32:35], s45 offen sc1
    buffer_load_dwordx2 v[74:75], v11, s[32:35], s45 offen offset:2048 sc1
    v_max_f32 v60, s50, v60
    v_max_f32 v61, s50, v61
    v_pk_add_f32 v[60:61], v[60:61], v[36:37]
    v_cvt_pk_bf16_f32 v54, v60, v61
    v_pk_add_f32 v[62:63], v[62:63], v[32:33] op_sel_hi:[1,0]
    v_pk_mul_f32 v[38:39], v[62:63], v[32:33] op_sel:[0,1] op_sel_hi:[1,1]
    s_add_u32 s45, s57, 3
    s_and_b32 s45, s45, 7
    s_lshl_b32 s45, s45, 12
    s_add_u32 s45, s45, s6
    buffer_load_dwordx2 v[76:77], v11, s[32:35], s45 offen sc1
    buffer_load_dwordx2 v[78:79], v11, s[32:35], s45 offen offset:2048 sc1
    v_exp_f32 v38, v38 clamp
    v_exp_f32 v39, v39 clamp
    v_max_f32 v62, s50, v62
    v_max_f32 v63, s50, v63
    v_pk_add_f32 v[62:63], v[62:63], v[38:39]
    v_cvt_pk_bf16_f32 v55, v62, v63
    s_add_u32 s45, s57, 4
    s_and_b32 s45, s45, 7
    s_lshl_b32 s45, s45, 12
    s_add_u32 s45, s45, s6
    buffer_load_dwordx2 v[80:81], v11, s[32:35], s45 offen sc1
    buffer_load_dwordx2 v[82:83], v11, s[32:35], s45 offen offset:2048 sc1
    v_cndmask_b32 v54, v54, 0, s[54:55]
    v_cndmask_b32 v55, v55, 0, s[54:55]
    s_mul_i32 s40, s58, 7
    v_lshrrev_b32 v16, 5, v0
    v_add_u32 v16, s40, v16
    v_and_b32 v17, 31, v0
    s_add_u32 s45, s57, 5
    s_and_b32 s45, s45, 7
    s_lshl_b32 s45, s45, 12
    s_add_u32 s45, s45, s6
    buffer_load_dwordx2 v[84:85], v11, s[32:35], s45 offen sc1
    buffer_load_dwordx2 v[86:87], v11, s[32:35], s45 offen offset:2048 sc1
    v_lshlrev_b32 v17, 4, v17
    v_and_b32 v18, 1, v16
    v_lshl_add_u32 v17, v18, 9, v17
    v_lshrrev_b32 v16, 1, v16
    v_add_u32 v18, 0, v16
    v_and_b32 v19, 1, v18
    s_add_u32 s45, s57, 6
    s_and_b32 s45, s45, 7
    s_lshl_b32 s45, s45, 12
    s_add_u32 s45, s45, s6
    buffer_load_dwordx2 v[88:89], v11, s[32:35], s45 offen sc1
    buffer_load_dwordx2 v[90:91], v11, s[32:35], s45 offen offset:2048 sc1
    v_lshrrev_b32 v18, 1, v18
    v_lshl_add_u32 v18, v18, 10, v17
    v_lshl_add_u32 v56, v19, 3, v18
    v_add_u32 v18, 1, v16
    v_and_b32 v19, 1, v18
    v_lshrrev_b32 v18, 1, v18
    s_add_u32 s45, s57, 7
    s_and_b32 s45, s45, 7
    s_lshl_b32 s45, s45, 12
    s_add_u32 s45, s45, s6
    buffer_load_dwordx2 v[92:93], v11, s[32:35], s45 offen sc1
    buffer_load_dwordx2 v[94:95], v11, s[32:35], s45 offen offset:2048 sc1
    v_lshl_add_u32 v18, v18, 10, v17
    v_lshl_add_u32 v57, v19, 3, v18
    v_add_u32 v18, 2, v16
    v_and_b32 v19, 1, v18
    v_lshrrev_b32 v18, 1, v18
    v_lshl_add_u32 v18, v18, 10, v17
    v_lshl_add_u32 v58, v19, 3, v18
    v_add_u32 v18, 3, v16
    v_and_b32 v19, 1, v18
    v_lshrrev_b32 v18, 1, v18
    v_lshl_add_u32 v18, v18, 10, v17
    v_lshl_add_u32 v59, v19, 3, v18
    s_lshr_b32 s40, s60, 1
    s_lshl_b32 s40, s40, 10
    s_and_b32 s41, s60, 1
    s_lshl_b32 s41, s41, 3
    s_add_u32 s40, s40, s41
    v_add_u32 v60, s40, v12
    s_lshl_b32 s40, s64, 7
    s_lshl_b32 s41, s58, 2
    s_add_u32 s40, s40, s41
    s_add_u32 s3, s40, 1434624
    buffer_load_dwordx4 a[248:251], v1, s[20:23], s24 offen offset:2048 sc1
    buffer_load_dwordx4 a[252:255], v1, s[20:23], s24 offen offset:3072 sc1
    s_add_u32 s24, s24, 4096
    buffer_load_dwordx4 v[176:179], v1, s[20:23], s24 offen offset:0 sc1
    buffer_load_dwordx4 v[180:183], v1, s[20:23], s24 offen offset:1024 sc1
    buffer_load_dwordx4 v[184:187], v1, s[20:23], s24 offen offset:2048 sc1
    buffer_load_dwordx4 v[188:191], v1, s[20:23], s24 offen offset:3072 sc1
    s_add_u32 s24, s24, 4096
    buffer_load_dwordx4 v[192:195], v1, s[20:23], s24 offen offset:0 sc1
    buffer_load_dwordx4 v[196:199], v1, s[20:23], s24 offen offset:1024 sc1
    s_mov_b32 s43, 0x3f80
    s_mov_b32 s44, 0x3f800000
    v_mov_b32 v16, 0
    v_mov_b32 v17, 0
    v_mov_b32 v18, 0
    v_mov_b32 v19, 0
    v_mov_b32 v20, 0
    s_waitcnt vmcnt(23)
    v_dot2c_f32_bf16 v16, s43, v64
    v_dot2c_f32_bf16 v17, s44, v64
    v_dot2c_f32_bf16 v18, s43, v65
    v_dot2c_f32_bf16 v19, s44, v65
    v_max3_u32 v20, v20, v64, v65
    s_waitcnt vmcnt(22)
    v_dot2c_f32_bf16 v16, s43, v66
    v_dot2c_f32_bf16 v17, s44, v66
    v_dot2c_f32_bf16 v18, s43, v67
    v_dot2c_f32_bf16 v19, s44, v67
    v_max3_u32 v20, v20, v66, v67
    s_waitcnt vmcnt(21)
    v_dot2c_f32_bf16 v16, s43, v68
    v_dot2c_f32_bf16 v17, s44, v68
    v_dot2c_f32_bf16 v18, s43, v69
    v_dot2c_f32_bf16 v19, s44, v69
    v_max3_u32 v20, v20, v68, v69
    s_waitcnt vmcnt(20)
    v_dot2c_f32_bf16 v16, s43, v70
    v_dot2c_f32_bf16 v17, s44, v70
    v_dot2c_f32_bf16 v18, s43, v71
    v_dot2c_f32_bf16 v19, s44, v71
    v_max3_u32 v20, v20, v70, v71
    s_waitcnt vmcnt(19)
    v_dot2c_f32_bf16 v16, s43, v72
    v_dot2c_f32_bf16 v17, s44, v72
    v_dot2c_f32_bf16 v18, s43, v73
    v_dot2c_f32_bf16 v19, s44, v73
    v_max3_u32 v20, v20, v72, v73
    s_waitcnt vmcnt(18)
    v_dot2c_f32_bf16 v16, s43, v74
    v_dot2c_f32_bf16 v17, s44, v74
    v_dot2c_f32_bf16 v18, s43, v75
    v_dot2c_f32_bf16 v19, s44, v75
    v_max3_u32 v20, v20, v74, v75
    s_waitcnt vmcnt(17)
    v_dot2c_f32_bf16 v16, s43, v76
    v_dot2c_f32_bf16 v17, s44, v76
    v_dot2c_f32_bf16 v18, s43, v77
    v_dot2c_f32_bf16 v19, s44, v77
    v_max3_u32 v20, v20, v76, v77
    s_waitcnt vmcnt(16)
    v_dot2c_f32_bf16 v16, s43, v78
    v_dot2c_f32_bf16 v17, s44, v78
    v_dot2c_f32_bf16 v18, s43, v79
    v_dot2c_f32_bf16 v19, s44, v79
    v_max3_u32 v20, v20, v78, v79
    s_waitcnt vmcnt(15)
    v_dot2c_f32_bf16 v16, s43, v80
    v_dot2c_f32_bf16 v17, s44, v80
    v_dot2c_f32_bf16 v18, s43, v81
    v_dot2c_f32_bf16 v19, s44, v81
    v_max3_u32 v20, v20, v80, v81
    s_waitcnt vmcnt(14)
    v_dot2c_f32_bf16 v16, s43, v82
    v_dot2c_f32_bf16 v17, s44, v82
    v_dot2c_f32_bf16 v18, s43, v83
    v_dot2c_f32_bf16 v19, s44, v83
    v_max3_u32 v20, v20, v82, v83
    s_waitcnt vmcnt(13)
    v_dot2c_f32_bf16 v16, s43, v84
    v_dot2c_f32_bf16 v17, s44, v84
    v_dot2c_f32_bf16 v18, s43, v85
    v_dot2c_f32_bf16 v19, s44, v85
    v_max3_u32 v20, v20, v84, v85
    s_waitcnt vmcnt(12)
    v_dot2c_f32_bf16 v16, s43, v86
    v_dot2c_f32_bf16 v17, s44, v86
    v_dot2c_f32_bf16 v18, s43, v87
    v_dot2c_f32_bf16 v19, s44, v87
    v_max3_u32 v20, v20, v86, v87
    s_waitcnt vmcnt(11)
    v_dot2c_f32_bf16 v16, s43, v88
    v_dot2c_f32_bf16 v17, s44, v88
    v_dot2c_f32_bf16 v18, s43, v89
    v_dot2c_f32_bf16 v19, s44, v89
    v_max3_u32 v20, v20, v88, v89
    s_waitcnt vmcnt(10)
    v_dot2c_f32_bf16 v16, s43, v90
    v_dot2c_f32_bf16 v17, s44, v90
    v_dot2c_f32_bf16 v18, s43, v91
    v_dot2c_f32_bf16 v19, s44, v91
    v_max3_u32 v20, v20, v90, v91
    s_waitcnt vmcnt(9)
    v_dot2c_f32_bf16 v16, s43, v92
    v_dot2c_f32_bf16 v17, s44, v92
    v_dot2c_f32_bf16 v18, s43, v93
    v_dot2c_f32_bf16 v19, s44, v93
    v_max3_u32 v20, v20, v92, v93
    s_waitcnt vmcnt(8)
    v_dot2c_f32_bf16 v16, s43, v94
    v_dot2c_f32_bf16 v17, s44, v94
    v_dot2c_f32_bf16 v18, s43, v95
    v_dot2c_f32_bf16 v19, s44, v95
    v_max3_u32 v20, v20, v94, v95
    v_cmp_eq_u32 vcc, -1, v20
    s_cbranch_vccnz L_kvspin_44
L_kvback_45:
    v_cvt_pk_bf16_f32 v20, v16, v17
    v_cvt_pk_bf16_f32 v21, v18, v19
    ds_write_b64 v60, v[20:21] offset:16384
    s_waitcnt lgkmcnt(0)
    s_barrier
    ds_read_b128 v[24:27], v12 offset:16384
    ds_read_b128 v[28:31], v12 offset:17408
    s_waitcnt lgkmcnt(1)
    v_mfma_f32_32x32x16_bf16 v[32:47], v[24:27], v[48:51], 0
    s_waitcnt lgkmcnt(0)
    v_mfma_f32_32x32x16_bf16 v[32:47], v[28:31], v[52:55], v[32:47]
    s_nop 11
    v_mov_b32 v16, v44
    v_mov_b32 v17, v44
    s_nop 1
    v_permlane32_swap_b32 v16, v17
    v_add_f32 v16, s50, v17
    v_rcp_f32 v16, v16
    s_nop 0
    v_pk_mul_f32 v[32:33], v[32:33], v[16:17] op_sel_hi:[1,0]
    v_pk_mul_f32 v[34:35], v[34:35], v[16:17] op_sel_hi:[1,0]
    v_pk_mul_f32 v[36:37], v[36:37], v[16:17] op_sel_hi:[1,0]
    v_pk_mul_f32 v[38:39], v[38:39], v[16:17] op_sel_hi:[1,0]
    v_pk_mul_f32 v[40:41], v[40:41], v[16:17] op_sel_hi:[1,0]
    v_pk_mul_f32 v[42:43], v[42:43], v[16:17] op_sel_hi:[1,0]
    v_pk_mul_f32 v[44:45], v[44:45], v[16:17] op_sel_hi:[1,0]
    v_pk_mul_f32 v[46:47], v[46:47], v[16:17] op_sel_hi:[1,0]
    v_cvt_pk_bf16_f32 v20, v32, v33
    v_cvt_pk_bf16_f32 v21, v34, v35
    v_cvt_pk_bf16_f32 v22, v36, v37
    v_cvt_pk_bf16_f32 v23, v38, v39
    v_cvt_pk_bf16_f32 v24, v40, v41
    v_cvt_pk_bf16_f32 v25, v42, v43
    v_cvt_pk_bf16_f32 v26, v44, v45
    v_cvt_pk_bf16_f32 v27, v46, v47
    buffer_store_dwordx2 v[20:21], v56, s[36:39], s67 offen sc1
    buffer_store_dwordx2 v[22:23], v57, s[36:39], s67 offen sc1
    buffer_store_dwordx2 v[24:25], v58, s[36:39], s67 offen sc1
    s_mov_b32 exec_hi, 0
    buffer_store_dwordx2 v[26:27], v59, s[36:39], s67 offen sc1
    s_mov_b64 exec, -1
    s_add_u32 s45, s56, 1
    v_mov_b32 v14, s45
    s_waitcnt vmcnt(0)
    s_mov_b64 exec, 1
    buffer_store_dword v14, v1, s[36:39], s3 offen sc1
    s_mov_b64 exec, -1
    s_cmp_ge_u32 s58, 14
    s_cbranch_scc1 L_spare0_s
    s_lshl_b32 s5, s58, 11
    s_add_u32 s5, s5, s68
    v_accvgpr_read_b32 v104, a56
    v_accvgpr_read_b32 v105, a57
    v_accvgpr_read_b32 v106, a58
    v_accvgpr_read_b32 v107, a59
    v_accvgpr_read_b32 v108, a60
    v_accvgpr_read_b32 v109, a61
    v_accvgpr_read_b32 v110, a62
    v_accvgpr_read_b32 v111, a63
    s_lshr_b32 s41, s58, 2
    s_lshl_b32 s41, s41, 10
    s_and_b32 s42, s58, 3
    s_lshl_b32 s42, s42, 2
    s_add_u32 s41, s41, s42
    s_add_u32 s6, s41, s69
    s_lshl_b32 s40, s64, 7
    s_lshl_b32 s41, s58, 3
    s_add_u32 s41, s40, s41
    s_add_u32 s7, s41, 1433600
    s_add_u32 s40, s40, 1434624
    v_and_b32 v13, 15, v0
    v_lshlrev_b32 v13, 2, v13
    ds_read_b64_tr_b16 v[48:49], v3 offset:28672
    ds_read_b64_tr_b16 v[50:51], v3 offset:29184
    ds_read_b64_tr_b16 v[52:53], v3 offset:29696
    ds_read_b64_tr_b16 v[54:55], v3 offset:30208
    buffer_load_dwordx4 v[200:203], v1, s[20:23], s24 offen offset:2048 sc1
    buffer_load_dwordx4 v[204:207], v1, s[20:23], s24 offen offset:3072 sc1
    s_add_u32 s24, s24, 4096
    buffer_load_dwordx4 v[208:211], v1, s[20:23], s24 offen offset:0 sc1
    buffer_load_dwordx4 v[212:215], v1, s[20:23], s24 offen offset:1024 sc1
    buffer_load_dwordx4 v[216:219], v1, s[20:23], s24 offen offset:2048 sc1
    buffer_load_dwordx4 v[220:223], v1, s[20:23], s24 offen offset:3072 sc1
    s_add_u32 s24, s24, 4096
    buffer_load_dwordx4 v[224:227], v1, s[20:23], s24 offen offset:0 sc1
    buffer_load_dwordx4 v[228:231], v1, s[20:23], s24 offen offset:1024 sc1
    s_min_u32 s70, s60, 2
    s_mul_i32 s70, s70, 28672
    v_add_u32 v60, s70, v2
    ds_read_b64_tr_b16 v[32:33], v60 offset:0
    ds_read_b64_tr_b16 v[34:35], v60 offset:512
    ds_read_b64_tr_b16 v[36:37], v60 offset:1024
    ds_read_b64_tr_b16 v[38:39], v60 offset:1536
    ds_read_b64_tr_b16 v[40:41], v60 offset:2048
    ds_read_b64_tr_b16 v[42:43], v60 offset:2560
    v_mov_b32 v15, 0
    s_mov_b32 exec_lo, 0x00100001
    s_mov_b32 exec_hi, 0x00100001
    v_mov_b32 v15, s48
    s_mov_b64 exec, -1
    v_accvgpr_write_b32 a32, v15
    v_accvgpr_write_b32 a33, v15
    v_accvgpr_write_b32 a34, v15
    v_accvgpr_write_b32 a35, v15
    s_waitcnt lgkmcnt(4)
    s_nop 0
    v_mfma_f32_16x16x32_bf16 a[36:39], a[32:35], v[32:35], 0
    ds_read_b64_tr_b16 v[44:45], v60 offset:3072
    ds_read_b64_tr_b16 v[46:47], v60 offset:3584
    s_waitcnt lgkmcnt(4)
    v_mfma_f32_16x16x32_bf16 a[36:39], a[32:35], v[36:39], a[36:39]
    ds_read_b64_tr_b16 v[32:33], v60 offset:4096
    ds_read_b64_tr_b16 v[34:35], v60 offset:4608
    s_waitcnt lgkmcnt(4)
    v_mfma_f32_16x16x32_bf16 a[36:39], a[32:35], v[40:43], a[36:39]
    ds_read_b64_tr_b16 v[36:37], v60 offset:5120
    ds_read_b64_tr_b16 v[38:39], v60 offset:5632
    s_waitcnt lgkmcnt(4)
    v_mfma_f32_16x16x32_bf16 a[36:39], a[32:35], v[44:47], a[36:39]
    ds_read_b64_tr_b16 v[40:41], v60 offset:6144
    ds_read_b64_tr_b16 v[42:43], v60 offset:6656
    s_waitcnt lgkmcnt(4)
    v_mfma_f32_16x16x32_bf16 a[36:39], a[32:35], v[32:35], a[36:39]
    ds_read_b64_tr_b16 v[44:45], v60 offset:7168
    ds_read_b64_tr_b16 v[46:47], v60 offset:7680
    s_waitcnt lgkmcnt(4)
    v_mfma_f32_16x16x32_bf16 a[36:39], a[32:35], v[36:39], a[36:39]
    ds_read_b64_tr_b16 v[32:33], v60 offset:8192
    ds_read_b64_tr_b16 v[34:35], v60 offset:8704
    s_waitcnt lgkmcnt(4)
    v_mfma_f32_16x16x32_bf16 a[36:39], a[32:35], v[40:43], a[36:39]
    ds_read_b64_tr_b16 v[36:37], v60 offset:9216
    ds_read_b64_tr_b16 v[38:39], v60 offset:9728
    s_waitcnt lgkmcnt(4)
    v_mfma_f32_16x16x32_bf16 a[36:39], a[32:35], v[44:47], a[36:39]
    ds_read_b64_tr_b16 v[40:41], v60 offset:10240
    ds_read_b64_tr_b16 v[42:43], v60 offset:10752
    s_waitcnt lgkmcnt(4)
    v_mfma_f32_16x16x32_bf16 a[36:39], a[32:35], v[32:35], a[36:39]
    ds_read_b64_tr_b16 v[44:45], v60 offset:11264
    ds_read_b64_tr_b16 v[46:47], v60 offset:11776
    s_waitcnt lgkmcnt(4)
    v_mfma_f32_16x16x32_bf16 a[36:39], a[32:35], v[36:39], a[36:39]
    ds_read_b64_tr_b16 v[32:33], v60 offset:12288
    ds_read_b64_tr_b16 v[34:35], v60 offset:12800
    s_waitcnt lgkmcnt(4)
    v_mfma_f32_16x16x32_bf16 a[36:39], a[32:35], v[40:43], a[36:39]
    ds_read_b64_tr_b16 v[36:37], v60 offset:13312
    ds_read_b64_tr_b16 v[38:39], v60 offset:13824
    s_waitcnt lgkmcnt(4)
    v_mfma_f32_16x16x32_bf16 a[36:39], a[32:35], v[44:47], a[36:39]
    ds_read_b64_tr_b16 v[40:41], v60 offset:14336
    ds_read_b64_tr_b16 v[42:43], v60 offset:14848
    s_waitcnt lgkmcnt(4)
    v_mfma_f32_16x16x32_bf16 a[36:39], a[32:35], v[32:35], a[36:39]
    ds_read_b64_tr_b16 v[44:45], v60 offset:15360
    ds_read_b64_tr_b16 v[46:47], v60 offset:15872
    s_waitcnt lgkmcnt(4)
    v_mfma_f32_16x16x32_bf16 a[36:39], a[32:35], v[36:39], a[36:39]
    ds_read_b64_tr_b16 v[32:33], v60 offset:16384
    ds_read_b64_tr_b16 v[34:35], v60 offset:16896
    s_waitcnt lgkmcnt(4)
    v_mfma_f32_16x16x32_bf16 a[36:39], a[32:35], v[40:43], a[36:39]
    ds_read_b64_tr_b16 v[36:37], v60 offset:17408
    ds_read_b64_tr_b16 v[38:39], v60 offset:17920
    s_waitcnt lgkmcnt(4)
    v_mfma_f32_16x16x32_bf16 a[36:39], a[32:35], v[44:47], a[36:39]
    ds_read_b64_tr_b16 v[40:41], v60 offset:18432
    ds_read_b64_tr_b16 v[42:43], v60 offset:18944
    s_waitcnt lgkmcnt(4)
    v_mfma_f32_16x16x32_bf16 a[36:39], a[32:35], v[32:35], a[36:39]
    ds_read_b64_tr_b16 v[44:45], v60 offset:19456
    ds_read_b64_tr_b16 v[46:47], v60 offset:19968
    s_waitcnt lgkmcnt(4)
    v_mfma_f32_16x16x32_bf16 a[36:39], a[32:35], v[36:39], a[36:39]
    ds_read_b64_tr_b16 v[32:33], v60 offset:20480
    ds_read_b64_tr_b16 v[34:35], v60 offset:20992
    s_waitcnt lgkmcnt(4)
    v_mfma_f32_16x16x32_bf16 a[36:39], a[32:35], v[40:43], a[36:39]
    ds_read_b64_tr_b16 v[36:37], v60 offset:21504
    ds_read_b64_tr_b16 v[38:39], v60 offset:22016
    s_waitcnt lgkmcnt(4)
    v_mfma_f32_16x16x32_bf16 a[36:39], a[32:35], v[44:47], a[36:39]
    ds_read_b64_tr_b16 v[40:41], v60 offset:22528
    ds_read_b64_tr_b16 v[42:43], v60 offset:23040
    s_waitcnt lgkmcnt(4)
    v_mfma_f32_16x16x32_bf16 a[36:39], a[32:35], v[32:35], a[36:39]
    ds_read_b64_tr_b16 v[44:45], v60 offset:23552
    ds_read_b64_tr_b16 v[46:47], v60 offset:24064
    s_waitcnt lgkmcnt(4)
    v_mfma_f32_16x16x32_bf16 a[36:39], a[32:35], v[36:39], a[36:39]
    ds_read_b64_tr_b16 v[32:33], v60 offset:24576
    ds_read_b64_tr_b16 v[34:35], v60 offset:25088
    s_waitcnt lgkmcnt(4)
    v_mfma_f32_16x16x32_bf16 a[36:39], a[32:35], v[40:43], a[36:39]
    ds_read_b64_tr_b16 v[36:37], v60 offset:25600
    ds_read_b64_tr_b16 v[38:39], v60 offset:26112
    s_waitcnt lgkmcnt(4)
    v_mfma_f32_16x16x32_bf16 a[36:39], a[32:35], v[44:47], a[36:39]
    ds_read_b64_tr_b16 v[40:41], v60 offset:26624
    ds_read_b64_tr_b16 v[42:43], v60 offset:27136
    s_waitcnt lgkmcnt(4)
    v_mfma_f32_16x16x32_bf16 a[36:39], a[32:35], v[32:35], a[36:39]
    ds_read_b64_tr_b16 v[44:45], v60 offset:27648
    ds_read_b64_tr_b16 v[46:47], v60 offset:28160
    s_waitcnt lgkmcnt(4)
    v_mfma_f32_16x16x32_bf16 a[36:39], a[32:35], v[36:39], a[36:39]
    s_waitcnt lgkmcnt(2)
    v_mfma_f32_16x16x32_bf16 a[36:39], a[32:35], v[40:43], a[36:39]
    s_waitcnt lgkmcnt(0)
    v_mfma_f32_16x16x32_bf16 a[36:39], a[32:35], v[44:47], a[36:39]
    s_lshl_b32 s70, s60, 9
    v_lshlrev_b32 v60, 3, v0
    v_add_u32 v60, 159744, v60
    v_add_u32 v61, s70, v60
    s_nop 3
    v_accvgpr_read_b32 v40, a36
    v_cvt_pk_bf16_f32 v42, v40, v40
    v_and_b32 v41, s51, v42
    v_sub_f32 v41, v40, v41
    v_cvt_pk_bf16_f32 v43, v41, 0
    ds_write_b64 v61, v[42:43]
    s_add_u32 s47, s56, 1
    s_mov_b32 s46, s66
L_poll_48:
    buffer_load_dword v14, v13, s[36:39], s40 offen sc1
    s_waitcnt vmcnt(0)
    v_subrev_u32 v14, s47, v14
    v_cmp_lt_u32 vcc, 3, v14
    s_cbranch_vccz L_polled_47
    s_sub_u32 s46, s46, 1
    s_cmp_lg_u32 s46, 0
    s_cbranch_scc1 L_poll_48
    s_mov_b32 s66, 1
L_polled_47:
    s_add_u32 s4, s67, 0
    buffer_load_dwordx4 v[64:67], v1, s[36:39], s4 offen offset:0 sc1
    v_lshlrev_b32 v16, 16, v104
    v_and_b32 v17, s51, v104
    buffer_load_dwordx4 v[68:71], v1, s[36:39], s4 offen offset:1024 sc1
    v_lshlrev_b32 v18, 16, v105
    v_and_b32 v19, s51, v105
    buffer_load_dwordx4 v[72:75], v1, s[36:39], s4 offen offset:2048 sc1
    v_lshlrev_b32 v20, 16, v106
    v_and_b32 v21, s51, v106
    buffer_load_dwordx4 v[76:79], v1, s[36:39], s4 offen offset:3072 sc1
    v_lshlrev_b32 v22, 16, v107
    v_and_b32 v23, s51, v107
    s_add_u32 s4, s67, 4096
    buffer_load_dwordx4 v[80:83], v1, s[36:39], s4 offen offset:0 sc1
    v_lshlrev_b32 v24, 16, v108
    v_and_b32 v25, s51, v108
    buffer_load_dwordx4 v[84:87], v1, s[36:39], s4 offen offset:1024 sc1
    v_lshlrev_b32 v26, 16, v109
    v_and_b32 v27, s51, v109
    buffer_load_dwordx4 v[88:91], v1, s[36:39], s4 offen offset:2048 sc1
    v_lshlrev_b32 v28, 16, v110
    v_and_b32 v29, s51, v110
    buffer_load_dwordx4 v[92:95], v1, s[36:39], s4 offen offset:3072 sc1
    v_lshlrev_b32 v30, 16, v111
    v_and_b32 v31, s51, v111
    s_waitcnt vmcnt(7)
    s_nop 0
    v_mfma_f32_32x32x16_bf16 v[16:31], v[48:51], v[64:67], v[16:31]
    s_add_u32 s4, s67, 8192
    buffer_load_dwordx4 v[96:99], v1, s[36:39], s4 offen offset:0 sc1
    ds_read_b64_tr_b16 v[56:57], v3 offset:30720
    ds_read_b64_tr_b16 v[58:59], v3 offset:31232
    v_mfma_f32_16x16x32_bf16 a[36:39], a[32:35], a[224:227], 0
    s_waitcnt vmcnt(7)
    v_mfma_f32_32x32x16_bf16 v[16:31], v[52:55], v[68:71], v[16:31]
    buffer_load_dwordx4 v[100:103], v1, s[36:39], s4 offen offset:1024 sc1
    ds_read_b64_tr_b16 v[48:49], v3 offset:31744
    ds_read_b64_tr_b16 v[50:51], v3 offset:32256
    v_mfma_f32_16x16x32_bf16 a[36:39], a[32:35], a[228:231], a[36:39]
    s_waitcnt vmcnt(7) lgkmcnt(2)
    v_mfma_f32_32x32x16_bf16 v[16:31], v[56:59], v[72:75], v[16:31]
    buffer_load_dwordx4 v[104:107], v1, s[36:39], s4 offen offset:2048 sc1
    ds_read_b64_tr_b16 v[52:53], v3 offset:32768
    ds_read_b64_tr_b16 v[54:55], v3 offset:33280
    v_mfma_f32_16x16x32_bf16 a[36:39], a[32:35], a[232:235], a[36:39]
    s_waitcnt vmcnt(7) lgkmcnt(2)
    v_mfma_f32_32x32x16_bf16 v[16:31], v[48:51], v[76:79], v[16:31]
    buffer_load_dwordx4 v[108:111], v1, s[36:39], s4 offen offset:3072 sc1
    ds_read_b64_tr_b16 v[56:57], v3 offset:33792
    ds_read_b64_tr_b16 v[58:59], v3 offset:34304
    v_mfma_f32_16x16x32_bf16 a[36:39], a[32:35], a[236:239], a[36:39]
    s_waitcnt vmcnt(7) lgkmcnt(2)
    v_mfma_f32_32x32x16_bf16 v[16:31], v[52:55], v[80:83], v[16:31]
    s_add_u32 s4, s67, 12288
    buffer_load_dwordx4 v[112:115], v1, s[36:39], s4 offen offset:0 sc1
    ds_read_b64_tr_b16 v[48:49], v3 offset:34816
    ds_read_b64_tr_b16 v[50:51], v3 offset:35328
    v_mfma_f32_16x16x32_bf16 a[36:39], a[32:35], a[240:243], a[36:39]
    s_waitcnt vmcnt(7) lgkmcnt(2)
    v_mfma_f32_32x32x16_bf16 v[16:31], v[56:59], v[84:87], v[16:31]
    buffer_load_dwordx4 v[116:119], v1, s[36:39], s4 offen offset:1024 sc1
    ds_read_b64_tr_b16 v[52:53], v3 offset:35840
    ds_read_b64_tr_b16 v[54:55], v3 offset:36352
    s_waitcnt vmcnt(7) lgkmcnt(2)
    v_mfma_f32_32x32x16_bf16 v[16:31], v[48:51], v[88:91], v[16:31]
    buffer_load_dwordx4 v[120:123], v1, s[36:39], s4 offen offset:2048 sc1
    ds_read_b64_tr_b16 v[56:57], v3 offset:36864
    ds_read_b64_tr_b16 v[58:59], v3 offset:37376
    v_mfma_f32_16x16x32_bf16 a[36:39], a[32:35], a[244:247], a[36:39]
    s_waitcnt vmcnt(7) lgkmcnt(2)
    v_mfma_f32_32x32x16_bf16 v[16:31], v[52:55], v[92:95], v[16:31]
    buffer_load_dwordx4 v[124:127], v1, s[36:39], s4 offen offset:3072 sc1
    ds_read_b64_tr_b16 v[48:49], v3 offset:37888
    ds_read_b64_tr_b16 v[50:51], v3 offset:38400
    v_mfma_f32_16x16x32_bf16 a[36:39], a[32:35], a[248:251], a[36:39]
    s_waitcnt vmcnt(7) lgkmcnt(2)
    v_mfma_f32_32x32x16_bf16 v[16:31], v[56:59], v[96:99], v[16:31]
    s_add_u32 s4, s67, 16384
    buffer_load_dwordx4 v[128:131], v1, s[36:39], s4 offen offset:0 sc1
    ds_read_b64_tr_b16 v[52:53], v3 offset:38912
    ds_read_b64_tr_b16 v[54:55], v3 offset:39424
    v_mfma_f32_16x16x32_bf16 a[36:39], a[32:35], a[252:255], a[36:39]
    s_waitcnt vmcnt(7) lgkmcnt(2)
    v_mfma_f32_32x32x16_bf16 v[16:31], v[48:51], v[100:103], v[16:31]
    buffer_load_dwordx4 v[132:135], v1, s[36:39], s4 offen offset:1024 sc1
    ds_read_b64_tr_b16 v[56:57], v3 offset:39936
    ds_read_b64_tr_b16 v[58:59], v3 offset:40448
    v_mfma_f32_16x16x32_bf16 a[36:39], a[32:35], v[176:179], a[36:39]
    s_waitcnt vmcnt(7) lgkmcnt(2)
    v_mfma_f32_32x32x16_bf16 v[16:31], v[52:55], v[104:107], v[16:31]
    buffer_load_dwordx4 v[136:139], v1, s[36:39], s4 offen offset:2048 sc1
    ds_read_b64_tr_b16 v[48:49], v3 offset:40960
    ds_read_b64_tr_b16 v[50:51], v3 offset:41472
    s_waitcnt vmcnt(7) lgkmcnt(2)
    v_mfma_f32_32x32x16_bf16 v[16:31], v[56:59], v[108:111], v[16:31]
    buffer_load_dwordx4 v[140:143], v1, s[36:39], s4 offen offset:3072 sc1
    ds_read_b64_tr_b16 v[52:53], v3 offset:41984
    ds_read_b64_tr_b16 v[54:55], v3 offset:42496
    v_mfma_f32_16x16x32_bf16 a[36:39], a[32:35], v[180:183], a[36:39]
    s_waitcnt vmcnt(7) lgkmcnt(2)
    v_mfma_f32_32x32x16_bf16 v[16:31], v[48:51], v[112:115], v[16:31]
    s_add_u32 s4, s67, 20480
    buffer_load_dwordx4 v[144:147], v1, s[36:39], s4 offen offset:0 sc1
    ds_read_b64_tr_b16 v[56:57], v3 offset:43008
    ds_read_b64_tr_b16 v[58:59], v3 offset:43520
    v_mfma_f32_16x16x32_bf16 a[36:39], a[32:35], v[184:187], a[36:39]
    s_waitcnt vmcnt(7) lgkmcnt(2)
    v_mfma_f32_32x32x16_bf16 v[16:31], v[52:55], v[116:119], v[16:31]
    buffer_load_dwordx4 v[148:151], v1, s[36:39], s4 offen offset:1024 sc1
    ds_read_b64_tr_b16 v[48:49], v3 offset:44032
    ds_read_b64_tr_b16 v[50:51], v3 offset:44544
    v_mfma_f32_16x16x32_bf16 a[36:39], a[32:35], v[188:191], a[36:39]
    v_and_b32 v13, 15, v0
    v_min_u32 v13, 13, v13
    v_lshlrev_b32 v13, 3, v13
    v_lshrrev_b32 v14, 4, v0
    v_lshl_add_u32 v107, v14, 7, v13
    s_mul_i32 s40, s59, 114688
    s_add_u32 s40, s40, 1032192
    s_and_b32 s0, s58, 1
    s_waitcnt vmcnt(7) lgkmcnt(2)
    v_mfma_f32_32x32x16_bf16 v[16:31], v[56:59], v[120:123], v[16:31]
    buffer_load_dwordx4 v[152:155], v1, s[36:39], s4 offen offset:2048 sc1
    ds_read_b64_tr_b16 v[52:53], v3 offset:45056
    ds_read_b64_tr_b16 v[54:55], v3 offset:45568
    v_mfma_f32_16x16x32_bf16 a[36:39], a[32:35], v[192:195], a[36:39]
    s_mul_i32 s16, s0, 28672
    s_add_u32 s40, s40, s16
    s_lshl_b32 s16, s16, 1
    v_add_u32 v110, s40, v1
    s_lshl_b32 s15, s60, 10
    s_add_u32 s15, s15, 114688
    s_lshl_b32 s40, s58, 13
    s_waitcnt vmcnt(7) lgkmcnt(2)
    v_mfma_f32_32x32x16_bf16 v[16:31], v[48:51], v[124:127], v[16:31]
    buffer_load_dwordx4 v[156:159], v1, s[36:39], s4 offen offset:3072 sc1
    ds_read_b64_tr_b16 v[56:57], v3 offset:46080
    ds_read_b64_tr_b16 v[58:59], v3 offset:46592
    v_mfma_f32_16x16x32_bf16 a[36:39], a[32:35], v[196:199], a[36:39]
    s_lshl_b32 s41, s60, 11
    s_add_u32 s3, s40, s41
    s_mul_i32 s40, s59, 458752
    s_add_u32 s3, s3, s40
    s_lshl_b32 s40, s59, 10
    s_lshl_b32 s41, s60, 6
    s_add_u32 s40, s40, s41
    s_lshl_b32 s41, s58, 2
    s_waitcnt vmcnt(7) lgkmcnt(2)
    v_mfma_f32_32x32x16_bf16 v[16:31], v[52:55], v[128:131], v[16:31]
    s_add_u32 s4, s67, 24576
    buffer_load_dwordx4 v[160:163], v1, s[36:39], s4 offen offset:0 sc1
    ds_read_b64_tr_b16 v[48:49], v3 offset:47104
    ds_read_b64_tr_b16 v[50:51], v3 offset:47616
    s_add_u32 s40, s40, s41
    s_add_u32 s2, s40, 1435648
    s_mul_i32 s40, s0, 229376
    s_sub_u32 s17, s3, s40
    s_add_u32 s3, s3, s40
    s_lshl_b32 s40, s0, 9
    s_sub_u32 s1, s2, s40
    s_waitcnt vmcnt(7) lgkmcnt(2)
    v_mfma_f32_32x32x16_bf16 v[16:31], v[56:59], v[132:135], v[16:31]
    buffer_load_dwordx4 v[164:167], v1, s[36:39], s4 offen offset:1024 sc1
    ds_read_b64_tr_b16 v[52:53], v3 offset:48128
    ds_read_b64_tr_b16 v[54:55], v3 offset:48640
    v_mfma_f32_16x16x32_bf16 a[36:39], a[32:35], v[200:203], a[36:39]
    s_add_u32 s2, s2, s40
    v_mov_b32 v84, v4
    v_mov_b32 v85, v5
    v_mov_b32 v86, 0
    v_mov_b32 v87, 0
    v_mov_b32 v90, 0
    v_mov_b32 v91, 0
    s_waitcnt vmcnt(7) lgkmcnt(2)
    v_mfma_f32_32x32x16_bf16 v[16:31], v[48:51], v[136:139], v[16:31]
    buffer_load_dwordx4 v[168:171], v1, s[36:39], s4 offen offset:2048 sc1
    ds_read_b64_tr_b16 v[56:57], v3 offset:49152
    ds_read_b64_tr_b16 v[58:59], v3 offset:49664
    v_mfma_f32_16x16x32_bf16 a[36:39], a[32:35], v[204:207], a[36:39]
    v_and_b32 v108, 31, v0
    v_lshlrev_b32 v108, 4, v108
    v_add_u32 v108, 159744, v108
    s_and_b32 s40, s65, 3
    s_lshl_b32 s40, s40, 9
    s_lshl_b32 s41, s0, 9
    s_xor_b32 s40, s40, s41
    v_add_u32 v109, s40, v108
    s_waitcnt vmcnt(7) lgkmcnt(2)
    v_mfma_f32_32x32x16_bf16 v[16:31], v[52:55], v[140:143], v[16:31]
    buffer_load_dwordx4 v[172:175], v1, s[36:39], s4 offen offset:3072 sc1
    ds_read_b64_tr_b16 v[48:49], v3 offset:50176
    ds_read_b64_tr_b16 v[50:51], v3 offset:50688
    v_mfma_f32_16x16x32_bf16 a[36:39], a[32:35], v[208:211], a[36:39]
    s_mul_i32 s73, s62, 229376
    s_lshl_b32 s43, s60, 11
    s_add_u32 s73, s73, s43
    s_lshl_b32 s74, s62, 9
    s_lshl_b32 s43, s60, 6
    s_add_u32 s74, s74, s43
    s_add_u32 s74, s74, 1435648
    s_waitcnt vmcnt(7) lgkmcnt(2)
    v_mfma_f32_32x32x16_bf16 v[16:31], v[56:59], v[144:147], v[16:31]
    ds_read_b64_tr_b16 v[52:53], v3 offset:51200
    ds_read_b64_tr_b16 v[54:55], v3 offset:51712
    v_mfma_f32_16x16x32_bf16 a[36:39], a[32:35], v[212:215], a[36:39]
    buffer_load_dwordx4 v[232:235], v1, s[20:23], s24 offen offset:2048 sc1
    buffer_load_dwordx4 v[236:239], v1, s[20:23], s24 offen offset:3072 sc1
    v_min_u32 v104, 6, v0
    v_lshlrev_b32 v104, 3, v104
    s_and_b32 s43, s62, 1
    s_lshl_b32 s44, s43, 2
    s_add_u32 s74, s74, s44
    s_lshl_b32 s44, s43, 13
    s_sub_u32 s78, s73, s44
    s_waitcnt vmcnt(8) lgkmcnt(2)
    v_mfma_f32_32x32x16_bf16 v[16:31], v[48:51], v[148:151], v[16:31]
    ds_read_b64_tr_b16 v[56:57], v3 offset:52224
    ds_read_b64_tr_b16 v[58:59], v3 offset:52736
    s_add_u32 s24, s24, 4096
    buffer_load_dwordx4 v[240:243], v1, s[20:23], s24 offen offset:0 sc1
    s_add_u32 s78, s78, 8192
    s_add_u32 s73, s73, s44
    s_lshr_b32 s43, s62, 1
    s_lshl_b32 s43, s43, 2
    s_and_b32 s44, s62, 1
    s_add_u32 s43, s43, s44
    s_mul_i32 s75, s43, 28672
    s_lshl_b32 s43, s63, 12
    s_waitcnt vmcnt(8) lgkmcnt(2)
    v_mfma_f32_32x32x16_bf16 v[16:31], v[52:55], v[152:155], v[16:31]
    ds_read_b64_tr_b16 v[48:49], v3 offset:53248
    ds_read_b64_tr_b16 v[50:51], v3 offset:53760
    v_mfma_f32_16x16x32_bf16 a[36:39], a[32:35], v[216:219], a[36:39]
    buffer_load_dwordx4 v[244:247], v1, s[20:23], s24 offen offset:1024 sc1
    s_lshl_b32 s44, s60, 7
    s_add_u32 s43, s43, s44
    s_add_u32 s75, s75, s43
    s_add_u32 s75, s75, 1146880
    s_mul_i32 s76, s62, 14336
    s_lshr_b32 s43, s63, 2
    s_lshl_b32 s43, s43, 10
    s_waitcnt vmcnt(8) lgkmcnt(2)
    v_mfma_f32_32x32x16_bf16 v[16:31], v[56:59], v[156:159], v[16:31]
    ds_read_b64_tr_b16 v[52:53], v3 offset:54272
    ds_read_b64_tr_b16 v[54:55], v3 offset:54784
    v_mfma_f32_16x16x32_bf16 a[36:39], a[32:35], v[220:223], a[36:39]
    buffer_load_dwordx4 v[248:251], v1, s[20:23], s24 offen offset:2048 sc1
    s_add_u32 s76, s76, s43
    s_and_b32 s43, s63, 3
    s_lshl_b32 s43, s43, 2
    s_add_u32 s43, s43, s44
    s_add_u32 s76, s76, s43
    s_add_u32 s76, s76, 1376256
    s_lshl_b32 s43, s62, 8
    s_waitcnt vmcnt(8) lgkmcnt(2)
    v_mfma_f32_32x32x16_bf16 v[16:31], v[48:51], v[160:163], v[16:31]
    ds_read_b64_tr_b16 v[56:57], v3 offset:55296
    ds_read_b64_tr_b16 v[58:59], v3 offset:55808
    v_mfma_f32_16x16x32_bf16 a[36:39], a[32:35], v[224:227], a[36:39]
    buffer_load_dwordx4 v[252:255], v1, s[20:23], s24 offen offset:3072 sc1
    s_mul_i32 s25, s63, 229376
    s_lshl_b32 s26, s60, 12
    s_add_u32 s25, s25, s26
    s_add_u32 s25, s25, 4038656
    s_and_b32 s26, s62, 1
    s_lshl_b32 s26, s26, 14
    s_sub_u32 s27, s25, s26
    s_add_u32 s27, s27, 16384
    s_add_u32 s25, s25, s26
    s_lshl_b32 s26, s12, 1
    s_add_u32 s26, s26, s25
    buffer_load_dwordx4 a[64:67], v1, s[20:23], s26 offen offset:0 sc1
    s_lshl_b32 s44, s63, 4
    s_add_u32 s43, s43, s44
    s_lshl_b32 s44, s60, 2
    s_add_u32 s43, s43, s44
    s_add_u32 s77, s43, 1433600
    s_lshl_b32 s43, s60, 13
    v_add_u32 v105, s43, v12
    v_lshrrev_b32 v14, 5, v0
    s_waitcnt vmcnt(9) lgkmcnt(2)
    v_mfma_f32_32x32x16_bf16 v[16:31], v[52:55], v[164:167], v[16:31]
    ds_read_b64_tr_b16 v[48:49], v3 offset:56320
    ds_read_b64_tr_b16 v[50:51], v3 offset:56832
    v_mfma_f32_16x16x32_bf16 a[36:39], a[32:35], v[228:231], a[36:39]
    buffer_load_dwordx4 a[68:71], v1, s[20:23], s26 offen offset:1024 sc1
    v_lshlrev_b32 v14, 7, v14
    v_xor_b32 v105, v105, v14
    v_mov_b32 v106, v105
    v_and_b32 v13, 7, v0
    v_lshlrev_b32 v13, 4, v13
    s_lshl_b32 s43, s60, 7
    v_add_u32 v13, s43, v13
    s_waitcnt vmcnt(9) lgkmcnt(2)
    v_mfma_f32_32x32x16_bf16 v[16:31], v[56:59], v[168:171], v[16:31]
    buffer_load_dwordx4 a[72:75], v1, s[20:23], s26 offen offset:2048 sc1
    v_bfe_u32 v14, v0, 3, 1
    v_lshlrev_b32 v15, 7, v14
    v_xor_b32 v13, v13, v15
    v_lshl_add_u32 v13, v14, 9, v13
    v_lshrrev_b32 v14, 4, v0
    v_lshl_add_u32 v13, v14, 11, v13
    v_add_u32 v111, 114688, v13
    s_waitcnt vmcnt(9) lgkmcnt(0)
    v_mfma_f32_32x32x16_bf16 v[16:31], v[48:51], v[172:175], v[16:31]
    buffer_load_dwordx4 a[76:79], v1, s[20:23], s26 offen offset:3072 sc1
    s_nop 10
    v_cvt_pk_bf16_f32 v32, v16, v17
    v_cvt_pk_bf16_f32 v33, v18, v19
    v_cvt_pk_bf16_f32 v34, v20, v21
    v_cvt_pk_bf16_f32 v35, v22, v23
    v_cvt_pk_bf16_f32 v36, v24, v25
    v_cvt_pk_bf16_f32 v37, v26, v27
    v_cvt_pk_bf16_f32 v38, v28, v29
    v_cvt_pk_bf16_f32 v39, v30, v31
    buffer_store_dwordx4 v[32:35], v1, s[36:39], s5 offen sc1
    buffer_store_dwordx4 v[36:39], v1, s[36:39], s5 offen offset:1024 sc1
    v_pk_mul_f32 v[42:43], v[16:17], v[16:17]
    v_pk_fma_f32 v[42:43], v[18:19], v[18:19], v[42:43]
    v_pk_add_f32 v[16:17], v[16:17], v[18:19]
    v_pk_fma_f32 v[42:43], v[20:21], v[20:21], v[42:43]
    v_pk_add_f32 v[16:17], v[16:17], v[20:21]
    v_pk_fma_f32 v[42:43], v[22:23], v[22:23], v[42:43]
    v_pk_add_f32 v[16:17], v[16:17], v[22:23]
    v_pk_fma_f32 v[42:43], v[24:25], v[24:25], v[42:43]
    v_pk_add_f32 v[16:17], v[16:17], v[24:25]
    v_pk_fma_f32 v[42:43], v[26:27], v[26:27], v[42:43]
    v_pk_add_f32 v[16:17], v[16:17], v[26:27]
    v_pk_fma_f32 v[42:43], v[28:29], v[28:29], v[42:43]
    v_pk_add_f32 v[16:17], v[16:17], v[28:29]
    v_pk_fma_f32 v[42:43], v[30:31], v[30:31], v[42:43]
    v_pk_add_f32 v[16:17], v[16:17], v[30:31]
    v_add_f32 v40, v16, v17
    v_add_f32 v42, v42, v43
    s_nop 1
    v_permlane32_swap_b32 v40, v42
    v_add_f32 v40, v40, v42
    buffer_store_dword v40, v1, s[36:39], s6 offen sc1
    s_add_u32 s45, s56, 1
    v_mov_b32 v14, s45
    v_mov_b32 v15, s45
    s_waitcnt vmcnt(0)
    s_mov_b64 exec, 1
    buffer_store_dwordx2 v[14:15], v1, s[36:39], s7 offen sc1
    s_mov_b64 exec, -1
    s_barrier
    v_lshlrev_b32 v13, 3, v0
    v_add_u32 v13, 159744, v13
    ds_read_b64 v[8:9], v13
    ds_read_b64 v[10:11], v13 offset:512
    ds_read_b64 v[6:7], v13 offset:1024
    v_mfma_f32_16x16x32_bf16 a[36:39], a[32:35], v[232:235], a[36:39]
    v_mfma_f32_16x16x32_bf16 a[36:39], a[32:35], v[236:239], a[36:39]
    v_mfma_f32_16x16x32_bf16 a[36:39], a[32:35], v[240:243], a[36:39]
    v_mfma_f32_16x16x32_bf16 a[36:39], a[32:35], v[244:247], a[36:39]
    v_mfma_f32_16x16x32_bf16 a[36:39], a[32:35], v[248:251], a[36:39]
    v_mfma_f32_16x16x32_bf16 a[36:39], a[32:35], v[252:255], a[36:39]
    s_nop 7
    v_accvgpr_read_b32 v62, a36
    v_cvt_pk_bf16_f32 v4, v62, v62
    v_and_b32 v63, s51, v4
    v_sub_f32 v63, v62, v63
    v_cvt_pk_bf16_f32 v5, v63, 0
    v_mov_b32 v84, v4
    v_mov_b32 v85, v5
    s_waitcnt lgkmcnt(0)
    s_barrier
    s_lshl_b32 s40, s59, 9
    s_add_u32 s40, s40, 1433600
    s_add_u32 s47, s56, 1
    s_mov_b32 s46, s66
L_poll_50:
    buffer_load_dwordx2 v[14:15], v107, s[36:39], s40 offen sc1
    s_waitcnt vmcnt(0)
    v_subrev_u32 v14, s47, v14
    v_subrev_u32 v15, s47, v15
    v_or_b32 v14, v14, v15
    v_cmp_lt_u32 vcc, 3, v14
    s_cbranch_vccz L_polled_49
    s_sub_u32 s46, s46, 1
    s_cmp_lg_u32 s46, 0
    s_cbranch_scc1 L_poll_50
    s_mov_b32 s66, 1
L_polled_49:
    s_mov_b32 m0, s15
    s_nop 0
    buffer_load_dwordx4 v110, s[36:39], m0 offen sc1 lds
    s_add_u32 m0, m0, 4096
    s_nop 0
    buffer_load_dwordx4 v110, s[36:39], m0 offen sc1 lds
    s_add_u32 m0, m0, 4096
    s_nop 0
    buffer_load_dwordx4 v110, s[36:39], m0 offen sc1 lds
    s_add_u32 m0, m0, 4096
    s_nop 0
    buffer_load_dwordx4 v110, s[36:39], m0 offen sc1 lds
    s_add_u32 m0, m0, 4096
    s_nop 0
    buffer_load_dwordx4 v110, s[36:39], m0 offen sc1 lds
    s_add_u32 m0, m0, 4096
    s_nop 0
    buffer_load_dwordx4 v110, s[36:39], m0 offen sc1 lds
    s_waitcnt vmcnt(4)
    s_barrier
    ds_read_b128 v[48:51], v12 offset:0
    ds_read_b128 v[52:55], v12 offset:1024
    ds_read_b128 v[56:59], v12 offset:2048
    ds_read_b128 v[60:63], v12 offset:3072
    s_waitcnt lgkmcnt(2)
    v_mfma_f32_32x32x16_bf16 v[16:31], a[224:227], v[48:51], 0
    ds_read_b128 v[64:67], v12 offset:4096
    s_add_u32 m0, m0, 4096
    s_nop 0
    buffer_load_dwordx4 v110, s[36:39], m0 offen sc1 lds
    s_lshl_b32 s26, s13, 1
    s_add_u32 s26, s26, s25
    buffer_load_dwordx4 a[80:83], v1, s[20:23], s26 offen offset:0 sc1
    v_mfma_f32_32x32x16_bf16 v[16:31], a[228:231], v[52:55], v[16:31]
    ds_read_b128 v[48:51], v12 offset:5120
    buffer_load_dwordx4 v[112:115], v1, s[36:39], s69 offen offset:0 sc1
    s_waitcnt lgkmcnt(2)
    v_mfma_f32_32x32x16_bf16 v[16:31], a[232:235], v[56:59], v[16:31]
    ds_read_b128 v[52:55], v12 offset:6144
    s_add_u32 m0, m0, 4096
    v_subrev_u32 v110, s16, v110
    buffer_load_dwordx4 v110, s[36:39], m0 offen sc1 lds
    buffer_load_dwordx4 a[84:87], v1, s[20:23], s26 offen offset:1024 sc1
    v_mfma_f32_32x32x16_bf16 v[16:31], a[236:239], v[60:63], v[16:31]
    ds_read_b128 v[56:59], v12 offset:7168
    buffer_load_dwordx4 v[116:119], v1, s[36:39], s69 offen offset:1024 sc1
    s_waitcnt lgkmcnt(2)
    v_mfma_f32_32x32x16_bf16 v[16:31], a[240:243], v[64:67], v[16:31]
    s_waitcnt vmcnt(8)
    s_barrier
    ds_read_b128 v[60:63], v12 offset:8192
    buffer_load_dwordx4 a[88:91], v1, s[20:23], s26 offen offset:2048 sc1
    v_mfma_f32_32x32x16_bf16 v[16:31], a[244:247], v[48:51], v[16:31]
    s_add_u32 m0, m0, 4096
    ds_read_b128 v[64:67], v12 offset:9216
    buffer_load_dwordx4 v110, s[36:39], m0 offen sc1 lds
    s_waitcnt lgkmcnt(2)
    v_mfma_f32_32x32x16_bf16 v[16:31], a[248:251], v[52:55], v[16:31]
    ds_read_b128 v[48:51], v12 offset:10240
    buffer_load_dwordx4 v[120:123], v1, s[36:39], s69 offen offset:2048 sc1
    buffer_load_dwordx4 a[92:95], v1, s[20:23], s26 offen offset:3072 sc1
    v_mfma_f32_32x32x16_bf16 v[16:31], a[252:255], v[56:59], v[16:31]
    ds_read_b128 v[52:55], v12 offset:11264
    buffer_load_dwordx4 v[124:127], v1, s[36:39], s69 offen offset:3072 sc1
    s_waitcnt lgkmcnt(2)
    v_mfma_f32_32x32x16_bf16 v[16:31], v[176:179], v[60:63], v[16:31]
    ds_read_b128 v[56:59], v12 offset:12288
    s_lshl_b32 s26, s14, 1
    s_add_u32 s26, s26, s25
    buffer_load_dwordx4 a[96:99], v1, s[20:23], s26 offen offset:0 sc1
    v_mfma_f32_32x32x16_bf16 v[16:31], v[180:183], v[64:67], v[16:31]
    s_add_u32 m0, m0, 4096
    ds_read_b128 v[60:63], v12 offset:13312
    buffer_load_dwordx4 v110, s[36:39], m0 offen sc1 lds
    s_waitcnt lgkmcnt(2)
    v_mfma_f32_32x32x16_bf16 v[16:31], v[184:187], v[48:51], v[16:31]
    ds_read_b128 v[64:67], v12 offset:14336
    buffer_load_dwordx4 a[100:103], v1, s[20:23], s26 offen offset:1024 sc1
    v_mfma_f32_32x32x16_bf16 v[16:31], v[188:191], v[52:55], v[16:31]
    ds_read_b128 v[48:51], v12 offset:15360
    s_waitcnt vmcnt(11)
    v_add_f32 v112, v112, v114
    v_add_f32 v113, v113, v115
    s_waitcnt vmcnt(8)
    v_add_f32 v112, v112, v116
    v_add_f32 v113, v113, v117
    v_add_f32 v112, v112, v118
    v_add_f32 v113, v113, v119
    s_waitcnt vmcnt(5)
    v_add_f32 v112, v112, v120
    v_add_f32 v113, v113, v121
    s_waitcnt lgkmcnt(2)
    v_mfma_f32_32x32x16_bf16 v[16:31], v[192:195], v[56:59], v[16:31]
    s_barrier
    ds_read_b128 v[52:55], v12 offset:16384
    buffer_load_dwordx4 a[104:107], v1, s[20:23], s26 offen offset:2048 sc1
    v_add_f32 v112, v112, v122
    v_mfma_f32_32x32x16_bf16 v[16:31], v[196:199], v[60:63], v[16:31]
    s_mov_b32 m0, s15
    v_add_u32 v110, 40960, v110
    ds_read_b128 v[56:59], v12 offset:17408
    buffer_load_dwordx4 v110, s[36:39], m0 offen sc1 lds
    v_add_f32 v113, v113, v123
    s_waitcnt vmcnt(5)
    v_add_f32 v112, v112, v124
    s_waitcnt lgkmcnt(2)
    v_mfma_f32_32x32x16_bf16 v[16:31], v[200:203], v[64:67], v[16:31]
    ds_read_b128 v[60:63], v12 offset:18432
    v_add_f32 v113, v113, v125
    v_add_f32 v112, v112, v113
    v_mov_b32 v113, v112
    s_nop 1
    v_permlane32_swap_b32 v112, v113
    v_mul_f32 v114, 0x3b124925, v112
    v_mul_f32 v115, 0x3b124925, v113
    v_fma_f32 v115, -v114, v114, v115
    v_mfma_f32_32x32x16_bf16 v[16:31], v[204:207], v[48:51], v[16:31]
    ds_read_b128 v[64:67], v12 offset:19456
    buffer_load_dwordx4 a[108:111], v1, s[20:23], s26 offen offset:3072 sc1
    v_max_f32 v115, 0, v115
    v_add_f32 v115, 0x3727c5ac, v115
    v_cvt_pk_bf16_f32 v116, -v114, -v114
    v_and_b32 v113, s51, v116
    v_sub_f32_e64 v113, -v114, v113
    s_waitcnt lgkmcnt(2)
    v_mfma_f32_32x32x16_bf16 v[16:31], v[208:211], v[52:55], v[16:31]
    ds_read_b128 v[48:51], v12 offset:20480
    v_and_b32 v117, 0xffff, v116
    v_cvt_pk_bf16_f32 v113, v113, v113
    v_and_or_b32 v116, v113, s51, v117
    v_rsq_f32 v118, v115
    v_sqrt_f32 v119, v115
    v_mfma_f32_32x32x16_bf16 v[16:31], v[212:215], v[56:59], v[16:31]
    s_add_u32 m0, m0, 4096
    ds_read_b128 v[52:55], v12 offset:21504
    buffer_load_dwordx4 v110, s[36:39], m0 offen sc1 lds
    s_lshl_b32 s26, s8, 1
    s_add_u32 s26, s26, s27
    buffer_load_dwordx4 a[112:115], v1, s[20:23], s26 offen offset:0 sc1
    s_waitcnt lgkmcnt(2)
    v_mfma_f32_32x32x16_bf16 v[16:31], v[216:219], v[60:63], v[16:31]
    ds_read_b128 v[56:59], v12 offset:22528
    v_mul_f32_e64 v118, -v118, s49
    ds_write_b128 v109, v[116:119]
    v_mfma_f32_32x32x16_bf16 v[16:31], v[220:223], v[64:67], v[16:31]
    ds_read_b128 v[60:63], v12 offset:23552
    buffer_load_dwordx4 a[116:119], v1, s[20:23], s26 offen offset:1024 sc1
    s_waitcnt lgkmcnt(3)
    v_mfma_f32_32x32x16_bf16 v[16:31], v[224:227], v[48:51], v[16:31]
    s_waitcnt lgkmcnt(1)
    s_barrier
    ds_read_b128 v[64:67], v12 offset:24576
    ds_read_b128 v[68:71], v108 offset:0
    ds_read_b128 v[72:75], v108 offset:512
    ds_read_b128 v[76:79], v108 offset:1024
    ds_read_b128 v[80:83], v108 offset:1536
    v_mfma_f32_32x32x16_bf16 v[16:31], v[228:231], v[52:55], v[16:31]
    s_add_u32 m0, m0, 4096
    ds_read_b128 v[48:51], v12 offset:25600
    buffer_load_dwordx4 v110, s[36:39], m0 offen sc1 lds
    buffer_load_dwordx4 a[120:123], v1, s[20:23], s26 offen offset:2048 sc1
    s_waitcnt lgkmcnt(6)
    v_mfma_f32_32x32x16_bf16 v[16:31], v[232:235], v[56:59], v[16:31]
    ds_read_b128 v[52:55], v12 offset:26624
    v_mfma_f32_32x32x16_bf16 v[16:31], v[236:239], v[60:63], v[16:31]
    ds_read_b128 v[56:59], v12 offset:27648
    buffer_load_dwordx4 a[124:127], v1, s[20:23], s26 offen offset:3072 sc1
    s_waitcnt lgkmcnt(2)
    v_mfma_f32_32x32x16_bf16 v[16:31], v[240:243], v[64:67], v[16:31]
    ds_read_b128 v[60:63], v12 offset:28672
    v_mov_b32 v88, v68
    v_mov_b32 v89, v69
    v_mfma_f32_32x32x16_bf16 v[16:31], v[244:247], v[48:51], v[16:31]
    s_add_u32 m0, m0, 4096
    ds_read_b128 v[64:67], v12 offset:29696
    buffer_load_dwordx4 v110, s[36:39], m0 offen sc1 lds
    s_lshl_b32 s26, s9, 1
    s_add_u32 s26, s26, s27
    buffer_load_dwordx4 a[128:131], v1, s[20:23], s26 offen offset:0 sc1
    s_waitcnt lgkmcnt(2)
    v_mfma_f32_32x32x16_bf16 v[16:31], v[248:251], v[52:55], v[16:31]
    ds_read_b128 v[48:51], v12 offset:30720
    v_mfma_f32_32x32x16_bf16 v[16:31], v[252:255], v[56:59], v[16:31]
    ds_read_b128 v[52:55], v12 offset:31744
    v_mfma_f32_32x32x16_bf16 v[16:31], v[84:87], v[88:91], v[16:31]
    buffer_load_dwordx4 a[132:135], v1, s[20:23], s26 offen offset:1024 sc1
    s_waitcnt lgkmcnt(2)
    v_mfma_f32_32x32x16_bf16 v[32:47], a[224:227], v[60:63], 0
    s_waitcnt vmcnt(13)
    s_barrier
    ds_read_b128 v[56:59], v12 offset:32768
    v_mfma_f32_32x32x16_bf16 v[32:47], a[228:231], v[64:67], v[32:47]
    s_add_u32 m0, m0, 4096
    v_add_u32 v110, s16, v110
    ds_read_b128 v[60:63], v12 offset:33792
    buffer_load_dwordx4 v110, s[36:39], m0 offen sc1 lds
    buffer_load_dwordx4 a[136:139], v1, s[20:23], s26 offen offset:2048 sc1
    s_waitcnt lgkmcnt(2)
    v_mfma_f32_32x32x16_bf16 v[32:47], a[232:235], v[48:51], v[32:47]
    ds_read_b128 v[64:67], v12 offset:34816
    v_mul_f32 v92, v16, v70
    v_mul_f32 v93, v17, v70
    v_exp_f32 v92, v92
    v_exp_f32 v93, v93
    v_fma_f32 v92, v92, v71, v71
    v_fma_f32 v93, v93, v71, v71
    v_mfma_f32_32x32x16_bf16 v[32:47], a[236:239], v[52:55], v[32:47]
    ds_read_b128 v[48:51], v12 offset:35840
    buffer_load_dwordx4 a[140:143], v1, s[20:23], s26 offen offset:3072 sc1
    v_rcp_f32 v92, v92
    v_rcp_f32 v93, v93
    v_mul_f32 v16, v16, v92
    s_waitcnt lgkmcnt(2)
    v_mfma_f32_32x32x16_bf16 v[32:47], a[240:243], v[56:59], v[32:47]
    ds_read_b128 v[52:55], v12 offset:36864
    v_mul_f32 v17, v17, v93
    v_cvt_pk_bf16_f32 v96, v16, v17
    v_mul_f32 v94, v18, v70
    v_mul_f32 v95, v19, v70
    v_exp_f32 v94, v94
    v_exp_f32 v95, v95
    v_mfma_f32_32x32x16_bf16 v[32:47], a[244:247], v[60:63], v[32:47]
    s_add_u32 m0, m0, 4096
    ds_read_b128 v[56:59], v12 offset:37888
    buffer_load_dwordx4 v110, s[36:39], m0 offen sc1 lds
    s_lshl_b32 s26, s10, 1
    s_add_u32 s26, s26, s27
    buffer_load_dwordx4 a[144:147], v1, s[20:23], s26 offen offset:0 sc1
    s_waitcnt lgkmcnt(2)
    v_mfma_f32_32x32x16_bf16 v[32:47], a[248:251], v[64:67], v[32:47]
    ds_read_b128 v[60:63], v12 offset:38912
    v_fma_f32 v94, v94, v71, v71
    v_fma_f32 v95, v95, v71, v71
    v_rcp_f32 v94, v94
    v_rcp_f32 v95, v95
    v_mul_f32 v18, v18, v94
    v_mfma_f32_32x32x16_bf16 v[32:47], a[252:255], v[48:51], v[32:47]
    ds_read_b128 v[64:67], v12 offset:39936
    buffer_load_dwordx4 a[148:151], v1, s[20:23], s26 offen offset:1024 sc1
    v_mul_f32 v19, v19, v95
    v_cvt_pk_bf16_f32 v97, v18, v19
    v_mul_f32 v92, v20, v70
    v_mul_f32 v93, v21, v70
    v_exp_f32 v92, v92
    s_waitcnt lgkmcnt(2)
    v_mfma_f32_32x32x16_bf16 v[32:47], v[176:179], v[52:55], v[32:47]
    s_waitcnt vmcnt(14)
    s_barrier
    ds_read_b128 v[48:51], v12 offset:0
    v_exp_f32 v93, v93
    v_fma_f32 v92, v92, v71, v71
    v_fma_f32 v93, v93, v71, v71
    v_mfma_f32_32x32x16_bf16 v[32:47], v[180:183], v[56:59], v[32:47]
    s_add_u32 m0, m0, 4096
    ds_read_b128 v[52:55], v12 offset:1024
    buffer_load_dwordx4 v110, s[36:39], m0 offen sc1 lds
    buffer_load_dwordx4 a[152:155], v1, s[20:23], s26 offen offset:2048 sc1
    s_waitcnt lgkmcnt(2)
    v_mfma_f32_32x32x16_bf16 v[32:47], v[184:187], v[60:63], v[32:47]
    ds_read_b128 v[56:59], v12 offset:2048
    v_rcp_f32 v92, v92
    v_rcp_f32 v93, v93
    v_mul_f32 v20, v20, v92
    v_mul_f32 v21, v21, v93
    v_cvt_pk_bf16_f32 v98, v20, v21
    v_mul_f32 v94, v22, v70
    v_mfma_f32_32x32x16_bf16 v[32:47], v[188:191], v[64:67], v[32:47]
    ds_read_b128 v[60:63], v12 offset:3072
    buffer_load_dwordx4 a[156:159], v1, s[20:23], s26 offen offset:3072 sc1
    v_mul_f32 v95, v23, v70
    v_exp_f32 v94, v94
    v_exp_f32 v95, v95
    v_fma_f32 v94, v94, v71, v71
    s_waitcnt lgkmcnt(2)
    v_mfma_f32_32x32x16_bf16 v[32:47], v[192:195], v[48:51], v[32:47]
    ds_read_b128 v[64:67], v12 offset:4096
    v_fma_f32 v95, v95, v71, v71
    v_rcp_f32 v94, v94
    v_rcp_f32 v95, v95
    v_mul_f32 v22, v22, v94
    v_mul_f32 v23, v23, v95
    v_mfma_f32_32x32x16_bf16 v[32:47], v[196:199], v[52:55], v[32:47]
    s_add_u32 m0, m0, 4096
    ds_read_b128 v[48:51], v12 offset:5120
    buffer_load_dwordx4 v110, s[36:39], m0 offen sc1 lds
    v_cvt_pk_bf16_f32 v99, v22, v23
    v_mul_f32 v92, v24, v70
    v_mul_f32 v93, v25, v70
    v_exp_f32 v92, v92
    s_waitcnt lgkmcnt(2)
    v_mfma_f32_32x32x16_bf16 v[32:47], v[200:203], v[56:59], v[32:47]
    ds_read_b128 v[52:55], v12 offset:6144
    s_lshl_b32 s26, s11, 1
    s_add_u32 s26, s26, s27
    buffer_load_dwordx4 a[160:163], v1, s[20:23], s26 offen offset:0 sc1
    v_exp_f32 v93, v93
    v_mfma_f32_32x32x16_bf16 v[32:47], v[204:207], v[60:63], v[32:47]
    ds_read_b128 v[56:59], v12 offset:7168
    v_fma_f32 v92, v92, v71, v71
    v_fma_f32 v93, v93, v71, v71
    v_rcp_f32 v92, v92
    v_rcp_f32 v93, v93
    v_mul_f32 v24, v24, v92
    v_mul_f32 v25, v25, v93
    s_waitcnt lgkmcnt(2)
    v_mfma_f32_32x32x16_bf16 v[32:47], v[208:211], v[64:67], v[32:47]
    s_waitcnt vmcnt(13)
    s_barrier
    ds_read_b128 v[60:63], v12 offset:8192
    buffer_load_dwordx4 a[164:167], v1, s[20:23], s26 offen offset:1024 sc1
    v_cvt_pk_bf16_f32 v100, v24, v25
    v_mfma_f32_32x32x16_bf16 v[32:47], v[212:215], v[48:51], v[32:47]
    s_add_u32 m0, m0, 4096
    ds_read_b128 v[64:67], v12 offset:9216
    buffer_load_dwordx4 v110, s[36:39], m0 offen sc1 lds
    v_mul_f32 v94, v26, v70
    v_mul_f32 v95, v27, v70
    v_exp_f32 v94, v94
    s_waitcnt lgkmcnt(2)
    v_mfma_f32_32x32x16_bf16 v[32:47], v[216:219], v[52:55], v[32:47]
    ds_read_b128 v[48:51], v12 offset:10240
    buffer_load_dwordx4 a[168:171], v1, s[20:23], s26 offen offset:2048 sc1
    v_exp_f32 v95, v95
    v_fma_f32 v94, v94, v71, v71
    v_fma_f32 v95, v95, v71, v71
    v_mfma_f32_32x32x16_bf16 v[32:47], v[220:223], v[56:59], v[32:47]
    ds_read_b128 v[52:55], v12 offset:11264
    v_rcp_f32 v94, v94
    v_rcp_f32 v95, v95
    v_mul_f32 v26, v26, v94
    v_mul_f32 v27, v27, v95
    v_cvt_pk_bf16_f32 v101, v26, v27
    v_mul_f32 v92, v28, v70
    v_mul_f32 v93, v29, v70
    s_waitcnt lgkmcnt(2)
    v_mfma_f32_32x32x16_bf16 v[32:47], v[224:227], v[60:63], v[32:47]
    ds_read_b128 v[56:59], v12 offset:12288
    buffer_load_dwordx4 a[172:175], v1, s[20:23], s26 offen offset:3072 sc1
    v_exp_f32 v92, v92
    v_exp_f32 v93, v93
    v_fma_f32 v92, v92, v71, v71
    v_mfma_f32_32x32x16_bf16 v[32:47], v[228:231], v[64:67], v[32:47]
    s_add_u32 m0, m0, 4096
    ds_read_b128 v[60:63], v12 offset:13312
    buffer_load_dwordx4 v110, s[36:39], m0 offen sc1 lds
    v_fma_f32 v93, v93, v71, v71
    v_rcp_f32 v92, v92
    v_rcp_f32 v93, v93
    s_waitcnt lgkmcnt(2)
    v_mfma_f32_32x32x16_bf16 v[32:47], v[232:235], v[48:51], v[32:47]
    ds_read_b128 v[64:67], v12 offset:14336
    s_lshl_b32 s26, s12, 1
    s_add_u32 s26, s26, s27
    buffer_load_dwordx4 a[176:179], v1, s[20:23], s26 offen offset:0 sc1
    v_mul_f32 v28, v28, v92
    v_mul_f32 v29, v29, v93
    v_mfma_f32_32x32x16_bf16 v[32:47], v[236:239], v[52:55], v[32:47]
    ds_read_b128 v[48:51], v12 offset:15360
    v_cvt_pk_bf16_f32 v102, v28, v29
    v_mul_f32 v94, v30, v70
    v_mul_f32 v95, v31, v70
    v_exp_f32 v94, v94
    v_exp_f32 v95, v95
    v_fma_f32 v94, v94, v71, v71
    s_waitcnt lgkmcnt(2)
    v_mfma_f32_32x32x16_bf16 v[32:47], v[240:243], v[56:59], v[32:47]
    s_waitcnt vmcnt(13)
    s_barrier
    ds_read_b128 v[52:55], v12 offset:16384
    v_mov_b32 v88, v72
    v_mov_b32 v89, v73
    buffer_load_dwordx4 a[180:183], v1, s[20:23], s26 offen offset:1024 sc1
    v_mfma_f32_32x32x16_bf16 v[32:47], v[244:247], v[60:63], v[32:47]
    s_mov_b32 m0, s15
    v_add_u32 v110, 40960, v110
    ds_read_b128 v[56:59], v12 offset:17408
    buffer_load_dwordx4 v110, s[36:39], m0 offen sc1 lds
    v_fma_f32 v95, v95, v71, v71
    v_rcp_f32 v94, v94
    s_waitcnt lgkmcnt(2)
    v_mfma_f32_32x32x16_bf16 v[32:47], v[248:251], v[64:67], v[32:47]
    ds_read_b128 v[60:63], v12 offset:18432
    v_rcp_f32 v95, v95
    v_mul_f32 v30, v30, v94
    v_mul_f32 v31, v31, v95
    v_cvt_pk_bf16_f32 v103, v30, v31
    v_mfma_f32_32x32x16_bf16 v[32:47], v[252:255], v[48:51], v[32:47]
    ds_read_b128 v[64:67], v12 offset:19456
    buffer_load_dwordx4 a[184:187], v1, s[20:23], s26 offen offset:2048 sc1
    s_add_u32 s40, s3, 0
    buffer_store_dwordx4 v[96:99], v1, s[36:39], s40 offen sc1
    buffer_store_dwordx4 v[100:103], v1, s[36:39], s40 offen offset:1024 sc1
    v_mfma_f32_32x32x16_bf16 v[32:47], v[84:87], v[88:91], v[32:47]
    s_waitcnt lgkmcnt(2)
    v_mfma_f32_32x32x16_bf16 v[16:31], a[224:227], v[52:55], 0
    ds_read_b128 v[48:51], v12 offset:20480
    buffer_load_dwordx4 a[188:191], v1, s[20:23], s26 offen offset:3072 sc1
    v_mfma_f32_32x32x16_bf16 v[16:31], a[228:231], v[56:59], v[16:31]
    s_add_u32 m0, m0, 4096
    v_subrev_u32 v110, s16, v110
    ds_read_b128 v[52:55], v12 offset:21504
    buffer_load_dwordx4 v110, s[36:39], m0 offen sc1 lds
    s_waitcnt lgkmcnt(2)
    v_mfma_f32_32x32x16_bf16 v[16:31], a[232:235], v[60:63], v[16:31]
    ds_read_b128 v[56:59], v12 offset:22528
    s_lshl_b32 s26, s13, 1
    s_add_u32 s26, s26, s27
    buffer_load_dwordx4 a[192:195], v1, s[20:23], s26 offen offset:0 sc1
    v_mul_f32 v92, v32, v74
    v_mul_f32 v93, v33, v74
    v_exp_f32 v92, v92
    v_mfma_f32_32x32x16_bf16 v[16:31], a[236:239], v[64:67], v[16:31]
    ds_read_b128 v[60:63], v12 offset:23552
    v_exp_f32 v93, v93
    v_fma_f32 v92, v92, v75, v75
    v_fma_f32 v93, v93, v75, v75
    v_rcp_f32 v92, v92
    v_rcp_f32 v93, v93
    v_mul_f32 v32, v32, v92
    s_waitcnt lgkmcnt(2)
    v_mfma_f32_32x32x16_bf16 v[16:31], a[240:243], v[48:51], v[16:31]
    s_waitcnt vmcnt(15)
    s_barrier
    ds_read_b128 v[64:67], v12 offset:24576
    buffer_load_dwordx4 a[196:199], v1, s[20:23], s26 offen offset:1024 sc1
    v_mul_f32 v33, v33, v93
    v_mfma_f32_32x32x16_bf16 v[16:31], a[244:247], v[52:55], v[16:31]
    s_add_u32 m0, m0, 4096
    ds_read_b128 v[48:51], v12 offset:25600
    buffer_load_dwordx4 v110, s[36:39], m0 offen sc1 lds
    v_cvt_pk_bf16_f32 v96, v32, v33
    v_mul_f32 v94, v34, v74
    v_mul_f32 v95, v35, v74
    v_exp_f32 v94, v94
    s_waitcnt lgkmcnt(2)
    v_mfma_f32_32x32x16_bf16 v[16:31], a[248:251], v[56:59], v[16:31]
    ds_read_b128 v[52:55], v12 offset:26624
    buffer_load_dwordx4 a[200:203], v1, s[20:23], s26 offen offset:2048 sc1
    v_exp_f32 v95, v95
    v_fma_f32 v94, v94, v75, v75
    v_fma_f32 v95, v95, v75, v75
    v_rcp_f32 v94, v94
    v_mfma_f32_32x32x16_bf16 v[16:31], a[252:255], v[60:63], v[16:31]
    ds_read_b128 v[56:59], v12 offset:27648
    v_rcp_f32 v95, v95
    v_mul_f32 v34, v34, v94
    v_mul_f32 v35, v35, v95
    v_cvt_pk_bf16_f32 v97, v34, v35
    v_mul_f32 v92, v36, v74
    v_mul_f32 v93, v37, v74
    v_exp_f32 v92, v92
    s_waitcnt lgkmcnt(2)
    v_mfma_f32_32x32x16_bf16 v[16:31], v[176:179], v[64:67], v[16:31]
    ds_read_b128 v[60:63], v12 offset:28672
    buffer_load_dwordx4 a[204:207], v1, s[20:23], s26 offen offset:3072 sc1
    v_exp_f32 v93, v93
    v_fma_f32 v92, v92, v75, v75
    v_fma_f32 v93, v93, v75, v75
    v_mfma_f32_32x32x16_bf16 v[16:31], v[180:183], v[48:51], v[16:31]
    s_add_u32 m0, m0, 4096
    ds_read_b128 v[64:67], v12 offset:29696
    buffer_load_dwordx4 v110, s[36:39], m0 offen sc1 lds
    v_rcp_f32 v92, v92
    v_rcp_f32 v93, v93
    v_mul_f32 v36, v36, v92
    v_mul_f32 v37, v37, v93
    s_waitcnt lgkmcnt(2)
    v_mfma_f32_32x32x16_bf16 v[16:31], v[184:187], v[52:55], v[16:31]
    ds_read_b128 v[48:51], v12 offset:30720
    s_lshl_b32 s26, s14, 1
    s_add_u32 s26, s26, s27
    buffer_load_dwordx4 a[208:211], v1, s[20:23], s26 offen offset:0 sc1
    v_cvt_pk_bf16_f32 v98, v36, v37
    v_mul_f32 v94, v38, v74
    v_mul_f32 v95, v39, v74
    v_mfma_f32_32x32x16_bf16 v[16:31], v[188:191], v[56:59], v[16:31]
    ds_read_b128 v[52:55], v12 offset:31744
    v_exp_f32 v94, v94
    v_exp_f32 v95, v95
    v_fma_f32 v94, v94, v75, v75
    v_fma_f32 v95, v95, v75, v75
    v_rcp_f32 v94, v94
    s_waitcnt lgkmcnt(2)
    v_mfma_f32_32x32x16_bf16 v[16:31], v[192:195], v[60:63], v[16:31]
    s_waitcnt vmcnt(15)
    s_barrier
    ds_read_b128 v[56:59], v12 offset:32768
    v_rcp_f32 v95, v95
    v_mul_f32 v38, v38, v94
    v_mul_f32 v39, v39, v95
    v_cvt_pk_bf16_f32 v99, v38, v39
    v_mul_f32 v92, v40, v74
    v_mfma_f32_32x32x16_bf16 v[16:31], v[196:199], v[64:67], v[16:31]
    s_add_u32 m0, m0, 4096
    ds_read_b128 v[60:63], v12 offset:33792
    buffer_load_dwordx4 v110, s[36:39], m0 offen sc1 lds
    buffer_load_dwordx4 a[212:215], v1, s[20:23], s26 offen offset:1024 sc1
    v_mul_f32 v93, v41, v74
    s_waitcnt lgkmcnt(2)
    v_mfma_f32_32x32x16_bf16 v[16:31], v[200:203], v[48:51], v[16:31]
    ds_read_b128 v[64:67], v12 offset:34816
    s_add_u32 s41, s2, 0
    s_add_u32 s42, s56, 1
    v_mov_b32 v14, s42
    s_waitcnt vmcnt(11)
    s_mov_b64 exec, 1
    buffer_store_dword v14, v1, s[36:39], s41 offen sc1
    s_mov_b64 exec, -1
    v_mfma_f32_32x32x16_bf16 v[16:31], v[204:207], v[52:55], v[16:31]
    ds_read_b128 v[48:51], v12 offset:35840
    buffer_load_dwordx4 a[216:219], v1, s[20:23], s26 offen offset:2048 sc1
    v_exp_f32 v92, v92
    v_exp_f32 v93, v93
    v_fma_f32 v92, v92, v75, v75
    v_fma_f32 v93, v93, v75, v75
    s_waitcnt lgkmcnt(2)
    v_mfma_f32_32x32x16_bf16 v[16:31], v[208:211], v[56:59], v[16:31]
    ds_read_b128 v[52:55], v12 offset:36864
    v_rcp_f32 v92, v92
    v_rcp_f32 v93, v93
    v_mul_f32 v40, v40, v92
    v_mul_f32 v41, v41, v93
    v_cvt_pk_bf16_f32 v100, v40, v41
    v_mul_f32 v94, v42, v74
    v_mul_f32 v95, v43, v74
    v_mfma_f32_32x32x16_bf16 v[16:31], v[212:215], v[60:63], v[16:31]
    s_add_u32 m0, m0, 4096
    ds_read_b128 v[56:59], v12 offset:37888
    buffer_load_dwordx4 v110, s[36:39], m0 offen sc1 lds
    buffer_load_dwordx4 a[220:223], v1, s[20:23], s26 offen offset:3072 sc1
    v_exp_f32 v94, v94
    s_waitcnt lgkmcnt(2)
    v_mfma_f32_32x32x16_bf16 v[16:31], v[216:219], v[64:67], v[16:31]
    ds_read_b128 v[60:63], v12 offset:38912
    v_exp_f32 v95, v95
    v_fma_f32 v94, v94, v75, v75
    v_fma_f32 v95, v95, v75, v75
    v_rcp_f32 v94, v94
    v_rcp_f32 v95, v95
    v_mfma_f32_32x32x16_bf16 v[16:31], v[220:223], v[48:51], v[16:31]
    ds_read_b128 v[64:67], v12 offset:39936
    s_lshl_b32 s26, s8, 1
    s_add_u32 s26, s26, s25
    buffer_load_dwordx4 a[0:3], v1, s[20:23], s26 offen offset:0 sc1
    v_mul_f32 v42, v42, v94
    v_mul_f32 v43, v43, v95
    v_cvt_pk_bf16_f32 v101, v42, v43
    v_mul_f32 v92, v44, v74
    s_waitcnt lgkmcnt(2)
    v_mfma_f32_32x32x16_bf16 v[16:31], v[224:227], v[52:55], v[16:31]
    s_waitcnt vmcnt(14)
    s_barrier
    ds_read_b128 v[48:51], v12 offset:0
    v_mul_f32 v93, v45, v74
    v_exp_f32 v92, v92
    v_exp_f32 v93, v93
    v_mfma_f32_32x32x16_bf16 v[16:31], v[228:231], v[56:59], v[16:31]
    s_add_u32 m0, m0, 4096
    ds_read_b128 v[52:55], v12 offset:1024
    buffer_load_dwordx4 v110, s[36:39], m0 offen sc1 lds
    buffer_load_dwordx4 a[4:7], v1, s[20:23], s26 offen offset:1024 sc1
    v_fma_f32 v92, v92, v75, v75
    s_waitcnt lgkmcnt(2)
    v_mfma_f32_32x32x16_bf16 v[16:31], v[232:235], v[60:63], v[16:31]
    ds_read_b128 v[56:59], v12 offset:2048
    v_fma_f32 v93, v93, v75, v75
    v_rcp_f32 v92, v92
    v_rcp_f32 v93, v93
    v_mul_f32 v44, v44, v92
    v_mul_f32 v45, v45, v93
    v_cvt_pk_bf16_f32 v102, v44, v45
    v_mul_f32 v94, v46, v74
    v_mfma_f32_32x32x16_bf16 v[16:31], v[236:239], v[64:67], v[16:31]
    ds_read_b128 v[60:63], v12 offset:3072
    buffer_load_dwordx4 a[8:11], v1, s[20:23], s26 offen offset:2048 sc1
    v_mul_f32 v95, v47, v74
    v_exp_f32 v94, v94
    v_exp_f32 v95, v95
    v_fma_f32 v94, v94, v75, v75
    s_waitcnt lgkmcnt(2)
    v_mfma_f32_32x32x16_bf16 v[16:31], v[240:243], v[48:51], v[16:31]
    ds_read_b128 v[64:67], v12 offset:4096
    v_mov_b32 v88, v76
    v_mov_b32 v89, v77
    v_fma_f32 v95, v95, v75, v75
    v_rcp_f32 v94, v94
    v_rcp_f32 v95, v95
    v_mul_f32 v46, v46, v94
    v_mfma_f32_32x32x16_bf16 v[16:31], v[244:247], v[52:55], v[16:31]
    s_add_u32 m0, m0, 4096
    ds_read_b128 v[48:51], v12 offset:5120
    buffer_load_dwordx4 v110, s[36:39], m0 offen sc1 lds
    v_mul_f32 v47, v47, v95
    v_cvt_pk_bf16_f32 v103, v46, v47
    s_waitcnt lgkmcnt(2)
    v_mfma_f32_32x32x16_bf16 v[16:31], v[248:251], v[56:59], v[16:31]
    ds_read_b128 v[52:55], v12 offset:6144
    s_add_u32 s70, s74, 0
    buffer_load_dword v109, v104, s[36:39], s70 offen sc1
    buffer_load_dwordx4 a[12:15], v1, s[20:23], s26 offen offset:3072 sc1
    s_add_u32 s40, s17, 229376
    buffer_store_dwordx4 v[96:99], v1, s[36:39], s40 offen sc1
    buffer_store_dwordx4 v[100:103], v1, s[36:39], s40 offen offset:1024 sc1
    v_mfma_f32_32x32x16_bf16 v[16:31], v[252:255], v[60:63], v[16:31]
    ds_read_b128 v[56:59], v12 offset:7168
    v_mfma_f32_32x32x16_bf16 v[16:31], v[84:87], v[88:91], v[16:31]
    s_lshl_b32 s26, s9, 1
    s_add_u32 s26, s26, s25
    buffer_load_dwordx4 a[16:19], v1, s[20:23], s26 offen offset:0 sc1
    s_waitcnt lgkmcnt(2)
    v_mfma_f32_32x32x16_bf16 v[32:47], a[224:227], v[64:67], 0
    s_waitcnt vmcnt(17)
    s_barrier
    ds_read_b128 v[60:63], v12 offset:8192
    v_mfma_f32_32x32x16_bf16 v[32:47], a[228:231], v[48:51], v[32:47]
    ds_read_b128 v[64:67], v12 offset:9216
    buffer_load_dwordx4 a[20:23], v1, s[20:23], s26 offen offset:1024 sc1
    s_waitcnt lgkmcnt(2)
    v_mfma_f32_32x32x16_bf16 v[32:47], a[232:235], v[52:55], v[32:47]
    ds_read_b128 v[48:51], v12 offset:10240
    v_mul_f32 v92, v16, v78
    v_mul_f32 v93, v17, v78
    v_exp_f32 v92, v92
    v_exp_f32 v93, v93
    v_fma_f32 v92, v92, v79, v79
    v_fma_f32 v93, v93, v79, v79
    v_mfma_f32_32x32x16_bf16 v[32:47], a[236:239], v[56:59], v[32:47]
    ds_read_b128 v[52:55], v12 offset:11264
    buffer_load_dwordx4 a[24:27], v1, s[20:23], s26 offen offset:2048 sc1
    v_rcp_f32 v92, v92
    v_rcp_f32 v93, v93
    v_mul_f32 v16, v16, v92
    v_mul_f32 v17, v17, v93
    s_waitcnt lgkmcnt(2)
    v_mfma_f32_32x32x16_bf16 v[32:47], a[240:243], v[60:63], v[32:47]
    ds_read_b128 v[56:59], v12 offset:12288
    s_add_u32 s47, s56, 1
    s_waitcnt vmcnt(6)
    v_subrev_u32 v109, s47, v109
    v_cmp_lt_u32 vcc, 3, v109
    s_cbranch_vccnz L_aspin_51
L_aback_52:
    v_cvt_pk_bf16_f32 v96, v16, v17
    v_mul_f32 v94, v18, v78
    v_mul_f32 v95, v19, v78
    v_mfma_f32_32x32x16_bf16 v[32:47], a[244:247], v[64:67], v[32:47]
    ds_read_b128 v[60:63], v12 offset:13312
    s_add_u32 s79, s73, 0
    v_add_u32 v15, s79, v1
    buffer_load_dwordx4 v[112:115], v15, s[36:39], s8 offen offset:0 sc1
    buffer_load_dwordx4 a[28:31], v1, s[20:23], s26 offen offset:3072 sc1
    s_waitcnt lgkmcnt(2)
    v_mfma_f32_32x32x16_bf16 v[32:47], a[248:251], v[48:51], v[32:47]
    ds_read_b128 v[64:67], v12 offset:14336
    buffer_load_dwordx4 v[116:119], v15, s[36:39], s8 offen offset:1024 sc1
    v_exp_f32 v94, v94
    v_exp_f32 v95, v95
    v_fma_f32 v94, v94, v79, v79
    v_mfma_f32_32x32x16_bf16 v[32:47], a[252:255], v[52:55], v[32:47]
    ds_read_b128 v[48:51], v12 offset:15360
    s_lshl_b32 s26, s10, 1
    s_add_u32 s26, s26, s25
    buffer_load_dwordx4 a[32:35], v1, s[20:23], s26 offen offset:0 sc1
    v_fma_f32 v95, v95, v79, v79
    v_rcp_f32 v94, v94
    s_waitcnt lgkmcnt(2)
    v_mfma_f32_32x32x16_bf16 v[32:47], v[176:179], v[56:59], v[32:47]
    s_barrier
    ds_read_b128 v[52:55], v12 offset:16384
    buffer_load_dwordx4 v[120:123], v15, s[36:39], s9 offen offset:0 sc1
    v_rcp_f32 v95, v95
    v_mfma_f32_32x32x16_bf16 v[32:47], v[180:183], v[60:63], v[32:47]
    ds_read_b128 v[56:59], v12 offset:17408
    buffer_load_dwordx4 a[36:39], v1, s[20:23], s26 offen offset:1024 sc1
    v_mul_f32 v18, v18, v94
    v_mul_f32 v19, v19, v95
    v_cvt_pk_bf16_f32 v97, v18, v19
    v_mul_f32 v92, v20, v78
    v_mul_f32 v93, v21, v78
    s_waitcnt lgkmcnt(2)
    v_mfma_f32_32x32x16_bf16 v[32:47], v[184:187], v[64:67], v[32:47]
    ds_read_b128 v[60:63], v12 offset:18432
    buffer_load_dwordx4 v[124:127], v15, s[36:39], s9 offen offset:1024 sc1
    v_exp_f32 v92, v92
    v_exp_f32 v93, v93
    v_fma_f32 v92, v92, v79, v79
    v_mfma_f32_32x32x16_bf16 v[32:47], v[188:191], v[48:51], v[32:47]
    ds_read_b128 v[64:67], v12 offset:19456
    v_fma_f32 v93, v93, v79, v79
    v_rcp_f32 v92, v92
    v_rcp_f32 v93, v93
    v_mul_f32 v20, v20, v92
    v_mul_f32 v21, v21, v93
    v_cvt_pk_bf16_f32 v98, v20, v21
    v_mul_f32 v94, v22, v78
    s_waitcnt lgkmcnt(2)
    v_mfma_f32_32x32x16_bf16 v[32:47], v[192:195], v[52:55], v[32:47]
    ds_read_b128 v[48:51], v12 offset:20480
    buffer_load_dwordx4 v[128:131], v15, s[36:39], s10 offen offset:0 sc1
    buffer_load_dwordx4 a[40:43], v1, s[20:23], s26 offen offset:2048 sc1
    v_mul_f32 v95, v23, v78
    v_mfma_f32_32x32x16_bf16 v[32:47], v[196:199], v[56:59], v[32:47]
    ds_read_b128 v[52:55], v12 offset:21504
    v_exp_f32 v94, v94
    v_exp_f32 v95, v95
    v_fma_f32 v94, v94, v79, v79
    v_fma_f32 v95, v95, v79, v79
    v_rcp_f32 v94, v94
    s_waitcnt lgkmcnt(2)
    v_mfma_f32_32x32x16_bf16 v[32:47], v[200:203], v[60:63], v[32:47]
    ds_read_b128 v[56:59], v12 offset:22528
    s_add_u32 s41, s1, 512
    s_add_u32 s42, s56, 1
    v_mov_b32 v14, s42
    s_waitcnt vmcnt(12)
    s_mov_b64 exec, 1
    buffer_store_dword v14, v1, s[36:39], s41 offen sc1
    s_mov_b64 exec, -1
    buffer_load_dwordx4 v[132:135], v15, s[36:39], s10 offen offset:1024 sc1
    buffer_load_dwordx4 a[44:47], v1, s[20:23], s26 offen offset:3072 sc1
    v_mfma_f32_32x32x16_bf16 v[32:47], v[204:207], v[64:67], v[32:47]
    ds_read_b128 v[60:63], v12 offset:23552
    v_rcp_f32 v95, v95
    v_mul_f32 v22, v22, v94
    v_mul_f32 v23, v23, v95
    v_cvt_pk_bf16_f32 v99, v22, v23
    v_mul_f32 v92, v24, v78
    v_mul_f32 v93, v25, v78
    v_exp_f32 v92, v92
    s_waitcnt lgkmcnt(2)
    v_mfma_f32_32x32x16_bf16 v[32:47], v[208:211], v[48:51], v[32:47]
    s_barrier
    ds_read_b128 v[64:67], v12 offset:24576
    buffer_load_dwordx4 v[136:139], v15, s[36:39], s11 offen offset:0 sc1
    s_lshl_b32 s26, s11, 1
    s_add_u32 s26, s26, s25
    buffer_load_dwordx4 a[48:51], v1, s[20:23], s26 offen offset:0 sc1
    v_mfma_f32_32x32x16_bf16 v[32:47], v[212:215], v[52:55], v[32:47]
    ds_read_b128 v[48:51], v12 offset:25600
    buffer_load_dwordx4 v[140:143], v15, s[36:39], s11 offen offset:1024 sc1
    v_exp_f32 v93, v93
    v_fma_f32 v92, v92, v79, v79
    v_fma_f32 v93, v93, v79, v79
    v_rcp_f32 v92, v92
    s_waitcnt lgkmcnt(2)
    v_mfma_f32_32x32x16_bf16 v[32:47], v[216:219], v[56:59], v[32:47]
    ds_read_b128 v[52:55], v12 offset:26624
    buffer_load_dwordx4 a[52:55], v1, s[20:23], s26 offen offset:1024 sc1
    v_rcp_f32 v93, v93
    v_mul_f32 v24, v24, v92
    v_mul_f32 v25, v25, v93
    v_cvt_pk_bf16_f32 v100, v24, v25
    v_mfma_f32_32x32x16_bf16 v[32:47], v[220:223], v[60:63], v[32:47]
    ds_read_b128 v[56:59], v12 offset:27648
    buffer_load_dwordx4 v[144:147], v15, s[36:39], s12 offen offset:0 sc1
    v_mul_f32 v94, v26, v78
    v_mul_f32 v95, v27, v78
    v_exp_f32 v94, v94
    v_exp_f32 v95, v95
    s_waitcnt lgkmcnt(2)
    v_mfma_f32_32x32x16_bf16 v[32:47], v[224:227], v[64:67], v[32:47]
    ds_read_b128 v[60:63], v12 offset:28672
    buffer_load_dwordx4 a[56:59], v1, s[20:23], s26 offen offset:2048 sc1
    v_fma_f32 v94, v94, v79, v79
    v_fma_f32 v95, v95, v79, v79
    v_rcp_f32 v94, v94
    v_mfma_f32_32x32x16_bf16 v[32:47], v[228:231], v[48:51], v[32:47]
    ds_read_b128 v[64:67], v12 offset:29696
    buffer_load_dwordx4 v[148:151], v15, s[36:39], s12 offen offset:1024 sc1
    v_rcp_f32 v95, v95
    v_mul_f32 v26, v26, v94
    v_mul_f32 v27, v27, v95
    v_cvt_pk_bf16_f32 v101, v26, v27
    s_waitcnt lgkmcnt(2)
    v_mfma_f32_32x32x16_bf16 v[32:47], v[232:235], v[52:55], v[32:47]
    ds_read_b128 v[48:51], v12 offset:30720
    buffer_load_dwordx4 a[60:63], v1, s[20:23], s26 offen offset:3072 sc1
    v_mul_f32 v92, v28, v78
    v_mul_f32 v93, v29, v78
    v_exp_f32 v92, v92
    v_mfma_f32_32x32x16_bf16 v[32:47], v[236:239], v[56:59], v[32:47]
    ds_read_b128 v[52:55], v12 offset:31744
    buffer_load_dwordx4 v[152:155], v15, s[36:39], s13 offen offset:0 sc1
    v_exp_f32 v93, v93
    v_fma_f32 v92, v92, v79, v79
    v_fma_f32 v93, v93, v79, v79
    v_rcp_f32 v92, v92
    s_waitcnt lgkmcnt(2)
    v_mfma_f32_32x32x16_bf16 v[32:47], v[240:243], v[60:63], v[32:47]
    v_mov_b32 v88, v80
    v_mov_b32 v89, v81
    v_rcp_f32 v93, v93
    v_mul_f32 v28, v28, v92
    v_mul_f32 v29, v29, v93
    v_cvt_pk_bf16_f32 v102, v28, v29
    v_mul_f32 v94, v30, v78
    v_mul_f32 v95, v31, v78
    v_mfma_f32_32x32x16_bf16 v[32:47], v[244:247], v[64:67], v[32:47]
    buffer_load_dwordx4 v[156:159], v15, s[36:39], s13 offen offset:1024 sc1
    v_exp_f32 v94, v94
    v_exp_f32 v95, v95
    v_fma_f32 v94, v94, v79, v79
    v_fma_f32 v95, v95, v79, v79
    s_waitcnt lgkmcnt(0)
    v_mfma_f32_32x32x16_bf16 v[32:47], v[248:251], v[48:51], v[32:47]
    v_rcp_f32 v94, v94
    v_rcp_f32 v95, v95
    v_mul_f32 v30, v30, v94
    v_mul_f32 v31, v31, v95
    v_cvt_pk_bf16_f32 v103, v30, v31
    v_mfma_f32_32x32x16_bf16 v[32:47], v[252:255], v[52:55], v[32:47]
    s_add_u32 s40, s3, 114688
    buffer_store_dwordx4 v[96:99], v1, s[36:39], s40 offen sc1
    buffer_store_dwordx4 v[100:103], v1, s[36:39], s40 offen offset:1024 sc1
    v_mfma_f32_32x32x16_bf16 v[32:47], v[84:87], v[88:91], v[32:47]
    s_nop 11
    v_pk_mul_f32 v[92:93], v[32:33], v[82:83] op_sel_hi:[1,0]
    s_xor_b32 s71, s74, 4
    buffer_load_dword v13, v104, s[36:39], s71 offen sc1
    v_pk_mul_f32 v[94:95], v[34:35], v[82:83] op_sel_hi:[1,0]
    v_exp_f32 v92, v92
    v_exp_f32 v93, v93
    v_exp_f32 v94, v94
    v_exp_f32 v95, v95
    v_pk_fma_f32 v[92:93], v[92:93], v[82:83], v[82:83] op_sel:[0,1,1] op_sel_hi:[1,1,1]
    v_pk_fma_f32 v[94:95], v[94:95], v[82:83], v[82:83] op_sel:[0,1,1] op_sel_hi:[1,1,1]
    v_rcp_f32 v92, v92
    v_rcp_f32 v93, v93
    v_rcp_f32 v94, v94
    v_rcp_f32 v95, v95
    v_pk_mul_f32 v[32:33], v[32:33], v[92:93]
    v_pk_mul_f32 v[34:35], v[34:35], v[94:95]
    v_cvt_pk_bf16_f32 v96, v32, v33
    v_cvt_pk_bf16_f32 v97, v34, v35
    v_pk_mul_f32 v[92:93], v[36:37], v[82:83] op_sel_hi:[1,0]
    v_pk_mul_f32 v[94:95], v[38:39], v[82:83] op_sel_hi:[1,0]
    v_exp_f32 v92, v92
    v_exp_f32 v93, v93
    v_exp_f32 v94, v94
    buffer_load_dwordx4 v[160:163], v15, s[36:39], s14 offen offset:0 sc1
    v_exp_f32 v95, v95
    v_pk_fma_f32 v[92:93], v[92:93], v[82:83], v[82:83] op_sel:[0,1,1] op_sel_hi:[1,1,1]
    v_pk_fma_f32 v[94:95], v[94:95], v[82:83], v[82:83] op_sel:[0,1,1] op_sel_hi:[1,1,1]
    v_rcp_f32 v92, v92
    v_rcp_f32 v93, v93
    v_rcp_f32 v94, v94
    v_rcp_f32 v95, v95
    v_pk_mul_f32 v[36:37], v[36:37], v[92:93]
    v_pk_mul_f32 v[38:39], v[38:39], v[94:95]
    v_cvt_pk_bf16_f32 v98, v36, v37
    v_cvt_pk_bf16_f32 v99, v38, v39
    v_pk_mul_f32 v[92:93], v[40:41], v[82:83] op_sel_hi:[1,0]
    v_pk_mul_f32 v[94:95], v[42:43], v[82:83] op_sel_hi:[1,0]
    v_exp_f32 v92, v92
    v_exp_f32 v93, v93
    v_exp_f32 v94, v94
    v_exp_f32 v95, v95
    v_pk_fma_f32 v[92:93], v[92:93], v[82:83], v[82:83] op_sel:[0,1,1] op_sel_hi:[1,1,1]
    v_pk_fma_f32 v[94:95], v[94:95], v[82:83], v[82:83] op_sel:[0,1,1] op_sel_hi:[1,1,1]
    v_rcp_f32 v92, v92
    v_rcp_f32 v93, v93
    buffer_load_dwordx4 v[164:167], v15, s[36:39], s14 offen offset:1024 sc1
    v_rcp_f32 v94, v94
    v_rcp_f32 v95, v95
    v_pk_mul_f32 v[40:41], v[40:41], v[92:93]
    v_pk_mul_f32 v[42:43], v[42:43], v[94:95]
    v_cvt_pk_bf16_f32 v100, v40, v41
    v_cvt_pk_bf16_f32 v101, v42, v43
    v_pk_mul_f32 v[92:93], v[44:45], v[82:83] op_sel_hi:[1,0]
    v_pk_mul_f32 v[94:95], v[46:47], v[82:83] op_sel_hi:[1,0]
    v_exp_f32 v92, v92
    v_exp_f32 v93, v93
    v_exp_f32 v94, v94
    v_exp_f32 v95, v95
    v_pk_fma_f32 v[92:93], v[92:93], v[82:83], v[82:83] op_sel:[0,1,1] op_sel_hi:[1,1,1]
    v_pk_fma_f32 v[94:95], v[94:95], v[82:83], v[82:83] op_sel:[0,1,1] op_sel_hi:[1,1,1]
    v_rcp_f32 v92, v92
    v_rcp_f32 v93, v93
    v_rcp_f32 v94, v94
    v_rcp_f32 v95, v95
    v_pk_mul_f32 v[44:45], v[44:45], v[92:93]
    v_pk_mul_f32 v[46:47], v[46:47], v[94:95]
    v_cvt_pk_bf16_f32 v102, v44, v45
    v_cvt_pk_bf16_f32 v103, v46, v47
    s_add_u32 s40, s17, 344064
    buffer_store_dwordx4 v[96:99], v1, s[36:39], s40 offen sc1
    buffer_store_dwordx4 v[100:103], v1, s[36:39], s40 offen offset:1024 sc1
    s_waitcnt vmcnt(28)
    v_mfma_f32_32x32x16_bf16 v[16:31], a[0:3], v[112:115], 0
    s_barrier
    v_mfma_f32_32x32x16_bf16 v[48:63], a[4:7], v[112:115], 0
    s_waitcnt vmcnt(26)
    v_mfma_f32_32x32x16_bf16 v[16:31], a[8:11], v[116:119], v[16:31]
    v_mfma_f32_32x32x16_bf16 v[48:63], a[12:15], v[116:119], v[48:63]
    s_waitcnt vmcnt(24)
    v_mfma_f32_32x32x16_bf16 v[16:31], a[16:19], v[120:123], v[16:31]
    s_add_u32 s41, s2, 256
    s_add_u32 s42, s56, 1
    v_mov_b32 v14, s42
    s_waitcnt vmcnt(5)
    s_mov_b64 exec, 1
    buffer_store_dword v14, v1, s[36:39], s41 offen sc1
    s_mov_b64 exec, -1
    v_mfma_f32_32x32x16_bf16 v[48:63], a[20:23], v[120:123], v[48:63]
    v_and_b32 v107, 7, v0
    v_mfma_f32_32x32x16_bf16 v[16:31], a[24:27], v[124:127], v[16:31]
    s_add_u32 s47, s56, 1
    s_waitcnt vmcnt(5)
    v_subrev_u32 v13, s47, v13
    v_cmp_lt_u32 vcc, 3, v13
    s_cbranch_vccnz L_aspin_54
L_aback_55:
    s_add_u32 s79, s78, 0
    v_add_u32 v15, s79, v1
    buffer_load_dwordx4 v[168:171], v15, s[36:39], s8 offen offset:0 sc1
    v_bfe_u32 v110, v0, 3, 1
    v_mfma_f32_32x32x16_bf16 v[48:63], a[28:31], v[124:127], v[48:63]
    v_mfma_f32_32x32x16_bf16 v[16:31], a[32:35], v[128:131], v[16:31]
    buffer_load_dwordx4 v[172:175], v15, s[36:39], s8 offen offset:1024 sc1
    v_lshrrev_b32 v108, 4, v0
    v_mfma_f32_32x32x16_bf16 v[48:63], a[36:39], v[128:131], v[48:63]
    v_lshlrev_b32 v108, 9, v108
    v_mfma_f32_32x32x16_bf16 v[16:31], a[40:43], v[132:135], v[16:31]
    buffer_load_dwordx4 v[112:115], v15, s[36:39], s9 offen offset:0 sc1
    v_mfma_f32_32x32x16_bf16 v[48:63], a[44:47], v[132:135], v[48:63]
    v_lshl_add_u32 v108, v107, 4, v108
    v_mfma_f32_32x32x16_bf16 v[16:31], a[48:51], v[136:139], v[16:31]
    buffer_load_dwordx4 v[116:119], v15, s[36:39], s9 offen offset:1024 sc1
    v_mfma_f32_32x32x16_bf16 v[48:63], a[52:55], v[136:139], v[48:63]
    v_lshlrev_b32 v107, 4, v107
    v_mfma_f32_32x32x16_bf16 v[16:31], a[56:59], v[140:143], v[16:31]
    buffer_load_dwordx4 v[120:123], v15, s[36:39], s10 offen offset:0 sc1
    v_lshl_add_u32 v107, v110, 9, v107
    v_mfma_f32_32x32x16_bf16 v[48:63], a[60:63], v[140:143], v[48:63]
    v_mfma_f32_32x32x16_bf16 v[16:31], a[64:67], v[144:147], v[16:31]
    buffer_load_dwordx4 v[124:127], v15, s[36:39], s10 offen offset:1024 sc1
    v_lshrrev_b32 v110, 4, v0
    v_mfma_f32_32x32x16_bf16 v[48:63], a[68:71], v[144:147], v[48:63]
    v_lshl_add_u32 v107, v110, 10, v107
    v_mfma_f32_32x32x16_bf16 v[16:31], a[72:75], v[148:151], v[16:31]
    buffer_load_dwordx4 v[128:131], v15, s[36:39], s11 offen offset:0 sc1
    v_mfma_f32_32x32x16_bf16 v[48:63], a[76:79], v[148:151], v[48:63]
    s_add_u32 s43, s75, 0
    buffer_load_dwordx4 v[88:91], v107, s[36:39], s43 offen sc1
    v_mfma_f32_32x32x16_bf16 v[16:31], a[80:83], v[152:155], v[16:31]
    buffer_load_dwordx4 v[132:135], v15, s[36:39], s11 offen offset:1024 sc1
    v_mfma_f32_32x32x16_bf16 v[48:63], a[84:87], v[152:155], v[48:63]
    v_mfma_f32_32x32x16_bf16 v[16:31], a[88:91], v[156:159], v[16:31]
    s_add_u32 s70, s74, 256
    buffer_load_dword v109, v104, s[36:39], s70 offen sc1
    buffer_load_dwordx4 v[136:139], v15, s[36:39], s12 offen offset:0 sc1
    v_mfma_f32_32x32x16_bf16 v[48:63], a[92:95], v[156:159], v[48:63]
    s_waitcnt vmcnt(15)
    v_mfma_f32_32x32x16_bf16 v[16:31], a[96:99], v[160:163], v[16:31]
    buffer_load_dwordx4 v[140:143], v15, s[36:39], s12 offen offset:1024 sc1
    s_add_u32 s41, s1, 768
    s_add_u32 s42, s56, 1
    v_mov_b32 v14, s42
    s_waitcnt vmcnt(13)
    s_mov_b64 exec, 1
    buffer_store_dword v14, v1, s[36:39], s41 offen sc1
    s_mov_b64 exec, -1
    v_mfma_f32_32x32x16_bf16 v[48:63], a[100:103], v[160:163], v[48:63]
    v_mfma_f32_32x32x16_bf16 v[16:31], a[104:107], v[164:167], v[16:31]
    v_mfma_f32_32x32x16_bf16 v[48:63], a[108:111], v[164:167], v[48:63]
    buffer_load_dwordx4 v[144:147], v15, s[36:39], s13 offen offset:0 sc1
    s_waitcnt vmcnt(13)
    v_mfma_f32_32x32x16_bf16 v[16:31], a[112:115], v[168:171], v[16:31]
    v_mfma_f32_32x32x16_bf16 v[48:63], a[116:119], v[168:171], v[48:63]
    buffer_load_dwordx4 v[148:151], v15, s[36:39], s13 offen offset:1024 sc1
    s_waitcnt vmcnt(13)
    v_mfma_f32_32x32x16_bf16 v[16:31], a[120:123], v[172:175], v[16:31]
    v_mfma_f32_32x32x16_bf16 v[48:63], a[124:127], v[172:175], v[48:63]
    buffer_load_dwordx4 v[152:155], v15, s[36:39], s14 offen offset:0 sc1
    s_waitcnt vmcnt(13)
    v_mfma_f32_32x32x16_bf16 v[16:31], a[128:131], v[112:115], v[16:31]
    v_mfma_f32_32x32x16_bf16 v[48:63], a[132:135], v[112:115], v[48:63]
    buffer_load_dwordx4 v[156:159], v15, s[36:39], s14 offen offset:1024 sc1
    s_waitcnt vmcnt(13)
    v_mfma_f32_32x32x16_bf16 v[16:31], a[136:139], v[116:119], v[16:31]
    v_mfma_f32_32x32x16_bf16 v[48:63], a[140:143], v[116:119], v[48:63]
    s_waitcnt vmcnt(12)
    v_mfma_f32_32x32x16_bf16 v[16:31], a[144:147], v[120:123], v[16:31]
    s_add_u32 s47, s56, 1
    s_waitcnt vmcnt(7)
    v_subrev_u32 v109, s47, v109
    v_cmp_lt_u32 vcc, 3, v109
    s_cbranch_vccnz L_aspin_57
L_aback_58:
    s_add_u32 s79, s73, 114688
    v_add_u32 v15, s79, v1
    buffer_load_dwordx4 v[160:163], v15, s[36:39], s8 offen offset:0 sc1
    v_mfma_f32_32x32x16_bf16 v[48:63], a[148:151], v[120:123], v[48:63]
    v_mfma_f32_32x32x16_bf16 v[16:31], a[152:155], v[124:127], v[16:31]
    buffer_load_dwordx4 v[164:167], v15, s[36:39], s8 offen offset:1024 sc1
    v_mfma_f32_32x32x16_bf16 v[48:63], a[156:159], v[124:127], v[48:63]
    v_mfma_f32_32x32x16_bf16 v[16:31], a[160:163], v[128:131], v[16:31]
    buffer_load_dwordx4 v[168:171], v15, s[36:39], s9 offen offset:0 sc1
    v_mfma_f32_32x32x16_bf16 v[48:63], a[164:167], v[128:131], v[48:63]
    v_mfma_f32_32x32x16_bf16 v[16:31], a[168:171], v[132:135], v[16:31]
    s_xor_b32 s71, s74, 4
    s_add_u32 s71, s71, 256
    buffer_load_dword v13, v104, s[36:39], s71 offen sc1
    buffer_load_dwordx4 v[172:175], v15, s[36:39], s9 offen offset:1024 sc1
    v_mfma_f32_32x32x16_bf16 v[48:63], a[172:175], v[132:135], v[48:63]
    s_waitcnt vmcnt(11)
    v_mfma_f32_32x32x16_bf16 v[16:31], a[176:179], v[136:139], v[16:31]
    buffer_load_dwordx4 v[112:115], v15, s[36:39], s10 offen offset:0 sc1
    v_mfma_f32_32x32x16_bf16 v[48:63], a[180:183], v[136:139], v[48:63]
    s_waitcnt vmcnt(11)
    v_mfma_f32_32x32x16_bf16 v[16:31], a[184:187], v[140:143], v[16:31]
    buffer_load_dwordx4 v[116:119], v15, s[36:39], s10 offen offset:1024 sc1
    v_mfma_f32_32x32x16_bf16 v[48:63], a[188:191], v[140:143], v[48:63]
    s_waitcnt vmcnt(10)
    v_mfma_f32_32x32x16_bf16 v[16:31], a[192:195], v[144:147], v[16:31]
    buffer_load_dwordx4 v[120:123], v15, s[36:39], s11 offen offset:0 sc1
    v_mfma_f32_32x32x16_bf16 v[48:63], a[196:199], v[144:147], v[48:63]
    s_waitcnt vmcnt(10)
    v_mfma_f32_32x32x16_bf16 v[16:31], a[200:203], v[148:151], v[16:31]
    buffer_load_dwordx4 v[124:127], v15, s[36:39], s11 offen offset:1024 sc1
    v_mfma_f32_32x32x16_bf16 v[48:63], a[204:207], v[148:151], v[48:63]
    s_waitcnt vmcnt(10)
    v_mfma_f32_32x32x16_bf16 v[16:31], a[208:211], v[152:155], v[16:31]
    buffer_load_dwordx4 v[128:131], v15, s[36:39], s12 offen offset:0 sc1
    v_mfma_f32_32x32x16_bf16 v[48:63], a[212:215], v[152:155], v[48:63]
    s_waitcnt vmcnt(10)
    v_mfma_f32_32x32x16_bf16 v[16:31], a[216:219], v[156:159], v[16:31]
    buffer_load_dwordx4 v[132:135], v15, s[36:39], s12 offen offset:1024 sc1
    v_mfma_f32_32x32x16_bf16 v[48:63], a[220:223], v[156:159], v[48:63]
    s_waitcnt vmcnt(10)
    v_mfma_f32_32x32x16_bf16 v[32:47], a[0:3], v[160:163], 0
    s_add_u32 s47, s56, 1
    s_waitcnt vmcnt(7)
    v_subrev_u32 v13, s47, v13
    v_cmp_lt_u32 vcc, 3, v13
    s_cbranch_vccnz L_aspin_60
L_aback_61:
    s_add_u32 s43, s75, 57344
    buffer_load_dwordx4 v[84:87], v107, s[36:39], s43 offen sc1
    v_mfma_f32_32x32x16_bf16 v[64:79], a[4:7], v[160:163], 0
    buffer_load_dwordx4 v[136:139], v15, s[36:39], s13 offen offset:0 sc1
    v_mfma_f32_32x32x16_bf16 v[32:47], a[8:11], v[164:167], v[32:47]
    ds_write_b128 v105, v[16:19] offset:0
    v_mfma_f32_32x32x16_bf16 v[64:79], a[12:15], v[164:167], v[64:79]
    buffer_load_dwordx4 v[140:143], v15, s[36:39], s13 offen offset:1024 sc1
    ds_write_b128 v106, v[20:23] offset:1024
    v_lshlrev_b32 v92, 16, v88
    v_mfma_f32_32x32x16_bf16 v[32:47], a[16:19], v[168:171], v[32:47]
    v_and_b32 v93, s51, v88
    v_mfma_f32_32x32x16_bf16 v[64:79], a[20:23], v[168:171], v[64:79]
    buffer_load_dwordx4 v[144:147], v15, s[36:39], s14 offen offset:0 sc1
    ds_write_b128 v105, v[24:27] offset:2048
    s_waitcnt vmcnt(10)
    v_mfma_f32_32x32x16_bf16 v[32:47], a[24:27], v[172:175], v[32:47]
    v_lshlrev_b32 v94, 16, v89
    v_mfma_f32_32x32x16_bf16 v[64:79], a[28:31], v[172:175], v[64:79]
    buffer_load_dwordx4 v[148:151], v15, s[36:39], s14 offen offset:1024 sc1
    ds_write_b128 v106, v[28:31] offset:3072
    v_and_b32 v95, s51, v89
    s_waitcnt vmcnt(10)
    v_mfma_f32_32x32x16_bf16 v[32:47], a[32:35], v[112:115], v[32:47]
    v_mfma_f32_32x32x16_bf16 v[64:79], a[36:39], v[112:115], v[64:79]
    s_add_u32 s79, s78, 114688
    v_add_u32 v15, s79, v1
    buffer_load_dwordx4 v[152:155], v15, s[36:39], s8 offen offset:0 sc1
    ds_write_b128 v105, v[48:51] offset:4096
    v_lshlrev_b32 v96, 16, v90
    s_waitcnt vmcnt(10)
    v_mfma_f32_32x32x16_bf16 v[32:47], a[40:43], v[116:119], v[32:47]
    ds_write_b128 v106, v[52:55] offset:5120
    v_mfma_f32_32x32x16_bf16 v[64:79], a[44:47], v[116:119], v[64:79]
    buffer_load_dwordx4 v[156:159], v15, s[36:39], s8 offen offset:1024 sc1
    v_and_b32 v97, s51, v90
    s_waitcnt vmcnt(10)
    v_mfma_f32_32x32x16_bf16 v[32:47], a[48:51], v[120:123], v[32:47]
    ds_write_b128 v105, v[56:59] offset:6144
    v_lshlrev_b32 v98, 16, v91
    v_mfma_f32_32x32x16_bf16 v[64:79], a[52:55], v[120:123], v[64:79]
    buffer_load_dwordx4 v[160:163], v15, s[36:39], s9 offen offset:0 sc1
    s_waitcnt vmcnt(10)
    v_mfma_f32_32x32x16_bf16 v[32:47], a[56:59], v[124:127], v[32:47]
    ds_write_b128 v106, v[60:63] offset:7168
    v_and_b32 v99, s51, v91
    v_mfma_f32_32x32x16_bf16 v[64:79], a[60:63], v[124:127], v[64:79]
    buffer_load_dwordx4 v[164:167], v15, s[36:39], s9 offen offset:1024 sc1
    s_waitcnt vmcnt(10)
    v_mfma_f32_32x32x16_bf16 v[32:47], a[64:67], v[128:131], v[32:47]
    v_mfma_f32_32x32x16_bf16 v[64:79], a[68:71], v[128:131], v[64:79]
    buffer_load_dwordx4 v[168:171], v15, s[36:39], s10 offen offset:0 sc1
    s_waitcnt lgkmcnt(0)
    s_barrier
    ds_read_b128 v[16:19], v111 offset:0
    s_waitcnt vmcnt(10)
    v_mfma_f32_32x32x16_bf16 v[32:47], a[72:75], v[132:135], v[32:47]
    ds_read_b128 v[20:23], v111 offset:1024
    v_mfma_f32_32x32x16_bf16 v[64:79], a[76:79], v[132:135], v[64:79]
    buffer_load_dwordx4 v[172:175], v15, s[36:39], s10 offen offset:1024 sc1
    ds_read_b128 v[24:27], v111 offset:8192
    s_waitcnt vmcnt(9)
    v_mfma_f32_32x32x16_bf16 v[32:47], a[80:83], v[136:139], v[32:47]
    ds_read_b128 v[28:31], v111 offset:9216
    v_mfma_f32_32x32x16_bf16 v[64:79], a[84:87], v[136:139], v[64:79]
    buffer_load_dwordx4 v[112:115], v15, s[36:39], s11 offen offset:0 sc1
    ds_read_b128 v[48:51], v111 offset:16384
    s_waitcnt vmcnt(9)
    v_mfma_f32_32x32x16_bf16 v[32:47], a[88:91], v[140:143], v[32:47]
    ds_read_b128 v[52:55], v111 offset:17408
    v_mfma_f32_32x32x16_bf16 v[64:79], a[92:95], v[140:143], v[64:79]
    ds_read_b128 v[56:59], v111 offset:24576
    s_waitcnt vmcnt(8)
    v_mfma_f32_32x32x16_bf16 v[32:47], a[96:99], v[144:147], v[32:47]
    buffer_load_dwordx4 v[116:119], v15, s[36:39], s11 offen offset:1024 sc1
    ds_read_b128 v[60:63], v111 offset:25600
    v_mfma_f32_32x32x16_bf16 v[64:79], a[100:103], v[144:147], v[64:79]
    s_waitcnt lgkmcnt(7)
    v_add_f32 v92, v92, v16
    v_add_f32 v93, v93, v17
    v_add_f32 v94, v94, v18
    v_add_f32 v95, v95, v19
    s_waitcnt vmcnt(8)
    v_mfma_f32_32x32x16_bf16 v[32:47], a[104:107], v[148:151], v[32:47]
    buffer_load_dwordx4 v[120:123], v15, s[36:39], s12 offen offset:0 sc1
    s_waitcnt lgkmcnt(6)
    v_add_f32 v96, v96, v20
    v_add_f32 v97, v97, v21
    v_add_f32 v98, v98, v22
    v_add_f32 v99, v99, v23
    v_mfma_f32_32x32x16_bf16 v[64:79], a[108:111], v[148:151], v[64:79]
    s_waitcnt lgkmcnt(5)
    v_add_f32 v92, v92, v24
    v_add_f32 v93, v93, v25
    v_add_f32 v94, v94, v26
    s_waitcnt vmcnt(8)
    v_mfma_f32_32x32x16_bf16 v[32:47], a[112:115], v[152:155], v[32:47]
    buffer_load_dwordx4 v[124:127], v15, s[36:39], s12 offen offset:1024 sc1
    v_add_f32 v95, v95, v27
    s_waitcnt lgkmcnt(4)
    v_add_f32 v96, v96, v28
    v_add_f32 v97, v97, v29
    v_add_f32 v98, v98, v30
    v_mfma_f32_32x32x16_bf16 v[64:79], a[116:119], v[152:155], v[64:79]
    v_add_f32 v99, v99, v31
    s_waitcnt lgkmcnt(3)
    v_add_f32 v92, v92, v48
    v_add_f32 v93, v93, v49
    s_waitcnt vmcnt(8)
    v_mfma_f32_32x32x16_bf16 v[32:47], a[120:123], v[156:159], v[32:47]
    buffer_load_dwordx4 v[128:131], v15, s[36:39], s13 offen offset:0 sc1
    v_add_f32 v94, v94, v50
    v_add_f32 v95, v95, v51
    s_waitcnt lgkmcnt(2)
    v_add_f32 v96, v96, v52
    v_add_f32 v97, v97, v53
    v_mfma_f32_32x32x16_bf16 v[64:79], a[124:127], v[156:159], v[64:79]
    v_add_f32 v98, v98, v54
    v_add_f32 v99, v99, v55
    s_waitcnt lgkmcnt(1)
    v_add_f32 v92, v92, v56
    s_waitcnt vmcnt(8)
    v_mfma_f32_32x32x16_bf16 v[32:47], a[128:131], v[160:163], v[32:47]
    buffer_load_dwordx4 v[132:135], v15, s[36:39], s13 offen offset:1024 sc1
    v_add_f32 v93, v93, v57
    v_add_f32 v94, v94, v58
    v_add_f32 v95, v95, v59
    s_waitcnt lgkmcnt(0)
    v_add_f32 v96, v96, v60
    v_mfma_f32_32x32x16_bf16 v[64:79], a[132:135], v[160:163], v[64:79]
    v_add_f32 v97, v97, v61
    v_add_f32 v98, v98, v62
    v_add_f32 v99, v99, v63
    s_waitcnt vmcnt(8)
    v_mfma_f32_32x32x16_bf16 v[32:47], a[136:139], v[164:167], v[32:47]
    buffer_load_dwordx4 v[136:139], v15, s[36:39], s14 offen offset:0 sc1
    v_cvt_pk_bf16_f32 v80, v92, v93
    v_cvt_pk_bf16_f32 v81, v94, v95
    v_cvt_pk_bf16_f32 v82, v96, v97
    v_cvt_pk_bf16_f32 v83, v98, v99
    v_mfma_f32_32x32x16_bf16 v[64:79], a[140:143], v[164:167], v[64:79]
    s_add_u32 s44, s75, 0
    buffer_store_dwordx4 v[80:83], v107, s[36:39], s44 offen sc1
    v_add_f32 v100, v92, v93
    v_mul_f32 v101, v92, v92
    s_waitcnt vmcnt(9)
    v_mfma_f32_32x32x16_bf16 v[32:47], a[144:147], v[168:171], v[32:47]
    buffer_load_dwordx4 v[140:143], v15, s[36:39], s14 offen offset:1024 sc1
    v_fmac_f32 v101, v93, v93
    v_add_f32 v100, v100, v94
    v_fmac_f32 v101, v94, v94
    v_add_f32 v100, v100, v95
    s_waitcnt vmcnt(9)
    v_mfma_f32_32x32x16_bf16 v[32:47], a[152:155], v[172:175], v[32:47]
    v_fmac_f32 v101, v95, v95
    v_add_f32 v100, v100, v96
    v_fmac_f32 v101, v96, v96
    s_waitcnt vmcnt(8)
    v_mfma_f32_32x32x16_bf16 v[32:47], a[160:163], v[112:115], v[32:47]
    v_add_f32 v100, v100, v97
    v_fmac_f32 v101, v97, v97
    v_add_f32 v100, v100, v98
    v_fmac_f32 v101, v98, v98
    s_waitcnt vmcnt(7)
    v_mfma_f32_32x32x16_bf16 v[32:47], a[168:171], v[116:119], v[32:47]
    v_add_f32 v100, v100, v99
    v_fmac_f32 v101, v99, v99
    s_nop 0
    v_add_f32_dpp v100, v100, v100 row_ror:8 row_mask:0xf bank_mask:0xf
    s_waitcnt vmcnt(6)
    v_mfma_f32_32x32x16_bf16 v[32:47], a[176:179], v[120:123], v[32:47]
    s_barrier
    v_add_f32_dpp v101, v101, v101 row_ror:8 row_mask:0xf bank_mask:0xf
    s_nop 1
    v_permlane16_swap_b32 v100, v101
    v_add_f32 v100, v100, v101
    v_mov_b32 v101, v100
    s_waitcnt vmcnt(5)
    v_mfma_f32_32x32x16_bf16 v[32:47], a[184:187], v[124:127], v[32:47]
    v_permlane32_swap_b32 v100, v101
    v_add_f32 v100, v100, v101
    s_add_u32 s43, s76, 0
    s_mov_b64 exec, 0x00ff00ff
    buffer_store_dword v100, v108, s[36:39], s43 offen sc1
    s_mov_b64 exec, -1
    s_waitcnt vmcnt(5)
    v_mfma_f32_32x32x16_bf16 v[32:47], a[192:195], v[128:131], v[32:47]
    v_lshlrev_b32 v92, 16, v84
    v_and_b32 v93, s51, v84
    s_waitcnt vmcnt(4)
    v_mfma_f32_32x32x16_bf16 v[32:47], a[200:203], v[132:135], v[32:47]
    v_lshlrev_b32 v94, 16, v85
    v_and_b32 v95, s51, v85
    s_waitcnt vmcnt(3)
    v_mfma_f32_32x32x16_bf16 v[32:47], a[208:211], v[136:139], v[32:47]
    v_lshlrev_b32 v96, 16, v86
    v_and_b32 v97, s51, v86
    s_waitcnt vmcnt(1)
    v_mfma_f32_32x32x16_bf16 v[32:47], a[216:219], v[140:143], v[32:47]
    v_lshlrev_b32 v98, 16, v87
    v_and_b32 v99, s51, v87
    v_mfma_f32_32x32x16_bf16 v[64:79], a[148:151], v[168:171], v[64:79]
    v_mfma_f32_32x32x16_bf16 v[64:79], a[156:159], v[172:175], v[64:79]
    v_mfma_f32_32x32x16_bf16 v[64:79], a[164:167], v[112:115], v[64:79]
    s_nop 6
    ds_write_b128 v105, v[32:35] offset:16384
    v_mfma_f32_32x32x16_bf16 v[64:79], a[172:175], v[116:119], v[64:79]
    v_mfma_f32_32x32x16_bf16 v[64:79], a[180:183], v[120:123], v[64:79]
    ds_write_b128 v106, v[36:39] offset:17408
    v_mfma_f32_32x32x16_bf16 v[64:79], a[188:191], v[124:127], v[64:79]
    v_mfma_f32_32x32x16_bf16 v[64:79], a[196:199], v[128:131], v[64:79]
    ds_write_b128 v105, v[40:43] offset:18432
    s_add_u32 s43, s77, 0
    s_add_u32 s44, s56, 2
    v_mov_b32 v102, s44
    s_waitcnt vmcnt(0)
    s_mov_b64 exec, 1
    buffer_store_dword v102, v1, s[36:39], s43 offen sc1
    s_mov_b64 exec, -1
    v_mfma_f32_32x32x16_bf16 v[64:79], a[204:207], v[132:135], v[64:79]
    v_mfma_f32_32x32x16_bf16 v[64:79], a[212:215], v[136:139], v[64:79]
    ds_write_b128 v106, v[44:47] offset:19456
    v_mfma_f32_32x32x16_bf16 v[64:79], a[220:223], v[140:143], v[64:79]
    s_nop 11
    ds_write_b128 v105, v[64:67] offset:20480
    ds_write_b128 v106, v[68:71] offset:21504
    ds_write_b128 v105, v[72:75] offset:22528
    ds_write_b128 v106, v[76:79] offset:23552
    s_waitcnt lgkmcnt(0)
    s_barrier
    ds_read_b128 v[32:35], v111 offset:16384
    ds_read_b128 v[36:39], v111 offset:17408
    ds_read_b128 v[40:43], v111 offset:24576
    ds_read_b128 v[44:47], v111 offset:25600
    ds_read_b128 v[64:67], v111 offset:32768
    ds_read_b128 v[68:71], v111 offset:33792
    ds_read_b128 v[72:75], v111 offset:40960
    ds_read_b128 v[76:79], v111 offset:41984
    s_waitcnt lgkmcnt(7)
    v_pk_add_f32 v[92:93], v[92:93], v[32:33]
    v_pk_add_f32 v[94:95], v[94:95], v[34:35]
    s_waitcnt lgkmcnt(6)
    v_pk_add_f32 v[96:97], v[96:97], v[36:37]
    v_pk_add_f32 v[98:99], v[98:99], v[38:39]
    s_waitcnt lgkmcnt(5)
    v_pk_add_f32 v[92:93], v[92:93], v[40:41]
    v_pk_add_f32 v[94:95], v[94:95], v[42:43]
    s_waitcnt lgkmcnt(4)
    v_pk_add_f32 v[96:97], v[96:97], v[44:45]
    v_pk_add_f32 v[98:99], v[98:99], v[46:47]
    s_waitcnt lgkmcnt(3)
    v_pk_add_f32 v[92:93], v[92:93], v[64:65]
    v_pk_add_f32 v[94:95], v[94:95], v[66:67]
    s_waitcnt lgkmcnt(2)
    v_pk_add_f32 v[96:97], v[96:97], v[68:69]
    v_pk_add_f32 v[98:99], v[98:99], v[70:71]
    s_waitcnt lgkmcnt(1)
    v_pk_add_f32 v[92:93], v[92:93], v[72:73]
    v_pk_add_f32 v[94:95], v[94:95], v[74:75]
    s_waitcnt lgkmcnt(0)
    v_pk_add_f32 v[96:97], v[96:97], v[76:77]
    v_pk_add_f32 v[98:99], v[98:99], v[78:79]
    v_cvt_pk_bf16_f32 v80, v92, v93
    v_cvt_pk_bf16_f32 v81, v94, v95
    v_cvt_pk_bf16_f32 v82, v96, v97
    v_cvt_pk_bf16_f32 v83, v98, v99
    s_add_u32 s44, s75, 57344
    buffer_store_dwordx4 v[80:83], v107, s[36:39], s44 offen sc1
    v_add_f32 v100, v92, v93
    v_mul_f32 v101, v92, v92
    v_fmac_f32 v101, v93, v93
    v_add_f32 v100, v100, v94
    v_fmac_f32 v101, v94, v94
    v_add_f32 v100, v100, v95
    v_fmac_f32 v101, v95, v95
    v_add_f32 v100, v100, v96
    v_fmac_f32 v101, v96, v96
    v_add_f32 v100, v100, v97
    v_fmac_f32 v101, v97, v97
    v_add_f32 v100, v100, v98
    v_fmac_f32 v101, v98, v98
    v_add_f32 v100, v100, v99
    v_fmac_f32 v101, v99, v99
    s_nop 0
    v_add_f32_dpp v100, v100, v100 row_ror:8 row_mask:0xf bank_mask:0xf
    v_add_f32_dpp v101, v101, v101 row_ror:8 row_mask:0xf bank_mask:0xf
    s_nop 1
    v_permlane16_swap_b32 v100, v101
    v_add_f32 v100, v100, v101
    v_mov_b32 v101, v100
    s_nop 1
    v_permlane32_swap_b32 v100, v101
    v_add_f32 v100, v100, v101
    s_add_u32 s43, s76, 7168
    s_mov_b64 exec, 0x00ff00ff
    buffer_store_dword v100, v108, s[36:39], s43 offen sc1
    s_mov_b64 exec, -1
    s_add_u32 s43, s77, 128
    s_add_u32 s44, s56, 2
    v_mov_b32 v102, s44
    s_waitcnt vmcnt(0)
    s_mov_b64 exec, 1
    buffer_store_dword v102, v1, s[36:39], s43 offen sc1
    s_mov_b64 exec, -1
L_layer1_s:
    s_waitcnt lgkmcnt(0)
    v_min_u32 v13, 27, v0
    v_lshlrev_b32 v13, 2, v13
    s_lshl_b32 s40, s64, 7
    s_add_u32 s40, s40, 1433600
    ds_read_b64_tr_b16 v[152:153], v2 offset:0
    ds_read_b64_tr_b16 v[154:155], v2 offset:512
    ds_read_b64_tr_b16 v[156:157], v2 offset:28672
    ds_read_b64_tr_b16 v[158:159], v2 offset:29184
    ds_read_b64_tr_b16 v[160:161], v3 offset:0
    ds_read_b64_tr_b16 v[162:163], v3 offset:512
    s_add_u32 s47, s56, 2
    s_mov_b32 s46, s66
L_poll_64:
    buffer_load_dword v14, v13, s[36:39], s40 offen sc1
    s_waitcnt vmcnt(0)
    v_subrev_u32 v14, s47, v14
    v_cmp_lt_u32 vcc, 3, v14
    s_cbranch_vccz L_polled_63
    s_sub_u32 s46, s46, 1
    s_cmp_lg_u32 s46, 0
    s_cbranch_scc1 L_poll_64
    s_mov_b32 s66, 1
L_polled_63:
    s_add_u32 s4, s68, 0
    buffer_load_dwordx4 v[96:99], v1, s[36:39], s4 offen offset:0 sc1
    buffer_load_dwordx4 v[100:103], v1, s[36:39], s4 offen offset:1024 sc1
    buffer_load_dwordx4 v[104:107], v1, s[36:39], s4 offen offset:2048 sc1
    buffer_load_dwordx4 v[108:111], v1, s[36:39], s4 offen offset:3072 sc1
    s_add_u32 s4, s68, 4096
    buffer_load_dwordx4 v[112:115], v1, s[36:39], s4 offen offset:0 sc1
    buffer_load_dwordx4 v[116:119], v1, s[36:39], s4 offen offset:1024 sc1
    s_waitcnt vmcnt(5) lgkmcnt(4)
    v_mfma_f32_32x32x16_bf16 v[16:31], v[96:99], v[152:155], 0
    ds_read_b64_tr_b16 v[164:165], v2 offset:1024
    ds_read_b64_tr_b16 v[166:167], v2 offset:1536
    buffer_load_dwordx4 v[120:123], v1, s[36:39], s4 offen offset:2048 sc1
    s_waitcnt lgkmcnt(4)
    v_mfma_f32_32x32x16_bf16 v[32:47], v[96:99], v[156:159], 0
    ds_read_b64_tr_b16 v[168:169], v2 offset:29696
    ds_read_b64_tr_b16 v[170:171], v2 offset:30208
    s_waitcnt lgkmcnt(4)
    v_mfma_f32_32x32x16_bf16 v[48:63], v[160:163], v[96:99], 0
    ds_read_b64_tr_b16 v[172:173], v3 offset:1024
    ds_read_b64_tr_b16 v[174:175], v3 offset:1536
    buffer_load_dwordx4 v[124:127], v1, s[36:39], s4 offen offset:3072 sc1
    s_waitcnt vmcnt(6) lgkmcnt(4)
    v_mfma_f32_32x32x16_bf16 v[16:31], v[100:103], v[164:167], v[16:31]
    ds_read_b64_tr_b16 v[152:153], v2 offset:2048
    ds_read_b64_tr_b16 v[154:155], v2 offset:2560
    s_waitcnt lgkmcnt(4)
    v_mfma_f32_32x32x16_bf16 v[32:47], v[100:103], v[168:171], v[32:47]
    ds_read_b64_tr_b16 v[156:157], v2 offset:30720
    ds_read_b64_tr_b16 v[158:159], v2 offset:31232
    s_add_u32 s4, s68, 8192
    buffer_load_dwordx4 v[128:131], v1, s[36:39], s4 offen offset:0 sc1
    s_waitcnt lgkmcnt(4)
    v_mfma_f32_32x32x16_bf16 v[48:63], v[172:175], v[100:103], v[48:63]
    ds_read_b64_tr_b16 v[160:161], v3 offset:2048
    ds_read_b64_tr_b16 v[162:163], v3 offset:2560
    s_waitcnt vmcnt(6) lgkmcnt(4)
    v_mfma_f32_32x32x16_bf16 v[16:31], v[104:107], v[152:155], v[16:31]
    ds_read_b64_tr_b16 v[164:165], v2 offset:3072
    ds_read_b64_tr_b16 v[166:167], v2 offset:3584
    buffer_load_dwordx4 v[132:135], v1, s[36:39], s4 offen offset:1024 sc1
    s_waitcnt lgkmcnt(4)
    v_mfma_f32_32x32x16_bf16 v[32:47], v[104:107], v[156:159], v[32:47]
    ds_read_b64_tr_b16 v[168:169], v2 offset:31744
    ds_read_b64_tr_b16 v[170:171], v2 offset:32256
    s_waitcnt lgkmcnt(4)
    v_mfma_f32_32x32x16_bf16 v[48:63], v[160:163], v[104:107], v[48:63]
    ds_read_b64_tr_b16 v[172:173], v3 offset:3072
    ds_read_b64_tr_b16 v[174:175], v3 offset:3584
    buffer_load_dwordx4 v[136:139], v1, s[36:39], s4 offen offset:2048 sc1
    s_waitcnt vmcnt(7) lgkmcnt(4)
    v_mfma_f32_32x32x16_bf16 v[16:31], v[108:111], v[164:167], v[16:31]
    ds_read_b64_tr_b16 v[152:153], v2 offset:4096
    ds_read_b64_tr_b16 v[154:155], v2 offset:4608
    s_waitcnt lgkmcnt(4)
    v_mfma_f32_32x32x16_bf16 v[32:47], v[108:111], v[168:171], v[32:47]
    ds_read_b64_tr_b16 v[156:157], v2 offset:32768
    ds_read_b64_tr_b16 v[158:159], v2 offset:33280
    buffer_load_dwordx4 v[140:143], v1, s[36:39], s4 offen offset:3072 sc1
    s_waitcnt lgkmcnt(4)
    v_mfma_f32_32x32x16_bf16 v[48:63], v[172:175], v[108:111], v[48:63]
    ds_read_b64_tr_b16 v[160:161], v3 offset:4096
    ds_read_b64_tr_b16 v[162:163], v3 offset:4608
    s_waitcnt vmcnt(7) lgkmcnt(4)
    v_mfma_f32_32x32x16_bf16 v[16:31], v[112:115], v[152:155], v[16:31]
    ds_read_b64_tr_b16 v[164:165], v2 offset:5120
    ds_read_b64_tr_b16 v[166:167], v2 offset:5632
    s_add_u32 s4, s68, 12288
    buffer_load_dwordx4 v[144:147], v1, s[36:39], s4 offen offset:0 sc1
    s_waitcnt lgkmcnt(4)
    v_mfma_f32_32x32x16_bf16 v[32:47], v[112:115], v[156:159], v[32:47]
    ds_read_b64_tr_b16 v[168:169], v2 offset:33792
    ds_read_b64_tr_b16 v[170:171], v2 offset:34304
    s_waitcnt lgkmcnt(4)
    v_mfma_f32_32x32x16_bf16 v[48:63], v[160:163], v[112:115], v[48:63]
    ds_read_b64_tr_b16 v[172:173], v3 offset:5120
    ds_read_b64_tr_b16 v[174:175], v3 offset:5632
    buffer_load_dwordx4 v[148:151], v1, s[36:39], s4 offen offset:1024 sc1
    s_waitcnt vmcnt(8) lgkmcnt(4)
    v_mfma_f32_32x32x16_bf16 v[16:31], v[116:119], v[164:167], v[16:31]
    ds_read_b64_tr_b16 v[152:153], v2 offset:6144
    ds_read_b64_tr_b16 v[154:155], v2 offset:6656
    s_waitcnt lgkmcnt(4)
    v_mfma_f32_32x32x16_bf16 v[32:47], v[116:119], v[168:171], v[32:47]
    ds_read_b64_tr_b16 v[156:157], v2 offset:34816
    ds_read_b64_tr_b16 v[158:159], v2 offset:35328
    buffer_load_dwordx4 v[64:67], v1, s[36:39], s69 offen offset:0 sc1
    s_waitcnt lgkmcnt(4)
    v_mfma_f32_32x32x16_bf16 v[48:63], v[172:175], v[116:119], v[48:63]
    ds_read_b64_tr_b16 v[160:161], v3 offset:6144
    ds_read_b64_tr_b16 v[162:163], v3 offset:6656
    s_waitcnt vmcnt(8) lgkmcnt(4)
    v_mfma_f32_32x32x16_bf16 v[16:31], v[120:123], v[152:155], v[16:31]
    ds_read_b64_tr_b16 v[164:165], v2 offset:7168
    ds_read_b64_tr_b16 v[166:167], v2 offset:7680
    buffer_load_dwordx4 v[68:71], v1, s[36:39], s69 offen offset:1024 sc1
    s_waitcnt lgkmcnt(4)
    v_mfma_f32_32x32x16_bf16 v[32:47], v[120:123], v[156:159], v[32:47]
    ds_read_b64_tr_b16 v[168:169], v2 offset:35840
    ds_read_b64_tr_b16 v[170:171], v2 offset:36352
    s_waitcnt lgkmcnt(4)
    v_mfma_f32_32x32x16_bf16 v[48:63], v[160:163], v[120:123], v[48:63]
    ds_read_b64_tr_b16 v[172:173], v3 offset:7168
    ds_read_b64_tr_b16 v[174:175], v3 offset:7680
    buffer_load_dwordx4 v[96:99], v1, s[36:39], s4 offen offset:2048 sc1
    s_waitcnt vmcnt(9) lgkmcnt(4)
    v_mfma_f32_32x32x16_bf16 v[16:31], v[124:127], v[164:167], v[16:31]
    ds_read_b64_tr_b16 v[152:153], v2 offset:8192
    ds_read_b64_tr_b16 v[154:155], v2 offset:8704
    s_waitcnt lgkmcnt(4)
    v_mfma_f32_32x32x16_bf16 v[32:47], v[124:127], v[168:171], v[32:47]
    ds_read_b64_tr_b16 v[156:157], v2 offset:36864
    ds_read_b64_tr_b16 v[158:159], v2 offset:37376
    buffer_load_dwordx4 v[100:103], v1, s[36:39], s4 offen offset:3072 sc1
    s_waitcnt lgkmcnt(4)
    v_mfma_f32_32x32x16_bf16 v[48:63], v[172:175], v[124:127], v[48:63]
    ds_read_b64_tr_b16 v[160:161], v3 offset:8192
    ds_read_b64_tr_b16 v[162:163], v3 offset:8704
    s_waitcnt vmcnt(9) lgkmcnt(4)
    v_mfma_f32_32x32x16_bf16 v[16:31], v[128:131], v[152:155], v[16:31]
    ds_read_b64_tr_b16 v[164:165], v2 offset:9216
    ds_read_b64_tr_b16 v[166:167], v2 offset:9728
    s_add_u32 s4, s68, 16384
    buffer_load_dwordx4 v[104:107], v1, s[36:39], s4 offen offset:0 sc1
    s_waitcnt lgkmcnt(4)
    v_mfma_f32_32x32x16_bf16 v[32:47], v[128:131], v[156:159], v[32:47]
    ds_read_b64_tr_b16 v[168:169], v2 offset:37888
    ds_read_b64_tr_b16 v[170:171], v2 offset:38400
    s_waitcnt lgkmcnt(4)
    v_mfma_f32_32x32x16_bf16 v[48:63], v[160:163], v[128:131], v[48:63]
    ds_read_b64_tr_b16 v[172:173], v3 offset:9216
    ds_read_b64_tr_b16 v[174:175], v3 offset:9728
    buffer_load_dwordx4 v[108:111], v1, s[36:39], s4 offen offset:1024 sc1
    s_waitcnt vmcnt(10) lgkmcnt(4)
    v_mfma_f32_32x32x16_bf16 v[16:31], v[132:135], v[164:167], v[16:31]
    ds_read_b64_tr_b16 v[152:153], v2 offset:10240
    ds_read_b64_tr_b16 v[154:155], v2 offset:10752
    s_waitcnt lgkmcnt(4)
    v_mfma_f32_32x32x16_bf16 v[32:47], v[132:135], v[168:171], v[32:47]
    ds_read_b64_tr_b16 v[156:157], v2 offset:38912
    ds_read_b64_tr_b16 v[158:159], v2 offset:39424
    buffer_load_dwordx4 v[112:115], v1, s[36:39], s4 offen offset:2048 sc1
    s_waitcnt lgkmcnt(4)
    v_mfma_f32_32x32x16_bf16 v[48:63], v[172:175], v[132:135], v[48:63]
    ds_read_b64_tr_b16 v[160:161], v3 offset:10240
    ds_read_b64_tr_b16 v[162:163], v3 offset:10752
    s_waitcnt vmcnt(10) lgkmcnt(4)
    v_mfma_f32_32x32x16_bf16 v[16:31], v[136:139], v[152:155], v[16:31]
    ds_read_b64_tr_b16 v[164:165], v2 offset:11264
    ds_read_b64_tr_b16 v[166:167], v2 offset:11776
    buffer_load_dwordx4 v[116:119], v1, s[36:39], s4 offen offset:3072 sc1
    s_waitcnt vmcnt(7)
    v_add_f32 v64, v64, v66
    v_add_f32 v65, v65, v67
    s_waitcnt lgkmcnt(4)
    v_mfma_f32_32x32x16_bf16 v[32:47], v[136:139], v[156:159], v[32:47]
    ds_read_b64_tr_b16 v[168:169], v2 offset:39936
    ds_read_b64_tr_b16 v[170:171], v2 offset:40448
    s_waitcnt vmcnt(6)
    v_add_f32 v64, v64, v68
    s_waitcnt lgkmcnt(4)
    v_mfma_f32_32x32x16_bf16 v[48:63], v[160:163], v[136:139], v[48:63]
    ds_read_b64_tr_b16 v[172:173], v3 offset:11264
    ds_read_b64_tr_b16 v[174:175], v3 offset:11776
    s_add_u32 s4, s68, 20480
    buffer_load_dwordx4 v[120:123], v1, s[36:39], s4 offen offset:0 sc1
    v_add_f32 v65, v65, v69
    v_add_f32 v64, v64, v70
    s_waitcnt lgkmcnt(4)
    v_mfma_f32_32x32x16_bf16 v[16:31], v[140:143], v[164:167], v[16:31]
    ds_read_b64_tr_b16 v[152:153], v2 offset:12288
    ds_read_b64_tr_b16 v[154:155], v2 offset:12800
    v_add_f32 v64, v64, v65
    s_waitcnt lgkmcnt(4)
    v_mfma_f32_32x32x16_bf16 v[32:47], v[140:143], v[168:171], v[32:47]
    ds_read_b64_tr_b16 v[156:157], v2 offset:40960
    ds_read_b64_tr_b16 v[158:159], v2 offset:41472
    buffer_load_dwordx4 v[124:127], v1, s[36:39], s4 offen offset:1024 sc1
    v_mov_b32 v65, v64
    s_nop 1
    v_permlane32_swap_b32 v64, v65
    s_waitcnt lgkmcnt(4)
    v_mfma_f32_32x32x16_bf16 v[48:63], v[172:175], v[140:143], v[48:63]
    ds_read_b64_tr_b16 v[160:161], v3 offset:12288
    ds_read_b64_tr_b16 v[162:163], v3 offset:12800
    v_mul_f32 v66, 0x3b124925, v64
    s_waitcnt lgkmcnt(4)
    v_mfma_f32_32x32x16_bf16 v[16:31], v[144:147], v[152:155], v[16:31]
    ds_read_b64_tr_b16 v[164:165], v2 offset:13312
    ds_read_b64_tr_b16 v[166:167], v2 offset:13824
    buffer_load_dwordx4 v[128:131], v1, s[36:39], s4 offen offset:2048 sc1
    v_mul_f32 v67, 0x3b124925, v65
    v_fma_f32 v67, -v66, v66, v67
    s_waitcnt lgkmcnt(4)
    v_mfma_f32_32x32x16_bf16 v[32:47], v[144:147], v[156:159], v[32:47]
    ds_read_b64_tr_b16 v[168:169], v2 offset:41984
    ds_read_b64_tr_b16 v[170:171], v2 offset:42496
    v_max_f32 v67, 0, v67
    s_waitcnt lgkmcnt(4)
    v_mfma_f32_32x32x16_bf16 v[48:63], v[160:163], v[144:147], v[48:63]
    ds_read_b64_tr_b16 v[172:173], v3 offset:13312
    ds_read_b64_tr_b16 v[174:175], v3 offset:13824
    buffer_load_dwordx4 v[132:135], v1, s[36:39], s4 offen offset:3072 sc1
    v_add_f32 v67, 0x3727c5ac, v67
    s_waitcnt lgkmcnt(4)
    v_mfma_f32_32x32x16_bf16 v[16:31], v[148:151], v[164:167], v[16:31]
    ds_read_b64_tr_b16 v[152:153], v2 offset:14336
    ds_read_b64_tr_b16 v[154:155], v2 offset:14848
    v_rsq_f32 v88, v67
    v_cvt_pk_bf16_f32 v92, -v66, -v66
    s_waitcnt lgkmcnt(4)
    v_mfma_f32_32x32x16_bf16 v[32:47], v[148:151], v[168:171], v[32:47]
    ds_read_b64_tr_b16 v[156:157], v2 offset:43008
    ds_read_b64_tr_b16 v[158:159], v2 offset:43520
    s_add_u32 s4, s68, 24576
    buffer_load_dwordx4 v[136:139], v1, s[36:39], s4 offen offset:0 sc1
    v_and_b32 v65, s51, v92
    s_waitcnt lgkmcnt(4)
    v_mfma_f32_32x32x16_bf16 v[48:63], v[172:175], v[148:151], v[48:63]
    v_sub_f32_e64 v65, -v66, v65
    v_and_b32 v93, 0xffff, v92
    s_waitcnt vmcnt(10) lgkmcnt(2)
    v_mfma_f32_32x32x16_bf16 v[16:31], v[96:99], v[152:155], v[16:31]
    ds_read_b64_tr_b16 v[164:165], v2 offset:15360
    ds_read_b64_tr_b16 v[166:167], v2 offset:15872
    buffer_load_dwordx4 v[140:143], v1, s[36:39], s4 offen offset:1024 sc1
    v_cvt_pk_bf16_f32 v65, v65, v65
    s_waitcnt lgkmcnt(2)
    v_mfma_f32_32x32x16_bf16 v[32:47], v[96:99], v[156:159], v[32:47]
    ds_read_b64_tr_b16 v[168:169], v2 offset:44032
    ds_read_b64_tr_b16 v[170:171], v2 offset:44544
    v_and_or_b32 v92, v65, s51, v93
    v_mov_b32 v94, 0
    s_waitcnt vmcnt(10) lgkmcnt(2)
    v_mfma_f32_32x32x16_bf16 v[16:31], v[100:103], v[164:167], v[16:31]
    ds_read_b64_tr_b16 v[152:153], v2 offset:16384
    ds_read_b64_tr_b16 v[154:155], v2 offset:16896
    buffer_load_dwordx4 v[144:147], v1, s[36:39], s4 offen offset:2048 sc1
    v_mov_b32 v95, 0
    s_waitcnt lgkmcnt(2)
    v_mfma_f32_32x32x16_bf16 v[32:47], v[100:103], v[168:171], v[32:47]
    ds_read_b64_tr_b16 v[156:157], v2 offset:45056
    ds_read_b64_tr_b16 v[158:159], v2 offset:45568
    v_cvt_pk_bf16_f32 v80, v88, v88
    s_waitcnt vmcnt(10) lgkmcnt(2)
    v_mfma_f32_32x32x16_bf16 v[16:31], v[104:107], v[152:155], v[16:31]
    ds_read_b64_tr_b16 v[164:165], v2 offset:17408
    ds_read_b64_tr_b16 v[166:167], v2 offset:17920
    buffer_load_dwordx4 v[148:151], v1, s[36:39], s4 offen offset:3072 sc1
    v_and_b32 v64, s51, v80
    v_sub_f32 v64, v88, v64
    s_waitcnt lgkmcnt(2)
    v_mfma_f32_32x32x16_bf16 v[32:47], v[104:107], v[156:159], v[32:47]
    ds_read_b64_tr_b16 v[168:169], v2 offset:46080
    ds_read_b64_tr_b16 v[170:171], v2 offset:46592
    v_cvt_pk_bf16_f32 v81, v64, v64
    s_waitcnt vmcnt(10) lgkmcnt(2)
    v_mfma_f32_32x32x16_bf16 v[16:31], v[108:111], v[164:167], v[16:31]
    ds_read_b64_tr_b16 v[152:153], v2 offset:18432
    ds_read_b64_tr_b16 v[154:155], v2 offset:18944
    v_and_b32 v65, s51, v81
    v_sub_f32 v65, v64, v65
    s_waitcnt lgkmcnt(2)
    v_mfma_f32_32x32x16_bf16 v[32:47], v[108:111], v[168:171], v[32:47]
    ds_read_b64_tr_b16 v[156:157], v2 offset:47104
    ds_read_b64_tr_b16 v[158:159], v2 offset:47616
    v_and_b32 v80, 0xffff, v80
    s_waitcnt vmcnt(9) lgkmcnt(2)
    v_mfma_f32_32x32x16_bf16 v[16:31], v[112:115], v[152:155], v[16:31]
    ds_read_b64_tr_b16 v[164:165], v2 offset:19456
    ds_read_b64_tr_b16 v[166:167], v2 offset:19968
    v_and_or_b32 v80, v81, s51, v80
    v_cvt_pk_bf16_f32 v81, v65, 0
    s_waitcnt lgkmcnt(2)
    v_mfma_f32_32x32x16_bf16 v[32:47], v[112:115], v[156:159], v[32:47]
    ds_read_b64_tr_b16 v[168:169], v2 offset:48128
    ds_read_b64_tr_b16 v[170:171], v2 offset:48640
    v_mov_b32 v82, 0
    s_waitcnt vmcnt(8) lgkmcnt(2)
    v_mfma_f32_32x32x16_bf16 v[16:31], v[116:119], v[164:167], v[16:31]
    ds_read_b64_tr_b16 v[152:153], v2 offset:20480
    ds_read_b64_tr_b16 v[154:155], v2 offset:20992
    v_mov_b32 v83, 0
    v_mov_b32 v84, s48
    s_waitcnt lgkmcnt(2)
    v_mfma_f32_32x32x16_bf16 v[32:47], v[116:119], v[168:171], v[32:47]
    ds_read_b64_tr_b16 v[156:157], v2 offset:49152
    ds_read_b64_tr_b16 v[158:159], v2 offset:49664
    v_cndmask_b32 v84, v84, 0, s[54:55]
    s_waitcnt vmcnt(7) lgkmcnt(2)
    v_mfma_f32_32x32x16_bf16 v[16:31], v[120:123], v[152:155], v[16:31]
    ds_read_b64_tr_b16 v[164:165], v2 offset:21504
    ds_read_b64_tr_b16 v[166:167], v2 offset:22016
    v_mov_b32 v85, v84
    s_waitcnt lgkmcnt(2)
    v_mfma_f32_32x32x16_bf16 v[32:47], v[120:123], v[156:159], v[32:47]
    ds_read_b64_tr_b16 v[168:169], v2 offset:50176
    ds_read_b64_tr_b16 v[170:171], v2 offset:50688
    v_mov_b32 v86, 0
    v_mov_b32 v87, 0
    s_waitcnt vmcnt(6) lgkmcnt(2)
    v_mfma_f32_32x32x16_bf16 v[16:31], v[124:127], v[164:167], v[16:31]
    ds_read_b64_tr_b16 v[152:153], v2 offset:22528
    ds_read_b64_tr_b16 v[154:155], v2 offset:23040
    v_mfma_f32_32x32x16_bf16 v[64:79], v[80:83], v[84:87], 0
    s_waitcnt lgkmcnt(2)
    v_mfma_f32_32x32x16_bf16 v[32:47], v[124:127], v[168:171], v[32:47]
    ds_read_b64_tr_b16 v[156:157], v2 offset:51200
    ds_read_b64_tr_b16 v[158:159], v2 offset:51712
    s_lshl_b32 s40, s60, 10
    v_add_u32 v89, s40, v12
    s_waitcnt vmcnt(5) lgkmcnt(2)
    v_mfma_f32_32x32x16_bf16 v[16:31], v[128:131], v[152:155], v[16:31]
    ds_read_b64_tr_b16 v[164:165], v2 offset:23552
    ds_read_b64_tr_b16 v[166:167], v2 offset:24064
    s_lshl_b32 s40, s60, 12
    s_waitcnt lgkmcnt(2)
    v_mfma_f32_32x32x16_bf16 v[32:47], v[128:131], v[156:159], v[32:47]
    ds_read_b64_tr_b16 v[168:169], v2 offset:52224
    ds_read_b64_tr_b16 v[170:171], v2 offset:52736
    v_add_u32 v90, s40, v12
    v_lshlrev_b32 v91, 3, v0
    s_waitcnt vmcnt(4) lgkmcnt(2)
    v_mfma_f32_32x32x16_bf16 v[16:31], v[132:135], v[164:167], v[16:31]
    ds_read_b64_tr_b16 v[152:153], v2 offset:24576
    ds_read_b64_tr_b16 v[154:155], v2 offset:25088
    s_lshl_b32 s40, s58, 15
    s_waitcnt lgkmcnt(2)
    v_mfma_f32_32x32x16_bf16 v[32:47], v[132:135], v[168:171], v[32:47]
    ds_read_b64_tr_b16 v[156:157], v2 offset:53248
    ds_read_b64_tr_b16 v[158:159], v2 offset:53760
    s_lshl_b32 s41, s60, 9
    s_waitcnt vmcnt(3) lgkmcnt(2)
    v_mfma_f32_32x32x16_bf16 v[16:31], v[136:139], v[152:155], v[16:31]
    ds_read_b64_tr_b16 v[164:165], v2 offset:25600
    ds_read_b64_tr_b16 v[166:167], v2 offset:26112
    s_add_u32 s40, s40, s41
    s_add_u32 s6, s40, 1048576
    s_waitcnt lgkmcnt(2)
    v_mfma_f32_32x32x16_bf16 v[32:47], v[136:139], v[156:159], v[32:47]
    ds_read_b64_tr_b16 v[168:169], v2 offset:54272
    ds_read_b64_tr_b16 v[170:171], v2 offset:54784
    s_lshl_b32 s41, s57, 1
    s_waitcnt vmcnt(2) lgkmcnt(2)
    v_mfma_f32_32x32x16_bf16 v[16:31], v[140:143], v[164:167], v[16:31]
    ds_read_b64_tr_b16 v[152:153], v2 offset:26624
    ds_read_b64_tr_b16 v[154:155], v2 offset:27136
    s_add_u32 s41, s41, s59
    s_lshl_b32 s41, s41, 11
    s_waitcnt lgkmcnt(2)
    v_mfma_f32_32x32x16_bf16 v[32:47], v[140:143], v[168:171], v[32:47]
    ds_read_b64_tr_b16 v[156:157], v2 offset:55296
    ds_read_b64_tr_b16 v[158:159], v2 offset:55808
    s_add_u32 s7, s41, s6
    s_waitcnt vmcnt(1) lgkmcnt(2)
    v_mfma_f32_32x32x16_bf16 v[16:31], v[144:147], v[152:155], v[16:31]
    ds_read_b64_tr_b16 v[164:165], v2 offset:27648
    ds_read_b64_tr_b16 v[166:167], v2 offset:28160
    v_mov_b32 v80, v8
    v_mov_b32 v81, v9
    s_waitcnt lgkmcnt(2)
    v_mfma_f32_32x32x16_bf16 v[32:47], v[144:147], v[156:159], v[32:47]
    ds_read_b64_tr_b16 v[168:169], v2 offset:56320
    ds_read_b64_tr_b16 v[170:171], v2 offset:56832
    v_mov_b32 v84, v10
    s_waitcnt vmcnt(0) lgkmcnt(2)
    v_mfma_f32_32x32x16_bf16 v[16:31], v[148:151], v[164:167], v[16:31]
    v_mov_b32 v85, v11
    s_waitcnt lgkmcnt(0)
    v_mfma_f32_32x32x16_bf16 v[32:47], v[148:151], v[168:171], v[32:47]
    v_mfma_f32_32x32x16_bf16 v[16:31], v[92:95], v[80:83], v[16:31]
    v_mfma_f32_32x32x16_bf16 v[32:47], v[92:95], v[84:87], v[32:47]
    ds_read_b64_tr_b16 v[160:161], v3 offset:14336
    ds_read_b64_tr_b16 v[162:163], v3 offset:14848
    ds_read_b64_tr_b16 v[164:165], v3 offset:15360
    ds_read_b64_tr_b16 v[166:167], v3 offset:15872
    ds_read_b64_tr_b16 v[152:153], v3 offset:16384
    ds_read_b64_tr_b16 v[154:155], v3 offset:16896
    v_mov_b32 v172, s50
    v_mov_b32 v173, s49
    v_mov_b32 v80, v6
    v_mov_b32 v81, v7
    s_nop 0
    v_pk_fma_f32 v[16:17], v[16:17], v[64:65], v[172:173] op_sel_hi:[1,1,0]
    v_pk_mul_f32 v[168:169], v[16:17], v[172:173] op_sel:[0,1] op_sel_hi:[1,1]
    v_exp_f32 v168, v168 clamp
    v_exp_f32 v169, v169 clamp
    v_max_f32 v16, s50, v16
    v_max_f32 v17, s50, v17
    v_pk_add_f32 v[16:17], v[16:17], v[168:169]
    v_cvt_pk_bf16_f32 v16, v16, v17
    v_pk_fma_f32 v[18:19], v[18:19], v[66:67], v[172:173] op_sel_hi:[1,1,0]
    v_pk_mul_f32 v[170:171], v[18:19], v[172:173] op_sel:[0,1] op_sel_hi:[1,1]
    v_exp_f32 v170, v170 clamp
    v_exp_f32 v171, v171 clamp
    v_max_f32 v18, s50, v18
    v_max_f32 v19, s50, v19
    v_pk_add_f32 v[18:19], v[18:19], v[170:171]
    v_cvt_pk_bf16_f32 v17, v18, v19
    v_pk_fma_f32 v[20:21], v[20:21], v[68:69], v[172:173] op_sel_hi:[1,1,0]
    v_pk_mul_f32 v[168:169], v[20:21], v[172:173] op_sel:[0,1] op_sel_hi:[1,1]
    v_exp_f32 v168, v168 clamp
    v_exp_f32 v169, v169 clamp
    v_max_f32 v20, s50, v20
    v_max_f32 v21, s50, v21
    v_pk_add_f32 v[20:21], v[20:21], v[168:169]
    v_cvt_pk_bf16_f32 v18, v20, v21
    v_pk_fma_f32 v[22:23], v[22:23], v[70:71], v[172:173] op_sel_hi:[1,1,0]
    v_pk_mul_f32 v[170:171], v[22:23], v[172:173] op_sel:[0,1] op_sel_hi:[1,1]
    v_exp_f32 v170, v170 clamp
    v_exp_f32 v171, v171 clamp
    v_max_f32 v22, s50, v22
    v_max_f32 v23, s50, v23
    v_pk_add_f32 v[22:23], v[22:23], v[170:171]
    v_cvt_pk_bf16_f32 v19, v22, v23
    v_pk_fma_f32 v[24:25], v[24:25], v[72:73], v[172:173] op_sel_hi:[1,1,0]
    v_pk_mul_f32 v[168:169], v[24:25], v[172:173] op_sel:[0,1] op_sel_hi:[1,1]
    v_exp_f32 v168, v168 clamp
    v_exp_f32 v169, v169 clamp
    v_max_f32 v24, s50, v24
    v_max_f32 v25, s50, v25
    v_pk_add_f32 v[24:25], v[24:25], v[168:169]
    v_cvt_pk_bf16_f32 v20, v24, v25
    v_pk_fma_f32 v[26:27], v[26:27], v[74:75], v[172:173] op_sel_hi:[1,1,0]
    v_pk_mul_f32 v[170:171], v[26:27], v[172:173] op_sel:[0,1] op_sel_hi:[1,1]
    v_exp_f32 v170, v170 clamp
    v_exp_f32 v171, v171 clamp
    v_max_f32 v26, s50, v26
    v_max_f32 v27, s50, v27
    v_pk_add_f32 v[26:27], v[26:27], v[170:171]
    v_cvt_pk_bf16_f32 v21, v26, v27
    v_pk_fma_f32 v[28:29], v[28:29], v[76:77], v[172:173] op_sel_hi:[1,1,0]
    v_pk_mul_f32 v[168:169], v[28:29], v[172:173] op_sel:[0,1] op_sel_hi:[1,1]
    v_exp_f32 v168, v168 clamp
    v_exp_f32 v169, v169 clamp
    v_max_f32 v28, s50, v28
    v_max_f32 v29, s50, v29
    v_pk_add_f32 v[28:29], v[28:29], v[168:169]
    v_cvt_pk_bf16_f32 v22, v28, v29
    v_pk_fma_f32 v[30:31], v[30:31], v[78:79], v[172:173] op_sel_hi:[1,1,0]
    v_pk_mul_f32 v[170:171], v[30:31], v[172:173] op_sel:[0,1] op_sel_hi:[1,1]
    v_exp_f32 v170, v170 clamp
    v_exp_f32 v171, v171 clamp
    v_max_f32 v30, s50, v30
    v_max_f32 v31, s50, v31
    v_pk_add_f32 v[30:31], v[30:31], v[170:171]
    v_cvt_pk_bf16_f32 v23, v30, v31
    v_pk_mul_f32 v[32:33], v[32:33], v[64:65]
    v_pk_mul_f32 v[34:35], v[34:35], v[66:67]
    v_pk_mul_f32 v[36:37], v[36:37], v[68:69]
    v_pk_mul_f32 v[38:39], v[38:39], v[70:71]
    v_pk_mul_f32 v[40:41], v[40:41], v[72:73]
    v_pk_mul_f32 v[42:43], v[42:43], v[74:75]
    v_pk_mul_f32 v[44:45], v[44:45], v[76:77]
    v_pk_mul_f32 v[46:47], v[46:47], v[78:79]
    v_cvt_pk_bf16_f32 v32, v32, v33
    v_cvt_pk_bf16_f32 v33, v34, v35
    v_cvt_pk_bf16_f32 v34, v36, v37
    v_cvt_pk_bf16_f32 v35, v38, v39
    v_cvt_pk_bf16_f32 v36, v40, v41
    v_cvt_pk_bf16_f32 v37, v42, v43
    v_cvt_pk_bf16_f32 v38, v44, v45
    v_cvt_pk_bf16_f32 v39, v46, v47
    s_mov_b64 exec, s[52:53]
    v_mov_b32 v32, s48
    v_mov_b32 v33, s48
    v_mov_b32 v34, s48
    v_mov_b32 v35, s48
    v_mov_b32 v36, s48
    v_mov_b32 v37, s48
    v_mov_b32 v38, s48
    v_mov_b32 v39, s48
    s_mov_b64 exec, -1
    v_mfma_f32_32x32x16_bf16 v[64:79], v[16:19], v[32:35], 0
    v_mfma_f32_32x32x16_bf16 v[64:79], v[20:23], v[36:39], v[64:79]
    s_nop 11
    ds_write_b128 v89, v[64:67] offset:0
    ds_write_b128 v89, v[68:71] offset:4096
    ds_write_b128 v89, v[72:75] offset:8192
    ds_write_b128 v89, v[76:79] offset:12288
    s_waitcnt lgkmcnt(0)
    s_barrier
    ds_read_b128 v[32:35], v90 offset:0
    ds_read_b128 v[36:39], v90 offset:1024
    ds_read_b128 v[40:43], v90 offset:2048
    ds_read_b128 v[44:47], v90 offset:3072
    s_waitcnt lgkmcnt(2)
    v_pk_add_f32 v[32:33], v[32:33], v[36:37]
    v_pk_add_f32 v[34:35], v[34:35], v[38:39]
    s_waitcnt lgkmcnt(0)
    v_pk_add_f32 v[40:41], v[40:41], v[44:45]
    v_pk_add_f32 v[42:43], v[42:43], v[46:47]
    v_pk_add_f32 v[32:33], v[32:33], v[40:41]
    v_pk_add_f32 v[34:35], v[34:35], v[42:43]
    v_cvt_pk_bf16_f32 v28, v32, v33
    v_cvt_pk_bf16_f32 v29, v34, v35
    buffer_store_dwordx2 v[28:29], v91, s[32:35], s7 offen sc1
    v_mfma_f32_32x32x16_bf16 v[48:63], v[160:163], v[96:99], v[48:63]
    ds_read_b64_tr_b16 v[156:157], v3 offset:17408
    ds_read_b64_tr_b16 v[158:159], v3 offset:17920
    v_mfma_f32_32x32x16_bf16 v[48:63], v[164:167], v[100:103], v[48:63]
    ds_read_b64_tr_b16 v[160:161], v3 offset:18432
    ds_read_b64_tr_b16 v[162:163], v3 offset:18944
    v_mfma_f32_32x32x16_bf16 v[48:63], v[152:155], v[104:107], v[48:63]
    ds_read_b64_tr_b16 v[164:165], v3 offset:19456
    ds_read_b64_tr_b16 v[166:167], v3 offset:19968
    s_waitcnt lgkmcnt(4)
    v_mfma_f32_32x32x16_bf16 v[48:63], v[156:159], v[108:111], v[48:63]
    ds_read_b64_tr_b16 v[152:153], v3 offset:20480
    ds_read_b64_tr_b16 v[154:155], v3 offset:20992
    s_waitcnt lgkmcnt(4)
    v_mfma_f32_32x32x16_bf16 v[48:63], v[160:163], v[112:115], v[48:63]
    ds_read_b64_tr_b16 v[156:157], v3 offset:21504
    ds_read_b64_tr_b16 v[158:159], v3 offset:22016
    s_waitcnt lgkmcnt(4)
    v_mfma_f32_32x32x16_bf16 v[48:63], v[164:167], v[116:119], v[48:63]
    ds_read_b64_tr_b16 v[160:161], v3 offset:22528
    ds_read_b64_tr_b16 v[162:163], v3 offset:23040
    s_waitcnt lgkmcnt(4)
    v_mfma_f32_32x32x16_bf16 v[48:63], v[152:155], v[120:123], v[48:63]
    ds_read_b64_tr_b16 v[164:165], v3 offset:23552
    ds_read_b64_tr_b16 v[166:167], v3 offset:24064
    s_waitcnt lgkmcnt(4)
    v_mfma_f32_32x32x16_bf16 v[48:63], v[156:159], v[124:127], v[48:63]
    ds_read_b64_tr_b16 v[152:153], v3 offset:24576
    ds_read_b64_tr_b16 v[154:155], v3 offset:25088
    s_waitcnt lgkmcnt(4)
    v_mfma_f32_32x32x16_bf16 v[48:63], v[160:163], v[128:131], v[48:63]
    ds_read_b64_tr_b16 v[156:157], v3 offset:25600
    ds_read_b64_tr_b16 v[158:159], v3 offset:26112
    s_waitcnt lgkmcnt(4)
    v_mfma_f32_32x32x16_bf16 v[48:63], v[164:167], v[132:135], v[48:63]
    ds_read_b64_tr_b16 v[160:161], v3 offset:26624
    ds_read_b64_tr_b16 v[162:163], v3 offset:27136
    s_waitcnt lgkmcnt(4)
    v_mfma_f32_32x32x16_bf16 v[48:63], v[152:155], v[136:139], v[48:63]
    ds_read_b64_tr_b16 v[164:165], v3 offset:27648
    ds_read_b64_tr_b16 v[166:167], v3 offset:28160
    s_waitcnt lgkmcnt(4)
    v_mfma_f32_32x32x16_bf16 v[48:63], v[156:159], v[140:143], v[48:63]
    s_waitcnt lgkmcnt(2)
    v_mfma_f32_32x32x16_bf16 v[48:63], v[160:163], v[144:147], v[48:63]
    s_waitcnt lgkmcnt(0)
    v_mfma_f32_32x32x16_bf16 v[48:63], v[164:167], v[148:151], v[48:63]
    v_mfma_f32_32x32x16_bf16 v[48:63], v[80:83], v[92:95], v[48:63]
    s_nop 11
    v_pk_fma_f32 v[48:49], v[48:49], v[88:89], v[172:173] op_sel_hi:[1,0,0]
    v_pk_mul_f32 v[168:169], v[48:49], v[172:173] op_sel:[0,1] op_sel_hi:[1,1]
    v_exp_f32 v168, v168 clamp
    v_exp_f32 v169, v169 clamp
    v_max_f32 v48, s50, v48
    v_max_f32 v49, s50, v49
    v_pk_add_f32 v[48:49], v[48:49], v[168:169]
    v_cvt_pk_bf16_f32 v48, v48, v49
    v_pk_fma_f32 v[50:51], v[50:51], v[88:89], v[172:173] op_sel_hi:[1,0,0]
    v_pk_mul_f32 v[170:171], v[50:51], v[172:173] op_sel:[0,1] op_sel_hi:[1,1]
    v_exp_f32 v170, v170 clamp
    v_exp_f32 v171, v171 clamp
    v_max_f32 v50, s50, v50
    v_max_f32 v51, s50, v51
    v_pk_add_f32 v[50:51], v[50:51], v[170:171]
    v_cvt_pk_bf16_f32 v49, v50, v51
    v_pk_fma_f32 v[52:53], v[52:53], v[88:89], v[172:173] op_sel_hi:[1,0,0]
    v_pk_mul_f32 v[168:169], v[52:53], v[172:173] op_sel:[0,1] op_sel_hi:[1,1]
    v_exp_f32 v168, v168 clamp
    v_exp_f32 v169, v169 clamp
    v_max_f32 v52, s50, v52
    v_max_f32 v53, s50, v53
    v_pk_add_f32 v[52:53], v[52:53], v[168:169]
    v_cvt_pk_bf16_f32 v50, v52, v53
    v_pk_fma_f32 v[54:55], v[54:55], v[88:89], v[172:173] op_sel_hi:[1,0,0]
    v_pk_mul_f32 v[170:171], v[54:55], v[172:173] op_sel:[0,1] op_sel_hi:[1,1]
    v_exp_f32 v170, v170 clamp
    v_exp_f32 v171, v171 clamp
    v_max_f32 v54, s50, v54
    v_max_f32 v55, s50, v55
    v_pk_add_f32 v[54:55], v[54:55], v[170:171]
    v_cvt_pk_bf16_f32 v51, v54, v55
    v_pk_fma_f32 v[56:57], v[56:57], v[88:89], v[172:173] op_sel_hi:[1,0,0]
    v_pk_mul_f32 v[168:169], v[56:57], v[172:173] op_sel:[0,1] op_sel_hi:[1,1]
    v_exp_f32 v168, v168 clamp
    v_exp_f32 v169, v169 clamp
    v_max_f32 v56, s50, v56
    v_max_f32 v57, s50, v57
    v_pk_add_f32 v[56:57], v[56:57], v[168:169]
    v_cvt_pk_bf16_f32 v52, v56, v57
    v_pk_fma_f32 v[58:59], v[58:59], v[88:89], v[172:173] op_sel_hi:[1,0,0]
    v_pk_mul_f32 v[170:171], v[58:59], v[172:173] op_sel:[0,1] op_sel_hi:[1,1]
    v_exp_f32 v170, v170 clamp
    v_exp_f32 v171, v171 clamp
    v_max_f32 v58, s50, v58
    v_max_f32 v59, s50, v59
    v_pk_add_f32 v[58:59], v[58:59], v[170:171]
    v_cvt_pk_bf16_f32 v53, v58, v59
    v_pk_fma_f32 v[60:61], v[60:61], v[88:89], v[172:173] op_sel_hi:[1,0,0]
    v_pk_mul_f32 v[168:169], v[60:61], v[172:173] op_sel:[0,1] op_sel_hi:[1,1]
    v_exp_f32 v168, v168 clamp
    v_exp_f32 v169, v169 clamp
    v_max_f32 v60, s50, v60
    v_max_f32 v61, s50, v61
    v_pk_add_f32 v[60:61], v[60:61], v[168:169]
    v_cvt_pk_bf16_f32 v54, v60, v61
    v_pk_fma_f32 v[62:63], v[62:63], v[88:89], v[172:173] op_sel_hi:[1,0,0]
    v_pk_mul_f32 v[170:171], v[62:63], v[172:173] op_sel:[0,1] op_sel_hi:[1,1]
    v_exp_f32 v170, v170 clamp
    v_exp_f32 v171, v171 clamp
    v_max_f32 v62, s50, v62
    v_max_f32 v63, s50, v63
    v_pk_add_f32 v[62:63], v[62:63], v[170:171]
    v_cvt_pk_bf16_f32 v55, v62, v63
    v_cndmask_b32 v54, v54, 0, s[54:55]
    v_cndmask_b32 v55, v55, 0, s[54:55]
    s_mul_i32 s40, s58, 7
    v_lshrrev_b32 v16, 5, v0
    v_add_u32 v16, s40, v16
    v_and_b32 v17, 31, v0
    v_lshlrev_b32 v17, 4, v17
    v_and_b32 v18, 1, v16
    v_lshl_add_u32 v17, v18, 9, v17
    v_lshrrev_b32 v16, 1, v16
    v_add_u32 v18, 0, v16
    v_and_b32 v19, 1, v18
    v_lshrrev_b32 v18, 1, v18
    v_lshl_add_u32 v18, v18, 10, v17
    v_lshl_add_u32 v56, v19, 3, v18
    v_add_u32 v18, 1, v16
    v_and_b32 v19, 1, v18
    v_lshrrev_b32 v18, 1, v18
    v_lshl_add_u32 v18, v18, 10, v17
    v_lshl_add_u32 v57, v19, 3, v18
    v_add_u32 v18, 2, v16
    v_and_b32 v19, 1, v18
    v_lshrrev_b32 v18, 1, v18
    v_lshl_add_u32 v18, v18, 10, v17
    v_lshl_add_u32 v58, v19, 3, v18
    v_add_u32 v18, 3, v16
    v_and_b32 v19, 1, v18
    v_lshrrev_b32 v18, 1, v18
    v_lshl_add_u32 v18, v18, 10, v17
    v_lshl_add_u32 v59, v19, 3, v18
    s_lshr_b32 s40, s60, 1
    s_lshl_b32 s40, s40, 10
    s_and_b32 s41, s60, 1
    s_lshl_b32 s41, s41, 3
    s_add_u32 s40, s40, s41
    v_add_u32 v60, s40, v12
    s_lshl_b32 s40, s64, 7
    s_lshl_b32 s41, s58, 2
    s_add_u32 s40, s40, s41
    s_add_u32 s3, s40, 1434624
    s_add_u32 s45, s57, 0
    s_and_b32 s45, s45, 7
    s_lshl_b32 s45, s45, 12
    s_add_u32 s45, s45, s6
    buffer_load_dwordx2 v[96:97], v91, s[32:35], s45 offen sc1
    buffer_load_dwordx2 v[98:99], v91, s[32:35], s45 offen offset:2048 sc1
    s_add_u32 s45, s57, 1
    s_and_b32 s45, s45, 7
    s_lshl_b32 s45, s45, 12
    s_add_u32 s45, s45, s6
    buffer_load_dwordx2 v[100:101], v91, s[32:35], s45 offen sc1
    buffer_load_dwordx2 v[102:103], v91, s[32:35], s45 offen offset:2048 sc1
    s_add_u32 s45, s57, 2
    s_and_b32 s45, s45, 7
    s_lshl_b32 s45, s45, 12
    s_add_u32 s45, s45, s6
    buffer_load_dwordx2 v[104:105], v91, s[32:35], s45 offen sc1
    buffer_load_dwordx2 v[106:107], v91, s[32:35], s45 offen offset:2048 sc1
    s_add_u32 s45, s57, 3
    s_and_b32 s45, s45, 7
    s_lshl_b32 s45, s45, 12
    s_add_u32 s45, s45, s6
    buffer_load_dwordx2 v[108:109], v91, s[32:35], s45 offen sc1
    buffer_load_dwordx2 v[110:111], v91, s[32:35], s45 offen offset:2048 sc1
    s_add_u32 s45, s57, 4
    s_and_b32 s45, s45, 7
    s_lshl_b32 s45, s45, 12
    s_add_u32 s45, s45, s6
    buffer_load_dwordx2 v[112:113], v91, s[32:35], s45 offen sc1
    buffer_load_dwordx2 v[114:115], v91, s[32:35], s45 offen offset:2048 sc1
    s_add_u32 s45, s57, 5
    s_and_b32 s45, s45, 7
    s_lshl_b32 s45, s45, 12
    s_add_u32 s45, s45, s6
    buffer_load_dwordx2 v[116:117], v91, s[32:35], s45 offen sc1
    buffer_load_dwordx2 v[118:119], v91, s[32:35], s45 offen offset:2048 sc1
    s_add_u32 s45, s57, 6
    s_and_b32 s45, s45, 7
    s_lshl_b32 s45, s45, 12
    s_add_u32 s45, s45, s6
    buffer_load_dwordx2 v[120:121], v91, s[32:35], s45 offen sc1
    buffer_load_dwordx2 v[122:123], v91, s[32:35], s45 offen offset:2048 sc1
    s_add_u32 s45, s57, 7
    s_and_b32 s45, s45, 7
    s_lshl_b32 s45, s45, 12
    s_add_u32 s45, s45, s6
    buffer_load_dwordx2 v[124:125], v91, s[32:35], s45 offen sc1
    buffer_load_dwordx2 v[126:127], v91, s[32:35], s45 offen offset:2048 sc1
    s_mov_b32 s43, 0x3f80
    s_mov_b32 s44, 0x3f800000
    v_mov_b32 v16, 0
    v_mov_b32 v17, 0
    v_mov_b32 v18, 0
    v_mov_b32 v19, 0
    v_mov_b32 v20, 0
    s_waitcnt vmcnt(15)
    v_dot2c_f32_bf16 v16, s43, v96
    v_dot2c_f32_bf16 v17, s44, v96
    v_dot2c_f32_bf16 v18, s43, v97
    v_dot2c_f32_bf16 v19, s44, v97
    v_max3_u32 v20, v20, v96, v97
    s_waitcnt vmcnt(14)
    v_dot2c_f32_bf16 v16, s43, v98
    v_dot2c_f32_bf16 v17, s44, v98
    v_dot2c_f32_bf16 v18, s43, v99
    v_dot2c_f32_bf16 v19, s44, v99
    v_max3_u32 v20, v20, v98, v99
    s_waitcnt vmcnt(13)
    v_dot2c_f32_bf16 v16, s43, v100
    v_dot2c_f32_bf16 v17, s44, v100
    v_dot2c_f32_bf16 v18, s43, v101
    v_dot2c_f32_bf16 v19, s44, v101
    v_max3_u32 v20, v20, v100, v101
    s_waitcnt vmcnt(12)
    v_dot2c_f32_bf16 v16, s43, v102
    v_dot2c_f32_bf16 v17, s44, v102
    v_dot2c_f32_bf16 v18, s43, v103
    v_dot2c_f32_bf16 v19, s44, v103
    v_max3_u32 v20, v20, v102, v103
    s_waitcnt vmcnt(11)
    v_dot2c_f32_bf16 v16, s43, v104
    v_dot2c_f32_bf16 v17, s44, v104
    v_dot2c_f32_bf16 v18, s43, v105
    v_dot2c_f32_bf16 v19, s44, v105
    v_max3_u32 v20, v20, v104, v105
    s_waitcnt vmcnt(10)
    v_dot2c_f32_bf16 v16, s43, v106
    v_dot2c_f32_bf16 v17, s44, v106
    v_dot2c_f32_bf16 v18, s43, v107
    v_dot2c_f32_bf16 v19, s44, v107
    v_max3_u32 v20, v20, v106, v107
    s_waitcnt vmcnt(9)
    v_dot2c_f32_bf16 v16, s43, v108
    v_dot2c_f32_bf16 v17, s44, v108
    v_dot2c_f32_bf16 v18, s43, v109
    v_dot2c_f32_bf16 v19, s44, v109
    v_max3_u32 v20, v20, v108, v109
    s_waitcnt vmcnt(8)
    v_dot2c_f32_bf16 v16, s43, v110
    v_dot2c_f32_bf16 v17, s44, v110
    v_dot2c_f32_bf16 v18, s43, v111
    v_dot2c_f32_bf16 v19, s44, v111
    v_max3_u32 v20, v20, v110, v111
    s_waitcnt vmcnt(7)
    v_dot2c_f32_bf16 v16, s43, v112
    v_dot2c_f32_bf16 v17, s44, v112
    v_dot2c_f32_bf16 v18, s43, v113
    v_dot2c_f32_bf16 v19, s44, v113
    v_max3_u32 v20, v20, v112, v113
    s_waitcnt vmcnt(6)
    v_dot2c_f32_bf16 v16, s43, v114
    v_dot2c_f32_bf16 v17, s44, v114
    v_dot2c_f32_bf16 v18, s43, v115
    v_dot2c_f32_bf16 v19, s44, v115
    v_max3_u32 v20, v20, v114, v115
    s_waitcnt vmcnt(5)
    v_dot2c_f32_bf16 v16, s43, v116
    v_dot2c_f32_bf16 v17, s44, v116
    v_dot2c_f32_bf16 v18, s43, v117
    v_dot2c_f32_bf16 v19, s44, v117
    v_max3_u32 v20, v20, v116, v117
    s_waitcnt vmcnt(4)
    v_dot2c_f32_bf16 v16, s43, v118
    v_dot2c_f32_bf16 v17, s44, v118
    v_dot2c_f32_bf16 v18, s43, v119
    v_dot2c_f32_bf16 v19, s44, v119
    v_max3_u32 v20, v20, v118, v119
    s_waitcnt vmcnt(3)
    v_dot2c_f32_bf16 v16, s43, v120
    v_dot2c_f32_bf16 v17, s44, v120
    v_dot2c_f32_bf16 v18, s43, v121
    v_dot2c_f32_bf16 v19, s44, v121
    v_max3_u32 v20, v20, v120, v121
    s_waitcnt vmcnt(2)
    v_dot2c_f32_bf16 v16, s43, v122
    v_dot2c_f32_bf16 v17, s44, v122
    v_dot2c_f32_bf16 v18, s43, v123
    v_dot2c_f32_bf16 v19, s44, v123
    v_max3_u32 v20, v20, v122, v123
    s_waitcnt vmcnt(1)
    v_dot2c_f32_bf16 v16, s43, v124
    v_dot2c_f32_bf16 v17, s44, v124
    v_dot2c_f32_bf16 v18, s43, v125
    v_dot2c_f32_bf16 v19, s44, v125
    v_max3_u32 v20, v20, v124, v125
    s_waitcnt vmcnt(0)
    v_dot2c_f32_bf16 v16, s43, v126
    v_dot2c_f32_bf16 v17, s44, v126
    v_dot2c_f32_bf16 v18, s43, v127
    v_dot2c_f32_bf16 v19, s44, v127
    v_max3_u32 v20, v20, v126, v127
    v_cmp_eq_u32 vcc, -1, v20
    s_cbranch_vccnz L_kvspin_65
L_kvback_66:
    v_cvt_pk_bf16_f32 v20, v16, v17
    v_cvt_pk_bf16_f32 v21, v18, v19
    ds_write_b64 v60, v[20:21] offset:16384
    s_waitcnt lgkmcnt(0)
    s_barrier
    ds_read_b128 v[24:27], v12 offset:16384
    ds_read_b128 v[28:31], v12 offset:17408
    s_waitcnt lgkmcnt(1)
    v_mfma_f32_32x32x16_bf16 v[32:47], v[24:27], v[48:51], 0
    s_waitcnt lgkmcnt(0)
    v_mfma_f32_32x32x16_bf16 v[32:47], v[28:31], v[52:55], v[32:47]
    s_nop 11
    v_mov_b32 v16, v44
    v_mov_b32 v17, v44
    s_nop 1
    v_permlane32_swap_b32 v16, v17
    v_add_f32 v16, s50, v17
    v_rcp_f32 v16, v16
    s_nop 0
    v_pk_mul_f32 v[32:33], v[32:33], v[16:17] op_sel_hi:[1,0]
    v_pk_mul_f32 v[34:35], v[34:35], v[16:17] op_sel_hi:[1,0]
    v_pk_mul_f32 v[36:37], v[36:37], v[16:17] op_sel_hi:[1,0]
    v_pk_mul_f32 v[38:39], v[38:39], v[16:17] op_sel_hi:[1,0]
    v_pk_mul_f32 v[40:41], v[40:41], v[16:17] op_sel_hi:[1,0]
    v_pk_mul_f32 v[42:43], v[42:43], v[16:17] op_sel_hi:[1,0]
    v_pk_mul_f32 v[44:45], v[44:45], v[16:17] op_sel_hi:[1,0]
    v_pk_mul_f32 v[46:47], v[46:47], v[16:17] op_sel_hi:[1,0]
    v_cvt_pk_bf16_f32 v20, v32, v33
    v_cvt_pk_bf16_f32 v21, v34, v35
    v_cvt_pk_bf16_f32 v22, v36, v37
    v_cvt_pk_bf16_f32 v23, v38, v39
    v_cvt_pk_bf16_f32 v24, v40, v41
    v_cvt_pk_bf16_f32 v25, v42, v43
    v_cvt_pk_bf16_f32 v26, v44, v45
    v_cvt_pk_bf16_f32 v27, v46, v47
    buffer_store_dwordx2 v[20:21], v56, s[36:39], s67 offen sc1
    buffer_store_dwordx2 v[22:23], v57, s[36:39], s67 offen sc1
    buffer_store_dwordx2 v[24:25], v58, s[36:39], s67 offen sc1
    s_mov_b32 exec_hi, 0
    buffer_store_dwordx2 v[26:27], v59, s[36:39], s67 offen sc1
    s_mov_b64 exec, -1
    s_add_u32 s45, s56, 2
    v_mov_b32 v14, s45
    s_waitcnt vmcnt(0)
    s_mov_b64 exec, 1
    buffer_store_dword v14, v1, s[36:39], s3 offen sc1
    s_mov_b64 exec, -1
    s_cmp_ge_u32 s58, 14
    s_cbranch_scc1 L_spare1_s
    s_lshl_b32 s5, s58, 11
    s_add_u32 s5, s5, s68
    buffer_load_dwordx4 v[104:107], v1, s[36:39], s5 offen sc1
    buffer_load_dwordx4 v[108:111], v1, s[36:39], s5 offen offset:1024 sc1
    s_lshr_b32 s41, s58, 2
    s_lshl_b32 s41, s41, 10
    s_and_b32 s42, s58, 3
    s_lshl_b32 s42, s42, 2
    s_add_u32 s41, s41, s42
    s_add_u32 s6, s41, s69
    s_lshl_b32 s40, s64, 7
    s_lshl_b32 s41, s58, 3
    s_add_u32 s41, s40, s41
    s_add_u32 s7, s41, 1433600
    s_add_u32 s40, s40, 1434624
    v_and_b32 v13, 15, v0
    v_lshlrev_b32 v13, 2, v13
    ds_read_b64_tr_b16 v[48:49], v3 offset:28672
    ds_read_b64_tr_b16 v[50:51], v3 offset:29184
    ds_read_b64_tr_b16 v[52:53], v3 offset:29696
    ds_read_b64_tr_b16 v[54:55], v3 offset:30208
    s_add_u32 s47, s56, 2
    s_mov_b32 s46, s66
L_poll_69:
    buffer_load_dword v14, v13, s[36:39], s40 offen sc1
    s_waitcnt vmcnt(0)
    v_subrev_u32 v14, s47, v14
    v_cmp_lt_u32 vcc, 3, v14
    s_cbranch_vccz L_polled_68
    s_sub_u32 s46, s46, 1
    s_cmp_lg_u32 s46, 0
    s_cbranch_scc1 L_poll_69
    s_mov_b32 s66, 1
L_polled_68:
    s_add_u32 s4, s67, 0
    buffer_load_dwordx4 v[64:67], v1, s[36:39], s4 offen offset:0 sc1
    v_lshlrev_b32 v16, 16, v104
    v_and_b32 v17, s51, v104
    buffer_load_dwordx4 v[68:71], v1, s[36:39], s4 offen offset:1024 sc1
    v_lshlrev_b32 v18, 16, v105
    v_and_b32 v19, s51, v105
    buffer_load_dwordx4 v[72:75], v1, s[36:39], s4 offen offset:2048 sc1
    v_lshlrev_b32 v20, 16, v106
    v_and_b32 v21, s51, v106
    buffer_load_dwordx4 v[76:79], v1, s[36:39], s4 offen offset:3072 sc1
    v_lshlrev_b32 v22, 16, v107
    v_and_b32 v23, s51, v107
    s_add_u32 s4, s67, 4096
    buffer_load_dwordx4 v[80:83], v1, s[36:39], s4 offen offset:0 sc1
    v_lshlrev_b32 v24, 16, v108
    v_and_b32 v25, s51, v108
    buffer_load_dwordx4 v[84:87], v1, s[36:39], s4 offen offset:1024 sc1
    v_lshlrev_b32 v26, 16, v109
    v_and_b32 v27, s51, v109
    buffer_load_dwordx4 v[88:91], v1, s[36:39], s4 offen offset:2048 sc1
    v_lshlrev_b32 v28, 16, v110
    v_and_b32 v29, s51, v110
    buffer_load_dwordx4 v[92:95], v1, s[36:39], s4 offen offset:3072 sc1
    v_lshlrev_b32 v30, 16, v111
    v_and_b32 v31, s51, v111
    s_waitcnt vmcnt(7) lgkmcnt(2)
    s_nop 0
    v_mfma_f32_32x32x16_bf16 v[16:31], v[48:51], v[64:67], v[16:31]
    s_add_u32 s4, s67, 8192
    buffer_load_dwordx4 v[96:99], v1, s[36:39], s4 offen offset:0 sc1
    ds_read_b64_tr_b16 v[56:57], v3 offset:30720
    ds_read_b64_tr_b16 v[58:59], v3 offset:31232
    s_waitcnt vmcnt(7) lgkmcnt(2)
    v_mfma_f32_32x32x16_bf16 v[16:31], v[52:55], v[68:71], v[16:31]
    buffer_load_dwordx4 v[100:103], v1, s[36:39], s4 offen offset:1024 sc1
    ds_read_b64_tr_b16 v[48:49], v3 offset:31744
    ds_read_b64_tr_b16 v[50:51], v3 offset:32256
    s_waitcnt vmcnt(7) lgkmcnt(2)
    v_mfma_f32_32x32x16_bf16 v[16:31], v[56:59], v[72:75], v[16:31]
    buffer_load_dwordx4 v[104:107], v1, s[36:39], s4 offen offset:2048 sc1
    ds_read_b64_tr_b16 v[52:53], v3 offset:32768
    ds_read_b64_tr_b16 v[54:55], v3 offset:33280
    s_waitcnt vmcnt(7) lgkmcnt(2)
    v_mfma_f32_32x32x16_bf16 v[16:31], v[48:51], v[76:79], v[16:31]
    buffer_load_dwordx4 v[108:111], v1, s[36:39], s4 offen offset:3072 sc1
    ds_read_b64_tr_b16 v[56:57], v3 offset:33792
    ds_read_b64_tr_b16 v[58:59], v3 offset:34304
    s_waitcnt vmcnt(7) lgkmcnt(2)
    v_mfma_f32_32x32x16_bf16 v[16:31], v[52:55], v[80:83], v[16:31]
    s_add_u32 s4, s67, 12288
    buffer_load_dwordx4 v[112:115], v1, s[36:39], s4 offen offset:0 sc1
    ds_read_b64_tr_b16 v[48:49], v3 offset:34816
    ds_read_b64_tr_b16 v[50:51], v3 offset:35328
    s_waitcnt vmcnt(7) lgkmcnt(2)
    v_mfma_f32_32x32x16_bf16 v[16:31], v[56:59], v[84:87], v[16:31]
    buffer_load_dwordx4 v[116:119], v1, s[36:39], s4 offen offset:1024 sc1
    ds_read_b64_tr_b16 v[52:53], v3 offset:35840
    ds_read_b64_tr_b16 v[54:55], v3 offset:36352
    s_waitcnt vmcnt(7) lgkmcnt(2)
    v_mfma_f32_32x32x16_bf16 v[16:31], v[48:51], v[88:91], v[16:31]
    buffer_load_dwordx4 v[120:123], v1, s[36:39], s4 offen offset:2048 sc1
    ds_read_b64_tr_b16 v[56:57], v3 offset:36864
    ds_read_b64_tr_b16 v[58:59], v3 offset:37376
    s_waitcnt vmcnt(7) lgkmcnt(2)
    v_mfma_f32_32x32x16_bf16 v[16:31], v[52:55], v[92:95], v[16:31]
    buffer_load_dwordx4 v[124:127], v1, s[36:39], s4 offen offset:3072 sc1
    ds_read_b64_tr_b16 v[48:49], v3 offset:37888
    ds_read_b64_tr_b16 v[50:51], v3 offset:38400
    s_waitcnt vmcnt(7) lgkmcnt(2)
    v_mfma_f32_32x32x16_bf16 v[16:31], v[56:59], v[96:99], v[16:31]
    s_add_u32 s4, s67, 16384
    buffer_load_dwordx4 v[128:131], v1, s[36:39], s4 offen offset:0 sc1
    ds_read_b64_tr_b16 v[52:53], v3 offset:38912
    ds_read_b64_tr_b16 v[54:55], v3 offset:39424
    s_waitcnt vmcnt(7) lgkmcnt(2)
    v_mfma_f32_32x32x16_bf16 v[16:31], v[48:51], v[100:103], v[16:31]
    buffer_load_dwordx4 v[132:135], v1, s[36:39], s4 offen offset:1024 sc1
    ds_read_b64_tr_b16 v[56:57], v3 offset:39936
    ds_read_b64_tr_b16 v[58:59], v3 offset:40448
    s_waitcnt vmcnt(7) lgkmcnt(2)
    v_mfma_f32_32x32x16_bf16 v[16:31], v[52:55], v[104:107], v[16:31]
    buffer_load_dwordx4 v[136:139], v1, s[36:39], s4 offen offset:2048 sc1
    ds_read_b64_tr_b16 v[48:49], v3 offset:40960
    ds_read_b64_tr_b16 v[50:51], v3 offset:41472
    s_waitcnt vmcnt(7) lgkmcnt(2)
    v_mfma_f32_32x32x16_bf16 v[16:31], v[56:59], v[108:111], v[16:31]
    buffer_load_dwordx4 v[140:143], v1, s[36:39], s4 offen offset:3072 sc1
    ds_read_b64_tr_b16 v[52:53], v3 offset:41984
    ds_read_b64_tr_b16 v[54:55], v3 offset:42496
    s_waitcnt vmcnt(7) lgkmcnt(2)
    v_mfma_f32_32x32x16_bf16 v[16:31], v[48:51], v[112:115], v[16:31]
    s_add_u32 s4, s67, 20480
    buffer_load_dwordx4 v[144:147], v1, s[36:39], s4 offen offset:0 sc1
    ds_read_b64_tr_b16 v[56:57], v3 offset:43008
    ds_read_b64_tr_b16 v[58:59], v3 offset:43520
    s_waitcnt vmcnt(7) lgkmcnt(2)
    v_mfma_f32_32x32x16_bf16 v[16:31], v[52:55], v[116:119], v[16:31]
    buffer_load_dwordx4 v[148:151], v1, s[36:39], s4 offen offset:1024 sc1
    ds_read_b64_tr_b16 v[48:49], v3 offset:44032
    ds_read_b64_tr_b16 v[50:51], v3 offset:44544
    v_and_b32 v13, 15, v0
    v_min_u32 v13, 13, v13
    v_lshlrev_b32 v13, 3, v13
    v_lshrrev_b32 v14, 4, v0
    v_lshl_add_u32 v107, v14, 7, v13
    s_mul_i32 s40, s59, 114688
    s_add_u32 s40, s40, 1146880
    s_waitcnt vmcnt(7) lgkmcnt(2)
    v_mfma_f32_32x32x16_bf16 v[16:31], v[56:59], v[120:123], v[16:31]
    buffer_load_dwordx4 v[152:155], v1, s[36:39], s4 offen offset:2048 sc1
    ds_read_b64_tr_b16 v[52:53], v3 offset:45056
    ds_read_b64_tr_b16 v[54:55], v3 offset:45568
    s_and_b32 s0, s58, 1
    s_mul_i32 s16, s0, 28672
    s_add_u32 s40, s40, s16
    s_lshl_b32 s16, s16, 1
    v_add_u32 v110, s40, v1
    s_lshl_b32 s15, s60, 10
    s_add_u32 s15, s15, 0
    s_waitcnt vmcnt(7) lgkmcnt(2)
    v_mfma_f32_32x32x16_bf16 v[16:31], v[48:51], v[124:127], v[16:31]
    buffer_load_dwordx4 v[156:159], v1, s[36:39], s4 offen offset:3072 sc1
    ds_read_b64_tr_b16 v[56:57], v3 offset:46080
    ds_read_b64_tr_b16 v[58:59], v3 offset:46592
    s_lshl_b32 s40, s58, 13
    s_lshl_b32 s41, s60, 11
    s_add_u32 s3, s40, s41
    s_mul_i32 s40, s59, 458752
    s_add_u32 s3, s3, s40
    s_lshl_b32 s40, s59, 10
    s_waitcnt vmcnt(7) lgkmcnt(2)
    v_mfma_f32_32x32x16_bf16 v[16:31], v[52:55], v[128:131], v[16:31]
    s_add_u32 s4, s67, 24576
    buffer_load_dwordx4 v[160:163], v1, s[36:39], s4 offen offset:0 sc1
    ds_read_b64_tr_b16 v[48:49], v3 offset:47104
    ds_read_b64_tr_b16 v[50:51], v3 offset:47616
    s_lshl_b32 s41, s60, 6
    s_add_u32 s40, s40, s41
    s_lshl_b32 s41, s58, 2
    s_add_u32 s40, s40, s41
    s_add_u32 s2, s40, 1435648
    s_mul_i32 s40, s0, 229376
    s_sub_u32 s17, s3, s40
    s_waitcnt vmcnt(7) lgkmcnt(2)
    v_mfma_f32_32x32x16_bf16 v[16:31], v[56:59], v[132:135], v[16:31]
    buffer_load_dwordx4 v[164:167], v1, s[36:39], s4 offen offset:1024 sc1
    ds_read_b64_tr_b16 v[52:53], v3 offset:48128
    ds_read_b64_tr_b16 v[54:55], v3 offset:48640
    s_add_u32 s3, s3, s40
    s_lshl_b32 s40, s0, 9
    s_sub_u32 s1, s2, s40
    s_add_u32 s2, s2, s40
    v_mov_b32 v84, v4
    v_mov_b32 v85, v5
    s_waitcnt vmcnt(7) lgkmcnt(2)
    v_mfma_f32_32x32x16_bf16 v[16:31], v[48:51], v[136:139], v[16:31]
    buffer_load_dwordx4 v[168:171], v1, s[36:39], s4 offen offset:2048 sc1
    ds_read_b64_tr_b16 v[56:57], v3 offset:49152
    ds_read_b64_tr_b16 v[58:59], v3 offset:49664
    v_mov_b32 v86, 0
    v_mov_b32 v87, 0
    v_mov_b32 v90, 0
    v_mov_b32 v91, 0
    v_and_b32 v108, 31, v0
    v_lshlrev_b32 v108, 4, v108
    v_add_u32 v108, 159744, v108
    s_waitcnt vmcnt(7) lgkmcnt(2)
    v_mfma_f32_32x32x16_bf16 v[16:31], v[52:55], v[140:143], v[16:31]
    buffer_load_dwordx4 v[172:175], v1, s[36:39], s4 offen offset:3072 sc1
    ds_read_b64_tr_b16 v[48:49], v3 offset:50176
    ds_read_b64_tr_b16 v[50:51], v3 offset:50688
    s_and_b32 s40, s65, 3
    s_lshl_b32 s40, s40, 9
    s_lshl_b32 s41, s0, 9
    s_xor_b32 s40, s40, s41
    v_add_u32 v109, s40, v108
    s_mul_i32 s73, s62, 229376
    s_waitcnt vmcnt(7) lgkmcnt(2)
    v_mfma_f32_32x32x16_bf16 v[16:31], v[56:59], v[144:147], v[16:31]
    ds_read_b64_tr_b16 v[52:53], v3 offset:51200
    ds_read_b64_tr_b16 v[54:55], v3 offset:51712
    s_lshl_b32 s43, s60, 11
    s_add_u32 s73, s73, s43
    s_lshl_b32 s74, s62, 9
    s_lshl_b32 s43, s60, 6
    s_add_u32 s74, s74, s43
    s_add_u32 s74, s74, 1435648
    v_min_u32 v104, 6, v0
    s_waitcnt vmcnt(6) lgkmcnt(2)
    v_mfma_f32_32x32x16_bf16 v[16:31], v[48:51], v[148:151], v[16:31]
    ds_read_b64_tr_b16 v[56:57], v3 offset:52224
    ds_read_b64_tr_b16 v[58:59], v3 offset:52736
    v_lshlrev_b32 v104, 3, v104
    s_and_b32 s43, s62, 1
    s_lshl_b32 s44, s43, 2
    s_add_u32 s74, s74, s44
    s_lshl_b32 s44, s43, 13
    s_sub_u32 s78, s73, s44
    s_add_u32 s78, s78, 8192
    s_waitcnt vmcnt(5) lgkmcnt(2)
    v_mfma_f32_32x32x16_bf16 v[16:31], v[52:55], v[152:155], v[16:31]
    ds_read_b64_tr_b16 v[48:49], v3 offset:53248
    ds_read_b64_tr_b16 v[50:51], v3 offset:53760
    s_add_u32 s73, s73, s44
    s_lshr_b32 s43, s62, 1
    s_lshl_b32 s43, s43, 2
    s_and_b32 s44, s62, 1
    s_add_u32 s43, s43, s44
    s_mul_i32 s75, s43, 28672
    s_waitcnt vmcnt(4) lgkmcnt(2)
    v_mfma_f32_32x32x16_bf16 v[16:31], v[56:59], v[156:159], v[16:31]
    ds_read_b64_tr_b16 v[52:53], v3 offset:54272
    ds_read_b64_tr_b16 v[54:55], v3 offset:54784
    s_lshl_b32 s43, s63, 12
    s_lshl_b32 s44, s60, 7
    s_add_u32 s43, s43, s44
    s_add_u32 s75, s75, s43
    s_add_u32 s75, s75, 1146880
    s_lshl_b32 s43, s57, 2
    s_add_u32 s43, s43, s62
    s_waitcnt vmcnt(3) lgkmcnt(2)
    v_mfma_f32_32x32x16_bf16 v[16:31], v[48:51], v[160:163], v[16:31]
    ds_read_b64_tr_b16 v[56:57], v3 offset:55296
    ds_read_b64_tr_b16 v[58:59], v3 offset:55808
    s_lshl_b32 s43, s43, 3
    s_add_u32 s43, s43, s60
    s_mul_i32 s43, s43, 7168
    s_lshl_b32 s44, s63, 7
    s_add_u32 s77, s43, s44
    s_lshl_b32 s43, s60, 13
    s_waitcnt vmcnt(2) lgkmcnt(2)
    v_mfma_f32_32x32x16_bf16 v[16:31], v[52:55], v[164:167], v[16:31]
    ds_read_b64_tr_b16 v[48:49], v3 offset:56320
    ds_read_b64_tr_b16 v[50:51], v3 offset:56832
    v_add_u32 v105, s43, v12
    v_xor_b32 v106, 0x80, v105
    v_and_b32 v13, 7, v0
    v_lshlrev_b32 v13, 4, v13
    s_lshl_b32 s43, s60, 7
    v_add_u32 v13, s43, v13
    v_bfe_u32 v14, v0, 3, 1
    s_waitcnt vmcnt(1) lgkmcnt(2)
    v_mfma_f32_32x32x16_bf16 v[16:31], v[56:59], v[168:171], v[16:31]
    v_lshlrev_b32 v15, 7, v14
    v_xor_b32 v13, v13, v15
    v_lshl_add_u32 v13, v14, 10, v13
    v_lshrrev_b32 v14, 4, v0
    v_lshl_add_u32 v13, v14, 11, v13
    v_add_u32 v111, 114688, v13
    s_waitcnt vmcnt(0) lgkmcnt(0)
    v_mfma_f32_32x32x16_bf16 v[16:31], v[48:51], v[172:175], v[16:31]
    s_nop 11
    v_cvt_pk_bf16_f32 v32, v16, v17
    v_cvt_pk_bf16_f32 v33, v18, v19
    v_cvt_pk_bf16_f32 v34, v20, v21
    v_cvt_pk_bf16_f32 v35, v22, v23
    v_cvt_pk_bf16_f32 v36, v24, v25
    v_cvt_pk_bf16_f32 v37, v26, v27
    v_cvt_pk_bf16_f32 v38, v28, v29
    v_cvt_pk_bf16_f32 v39, v30, v31
    buffer_store_dwordx4 v[32:35], v1, s[36:39], s5 offen sc1
    buffer_store_dwordx4 v[36:39], v1, s[36:39], s5 offen offset:1024 sc1
    v_pk_mul_f32 v[42:43], v[16:17], v[16:17]
    v_pk_fma_f32 v[42:43], v[18:19], v[18:19], v[42:43]
    v_pk_add_f32 v[16:17], v[16:17], v[18:19]
    v_pk_fma_f32 v[42:43], v[20:21], v[20:21], v[42:43]
    v_pk_add_f32 v[16:17], v[16:17], v[20:21]
    v_pk_fma_f32 v[42:43], v[22:23], v[22:23], v[42:43]
    v_pk_add_f32 v[16:17], v[16:17], v[22:23]
    v_pk_fma_f32 v[42:43], v[24:25], v[24:25], v[42:43]
    v_pk_add_f32 v[16:17], v[16:17], v[24:25]
    v_pk_fma_f32 v[42:43], v[26:27], v[26:27], v[42:43]
    v_pk_add_f32 v[16:17], v[16:17], v[26:27]
    v_pk_fma_f32 v[42:43], v[28:29], v[28:29], v[42:43]
    v_pk_add_f32 v[16:17], v[16:17], v[28:29]
    v_pk_fma_f32 v[42:43], v[30:31], v[30:31], v[42:43]
    v_pk_add_f32 v[16:17], v[16:17], v[30:31]
    v_add_f32 v40, v16, v17
    v_add_f32 v42, v42, v43
    s_nop 1
    v_permlane32_swap_b32 v40, v42
    v_add_f32 v40, v40, v42
    buffer_store_dword v40, v1, s[36:39], s6 offen sc1
    s_add_u32 s45, s56, 3
    v_mov_b32 v14, s45
    v_mov_b32 v15, s45
    s_waitcnt vmcnt(0)
    s_mov_b64 exec, 1
    buffer_store_dwordx2 v[14:15], v1, s[36:39], s7 offen sc1
    s_mov_b64 exec, -1
    v_add_u32 v3, 57344, v1
    s_barrier
    s_lshl_b32 s40, s59, 9
    s_add_u32 s40, s40, 1433600
    s_add_u32 s47, s56, 3
    s_mov_b32 s46, s66
L_poll_71:
    buffer_load_dwordx2 v[14:15], v107, s[36:39], s40 offen sc1
    s_waitcnt vmcnt(0)
    v_subrev_u32 v14, s47, v14
    v_subrev_u32 v15, s47, v15
    v_or_b32 v14, v14, v15
    v_cmp_lt_u32 vcc, 3, v14
    s_cbranch_vccz L_polled_70
    s_sub_u32 s46, s46, 1
    s_cmp_lg_u32 s46, 0
    s_cbranch_scc1 L_poll_71
    s_mov_b32 s66, 1
L_polled_70:
    s_mov_b32 m0, s15
    s_nop 0
    buffer_load_dwordx4 v110, s[36:39], m0 offen sc1 lds
    s_add_u32 m0, m0, 4096
    s_nop 0
    buffer_load_dwordx4 v110, s[36:39], m0 offen sc1 lds
    s_add_u32 m0, m0, 4096
    s_nop 0
    buffer_load_dwordx4 v110, s[36:39], m0 offen sc1 lds
    s_add_u32 m0, m0, 4096
    s_nop 0
    buffer_load_dwordx4 v110, s[36:39], m0 offen sc1 lds
    s_add_u32 m0, m0, 4096
    s_nop 0
    buffer_load_dwordx4 v110, s[36:39], m0 offen sc1 lds
    s_add_u32 m0, m0, 4096
    s_nop 0
    buffer_load_dwordx4 v110, s[36:39], m0 offen sc1 lds
    s_waitcnt vmcnt(4)
    s_barrier
    ds_read_b128 v[48:51], v1 offset:0
    ds_read_b128 v[52:55], v1 offset:1024
    ds_read_b128 v[56:59], v1 offset:2048
    ds_read_b128 v[60:63], v1 offset:3072
    s_waitcnt lgkmcnt(2)
    v_mfma_f32_32x32x16_bf16 v[16:31], a[224:227], v[48:51], 0
    ds_read_b128 v[64:67], v1 offset:4096
    s_add_u32 m0, m0, 4096
    s_nop 0
    buffer_load_dwordx4 v110, s[36:39], m0 offen sc1 lds
    v_mfma_f32_32x32x16_bf16 v[16:31], a[228:231], v[52:55], v[16:31]
    ds_read_b128 v[48:51], v1 offset:5120
    buffer_load_dwordx4 v[112:115], v1, s[36:39], s69 offen offset:0 sc1
    s_waitcnt lgkmcnt(2)
    v_mfma_f32_32x32x16_bf16 v[16:31], a[232:235], v[56:59], v[16:31]
    ds_read_b128 v[52:55], v1 offset:6144
    s_add_u32 m0, m0, 4096
    v_subrev_u32 v110, s16, v110
    buffer_load_dwordx4 v110, s[36:39], m0 offen sc1 lds
    v_mfma_f32_32x32x16_bf16 v[16:31], a[236:239], v[60:63], v[16:31]
    ds_read_b128 v[56:59], v1 offset:7168
    buffer_load_dwordx4 v[116:119], v1, s[36:39], s69 offen offset:1024 sc1
    s_waitcnt lgkmcnt(2)
    v_mfma_f32_32x32x16_bf16 v[16:31], a[240:243], v[64:67], v[16:31]
    s_waitcnt vmcnt(6)
    s_barrier
    ds_read_b128 v[60:63], v1 offset:8192
    v_mfma_f32_32x32x16_bf16 v[16:31], a[244:247], v[48:51], v[16:31]
    ds_read_b128 v[64:67], v1 offset:9216
    s_waitcnt lgkmcnt(2)
    v_mfma_f32_32x32x16_bf16 v[16:31], a[248:251], v[52:55], v[16:31]
    ds_read_b128 v[48:51], v1 offset:10240
    buffer_load_dwordx4 v[120:123], v1, s[36:39], s69 offen offset:2048 sc1
    v_mfma_f32_32x32x16_bf16 v[16:31], a[252:255], v[56:59], v[16:31]
    ds_read_b128 v[52:55], v1 offset:11264
    buffer_load_dwordx4 v[124:127], v1, s[36:39], s69 offen offset:3072 sc1
    s_waitcnt lgkmcnt(2)
    v_mfma_f32_32x32x16_bf16 v[16:31], v[176:179], v[60:63], v[16:31]
    ds_read_b128 v[56:59], v1 offset:12288
    v_mfma_f32_32x32x16_bf16 v[16:31], v[180:183], v[64:67], v[16:31]
    s_add_u32 m0, m0, 4096
    ds_read_b128 v[60:63], v1 offset:13312
    buffer_load_dwordx4 v110, s[36:39], m0 offen sc1 lds
    s_waitcnt lgkmcnt(2)
    v_mfma_f32_32x32x16_bf16 v[16:31], v[184:187], v[48:51], v[16:31]
    ds_read_b128 v[64:67], v1 offset:14336
    v_mfma_f32_32x32x16_bf16 v[16:31], v[188:191], v[52:55], v[16:31]
    s_add_u32 m0, m0, 4096
    ds_read_b128 v[48:51], v1 offset:15360
    buffer_load_dwordx4 v110, s[36:39], m0 offen sc1 lds
    s_waitcnt vmcnt(6)
    v_add_f32 v112, v112, v114
    v_add_f32 v113, v113, v115
    s_waitcnt vmcnt(4)
    v_add_f32 v112, v112, v116
    v_add_f32 v113, v113, v117
    s_waitcnt lgkmcnt(2)
    v_mfma_f32_32x32x16_bf16 v[16:31], v[192:195], v[56:59], v[16:31]
    s_barrier
    ds_read_b128 v[52:55], v1 offset:16384
    v_add_f32 v112, v112, v118
    v_add_f32 v113, v113, v119
    s_waitcnt vmcnt(3)
    v_add_f32 v112, v112, v120
    v_mfma_f32_32x32x16_bf16 v[16:31], v[196:199], v[60:63], v[16:31]
    s_add_u32 m0, m0, 4096
    ds_read_b128 v[56:59], v1 offset:17408
    buffer_load_dwordx4 v110, s[36:39], m0 offen sc1 lds
    v_add_f32 v113, v113, v121
    v_add_f32 v112, v112, v122
    v_add_f32 v113, v113, v123
    s_waitcnt vmcnt(3)
    v_add_f32 v112, v112, v124
    s_waitcnt lgkmcnt(2)
    v_mfma_f32_32x32x16_bf16 v[16:31], v[200:203], v[64:67], v[16:31]
    ds_read_b128 v[60:63], v1 offset:18432
    v_add_f32 v113, v113, v125
    v_add_f32 v112, v112, v113
    v_mov_b32 v113, v112
    s_nop 1
    v_permlane32_swap_b32 v112, v113
    v_mul_f32 v114, 0x3b124925, v112
    v_mul_f32 v115, 0x3b124925, v113
    v_mfma_f32_32x32x16_bf16 v[16:31], v[204:207], v[48:51], v[16:31]
    s_add_u32 m0, m0, 4096
    ds_read_b128 v[64:67], v1 offset:19456
    buffer_load_dwordx4 v110, s[36:39], m0 offen sc1 lds
    v_fma_f32 v115, -v114, v114, v115
    v_max_f32 v115, 0, v115
    v_add_f32 v115, 0x3727c5ac, v115
    v_cvt_pk_bf16_f32 v116, -v114, -v114
    s_waitcnt lgkmcnt(2)
    v_mfma_f32_32x32x16_bf16 v[16:31], v[208:211], v[52:55], v[16:31]
    ds_read_b128 v[48:51], v1 offset:20480
    v_and_b32 v113, s51, v116
    v_sub_f32_e64 v113, -v114, v113
    v_and_b32 v117, 0xffff, v116
    v_cvt_pk_bf16_f32 v113, v113, v113
    v_and_or_b32 v116, v113, s51, v117
    v_rsq_f32 v118, v115
    v_mfma_f32_32x32x16_bf16 v[16:31], v[212:215], v[56:59], v[16:31]
    s_add_u32 m0, m0, 4096
    ds_read_b128 v[52:55], v1 offset:21504
    buffer_load_dwordx4 v110, s[36:39], m0 offen sc1 lds
    v_sqrt_f32 v119, v115
    v_mul_f32_e64 v118, -v118, s49
    s_waitcnt lgkmcnt(2)
    v_mfma_f32_32x32x16_bf16 v[16:31], v[216:219], v[60:63], v[16:31]
    ds_read_b128 v[56:59], v1 offset:22528
    ds_write_b128 v109, v[116:119]
    v_mfma_f32_32x32x16_bf16 v[16:31], v[220:223], v[64:67], v[16:31]
    s_add_u32 m0, m0, 4096
    ds_read_b128 v[60:63], v1 offset:23552
    buffer_load_dwordx4 v110, s[36:39], m0 offen sc1 lds
    s_waitcnt lgkmcnt(3)
    v_mfma_f32_32x32x16_bf16 v[16:31], v[224:227], v[48:51], v[16:31]
    s_waitcnt vmcnt(4)
    s_waitcnt lgkmcnt(1)
    s_barrier
    ds_read_b128 v[64:67], v1 offset:24576
    ds_read_b128 v[68:71], v108 offset:0
    ds_read_b128 v[72:75], v108 offset:512
    ds_read_b128 v[76:79], v108 offset:1024
    ds_read_b128 v[80:83], v108 offset:1536
    v_mfma_f32_32x32x16_bf16 v[16:31], v[228:231], v[52:55], v[16:31]
    s_add_u32 m0, m0, 4096
    v_add_u32 v110, s16, v110
    ds_read_b128 v[48:51], v1 offset:25600
    buffer_load_dwordx4 v110, s[36:39], m0 offen sc1 lds
    s_waitcnt lgkmcnt(6)
    v_mfma_f32_32x32x16_bf16 v[16:31], v[232:235], v[56:59], v[16:31]
    ds_read_b128 v[52:55], v1 offset:26624
    v_mfma_f32_32x32x16_bf16 v[16:31], v[236:239], v[60:63], v[16:31]
    s_add_u32 m0, m0, 4096
    ds_read_b128 v[56:59], v1 offset:27648
    buffer_load_dwordx4 v110, s[36:39], m0 offen sc1 lds
    s_waitcnt lgkmcnt(2)
    v_mfma_f32_32x32x16_bf16 v[16:31], v[240:243], v[64:67], v[16:31]
    ds_read_b128 v[60:63], v1 offset:28672
    v_mov_b32 v88, v68
    v_mov_b32 v89, v69
    v_mfma_f32_32x32x16_bf16 v[16:31], v[244:247], v[48:51], v[16:31]
    s_add_u32 m0, m0, 4096
    ds_read_b128 v[64:67], v1 offset:29696
    buffer_load_dwordx4 v110, s[36:39], m0 offen sc1 lds
    s_waitcnt lgkmcnt(2)
    v_mfma_f32_32x32x16_bf16 v[16:31], v[248:251], v[52:55], v[16:31]
    ds_read_b128 v[48:51], v1 offset:30720
    v_mfma_f32_32x32x16_bf16 v[16:31], v[252:255], v[56:59], v[16:31]
    s_add_u32 m0, m0, 4096
    ds_read_b128 v[52:55], v1 offset:31744
    buffer_load_dwordx4 v110, s[36:39], m0 offen sc1 lds
    v_mfma_f32_32x32x16_bf16 v[16:31], v[84:87], v[88:91], v[16:31]
    s_waitcnt lgkmcnt(2)
    v_mfma_f32_32x32x16_bf16 v[32:47], a[224:227], v[60:63], 0
    ds_read_b128 v[56:59], v1 offset:32768
    v_mfma_f32_32x32x16_bf16 v[32:47], a[228:231], v[64:67], v[32:47]
    s_add_u32 m0, m0, 4096
    ds_read_b128 v[60:63], v1 offset:33792
    buffer_load_dwordx4 v110, s[36:39], m0 offen sc1 lds
    s_waitcnt lgkmcnt(2)
    v_mfma_f32_32x32x16_bf16 v[32:47], a[232:235], v[48:51], v[32:47]
    ds_read_b128 v[64:67], v1 offset:34816
    s_nop 1
    v_mul_f32 v92, v16, v70
    v_mul_f32 v93, v17, v70
    v_exp_f32 v92, v92
    v_exp_f32 v93, v93
    v_mfma_f32_32x32x16_bf16 v[32:47], a[236:239], v[52:55], v[32:47]
    s_add_u32 m0, m0, 4096
    ds_read_b128 v[48:51], v1 offset:35840
    buffer_load_dwordx4 v110, s[36:39], m0 offen sc1 lds
    v_fma_f32 v92, v92, v71, v71
    v_fma_f32 v93, v93, v71, v71
    v_rcp_f32 v92, v92
    s_waitcnt lgkmcnt(2)
    v_mfma_f32_32x32x16_bf16 v[32:47], a[240:243], v[56:59], v[32:47]
    ds_read_b128 v[52:55], v1 offset:36864
    v_rcp_f32 v93, v93
    v_mul_f32 v16, v16, v92
    v_mul_f32 v17, v17, v93
    v_cvt_pk_bf16_f32 v96, v16, v17
    v_mfma_f32_32x32x16_bf16 v[32:47], a[244:247], v[60:63], v[32:47]
    s_add_u32 m0, m0, 4096
    ds_read_b128 v[56:59], v1 offset:37888
    buffer_load_dwordx4 v110, s[36:39], m0 offen sc1 lds
    v_mul_f32 v94, v18, v70
    v_mul_f32 v95, v19, v70
    v_exp_f32 v94, v94
    s_waitcnt lgkmcnt(2)
    v_mfma_f32_32x32x16_bf16 v[32:47], a[248:251], v[64:67], v[32:47]
    ds_read_b128 v[60:63], v1 offset:38912
    v_exp_f32 v95, v95
    v_fma_f32 v94, v94, v71, v71
    v_fma_f32 v95, v95, v71, v71
    v_rcp_f32 v94, v94
    v_mfma_f32_32x32x16_bf16 v[32:47], a[252:255], v[48:51], v[32:47]
    s_add_u32 m0, m0, 4096
    v_subrev_u32 v110, s16, v110
    ds_read_b128 v[64:67], v1 offset:39936
    buffer_load_dwordx4 v110, s[36:39], m0 offen sc1 lds
    v_rcp_f32 v95, v95
    s_waitcnt lgkmcnt(2)
    v_mfma_f32_32x32x16_bf16 v[32:47], v[176:179], v[52:55], v[32:47]
    s_waitcnt vmcnt(6)
    s_barrier
    ds_read_b128 v[48:51], v1 offset:40960
    v_mul_f32 v18, v18, v94
    v_mul_f32 v19, v19, v95
    v_mfma_f32_32x32x16_bf16 v[32:47], v[180:183], v[56:59], v[32:47]
    s_add_u32 m0, m0, 4096
    ds_read_b128 v[52:55], v1 offset:41984
    buffer_load_dwordx4 v110, s[36:39], m0 offen sc1 lds
    v_cvt_pk_bf16_f32 v97, v18, v19
    v_mul_f32 v92, v20, v70
    v_mul_f32 v93, v21, v70
    s_waitcnt lgkmcnt(2)
    v_mfma_f32_32x32x16_bf16 v[32:47], v[184:187], v[60:63], v[32:47]
    ds_read_b128 v[56:59], v1 offset:43008
    v_exp_f32 v92, v92
    v_exp_f32 v93, v93
    v_fma_f32 v92, v92, v71, v71
    v_fma_f32 v93, v93, v71, v71
    v_mfma_f32_32x32x16_bf16 v[32:47], v[188:191], v[64:67], v[32:47]
    s_add_u32 m0, m0, 4096
    ds_read_b128 v[60:63], v1 offset:44032
    buffer_load_dwordx4 v110, s[36:39], m0 offen sc1 lds
    v_rcp_f32 v92, v92
    v_rcp_f32 v93, v93
    s_waitcnt lgkmcnt(2)
    v_mfma_f32_32x32x16_bf16 v[32:47], v[192:195], v[48:51], v[32:47]
    ds_read_b128 v[64:67], v1 offset:45056
    v_mul_f32 v20, v20, v92
    v_mul_f32 v21, v21, v93
    v_cvt_pk_bf16_f32 v98, v20, v21
    v_mul_f32 v94, v22, v70
    v_mul_f32 v95, v23, v70
    v_mfma_f32_32x32x16_bf16 v[32:47], v[196:199], v[52:55], v[32:47]
    s_add_u32 m0, m0, 4096
    ds_read_b128 v[48:51], v1 offset:46080
    buffer_load_dwordx4 v110, s[36:39], m0 offen sc1 lds
    v_exp_f32 v94, v94
    v_exp_f32 v95, v95
    s_waitcnt lgkmcnt(2)
    v_mfma_f32_32x32x16_bf16 v[32:47], v[200:203], v[56:59], v[32:47]
    ds_read_b128 v[52:55], v1 offset:47104
    v_fma_f32 v94, v94, v71, v71
    v_fma_f32 v95, v95, v71, v71
    v_rcp_f32 v94, v94
    v_rcp_f32 v95, v95
    v_mfma_f32_32x32x16_bf16 v[32:47], v[204:207], v[60:63], v[32:47]
    s_add_u32 m0, m0, 4096
    ds_read_b128 v[56:59], v1 offset:48128
    buffer_load_dwordx4 v110, s[36:39], m0 offen sc1 lds
    v_mul_f32 v22, v22, v94
    v_mul_f32 v23, v23, v95
    s_waitcnt lgkmcnt(2)
    v_mfma_f32_32x32x16_bf16 v[32:47], v[208:211], v[64:67], v[32:47]
    ds_read_b128 v[60:63], v1 offset:49152
    v_cvt_pk_bf16_f32 v99, v22, v23
    v_mul_f32 v92, v24, v70
    v_mul_f32 v93, v25, v70
    v_exp_f32 v92, v92
    v_exp_f32 v93, v93
    v_mfma_f32_32x32x16_bf16 v[32:47], v[212:215], v[48:51], v[32:47]
    s_add_u32 m0, m0, 4096
    ds_read_b128 v[64:67], v1 offset:50176
    buffer_load_dwordx4 v110, s[36:39], m0 offen sc1 lds
    v_fma_f32 v92, v92, v71, v71
    v_fma_f32 v93, v93, v71, v71
    s_waitcnt lgkmcnt(2)
    v_mfma_f32_32x32x16_bf16 v[32:47], v[216:219], v[52:55], v[32:47]
    ds_read_b128 v[48:51], v1 offset:51200
    v_rcp_f32 v92, v92
    v_rcp_f32 v93, v93
    v_mul_f32 v24, v24, v92
    v_mul_f32 v25, v25, v93
    v_mfma_f32_32x32x16_bf16 v[32:47], v[220:223], v[56:59], v[32:47]
    s_add_u32 m0, m0, 4096
    ds_read_b128 v[52:55], v1 offset:52224
    buffer_load_dwordx4 v110, s[36:39], m0 offen sc1 lds
    v_cvt_pk_bf16_f32 v100, v24, v25
    v_mul_f32 v94, v26, v70
    v_mul_f32 v95, v27, v70
    s_waitcnt lgkmcnt(2)
    v_mfma_f32_32x32x16_bf16 v[32:47], v[224:227], v[60:63], v[32:47]
    ds_read_b128 v[56:59], v1 offset:53248
    v_exp_f32 v94, v94
    v_exp_f32 v95, v95
    v_fma_f32 v94, v94, v71, v71
    v_fma_f32 v95, v95, v71, v71
    v_mfma_f32_32x32x16_bf16 v[32:47], v[228:231], v[64:67], v[32:47]
    ds_read_b128 v[60:63], v1 offset:54272
    v_rcp_f32 v94, v94
    v_rcp_f32 v95, v95
    v_mul_f32 v26, v26, v94
    v_mul_f32 v27, v27, v95
    v_cvt_pk_bf16_f32 v101, v26, v27
    v_mul_f32 v92, v28, v70
    s_waitcnt lgkmcnt(2)
    v_mfma_f32_32x32x16_bf16 v[32:47], v[232:235], v[48:51], v[32:47]
    ds_read_b128 v[64:67], v1 offset:55296
    v_mul_f32 v93, v29, v70
    v_exp_f32 v92, v92
    v_exp_f32 v93, v93
    v_fma_f32 v92, v92, v71, v71
    v_mfma_f32_32x32x16_bf16 v[32:47], v[236:239], v[52:55], v[32:47]
    ds_read_b128 v[48:51], v1 offset:56320
    v_fma_f32 v93, v93, v71, v71
    v_rcp_f32 v92, v92
    v_rcp_f32 v93, v93
    v_mul_f32 v28, v28, v92
    v_mul_f32 v29, v29, v93
    s_waitcnt lgkmcnt(2)
    v_mfma_f32_32x32x16_bf16 v[32:47], v[240:243], v[56:59], v[32:47]
    ds_read_b128 v[52:55], v3 offset:0
    v_mov_b32 v88, v72
    v_mov_b32 v89, v73
    v_cvt_pk_bf16_f32 v102, v28, v29
    v_mul_f32 v94, v30, v70
    v_mul_f32 v95, v31, v70
    v_exp_f32 v94, v94
    v_mfma_f32_32x32x16_bf16 v[32:47], v[244:247], v[60:63], v[32:47]
    ds_read_b128 v[56:59], v3 offset:1024
    v_exp_f32 v95, v95
    v_fma_f32 v94, v94, v71, v71
    v_fma_f32 v95, v95, v71, v71
    v_rcp_f32 v94, v94
    s_waitcnt lgkmcnt(2)
    v_mfma_f32_32x32x16_bf16 v[32:47], v[248:251], v[64:67], v[32:47]
    ds_read_b128 v[60:63], v3 offset:2048
    v_rcp_f32 v95, v95
    v_mul_f32 v30, v30, v94
    v_mul_f32 v31, v31, v95
    v_cvt_pk_bf16_f32 v103, v30, v31
    v_mfma_f32_32x32x16_bf16 v[32:47], v[252:255], v[48:51], v[32:47]
    ds_read_b128 v[64:67], v3 offset:3072
    s_add_u32 s40, s3, 0
    buffer_store_dwordx4 v[96:99], v1, s[36:39], s40 offen sc1
    buffer_store_dwordx4 v[100:103], v1, s[36:39], s40 offen offset:1024 sc1
    v_mfma_f32_32x32x16_bf16 v[32:47], v[84:87], v[88:91], v[32:47]
    s_waitcnt lgkmcnt(2)
    v_mfma_f32_32x32x16_bf16 v[16:31], a[224:227], v[52:55], 0
    ds_read_b128 v[48:51], v3 offset:4096
    v_mfma_f32_32x32x16_bf16 v[16:31], a[228:231], v[56:59], v[16:31]
    ds_read_b128 v[52:55], v3 offset:5120
    s_waitcnt lgkmcnt(2)
    v_mfma_f32_32x32x16_bf16 v[16:31], a[232:235], v[60:63], v[16:31]
    ds_read_b128 v[56:59], v3 offset:6144
    s_nop 3
    v_mul_f32 v92, v32, v74
    v_mul_f32 v93, v33, v74
    v_exp_f32 v92, v92
    v_exp_f32 v93, v93
    v_mfma_f32_32x32x16_bf16 v[16:31], a[236:239], v[64:67], v[16:31]
    ds_read_b128 v[60:63], v3 offset:7168
    v_fma_f32 v92, v92, v75, v75
    v_fma_f32 v93, v93, v75, v75
    v_rcp_f32 v92, v92
    v_rcp_f32 v93, v93
    s_waitcnt lgkmcnt(2)
    v_mfma_f32_32x32x16_bf16 v[16:31], a[240:243], v[48:51], v[16:31]
    s_waitcnt vmcnt(8)
    s_barrier
    ds_read_b128 v[64:67], v3 offset:8192
    v_mul_f32 v32, v32, v92
    v_mfma_f32_32x32x16_bf16 v[16:31], a[244:247], v[52:55], v[16:31]
    ds_read_b128 v[48:51], v3 offset:9216
    v_mul_f32 v33, v33, v93
    v_cvt_pk_bf16_f32 v96, v32, v33
    v_mul_f32 v94, v34, v74
    v_mul_f32 v95, v35, v74
    v_exp_f32 v94, v94
    s_waitcnt lgkmcnt(2)
    v_mfma_f32_32x32x16_bf16 v[16:31], a[248:251], v[56:59], v[16:31]
    ds_read_b128 v[52:55], v3 offset:10240
    v_exp_f32 v95, v95
    v_fma_f32 v94, v94, v75, v75
    v_fma_f32 v95, v95, v75, v75
    v_mfma_f32_32x32x16_bf16 v[16:31], a[252:255], v[60:63], v[16:31]
    ds_read_b128 v[56:59], v3 offset:11264
    v_rcp_f32 v94, v94
    v_rcp_f32 v95, v95
    v_mul_f32 v34, v34, v94
    v_mul_f32 v35, v35, v95
    v_cvt_pk_bf16_f32 v97, v34, v35
    s_waitcnt lgkmcnt(2)
    v_mfma_f32_32x32x16_bf16 v[16:31], v[176:179], v[64:67], v[16:31]
    ds_read_b128 v[60:63], v3 offset:12288
    v_mul_f32 v92, v36, v74
    v_mul_f32 v93, v37, v74
    v_exp_f32 v92, v92
    v_mfma_f32_32x32x16_bf16 v[16:31], v[180:183], v[48:51], v[16:31]
    ds_read_b128 v[64:67], v3 offset:13312
    v_exp_f32 v93, v93
    v_fma_f32 v92, v92, v75, v75
    v_fma_f32 v93, v93, v75, v75
    v_rcp_f32 v92, v92
    s_waitcnt lgkmcnt(2)
    v_mfma_f32_32x32x16_bf16 v[16:31], v[184:187], v[52:55], v[16:31]
    ds_read_b128 v[48:51], v3 offset:14336
    v_rcp_f32 v93, v93
    v_mul_f32 v36, v36, v92
    v_mul_f32 v37, v37, v93
    v_cvt_pk_bf16_f32 v98, v36, v37
    v_mul_f32 v94, v38, v74
    v_mfma_f32_32x32x16_bf16 v[16:31], v[188:191], v[56:59], v[16:31]
    ds_read_b128 v[52:55], v3 offset:15360
    v_mul_f32 v95, v39, v74
    v_exp_f32 v94, v94
    v_exp_f32 v95, v95
    v_fma_f32 v94, v94, v75, v75
    s_waitcnt lgkmcnt(2)
    v_mfma_f32_32x32x16_bf16 v[16:31], v[192:195], v[60:63], v[16:31]
    ds_read_b128 v[56:59], v3 offset:16384
    v_fma_f32 v95, v95, v75, v75
    v_rcp_f32 v94, v94
    v_rcp_f32 v95, v95
    v_mfma_f32_32x32x16_bf16 v[16:31], v[196:199], v[64:67], v[16:31]
    ds_read_b128 v[60:63], v3 offset:17408
    v_mul_f32 v38, v38, v94
    v_mul_f32 v39, v39, v95
    v_cvt_pk_bf16_f32 v99, v38, v39
    v_mul_f32 v92, v40, v74
    v_mul_f32 v93, v41, v74
    s_waitcnt lgkmcnt(2)
    v_mfma_f32_32x32x16_bf16 v[16:31], v[200:203], v[48:51], v[16:31]
    ds_read_b128 v[64:67], v3 offset:18432
    s_add_u32 s41, s2, 0
    s_add_u32 s42, s56, 2
    v_mov_b32 v14, s42
    s_waitcnt vmcnt(0)
    s_mov_b64 exec, 1
    buffer_store_dword v14, v1, s[36:39], s41 offen sc1
    s_mov_b64 exec, -1
    v_mfma_f32_32x32x16_bf16 v[16:31], v[204:207], v[52:55], v[16:31]
    ds_read_b128 v[48:51], v3 offset:19456
    v_exp_f32 v92, v92
    v_exp_f32 v93, v93
    v_fma_f32 v92, v92, v75, v75
    v_fma_f32 v93, v93, v75, v75
    s_waitcnt lgkmcnt(2)
    v_mfma_f32_32x32x16_bf16 v[16:31], v[208:211], v[56:59], v[16:31]
    ds_read_b128 v[52:55], v3 offset:20480
    v_rcp_f32 v92, v92
    v_rcp_f32 v93, v93
    v_mul_f32 v40, v40, v92
    v_mul_f32 v41, v41, v93
    v_mfma_f32_32x32x16_bf16 v[16:31], v[212:215], v[60:63], v[16:31]
    ds_read_b128 v[56:59], v3 offset:21504
    v_cvt_pk_bf16_f32 v100, v40, v41
    v_mul_f32 v94, v42, v74
    v_mul_f32 v95, v43, v74
    v_exp_f32 v94, v94
    s_waitcnt lgkmcnt(2)
    v_mfma_f32_32x32x16_bf16 v[16:31], v[216:219], v[64:67], v[16:31]
    ds_read_b128 v[60:63], v3 offset:22528
    v_exp_f32 v95, v95
    v_fma_f32 v94, v94, v75, v75
    v_fma_f32 v95, v95, v75, v75
    v_rcp_f32 v94, v94
    v_mfma_f32_32x32x16_bf16 v[16:31], v[220:223], v[48:51], v[16:31]
    ds_read_b128 v[64:67], v3 offset:23552
    v_rcp_f32 v95, v95
    v_mul_f32 v42, v42, v94
    v_mul_f32 v43, v43, v95
    v_cvt_pk_bf16_f32 v101, v42, v43
    s_waitcnt lgkmcnt(2)
    v_mfma_f32_32x32x16_bf16 v[16:31], v[224:227], v[52:55], v[16:31]
    ds_read_b128 v[48:51], v3 offset:24576
    v_mul_f32 v92, v44, v74
    v_mul_f32 v93, v45, v74
    v_exp_f32 v92, v92
    v_exp_f32 v93, v93
    v_mfma_f32_32x32x16_bf16 v[16:31], v[228:231], v[56:59], v[16:31]
    ds_read_b128 v[52:55], v3 offset:25600
    v_fma_f32 v92, v92, v75, v75
    v_fma_f32 v93, v93, v75, v75
    v_rcp_f32 v92, v92
    v_rcp_f32 v93, v93
    s_waitcnt lgkmcnt(2)
    v_mfma_f32_32x32x16_bf16 v[16:31], v[232:235], v[60:63], v[16:31]
    ds_read_b128 v[56:59], v3 offset:26624
    v_mul_f32 v44, v44, v92
    v_mul_f32 v45, v45, v93
    v_cvt_pk_bf16_f32 v102, v44, v45
    v_mul_f32 v94, v46, v74
    v_mfma_f32_32x32x16_bf16 v[16:31], v[236:239], v[64:67], v[16:31]
    ds_read_b128 v[60:63], v3 offset:27648
    v_mul_f32 v95, v47, v74
    v_exp_f32 v94, v94
    v_exp_f32 v95, v95
    v_fma_f32 v94, v94, v75, v75
    s_waitcnt lgkmcnt(2)
    v_mfma_f32_32x32x16_bf16 v[16:31], v[240:243], v[48:51], v[16:31]
    ds_read_b128 v[64:67], v3 offset:28672
    v_mov_b32 v88, v76
    v_mov_b32 v89, v77
    v_fma_f32 v95, v95, v75, v75
    v_rcp_f32 v94, v94
    v_mfma_f32_32x32x16_bf16 v[16:31], v[244:247], v[52:55], v[16:31]
    ds_read_b128 v[48:51], v3 offset:29696
    v_rcp_f32 v95, v95
    v_mul_f32 v46, v46, v94
    v_mul_f32 v47, v47, v95
    v_cvt_pk_bf16_f32 v103, v46, v47
    s_waitcnt lgkmcnt(2)
    v_mfma_f32_32x32x16_bf16 v[16:31], v[248:251], v[56:59], v[16:31]
    ds_read_b128 v[52:55], v3 offset:30720
    s_add_u32 s70, s74, 0
    buffer_load_dword v109, v104, s[36:39], s70 offen sc1
    v_mfma_f32_32x32x16_bf16 v[16:31], v[252:255], v[60:63], v[16:31]
    ds_read_b128 v[56:59], v3 offset:31744
    s_add_u32 s40, s17, 229376
    buffer_store_dwordx4 v[96:99], v1, s[36:39], s40 offen sc1
    buffer_store_dwordx4 v[100:103], v1, s[36:39], s40 offen offset:1024 sc1
    v_mfma_f32_32x32x16_bf16 v[16:31], v[84:87], v[88:91], v[16:31]
    s_waitcnt lgkmcnt(2)
    v_mfma_f32_32x32x16_bf16 v[32:47], a[224:227], v[64:67], 0
    s_barrier
    ds_read_b128 v[60:63], v3 offset:32768
    v_mfma_f32_32x32x16_bf16 v[32:47], a[228:231], v[48:51], v[32:47]
    ds_read_b128 v[64:67], v3 offset:33792
    s_waitcnt lgkmcnt(2)
    v_mfma_f32_32x32x16_bf16 v[32:47], a[232:235], v[52:55], v[32:47]
    ds_read_b128 v[48:51], v3 offset:34816
    s_nop 2
    v_mul_f32 v92, v16, v78
    v_mul_f32 v93, v17, v78
    v_exp_f32 v92, v92
    v_exp_f32 v93, v93
    v_fma_f32 v92, v92, v79, v79
    v_mfma_f32_32x32x16_bf16 v[32:47], a[236:239], v[56:59], v[32:47]
    ds_read_b128 v[52:55], v3 offset:35840
    v_fma_f32 v93, v93, v79, v79
    v_rcp_f32 v92, v92
    v_rcp_f32 v93, v93
    v_mul_f32 v16, v16, v92
    v_mul_f32 v17, v17, v93
    s_waitcnt lgkmcnt(2)
    v_mfma_f32_32x32x16_bf16 v[32:47], a[240:243], v[60:63], v[32:47]
    ds_read_b128 v[56:59], v3 offset:36864
    s_add_u32 s47, s56, 2
    s_waitcnt vmcnt(2)
    v_subrev_u32 v109, s47, v109
    v_cmp_lt_u32 vcc, 3, v109
    s_cbranch_vccnz L_aspin_72
L_aback_73:
    v_cvt_pk_bf16_f32 v96, v16, v17
    v_mul_f32 v94, v18, v78
    v_mul_f32 v95, v19, v78
    v_mfma_f32_32x32x16_bf16 v[32:47], a[244:247], v[64:67], v[32:47]
    ds_read_b128 v[60:63], v3 offset:37888
    s_add_u32 s79, s73, 0
    v_add_u32 v15, s79, v1
    buffer_load_dwordx4 v[112:115], v15, s[36:39], s8 offen offset:0 sc1
    v_exp_f32 v94, v94
    s_waitcnt lgkmcnt(2)
    v_mfma_f32_32x32x16_bf16 v[32:47], a[248:251], v[48:51], v[32:47]
    ds_read_b128 v[64:67], v3 offset:38912
    buffer_load_dwordx4 v[116:119], v15, s[36:39], s8 offen offset:1024 sc1
    v_exp_f32 v95, v95
    v_fma_f32 v94, v94, v79, v79
    v_mfma_f32_32x32x16_bf16 v[32:47], a[252:255], v[52:55], v[32:47]
    ds_read_b128 v[48:51], v3 offset:39936
    v_fma_f32 v95, v95, v79, v79
    v_rcp_f32 v94, v94
    v_rcp_f32 v95, v95
    v_mul_f32 v18, v18, v94
    v_mul_f32 v19, v19, v95
    s_waitcnt lgkmcnt(2)
    v_mfma_f32_32x32x16_bf16 v[32:47], v[176:179], v[56:59], v[32:47]
    ds_read_b128 v[52:55], v3 offset:40960
    buffer_load_dwordx4 v[120:123], v15, s[36:39], s9 offen offset:0 sc1
    v_cvt_pk_bf16_f32 v97, v18, v19
    v_mul_f32 v92, v20, v78
    v_mul_f32 v93, v21, v78
    v_mfma_f32_32x32x16_bf16 v[32:47], v[180:183], v[60:63], v[32:47]
    ds_read_b128 v[56:59], v3 offset:41984
    v_exp_f32 v92, v92
    v_exp_f32 v93, v93
    v_fma_f32 v92, v92, v79, v79
    v_fma_f32 v93, v93, v79, v79
    v_rcp_f32 v92, v92
    s_waitcnt lgkmcnt(2)
    v_mfma_f32_32x32x16_bf16 v[32:47], v[184:187], v[64:67], v[32:47]
    ds_read_b128 v[60:63], v3 offset:43008
    buffer_load_dwordx4 v[124:127], v15, s[36:39], s9 offen offset:1024 sc1
    v_rcp_f32 v93, v93
    v_mul_f32 v20, v20, v92
    v_mfma_f32_32x32x16_bf16 v[32:47], v[188:191], v[48:51], v[32:47]
    ds_read_b128 v[64:67], v3 offset:44032
    v_mul_f32 v21, v21, v93
    v_cvt_pk_bf16_f32 v98, v20, v21
    v_mul_f32 v94, v22, v78
    v_mul_f32 v95, v23, v78
    v_exp_f32 v94, v94
    v_exp_f32 v95, v95
    s_waitcnt lgkmcnt(2)
    v_mfma_f32_32x32x16_bf16 v[32:47], v[192:195], v[52:55], v[32:47]
    ds_read_b128 v[48:51], v3 offset:45056
    buffer_load_dwordx4 v[128:131], v15, s[36:39], s10 offen offset:0 sc1
    v_fma_f32 v94, v94, v79, v79
    v_fma_f32 v95, v95, v79, v79
    v_mfma_f32_32x32x16_bf16 v[32:47], v[196:199], v[56:59], v[32:47]
    ds_read_b128 v[52:55], v3 offset:46080
    v_rcp_f32 v94, v94
    v_rcp_f32 v95, v95
    v_mul_f32 v22, v22, v94
    v_mul_f32 v23, v23, v95
    v_cvt_pk_bf16_f32 v99, v22, v23
    v_mul_f32 v92, v24, v78
    s_waitcnt lgkmcnt(2)
    v_mfma_f32_32x32x16_bf16 v[32:47], v[200:203], v[60:63], v[32:47]
    ds_read_b128 v[56:59], v3 offset:47104
    s_add_u32 s41, s1, 512
    s_add_u32 s42, s56, 2
    v_mov_b32 v14, s42
    s_waitcnt vmcnt(5)
    s_mov_b64 exec, 1
    buffer_store_dword v14, v1, s[36:39], s41 offen sc1
    s_mov_b64 exec, -1
    buffer_load_dwordx4 v[132:135], v15, s[36:39], s10 offen offset:1024 sc1
    v_mfma_f32_32x32x16_bf16 v[32:47], v[204:207], v[64:67], v[32:47]
    ds_read_b128 v[60:63], v3 offset:48128
    v_mul_f32 v93, v25, v78
    v_exp_f32 v92, v92
    v_exp_f32 v93, v93
    v_fma_f32 v92, v92, v79, v79
    v_fma_f32 v93, v93, v79, v79
    s_waitcnt lgkmcnt(2)
    v_mfma_f32_32x32x16_bf16 v[32:47], v[208:211], v[48:51], v[32:47]
    ds_read_b128 v[64:67], v3 offset:49152
    buffer_load_dwordx4 v[136:139], v15, s[36:39], s11 offen offset:0 sc1
    v_rcp_f32 v92, v92
    v_rcp_f32 v93, v93
    v_mfma_f32_32x32x16_bf16 v[32:47], v[212:215], v[52:55], v[32:47]
    ds_read_b128 v[48:51], v3 offset:50176
    buffer_load_dwordx4 v[140:143], v15, s[36:39], s11 offen offset:1024 sc1
    v_mul_f32 v24, v24, v92
    v_mul_f32 v25, v25, v93
    v_cvt_pk_bf16_f32 v100, v24, v25
    s_waitcnt lgkmcnt(2)
    v_mfma_f32_32x32x16_bf16 v[32:47], v[216:219], v[56:59], v[32:47]
    ds_read_b128 v[52:55], v3 offset:51200
    v_mul_f32 v94, v26, v78
    v_mul_f32 v95, v27, v78
    v_exp_f32 v94, v94
    v_exp_f32 v95, v95
    v_fma_f32 v94, v94, v79, v79
    v_mfma_f32_32x32x16_bf16 v[32:47], v[220:223], v[60:63], v[32:47]
    ds_read_b128 v[56:59], v3 offset:52224
    buffer_load_dwordx4 v[144:147], v15, s[36:39], s12 offen offset:0 sc1
    v_fma_f32 v95, v95, v79, v79
    v_rcp_f32 v94, v94
    s_waitcnt lgkmcnt(2)
    v_mfma_f32_32x32x16_bf16 v[32:47], v[224:227], v[64:67], v[32:47]
    ds_read_b128 v[60:63], v3 offset:53248
    v_rcp_f32 v95, v95
    v_mul_f32 v26, v26, v94
    v_mul_f32 v27, v27, v95
    v_cvt_pk_bf16_f32 v101, v26, v27
    v_mul_f32 v92, v28, v78
    v_mul_f32 v93, v29, v78
    v_mfma_f32_32x32x16_bf16 v[32:47], v[228:231], v[48:51], v[32:47]
    ds_read_b128 v[64:67], v3 offset:54272
    buffer_load_dwordx4 v[148:151], v15, s[36:39], s12 offen offset:1024 sc1
    v_exp_f32 v92, v92
    v_exp_f32 v93, v93
    s_waitcnt lgkmcnt(2)
    v_mfma_f32_32x32x16_bf16 v[32:47], v[232:235], v[52:55], v[32:47]
    ds_read_b128 v[48:51], v3 offset:55296
    v_fma_f32 v92, v92, v79, v79
    v_fma_f32 v93, v93, v79, v79
    v_rcp_f32 v92, v92
    v_rcp_f32 v93, v93
    v_mul_f32 v28, v28, v92
    v_mfma_f32_32x32x16_bf16 v[32:47], v[236:239], v[56:59], v[32:47]
    ds_read_b128 v[52:55], v3 offset:56320
    buffer_load_dwordx4 v[152:155], v15, s[36:39], s13 offen offset:0 sc1
    v_mul_f32 v29, v29, v93
    v_cvt_pk_bf16_f32 v102, v28, v29
    v_mul_f32 v94, v30, v78
    v_mul_f32 v95, v31, v78
    s_waitcnt lgkmcnt(2)
    v_mfma_f32_32x32x16_bf16 v[32:47], v[240:243], v[60:63], v[32:47]
    v_mov_b32 v88, v80
    v_mov_b32 v89, v81
    v_exp_f32 v94, v94
    v_exp_f32 v95, v95
    v_fma_f32 v94, v94, v79, v79
    v_mfma_f32_32x32x16_bf16 v[32:47], v[244:247], v[64:67], v[32:47]
    buffer_load_dwordx4 v[156:159], v15, s[36:39], s13 offen offset:1024 sc1
    v_fma_f32 v95, v95, v79, v79
    v_rcp_f32 v94, v94
    v_rcp_f32 v95, v95
    s_waitcnt lgkmcnt(0)
    v_mfma_f32_32x32x16_bf16 v[32:47], v[248:251], v[48:51], v[32:47]
    v_mul_f32 v30, v30, v94
    v_mul_f32 v31, v31, v95
    v_cvt_pk_bf16_f32 v103, v30, v31
    s_add_u32 s40, s3, 114688
    buffer_store_dwordx4 v[96:99], v1, s[36:39], s40 offen sc1
    buffer_store_dwordx4 v[100:103], v1, s[36:39], s40 offen offset:1024 sc1
    v_mfma_f32_32x32x16_bf16 v[32:47], v[252:255], v[52:55], v[32:47]
    v_mfma_f32_32x32x16_bf16 v[32:47], v[84:87], v[88:91], v[32:47]
    s_nop 11
    v_pk_mul_f32 v[92:93], v[32:33], v[82:83] op_sel_hi:[1,0]
    s_xor_b32 s71, s74, 4
    buffer_load_dword v13, v104, s[36:39], s71 offen sc1
    v_pk_mul_f32 v[94:95], v[34:35], v[82:83] op_sel_hi:[1,0]
    v_exp_f32 v92, v92
    v_exp_f32 v93, v93
    v_exp_f32 v94, v94
    v_exp_f32 v95, v95
    v_pk_fma_f32 v[92:93], v[92:93], v[82:83], v[82:83] op_sel:[0,1,1] op_sel_hi:[1,1,1]
    v_pk_fma_f32 v[94:95], v[94:95], v[82:83], v[82:83] op_sel:[0,1,1] op_sel_hi:[1,1,1]
    v_rcp_f32 v92, v92
    v_rcp_f32 v93, v93
    v_rcp_f32 v94, v94
    v_rcp_f32 v95, v95
    v_pk_mul_f32 v[32:33], v[32:33], v[92:93]
    v_pk_mul_f32 v[34:35], v[34:35], v[94:95]
    v_cvt_pk_bf16_f32 v96, v32, v33
    v_cvt_pk_bf16_f32 v97, v34, v35
    v_pk_mul_f32 v[92:93], v[36:37], v[82:83] op_sel_hi:[1,0]
    v_pk_mul_f32 v[94:95], v[38:39], v[82:83] op_sel_hi:[1,0]
    v_exp_f32 v92, v92
    v_exp_f32 v93, v93
    v_exp_f32 v94, v94
    buffer_load_dwordx4 v[160:163], v15, s[36:39], s14 offen offset:0 sc1
    v_exp_f32 v95, v95
    v_pk_fma_f32 v[92:93], v[92:93], v[82:83], v[82:83] op_sel:[0,1,1] op_sel_hi:[1,1,1]
    v_pk_fma_f32 v[94:95], v[94:95], v[82:83], v[82:83] op_sel:[0,1,1] op_sel_hi:[1,1,1]
    v_rcp_f32 v92, v92
    v_rcp_f32 v93, v93
    v_rcp_f32 v94, v94
    v_rcp_f32 v95, v95
    v_pk_mul_f32 v[36:37], v[36:37], v[92:93]
    v_pk_mul_f32 v[38:39], v[38:39], v[94:95]
    v_cvt_pk_bf16_f32 v98, v36, v37
    v_cvt_pk_bf16_f32 v99, v38, v39
    v_pk_mul_f32 v[92:93], v[40:41], v[82:83] op_sel_hi:[1,0]
    v_pk_mul_f32 v[94:95], v[42:43], v[82:83] op_sel_hi:[1,0]
    v_exp_f32 v92, v92
    v_exp_f32 v93, v93
    v_exp_f32 v94, v94
    v_exp_f32 v95, v95
    v_pk_fma_f32 v[92:93], v[92:93], v[82:83], v[82:83] op_sel:[0,1,1] op_sel_hi:[1,1,1]
    v_pk_fma_f32 v[94:95], v[94:95], v[82:83], v[82:83] op_sel:[0,1,1] op_sel_hi:[1,1,1]
    v_rcp_f32 v92, v92
    v_rcp_f32 v93, v93
    buffer_load_dwordx4 v[164:167], v15, s[36:39], s14 offen offset:1024 sc1
    v_rcp_f32 v94, v94
    v_rcp_f32 v95, v95
    v_pk_mul_f32 v[40:41], v[40:41], v[92:93]
    v_pk_mul_f32 v[42:43], v[42:43], v[94:95]
    v_cvt_pk_bf16_f32 v100, v40, v41
    v_cvt_pk_bf16_f32 v101, v42, v43
    v_pk_mul_f32 v[92:93], v[44:45], v[82:83] op_sel_hi:[1,0]
    v_pk_mul_f32 v[94:95], v[46:47], v[82:83] op_sel_hi:[1,0]
    v_exp_f32 v92, v92
    v_exp_f32 v93, v93
    v_exp_f32 v94, v94
    v_exp_f32 v95, v95
    v_pk_fma_f32 v[92:93], v[92:93], v[82:83], v[82:83] op_sel:[0,1,1] op_sel_hi:[1,1,1]
    v_pk_fma_f32 v[94:95], v[94:95], v[82:83], v[82:83] op_sel:[0,1,1] op_sel_hi:[1,1,1]
    v_rcp_f32 v92, v92
    v_rcp_f32 v93, v93
    v_rcp_f32 v94, v94
    v_rcp_f32 v95, v95
    v_pk_mul_f32 v[44:45], v[44:45], v[92:93]
    v_pk_mul_f32 v[46:47], v[46:47], v[94:95]
    v_cvt_pk_bf16_f32 v102, v44, v45
    v_cvt_pk_bf16_f32 v103, v46, v47
    s_add_u32 s40, s17, 344064
    buffer_store_dwordx4 v[96:99], v1, s[36:39], s40 offen sc1
    buffer_store_dwordx4 v[100:103], v1, s[36:39], s40 offen offset:1024 sc1
    s_waitcnt vmcnt(19)
    v_mfma_f32_32x32x16_bf16 v[16:31], a[0:3], v[112:115], 0
    s_barrier
    v_mfma_f32_32x32x16_bf16 v[48:63], a[4:7], v[112:115], 0
    s_waitcnt vmcnt(18)
    v_mfma_f32_32x32x16_bf16 v[16:31], a[8:11], v[116:119], v[16:31]
    v_mfma_f32_32x32x16_bf16 v[48:63], a[12:15], v[116:119], v[48:63]
    s_waitcnt vmcnt(17)
    v_mfma_f32_32x32x16_bf16 v[16:31], a[16:19], v[120:123], v[16:31]
    s_add_u32 s41, s2, 256
    s_add_u32 s42, s56, 2
    v_mov_b32 v14, s42
    s_waitcnt vmcnt(5)
    s_mov_b64 exec, 1
    buffer_store_dword v14, v1, s[36:39], s41 offen sc1
    s_mov_b64 exec, -1
    v_mfma_f32_32x32x16_bf16 v[48:63], a[20:23], v[120:123], v[48:63]
    v_and_b32 v107, 7, v0
    v_mfma_f32_32x32x16_bf16 v[16:31], a[24:27], v[124:127], v[16:31]
    s_add_u32 s47, s56, 2
    s_waitcnt vmcnt(5)
    v_subrev_u32 v13, s47, v13
    v_cmp_lt_u32 vcc, 3, v13
    s_cbranch_vccnz L_aspin_75
L_aback_76:
    s_add_u32 s79, s78, 0
    v_add_u32 v15, s79, v1
    buffer_load_dwordx4 v[168:171], v15, s[36:39], s8 offen offset:0 sc1
    v_bfe_u32 v110, v0, 3, 1
    v_mfma_f32_32x32x16_bf16 v[48:63], a[28:31], v[124:127], v[48:63]
    v_mfma_f32_32x32x16_bf16 v[16:31], a[32:35], v[128:131], v[16:31]
    buffer_load_dwordx4 v[172:175], v15, s[36:39], s8 offen offset:1024 sc1
    v_mul_u32_u24 v108, 896, v107
    v_mfma_f32_32x32x16_bf16 v[48:63], a[36:39], v[128:131], v[48:63]
    v_lshlrev_b32 v107, 4, v107
    v_mfma_f32_32x32x16_bf16 v[16:31], a[40:43], v[132:135], v[16:31]
    buffer_load_dwordx4 v[112:115], v15, s[36:39], s9 offen offset:0 sc1
    v_mfma_f32_32x32x16_bf16 v[48:63], a[44:47], v[132:135], v[48:63]
    v_lshl_add_u32 v107, v110, 3, v107
    v_mfma_f32_32x32x16_bf16 v[16:31], a[48:51], v[136:139], v[16:31]
    buffer_load_dwordx4 v[116:119], v15, s[36:39], s9 offen offset:1024 sc1
    v_mfma_f32_32x32x16_bf16 v[48:63], a[52:55], v[136:139], v[48:63]
    v_lshrrev_b32 v110, 3, v0
    v_mfma_f32_32x32x16_bf16 v[16:31], a[56:59], v[140:143], v[16:31]
    buffer_load_dwordx4 v[120:123], v15, s[36:39], s10 offen offset:0 sc1
    v_lshl_add_u32 v108, v110, 4, v108
    v_mfma_f32_32x32x16_bf16 v[48:63], a[60:63], v[140:143], v[48:63]
    v_mfma_f32_32x32x16_bf16 v[16:31], a[64:67], v[144:147], v[16:31]
    buffer_load_dwordx4 v[124:127], v15, s[36:39], s10 offen offset:1024 sc1
    v_lshrrev_b32 v110, 4, v0
    v_mfma_f32_32x32x16_bf16 v[48:63], a[68:71], v[144:147], v[48:63]
    v_lshl_add_u32 v107, v110, 10, v107
    v_mfma_f32_32x32x16_bf16 v[16:31], a[72:75], v[148:151], v[16:31]
    buffer_load_dwordx4 v[128:131], v15, s[36:39], s11 offen offset:0 sc1
    v_mfma_f32_32x32x16_bf16 v[48:63], a[76:79], v[148:151], v[48:63]
    s_add_u32 s43, s75, 0
    buffer_load_dwordx2 v[88:89], v107, s[36:39], s43 offen sc1
    buffer_load_dwordx2 v[90:91], v107, s[36:39], s43 offen offset:512 sc1
    v_mfma_f32_32x32x16_bf16 v[16:31], a[80:83], v[152:155], v[16:31]
    buffer_load_dwordx4 v[132:135], v15, s[36:39], s11 offen offset:1024 sc1
    v_mfma_f32_32x32x16_bf16 v[48:63], a[84:87], v[152:155], v[48:63]
    v_mfma_f32_32x32x16_bf16 v[16:31], a[88:91], v[156:159], v[16:31]
    s_add_u32 s70, s74, 256
    buffer_load_dword v109, v104, s[36:39], s70 offen sc1
    buffer_load_dwordx4 v[136:139], v15, s[36:39], s12 offen offset:0 sc1
    v_mfma_f32_32x32x16_bf16 v[48:63], a[92:95], v[156:159], v[48:63]
    s_waitcnt vmcnt(16)
    v_mfma_f32_32x32x16_bf16 v[16:31], a[96:99], v[160:163], v[16:31]
    buffer_load_dwordx4 v[140:143], v15, s[36:39], s12 offen offset:1024 sc1
    s_add_u32 s41, s1, 768
    s_add_u32 s42, s56, 2
    v_mov_b32 v14, s42
    s_waitcnt vmcnt(14)
    s_mov_b64 exec, 1
    buffer_store_dword v14, v1, s[36:39], s41 offen sc1
    s_mov_b64 exec, -1
    v_mfma_f32_32x32x16_bf16 v[48:63], a[100:103], v[160:163], v[48:63]
    v_mfma_f32_32x32x16_bf16 v[16:31], a[104:107], v[164:167], v[16:31]
    v_mfma_f32_32x32x16_bf16 v[48:63], a[108:111], v[164:167], v[48:63]
    buffer_load_dwordx4 v[144:147], v15, s[36:39], s13 offen offset:0 sc1
    s_waitcnt vmcnt(14)
    v_mfma_f32_32x32x16_bf16 v[16:31], a[112:115], v[168:171], v[16:31]
    v_mfma_f32_32x32x16_bf16 v[48:63], a[116:119], v[168:171], v[48:63]
    buffer_load_dwordx4 v[148:151], v15, s[36:39], s13 offen offset:1024 sc1
    s_waitcnt vmcnt(14)
    v_mfma_f32_32x32x16_bf16 v[16:31], a[120:123], v[172:175], v[16:31]
    v_mfma_f32_32x32x16_bf16 v[48:63], a[124:127], v[172:175], v[48:63]
    buffer_load_dwordx4 v[152:155], v15, s[36:39], s14 offen offset:0 sc1
    s_waitcnt vmcnt(14)
    v_mfma_f32_32x32x16_bf16 v[16:31], a[128:131], v[112:115], v[16:31]
    v_mfma_f32_32x32x16_bf16 v[48:63], a[132:135], v[112:115], v[48:63]
    buffer_load_dwordx4 v[156:159], v15, s[36:39], s14 offen offset:1024 sc1
    s_waitcnt vmcnt(14)
    v_mfma_f32_32x32x16_bf16 v[16:31], a[136:139], v[116:119], v[16:31]
    v_mfma_f32_32x32x16_bf16 v[48:63], a[140:143], v[116:119], v[48:63]
    s_waitcnt vmcnt(13)
    v_mfma_f32_32x32x16_bf16 v[16:31], a[144:147], v[120:123], v[16:31]
    s_add_u32 s47, s56, 2
    s_waitcnt vmcnt(7)
    v_subrev_u32 v109, s47, v109
    v_cmp_lt_u32 vcc, 3, v109
    s_cbranch_vccnz L_aspin_78
L_aback_79:
    s_add_u32 s79, s73, 114688
    v_add_u32 v15, s79, v1
    buffer_load_dwordx4 v[160:163], v15, s[36:39], s8 offen offset:0 sc1
    v_mfma_f32_32x32x16_bf16 v[48:63], a[148:151], v[120:123], v[48:63]
    v_mfma_f32_32x32x16_bf16 v[16:31], a[152:155], v[124:127], v[16:31]
    buffer_load_dwordx4 v[164:167], v15, s[36:39], s8 offen offset:1024 sc1
    v_mfma_f32_32x32x16_bf16 v[48:63], a[156:159], v[124:127], v[48:63]
    v_mfma_f32_32x32x16_bf16 v[16:31], a[160:163], v[128:131], v[16:31]
    buffer_load_dwordx4 v[168:171], v15, s[36:39], s9 offen offset:0 sc1
    v_mfma_f32_32x32x16_bf16 v[48:63], a[164:167], v[128:131], v[48:63]
    v_mfma_f32_32x32x16_bf16 v[16:31], a[168:171], v[132:135], v[16:31]
    s_xor_b32 s71, s74, 4
    s_add_u32 s71, s71, 256
    buffer_load_dword v13, v104, s[36:39], s71 offen sc1
    buffer_load_dwordx4 v[172:175], v15, s[36:39], s9 offen offset:1024 sc1
    v_mfma_f32_32x32x16_bf16 v[48:63], a[172:175], v[132:135], v[48:63]
    s_waitcnt vmcnt(11)
    v_mfma_f32_32x32x16_bf16 v[16:31], a[176:179], v[136:139], v[16:31]
    buffer_load_dwordx4 v[112:115], v15, s[36:39], s10 offen offset:0 sc1
    v_mfma_f32_32x32x16_bf16 v[48:63], a[180:183], v[136:139], v[48:63]
    s_waitcnt vmcnt(11)
    v_mfma_f32_32x32x16_bf16 v[16:31], a[184:187], v[140:143], v[16:31]
    buffer_load_dwordx4 v[116:119], v15, s[36:39], s10 offen offset:1024 sc1
    v_mfma_f32_32x32x16_bf16 v[48:63], a[188:191], v[140:143], v[48:63]
    s_waitcnt vmcnt(10)
    v_mfma_f32_32x32x16_bf16 v[16:31], a[192:195], v[144:147], v[16:31]
    buffer_load_dwordx4 v[120:123], v15, s[36:39], s11 offen offset:0 sc1
    v_mfma_f32_32x32x16_bf16 v[48:63], a[196:199], v[144:147], v[48:63]
    s_waitcnt vmcnt(10)
    v_mfma_f32_32x32x16_bf16 v[16:31], a[200:203], v[148:151], v[16:31]
    buffer_load_dwordx4 v[124:127], v15, s[36:39], s11 offen offset:1024 sc1
    v_mfma_f32_32x32x16_bf16 v[48:63], a[204:207], v[148:151], v[48:63]
    s_waitcnt vmcnt(10)
    v_mfma_f32_32x32x16_bf16 v[16:31], a[208:211], v[152:155], v[16:31]
    buffer_load_dwordx4 v[128:131], v15, s[36:39], s12 offen offset:0 sc1
    v_mfma_f32_32x32x16_bf16 v[48:63], a[212:215], v[152:155], v[48:63]
    s_waitcnt vmcnt(10)
    v_mfma_f32_32x32x16_bf16 v[16:31], a[216:219], v[156:159], v[16:31]
    buffer_load_dwordx4 v[132:135], v15, s[36:39], s12 offen offset:1024 sc1
    v_mfma_f32_32x32x16_bf16 v[48:63], a[220:223], v[156:159], v[48:63]
    s_waitcnt vmcnt(10)
    v_mfma_f32_32x32x16_bf16 v[32:47], a[0:3], v[160:163], 0
    s_add_u32 s47, s56, 2
    s_waitcnt vmcnt(7)
    v_subrev_u32 v13, s47, v13
    v_cmp_lt_u32 vcc, 3, v13
    s_cbranch_vccnz L_aspin_81
L_aback_82:
    s_add_u32 s43, s75, 57344
    buffer_load_dwordx2 v[84:85], v107, s[36:39], s43 offen sc1
    buffer_load_dwordx2 v[86:87], v107, s[36:39], s43 offen offset:512 sc1
    v_mfma_f32_32x32x16_bf16 v[64:79], a[4:7], v[160:163], 0
    buffer_load_dwordx4 v[136:139], v15, s[36:39], s13 offen offset:0 sc1
    v_mfma_f32_32x32x16_bf16 v[32:47], a[8:11], v[164:167], v[32:47]
    ds_write_b128 v105, v[16:19] offset:0
    v_mfma_f32_32x32x16_bf16 v[64:79], a[12:15], v[164:167], v[64:79]
    buffer_load_dwordx4 v[140:143], v15, s[36:39], s13 offen offset:1024 sc1
    ds_write_b128 v106, v[20:23] offset:1024
    v_lshlrev_b32 v92, 16, v88
    v_mfma_f32_32x32x16_bf16 v[32:47], a[16:19], v[168:171], v[32:47]
    v_and_b32 v93, s51, v88
    v_mfma_f32_32x32x16_bf16 v[64:79], a[20:23], v[168:171], v[64:79]
    buffer_load_dwordx4 v[144:147], v15, s[36:39], s14 offen offset:0 sc1
    ds_write_b128 v105, v[24:27] offset:2048
    s_waitcnt vmcnt(11)
    v_mfma_f32_32x32x16_bf16 v[32:47], a[24:27], v[172:175], v[32:47]
    v_lshlrev_b32 v94, 16, v89
    v_mfma_f32_32x32x16_bf16 v[64:79], a[28:31], v[172:175], v[64:79]
    buffer_load_dwordx4 v[148:151], v15, s[36:39], s14 offen offset:1024 sc1
    ds_write_b128 v106, v[28:31] offset:3072
    v_and_b32 v95, s51, v89
    s_waitcnt vmcnt(11)
    v_mfma_f32_32x32x16_bf16 v[32:47], a[32:35], v[112:115], v[32:47]
    v_mfma_f32_32x32x16_bf16 v[64:79], a[36:39], v[112:115], v[64:79]
    s_add_u32 s79, s78, 114688
    v_add_u32 v15, s79, v1
    buffer_load_dwordx4 v[152:155], v15, s[36:39], s8 offen offset:0 sc1
    ds_write_b128 v105, v[48:51] offset:4096
    v_lshlrev_b32 v96, 16, v90
    s_waitcnt vmcnt(11)
    v_mfma_f32_32x32x16_bf16 v[32:47], a[40:43], v[116:119], v[32:47]
    ds_write_b128 v106, v[52:55] offset:5120
    v_mfma_f32_32x32x16_bf16 v[64:79], a[44:47], v[116:119], v[64:79]
    buffer_load_dwordx4 v[156:159], v15, s[36:39], s8 offen offset:1024 sc1
    v_and_b32 v97, s51, v90
    s_waitcnt vmcnt(11)
    v_mfma_f32_32x32x16_bf16 v[32:47], a[48:51], v[120:123], v[32:47]
    ds_write_b128 v105, v[56:59] offset:6144
    v_lshlrev_b32 v98, 16, v91
    v_mfma_f32_32x32x16_bf16 v[64:79], a[52:55], v[120:123], v[64:79]
    buffer_load_dwordx4 v[160:163], v15, s[36:39], s9 offen offset:0 sc1
    s_waitcnt vmcnt(11)
    v_mfma_f32_32x32x16_bf16 v[32:47], a[56:59], v[124:127], v[32:47]
    ds_write_b128 v106, v[60:63] offset:7168
    v_and_b32 v99, s51, v91
    v_mfma_f32_32x32x16_bf16 v[64:79], a[60:63], v[124:127], v[64:79]
    buffer_load_dwordx4 v[164:167], v15, s[36:39], s9 offen offset:1024 sc1
    s_waitcnt vmcnt(11)
    v_mfma_f32_32x32x16_bf16 v[32:47], a[64:67], v[128:131], v[32:47]
    v_mfma_f32_32x32x16_bf16 v[64:79], a[68:71], v[128:131], v[64:79]
    buffer_load_dwordx4 v[168:171], v15, s[36:39], s10 offen offset:0 sc1
    s_waitcnt lgkmcnt(0)
    s_barrier
    ds_read_b128 v[16:19], v111 offset:0
    s_waitcnt vmcnt(11)
    v_mfma_f32_32x32x16_bf16 v[32:47], a[72:75], v[132:135], v[32:47]
    ds_read_b128 v[20:23], v111 offset:512
    v_mfma_f32_32x32x16_bf16 v[64:79], a[76:79], v[132:135], v[64:79]
    buffer_load_dwordx4 v[172:175], v15, s[36:39], s10 offen offset:1024 sc1
    ds_read_b128 v[24:27], v111 offset:8192
    s_waitcnt vmcnt(9)
    v_mfma_f32_32x32x16_bf16 v[32:47], a[80:83], v[136:139], v[32:47]
    ds_read_b128 v[28:31], v111 offset:8704
    v_mfma_f32_32x32x16_bf16 v[64:79], a[84:87], v[136:139], v[64:79]
    buffer_load_dwordx4 v[112:115], v15, s[36:39], s11 offen offset:0 sc1
    ds_read_b128 v[48:51], v111 offset:16384
    s_waitcnt vmcnt(9)
    v_mfma_f32_32x32x16_bf16 v[32:47], a[88:91], v[140:143], v[32:47]
    ds_read_b128 v[52:55], v111 offset:16896
    v_mfma_f32_32x32x16_bf16 v[64:79], a[92:95], v[140:143], v[64:79]
    ds_read_b128 v[56:59], v111 offset:24576
    s_waitcnt vmcnt(8)
    v_mfma_f32_32x32x16_bf16 v[32:47], a[96:99], v[144:147], v[32:47]
    buffer_load_dwordx4 v[116:119], v15, s[36:39], s11 offen offset:1024 sc1
    ds_read_b128 v[60:63], v111 offset:25088
    v_mfma_f32_32x32x16_bf16 v[64:79], a[100:103], v[144:147], v[64:79]
    s_waitcnt lgkmcnt(7)
    v_add_f32 v92, v92, v16
    v_add_f32 v93, v93, v17
    v_add_f32 v94, v94, v18
    s_waitcnt vmcnt(8)
    v_mfma_f32_32x32x16_bf16 v[32:47], a[104:107], v[148:151], v[32:47]
    buffer_load_dwordx4 v[120:123], v15, s[36:39], s12 offen offset:0 sc1
    v_add_f32 v95, v95, v19
    s_waitcnt lgkmcnt(6)
    v_add_f32 v96, v96, v20
    v_mfma_f32_32x32x16_bf16 v[64:79], a[108:111], v[148:151], v[64:79]
    v_add_f32 v97, v97, v21
    v_add_f32 v98, v98, v22
    s_waitcnt vmcnt(8)
    v_mfma_f32_32x32x16_bf16 v[32:47], a[112:115], v[152:155], v[32:47]
    buffer_load_dwordx4 v[124:127], v15, s[36:39], s12 offen offset:1024 sc1
    v_add_f32 v99, v99, v23
    s_waitcnt lgkmcnt(5)
    v_add_f32 v92, v92, v24
    v_mfma_f32_32x32x16_bf16 v[64:79], a[116:119], v[152:155], v[64:79]
    v_add_f32 v93, v93, v25
    v_add_f32 v94, v94, v26
    s_waitcnt vmcnt(8)
    v_mfma_f32_32x32x16_bf16 v[32:47], a[120:123], v[156:159], v[32:47]
    buffer_load_dwordx4 v[128:131], v15, s[36:39], s13 offen offset:0 sc1
    v_add_f32 v95, v95, v27
    s_waitcnt lgkmcnt(4)
    v_add_f32 v96, v96, v28
    v_mfma_f32_32x32x16_bf16 v[64:79], a[124:127], v[156:159], v[64:79]
    v_add_f32 v97, v97, v29
    v_add_f32 v98, v98, v30
    s_waitcnt vmcnt(8)
    v_mfma_f32_32x32x16_bf16 v[32:47], a[128:131], v[160:163], v[32:47]
    buffer_load_dwordx4 v[132:135], v15, s[36:39], s13 offen offset:1024 sc1
    v_add_f32 v99, v99, v31
    s_waitcnt lgkmcnt(3)
    v_add_f32 v92, v92, v48
    v_mfma_f32_32x32x16_bf16 v[64:79], a[132:135], v[160:163], v[64:79]
    v_add_f32 v93, v93, v49
    v_add_f32 v94, v94, v50
    v_add_f32 v95, v95, v51
    s_waitcnt vmcnt(8)
    v_mfma_f32_32x32x16_bf16 v[32:47], a[136:139], v[164:167], v[32:47]
    buffer_load_dwordx4 v[136:139], v15, s[36:39], s14 offen offset:0 sc1
    s_waitcnt lgkmcnt(2)
    v_add_f32 v96, v96, v52
    v_add_f32 v97, v97, v53
    v_mfma_f32_32x32x16_bf16 v[64:79], a[140:143], v[164:167], v[64:79]
    v_add_f32 v98, v98, v54
    v_add_f32 v99, v99, v55
    s_waitcnt vmcnt(8)
    v_mfma_f32_32x32x16_bf16 v[32:47], a[144:147], v[168:171], v[32:47]
    buffer_load_dwordx4 v[140:143], v15, s[36:39], s14 offen offset:1024 sc1
    s_waitcnt lgkmcnt(1)
    v_add_f32 v92, v92, v56
    v_add_f32 v93, v93, v57
    s_waitcnt vmcnt(8)
    v_mfma_f32_32x32x16_bf16 v[32:47], a[152:155], v[172:175], v[32:47]
    v_add_f32 v94, v94, v58
    v_add_f32 v95, v95, v59
    s_waitcnt vmcnt(7)
    v_mfma_f32_32x32x16_bf16 v[32:47], a[160:163], v[112:115], v[32:47]
    s_waitcnt lgkmcnt(0)
    v_add_f32 v96, v96, v60
    v_add_f32 v97, v97, v61
    s_waitcnt vmcnt(6)
    v_mfma_f32_32x32x16_bf16 v[32:47], a[168:171], v[116:119], v[32:47]
    v_add_f32 v98, v98, v62
    v_add_f32 v99, v99, v63
    s_waitcnt vmcnt(5)
    v_mfma_f32_32x32x16_bf16 v[32:47], a[176:179], v[120:123], v[32:47]
    s_barrier
    v_cvt_pk_bf16_f32 v80, v92, v93
    v_cvt_pk_bf16_f32 v81, v94, v95
    s_waitcnt vmcnt(4)
    v_mfma_f32_32x32x16_bf16 v[32:47], a[184:187], v[124:127], v[32:47]
    v_cvt_pk_bf16_f32 v82, v96, v97
    v_cvt_pk_bf16_f32 v83, v98, v99
    s_waitcnt vmcnt(3)
    v_mfma_f32_32x32x16_bf16 v[32:47], a[192:195], v[128:131], v[32:47]
    v_lshlrev_b32 v92, 16, v84
    v_and_b32 v93, s51, v84
    s_waitcnt vmcnt(2)
    v_mfma_f32_32x32x16_bf16 v[32:47], a[200:203], v[132:135], v[32:47]
    v_lshlrev_b32 v94, 16, v85
    v_and_b32 v95, s51, v85
    s_waitcnt vmcnt(1)
    v_mfma_f32_32x32x16_bf16 v[32:47], a[208:211], v[136:139], v[32:47]
    v_lshlrev_b32 v96, 16, v86
    v_and_b32 v97, s51, v86
    s_waitcnt vmcnt(0)
    v_mfma_f32_32x32x16_bf16 v[32:47], a[216:219], v[140:143], v[32:47]
    v_lshlrev_b32 v98, 16, v87
    v_and_b32 v99, s51, v87
    v_mfma_f32_32x32x16_bf16 v[64:79], a[148:151], v[168:171], v[64:79]
    v_mfma_f32_32x32x16_bf16 v[64:79], a[156:159], v[172:175], v[64:79]
    v_mfma_f32_32x32x16_bf16 v[64:79], a[164:167], v[112:115], v[64:79]
    s_nop 6
    ds_write_b128 v105, v[32:35] offset:16384
    v_mfma_f32_32x32x16_bf16 v[64:79], a[172:175], v[116:119], v[64:79]
    v_mfma_f32_32x32x16_bf16 v[64:79], a[180:183], v[120:123], v[64:79]
    s_add_u32 s43, s77, 0
    buffer_store_dwordx4 v[80:83], v108, s[28:31], s43 offen sc1
    ds_write_b128 v106, v[36:39] offset:17408
    v_mfma_f32_32x32x16_bf16 v[64:79], a[188:191], v[124:127], v[64:79]
    v_mfma_f32_32x32x16_bf16 v[64:79], a[196:199], v[128:131], v[64:79]
    ds_write_b128 v105, v[40:43] offset:18432
    v_mfma_f32_32x32x16_bf16 v[64:79], a[204:207], v[132:135], v[64:79]
    v_mfma_f32_32x32x16_bf16 v[64:79], a[212:215], v[136:139], v[64:79]
    ds_write_b128 v106, v[44:47] offset:19456
    v_mfma_f32_32x32x16_bf16 v[64:79], a[220:223], v[140:143], v[64:79]
    s_nop 11
    ds_write_b128 v105, v[64:67] offset:20480
    ds_write_b128 v106, v[68:71] offset:21504
    ds_write_b128 v105, v[72:75] offset:22528
    ds_write_b128 v106, v[76:79] offset:23552
    s_waitcnt lgkmcnt(0)
    s_barrier
    ds_read_b128 v[32:35], v111 offset:16384
    ds_read_b128 v[36:39], v111 offset:16896
    ds_read_b128 v[40:43], v111 offset:24576
    ds_read_b128 v[44:47], v111 offset:25088
    ds_read_b128 v[64:67], v111 offset:32768
    ds_read_b128 v[68:71], v111 offset:33280
    ds_read_b128 v[72:75], v111 offset:40960
    ds_read_b128 v[76:79], v111 offset:41472
    s_waitcnt lgkmcnt(7)
    v_pk_add_f32 v[92:93], v[92:93], v[32:33]
    v_pk_add_f32 v[94:95], v[94:95], v[34:35]
    s_waitcnt lgkmcnt(6)
    v_pk_add_f32 v[96:97], v[96:97], v[36:37]
    v_pk_add_f32 v[98:99], v[98:99], v[38:39]
    s_waitcnt lgkmcnt(5)
    v_pk_add_f32 v[92:93], v[92:93], v[40:41]
    v_pk_add_f32 v[94:95], v[94:95], v[42:43]
    s_waitcnt lgkmcnt(4)
    v_pk_add_f32 v[96:97], v[96:97], v[44:45]
    v_pk_add_f32 v[98:99], v[98:99], v[46:47]
    s_waitcnt lgkmcnt(3)
    v_pk_add_f32 v[92:93], v[92:93], v[64:65]
    v_pk_add_f32 v[94:95], v[94:95], v[66:67]
    s_waitcnt lgkmcnt(2)
    v_pk_add_f32 v[96:97], v[96:97], v[68:69]
    v_pk_add_f32 v[98:99], v[98:99], v[70:71]
    s_waitcnt lgkmcnt(1)
    v_pk_add_f32 v[92:93], v[92:93], v[72:73]
    v_pk_add_f32 v[94:95], v[94:95], v[74:75]
    s_waitcnt lgkmcnt(0)
    v_pk_add_f32 v[96:97], v[96:97], v[76:77]
    v_pk_add_f32 v[98:99], v[98:99], v[78:79]
    v_cvt_pk_bf16_f32 v80, v92, v93
    v_cvt_pk_bf16_f32 v81, v94, v95
    v_cvt_pk_bf16_f32 v82, v96, v97
    v_cvt_pk_bf16_f32 v83, v98, v99
    s_add_u32 s43, s77, 28672
    buffer_store_dwordx4 v[80:83], v108, s[28:31], s43 offen sc1
    s_or_b32 s40, s57, s58
    s_or_b32 s40, s40, s59
    s_or_b32 s40, s40, s60
    s_cmp_lg_u32 s40, 0
    s_cbranch_scc1 L_fin_s
    s_add_u32 s40, s56, 64
    v_mov_b32 v14, s40
    s_mov_b64 exec, 1
    buffer_store_dword v14, v1, s[32:35], 0 offen sc1
    s_mov_b64 exec, -1
L_fin_s:
    s_waitcnt vmcnt(0)
    s_endpgm
L_spare0_s:
    s_waitcnt vmcnt(0) lgkmcnt(0)
    s_min_u32 s70, s60, 2
    s_mul_i32 s70, s70, 28672
    v_add_u32 v60, s70, v2
    ds_read_b64_tr_b16 v[32:33], v60 offset:0
    ds_read_b64_tr_b16 v[34:35], v60 offset:512
    ds_read_b64_tr_b16 v[36:37], v60 offset:1024
    ds_read_b64_tr_b16 v[38:39], v60 offset:1536
    ds_read_b64_tr_b16 v[40:41], v60 offset:2048
    ds_read_b64_tr_b16 v[42:43], v60 offset:2560
    v_mov_b32 v15, 0
    s_mov_b32 exec_lo, 0x00100001
    s_mov_b32 exec_hi, 0x00100001
    v_mov_b32 v15, s48
    s_mov_b64 exec, -1
    v_accvgpr_write_b32 a32, v15
    v_accvgpr_write_b32 a33, v15
    v_accvgpr_write_b32 a34, v15
    v_accvgpr_write_b32 a35, v15
    s_waitcnt lgkmcnt(4)
    s_nop 0
    v_mfma_f32_16x16x32_bf16 a[36:39], a[32:35], v[32:35], 0
    ds_read_b64_tr_b16 v[44:45], v60 offset:3072
    ds_read_b64_tr_b16 v[46:47], v60 offset:3584
    s_waitcnt lgkmcnt(4)
    v_mfma_f32_16x16x32_bf16 a[36:39], a[32:35], v[36:39], a[36:39]
    ds_read_b64_tr_b16 v[32:33], v60 offset:4096
    ds_read_b64_tr_b16 v[34:35], v60 offset:4608
    s_waitcnt lgkmcnt(4)
    v_mfma_f32_16x16x32_bf16 a[36:39], a[32:35], v[40:43], a[36:39]
    ds_read_b64_tr_b16 v[36:37], v60 offset:5120
    ds_read_b64_tr_b16 v[38:39], v60 offset:5632
    s_waitcnt lgkmcnt(4)
    v_mfma_f32_16x16x32_bf16 a[36:39], a[32:35], v[44:47], a[36:39]
    ds_read_b64_tr_b16 v[40:41], v60 offset:6144
    ds_read_b64_tr_b16 v[42:43], v60 offset:6656
    s_waitcnt lgkmcnt(4)
    v_mfma_f32_16x16x32_bf16 a[36:39], a[32:35], v[32:35], a[36:39]
    ds_read_b64_tr_b16 v[44:45], v60 offset:7168
    ds_read_b64_tr_b16 v[46:47], v60 offset:7680
    s_waitcnt lgkmcnt(4)
    v_mfma_f32_16x16x32_bf16 a[36:39], a[32:35], v[36:39], a[36:39]
    ds_read_b64_tr_b16 v[32:33], v60 offset:8192
    ds_read_b64_tr_b16 v[34:35], v60 offset:8704
    s_waitcnt lgkmcnt(4)
    v_mfma_f32_16x16x32_bf16 a[36:39], a[32:35], v[40:43], a[36:39]
    ds_read_b64_tr_b16 v[36:37], v60 offset:9216
    ds_read_b64_tr_b16 v[38:39], v60 offset:9728
    s_waitcnt lgkmcnt(4)
    v_mfma_f32_16x16x32_bf16 a[36:39], a[32:35], v[44:47], a[36:39]
    ds_read_b64_tr_b16 v[40:41], v60 offset:10240
    ds_read_b64_tr_b16 v[42:43], v60 offset:10752
    s_waitcnt lgkmcnt(4)
    v_mfma_f32_16x16x32_bf16 a[36:39], a[32:35], v[32:35], a[36:39]
    ds_read_b64_tr_b16 v[44:45], v60 offset:11264
    ds_read_b64_tr_b16 v[46:47], v60 offset:11776
    s_waitcnt lgkmcnt(4)
    v_mfma_f32_16x16x32_bf16 a[36:39], a[32:35], v[36:39], a[36:39]
    ds_read_b64_tr_b16 v[32:33], v60 offset:12288
    ds_read_b64_tr_b16 v[34:35], v60 offset:12800
    s_waitcnt lgkmcnt(4)
    v_mfma_f32_16x16x32_bf16 a[36:39], a[32:35], v[40:43], a[36:39]
    ds_read_b64_tr_b16 v[36:37], v60 offset:13312
    ds_read_b64_tr_b16 v[38:39], v60 offset:13824
    s_waitcnt lgkmcnt(4)
    v_mfma_f32_16x16x32_bf16 a[36:39], a[32:35], v[44:47], a[36:39]
    ds_read_b64_tr_b16 v[40:41], v60 offset:14336
    ds_read_b64_tr_b16 v[42:43], v60 offset:14848
    s_waitcnt lgkmcnt(4)
    v_mfma_f32_16x16x32_bf16 a[36:39], a[32:35], v[32:35], a[36:39]
    ds_read_b64_tr_b16 v[44:45], v60 offset:15360
    ds_read_b64_tr_b16 v[46:47], v60 offset:15872
    s_waitcnt lgkmcnt(4)
    v_mfma_f32_16x16x32_bf16 a[36:39], a[32:35], v[36:39], a[36:39]
    ds_read_b64_tr_b16 v[32:33], v60 offset:16384
    ds_read_b64_tr_b16 v[34:35], v60 offset:16896
    s_waitcnt lgkmcnt(4)
    v_mfma_f32_16x16x32_bf16 a[36:39], a[32:35], v[40:43], a[36:39]
    ds_read_b64_tr_b16 v[36:37], v60 offset:17408
    ds_read_b64_tr_b16 v[38:39], v60 offset:17920
    s_waitcnt lgkmcnt(4)
    v_mfma_f32_16x16x32_bf16 a[36:39], a[32:35], v[44:47], a[36:39]
    ds_read_b64_tr_b16 v[40:41], v60 offset:18432
    ds_read_b64_tr_b16 v[42:43], v60 offset:18944
    s_waitcnt lgkmcnt(4)
    v_mfma_f32_16x16x32_bf16 a[36:39], a[32:35], v[32:35], a[36:39]
    ds_read_b64_tr_b16 v[44:45], v60 offset:19456
    ds_read_b64_tr_b16 v[46:47], v60 offset:19968
    s_waitcnt lgkmcnt(4)
    v_mfma_f32_16x16x32_bf16 a[36:39], a[32:35], v[36:39], a[36:39]
    ds_read_b64_tr_b16 v[32:33], v60 offset:20480
    ds_read_b64_tr_b16 v[34:35], v60 offset:20992
    s_waitcnt lgkmcnt(4)
    v_mfma_f32_16x16x32_bf16 a[36:39], a[32:35], v[40:43], a[36:39]
    ds_read_b64_tr_b16 v[36:37], v60 offset:21504
    ds_read_b64_tr_b16 v[38:39], v60 offset:22016
    s_waitcnt lgkmcnt(4)
    v_mfma_f32_16x16x32_bf16 a[36:39], a[32:35], v[44:47], a[36:39]
    ds_read_b64_tr_b16 v[40:41], v60 offset:22528
    ds_read_b64_tr_b16 v[42:43], v60 offset:23040
    s_waitcnt lgkmcnt(4)
    v_mfma_f32_16x16x32_bf16 a[36:39], a[32:35], v[32:35], a[36:39]
    ds_read_b64_tr_b16 v[44:45], v60 offset:23552
    ds_read_b64_tr_b16 v[46:47], v60 offset:24064
    s_waitcnt lgkmcnt(4)
    v_mfma_f32_16x16x32_bf16 a[36:39], a[32:35], v[36:39], a[36:39]
    ds_read_b64_tr_b16 v[32:33], v60 offset:24576
    ds_read_b64_tr_b16 v[34:35], v60 offset:25088
    s_waitcnt lgkmcnt(4)
    v_mfma_f32_16x16x32_bf16 a[36:39], a[32:35], v[40:43], a[36:39]
    ds_read_b64_tr_b16 v[36:37], v60 offset:25600
    ds_read_b64_tr_b16 v[38:39], v60 offset:26112
    s_waitcnt lgkmcnt(4)
    v_mfma_f32_16x16x32_bf16 a[36:39], a[32:35], v[44:47], a[36:39]
    ds_read_b64_tr_b16 v[40:41], v60 offset:26624
    ds_read_b64_tr_b16 v[42:43], v60 offset:27136
    s_waitcnt lgkmcnt(4)
    v_mfma_f32_16x16x32_bf16 a[36:39], a[32:35], v[32:35], a[36:39]
    ds_read_b64_tr_b16 v[44:45], v60 offset:27648
    ds_read_b64_tr_b16 v[46:47], v60 offset:28160
    s_waitcnt lgkmcnt(4)
    v_mfma_f32_16x16x32_bf16 a[36:39], a[32:35], v[36:39], a[36:39]
    s_waitcnt lgkmcnt(2)
    v_mfma_f32_16x16x32_bf16 a[36:39], a[32:35], v[40:43], a[36:39]
    s_waitcnt lgkmcnt(0)
    v_mfma_f32_16x16x32_bf16 a[36:39], a[32:35], v[44:47], a[36:39]
    s_lshl_b32 s70, s60, 9
    v_lshlrev_b32 v60, 3, v0
    v_add_u32 v60, 159744, v60
    v_add_u32 v61, s70, v60
    s_nop 3
    v_accvgpr_read_b32 v40, a36
    v_cvt_pk_bf16_f32 v42, v40, v40
    v_and_b32 v41, s51, v42
    v_sub_f32 v41, v40, v41
    v_cvt_pk_bf16_f32 v43, v41, 0
    ds_write_b64 v61, v[42:43]
    s_waitcnt lgkmcnt(0)
    s_barrier
    v_lshlrev_b32 v13, 3, v0
    v_add_u32 v13, 159744, v13
    ds_read_b64 v[8:9], v13
    ds_read_b64 v[10:11], v13 offset:512
    ds_read_b64 v[6:7], v13 offset:1024
    s_and_b32 s40, s58, 1
    s_lshl_b32 s40, s40, 3
    s_add_u32 s40, s40, s64
    v_lshlrev_b32 v64, 7, v0
    s_add_u32 s41, s40, 0
    s_min_u32 s41, s41, 97
    s_mul_i32 s42, s41, 147
    s_lshr_b32 s42, s42, 10
    s_mul_i32 s43, s42, 7
    s_sub_u32 s41, s41, s43
    s_add_u32 s42, s42, 8
    s_cmp_ge_u32 s42, 14
    s_cselect_b32 s43, 14, 0
    s_sub_u32 s42, s42, s43
    s_mul_i32 s41, s41, 229376
    s_lshl_b32 s42, s42, 14
    s_add_u32 s41, s41, s42
    s_add_u32 s41, s41, 4038656
    buffer_load_dword v65, v64, s[32:35], s41 offen sc1
    s_add_u32 s41, s41, 8192
    buffer_load_dword v65, v64, s[32:35], s41 offen sc1
    s_add_u32 s41, s40, 16
    s_min_u32 s41, s41, 97
    s_mul_i32 s42, s41, 147
    s_lshr_b32 s42, s42, 10
    s_mul_i32 s43, s42, 7
    s_sub_u32 s41, s41, s43
    s_add_u32 s42, s42, 8
    s_cmp_ge_u32 s42, 14
    s_cselect_b32 s43, 14, 0
    s_sub_u32 s42, s42, s43
    s_mul_i32 s41, s41, 229376
    s_lshl_b32 s42, s42, 14
    s_add_u32 s41, s41, s42
    s_add_u32 s41, s41, 4038656
    buffer_load_dword v65, v64, s[32:35], s41 offen sc1
    s_add_u32 s41, s41, 8192
    buffer_load_dword v65, v64, s[32:35], s41 offen sc1
    s_add_u32 s41, s40, 32
    s_min_u32 s41, s41, 97
    s_mul_i32 s42, s41, 147
    s_lshr_b32 s42, s42, 10
    s_mul_i32 s43, s42, 7
    s_sub_u32 s41, s41, s43
    s_add_u32 s42, s42, 8
    s_cmp_ge_u32 s42, 14
    s_cselect_b32 s43, 14, 0
    s_sub_u32 s42, s42, s43
    s_mul_i32 s41, s41, 229376
    s_lshl_b32 s42, s42, 14
    s_add_u32 s41, s41, s42
    s_add_u32 s41, s41, 4038656
    buffer_load_dword v65, v64, s[32:35], s41 offen sc1
    s_add_u32 s41, s41, 8192
    buffer_load_dword v65, v64, s[32:35], s41 offen sc1
    s_add_u32 s41, s40, 48
    s_min_u32 s41, s41, 97
    s_mul_i32 s42, s41, 147
    s_lshr_b32 s42, s42, 10
    s_mul_i32 s43, s42, 7
    s_sub_u32 s41, s41, s43
    s_add_u32 s42, s42, 8
    s_cmp_ge_u32 s42, 14
    s_cselect_b32 s43, 14, 0
    s_sub_u32 s42, s42, s43
    s_mul_i32 s41, s41, 229376
    s_lshl_b32 s42, s42, 14
    s_add_u32 s41, s41, s42
    s_add_u32 s41, s41, 4038656
    buffer_load_dword v65, v64, s[32:35], s41 offen sc1
    s_add_u32 s41, s41, 8192
    buffer_load_dword v65, v64, s[32:35], s41 offen sc1
    s_add_u32 s41, s40, 64
    s_min_u32 s41, s41, 97
    s_mul_i32 s42, s41, 147
    s_lshr_b32 s42, s42, 10
    s_mul_i32 s43, s42, 7
    s_sub_u32 s41, s41, s43
    s_add_u32 s42, s42, 8
    s_cmp_ge_u32 s42, 14
    s_cselect_b32 s43, 14, 0
    s_sub_u32 s42, s42, s43
    s_mul_i32 s41, s41, 229376
    s_lshl_b32 s42, s42, 14
    s_add_u32 s41, s41, s42
    s_add_u32 s41, s41, 4038656
    buffer_load_dword v65, v64, s[32:35], s41 offen sc1
    s_add_u32 s41, s41, 8192
    buffer_load_dword v65, v64, s[32:35], s41 offen sc1
    s_add_u32 s41, s40, 80
    s_min_u32 s41, s41, 97
    s_mul_i32 s42, s41, 147
    s_lshr_b32 s42, s42, 10
    s_mul_i32 s43, s42, 7
    s_sub_u32 s41, s41, s43
    s_add_u32 s42, s42, 8
    s_cmp_ge_u32 s42, 14
    s_cselect_b32 s43, 14, 0
    s_sub_u32 s42, s42, s43
    s_mul_i32 s41, s41, 229376
    s_lshl_b32 s42, s42, 14
    s_add_u32 s41, s41, s42
    s_add_u32 s41, s41, 4038656
    buffer_load_dword v65, v64, s[32:35], s41 offen sc1
    s_add_u32 s41, s41, 8192
    buffer_load_dword v65, v64, s[32:35], s41 offen sc1
    s_add_u32 s41, s40, 96
    s_min_u32 s41, s41, 97
    s_mul_i32 s42, s41, 147
    s_lshr_b32 s42, s42, 10
    s_mul_i32 s43, s42, 7
    s_sub_u32 s41, s41, s43
    s_add_u32 s42, s42, 8
    s_cmp_ge_u32 s42, 14
    s_cselect_b32 s43, 14, 0
    s_sub_u32 s42, s42, s43
    s_mul_i32 s41, s41, 229376
    s_lshl_b32 s42, s42, 14
    s_add_u32 s41, s41, s42
    s_add_u32 s41, s41, 4038656
    buffer_load_dword v65, v64, s[32:35], s41 offen sc1
    s_add_u32 s41, s41, 8192
    buffer_load_dword v65, v64, s[32:35], s41 offen sc1
    s_waitcnt vmcnt(0) lgkmcnt(0)
    s_branch L_layer1_s
L_spare1_s:
    s_waitcnt vmcnt(0) lgkmcnt(0)
    s_branch L_fin_s
L_kvspin_44:
    s_mov_b32 s46, s66
L_kvloop_46:
    s_add_u32 s45, s57, 0
    s_and_b32 s45, s45, 7
    s_lshl_b32 s45, s45, 12
    s_add_u32 s45, s45, s6
    buffer_load_dwordx2 v[64:65], v11, s[32:35], s45 offen sc1
    buffer_load_dwordx2 v[66:67], v11, s[32:35], s45 offen offset:2048 sc1
    s_add_u32 s45, s57, 1
    s_and_b32 s45, s45, 7
    s_lshl_b32 s45, s45, 12
    s_add_u32 s45, s45, s6
    buffer_load_dwordx2 v[68:69], v11, s[32:35], s45 offen sc1
    buffer_load_dwordx2 v[70:71], v11, s[32:35], s45 offen offset:2048 sc1
    s_add_u32 s45, s57, 2
    s_and_b32 s45, s45, 7
    s_lshl_b32 s45, s45, 12
    s_add_u32 s45, s45, s6
    buffer_load_dwordx2 v[72:73], v11, s[32:35], s45 offen sc1
    buffer_load_dwordx2 v[74:75], v11, s[32:35], s45 offen offset:2048 sc1
    s_add_u32 s45, s57, 3
    s_and_b32 s45, s45, 7
    s_lshl_b32 s45, s45, 12
    s_add_u32 s45, s45, s6
    buffer_load_dwordx2 v[76:77], v11, s[32:35], s45 offen sc1
    buffer_load_dwordx2 v[78:79], v11, s[32:35], s45 offen offset:2048 sc1
    s_add_u32 s45, s57, 4
    s_and_b32 s45, s45, 7
    s_lshl_b32 s45, s45, 12
    s_add_u32 s45, s45, s6
    buffer_load_dwordx2 v[80:81], v11, s[32:35], s45 offen sc1
    buffer_load_dwordx2 v[82:83], v11, s[32:35], s45 offen offset:2048 sc1
    s_add_u32 s45, s57, 5
    s_and_b32 s45, s45, 7
    s_lshl_b32 s45, s45, 12
    s_add_u32 s45, s45, s6
    buffer_load_dwordx2 v[84:85], v11, s[32:35], s45 offen sc1
    buffer_load_dwordx2 v[86:87], v11, s[32:35], s45 offen offset:2048 sc1
    s_add_u32 s45, s57, 6
    s_and_b32 s45, s45, 7
    s_lshl_b32 s45, s45, 12
    s_add_u32 s45, s45, s6
    buffer_load_dwordx2 v[88:89], v11, s[32:35], s45 offen sc1
    buffer_load_dwordx2 v[90:91], v11, s[32:35], s45 offen offset:2048 sc1
    s_add_u32 s45, s57, 7
    s_and_b32 s45, s45, 7
    s_lshl_b32 s45, s45, 12
    s_add_u32 s45, s45, s6
    buffer_load_dwordx2 v[92:93], v11, s[32:35], s45 offen sc1
    buffer_load_dwordx2 v[94:95], v11, s[32:35], s45 offen offset:2048 sc1
    s_waitcnt vmcnt(0)
    v_mov_b32 v16, 0
    v_mov_b32 v17, 0
    v_mov_b32 v18, 0
    v_mov_b32 v19, 0
    v_mov_b32 v20, 0
    v_dot2c_f32_bf16 v16, s43, v64
    v_dot2c_f32_bf16 v17, s44, v64
    v_dot2c_f32_bf16 v18, s43, v65
    v_dot2c_f32_bf16 v19, s44, v65
    v_max3_u32 v20, v20, v64, v65
    v_dot2c_f32_bf16 v16, s43, v66
    v_dot2c_f32_bf16 v17, s44, v66
    v_dot2c_f32_bf16 v18, s43, v67
    v_dot2c_f32_bf16 v19, s44, v67
    v_max3_u32 v20, v20, v66, v67
    v_dot2c_f32_bf16 v16, s43, v68
    v_dot2c_f32_bf16 v17, s44, v68
    v_dot2c_f32_bf16 v18, s43, v69
    v_dot2c_f32_bf16 v19, s44, v69
    v_max3_u32 v20, v20, v68, v69
    v_dot2c_f32_bf16 v16, s43, v70
    v_dot2c_f32_bf16 v17, s44, v70
    v_dot2c_f32_bf16 v18, s43, v71
    v_dot2c_f32_bf16 v19, s44, v71
    v_max3_u32 v20, v20, v70, v71
    v_dot2c_f32_bf16 v16, s43, v72
    v_dot2c_f32_bf16 v17, s44, v72
    v_dot2c_f32_bf16 v18, s43, v73
    v_dot2c_f32_bf16 v19, s44, v73
    v_max3_u32 v20, v20, v72, v73
    v_dot2c_f32_bf16 v16, s43, v74
    v_dot2c_f32_bf16 v17, s44, v74
    v_dot2c_f32_bf16 v18, s43, v75
    v_dot2c_f32_bf16 v19, s44, v75
    v_max3_u32 v20, v20, v74, v75
    v_dot2c_f32_bf16 v16, s43, v76
    v_dot2c_f32_bf16 v17, s44, v76
    v_dot2c_f32_bf16 v18, s43, v77
    v_dot2c_f32_bf16 v19, s44, v77
    v_max3_u32 v20, v20, v76, v77
    v_dot2c_f32_bf16 v16, s43, v78
    v_dot2c_f32_bf16 v17, s44, v78
    v_dot2c_f32_bf16 v18, s43, v79
    v_dot2c_f32_bf16 v19, s44, v79
    v_max3_u32 v20, v20, v78, v79
    v_dot2c_f32_bf16 v16, s43, v80
    v_dot2c_f32_bf16 v17, s44, v80
    v_dot2c_f32_bf16 v18, s43, v81
    v_dot2c_f32_bf16 v19, s44, v81
    v_max3_u32 v20, v20, v80, v81
    v_dot2c_f32_bf16 v16, s43, v82
    v_dot2c_f32_bf16 v17, s44, v82
    v_dot2c_f32_bf16 v18, s43, v83
    v_dot2c_f32_bf16 v19, s44, v83
    v_max3_u32 v20, v20, v82, v83
    v_dot2c_f32_bf16 v16, s43, v84
    v_dot2c_f32_bf16 v17, s44, v84
    v_dot2c_f32_bf16 v18, s43, v85
    v_dot2c_f32_bf16 v19, s44, v85
    v_max3_u32 v20, v20, v84, v85
    v_dot2c_f32_bf16 v16, s43, v86
    v_dot2c_f32_bf16 v17, s44, v86
    v_dot2c_f32_bf16 v18, s43, v87
    v_dot2c_f32_bf16 v19, s44, v87
    v_max3_u32 v20, v20, v86, v87
    v_dot2c_f32_bf16 v16, s43, v88
    v_dot2c_f32_bf16 v17, s44, v88
    v_dot2c_f32_bf16 v18, s43, v89
    v_dot2c_f32_bf16 v19, s44, v89
    v_max3_u32 v20, v20, v88, v89
    v_dot2c_f32_bf16 v16, s43, v90
    v_dot2c_f32_bf16 v17, s44, v90
    v_dot2c_f32_bf16 v18, s43, v91
    v_dot2c_f32_bf16 v19, s44, v91
    v_max3_u32 v20, v20, v90, v91
    v_dot2c_f32_bf16 v16, s43, v92
    v_dot2c_f32_bf16 v17, s44, v92
    v_dot2c_f32_bf16 v18, s43, v93
    v_dot2c_f32_bf16 v19, s44, v93
    v_max3_u32 v20, v20, v92, v93
    v_dot2c_f32_bf16 v16, s43, v94
    v_dot2c_f32_bf16 v17, s44, v94
    v_dot2c_f32_bf16 v18, s43, v95
    v_dot2c_f32_bf16 v19, s44, v95
    v_max3_u32 v20, v20, v94, v95
    v_cmp_eq_u32 vcc, -1, v20
    s_cbranch_vccz L_kvback_45
    s_sub_u32 s46, s46, 1
    s_cmp_lg_u32 s46, 0
    s_cbranch_scc1 L_kvloop_46
    s_mov_b32 s66, 1
    s_branch L_kvback_45
L_aspin_51:
    s_nop 4
    s_mov_b32 s46, s66
L_poll_53:
    buffer_load_dword v109, v104, s[36:39], s70 offen sc1
    s_waitcnt vmcnt(0)
    v_subrev_u32 v109, s47, v109
    v_cmp_lt_u32 vcc, 3, v109
    s_cbranch_vccz L_aback_52
    s_sub_u32 s46, s46, 1
    s_cmp_lg_u32 s46, 0
    s_cbranch_scc1 L_poll_53
    s_mov_b32 s66, 1
    s_branch L_aback_52
L_aspin_54:
    s_nop 4
    s_mov_b32 s46, s66
L_poll_56:
    buffer_load_dword v13, v104, s[36:39], s71 offen sc1
    s_waitcnt vmcnt(0)
    v_subrev_u32 v13, s47, v13
    v_cmp_lt_u32 vcc, 3, v13
    s_cbranch_vccz L_aback_55
    s_sub_u32 s46, s46, 1
    s_cmp_lg_u32 s46, 0
    s_cbranch_scc1 L_poll_56
    s_mov_b32 s66, 1
    s_branch L_aback_55
L_aspin_57:
    s_nop 4
    s_mov_b32 s46, s66
L_poll_59:
    buffer_load_dword v109, v104, s[36:39], s70 offen sc1
    s_waitcnt vmcnt(0)
    v_subrev_u32 v109, s47, v109
    v_cmp_lt_u32 vcc, 3, v109
    s_cbranch_vccz L_aback_58
    s_sub_u32 s46, s46, 1
    s_cmp_lg_u32 s46, 0
    s_cbranch_scc1 L_poll_59
    s_mov_b32 s66, 1
    s_branch L_aback_58
L_aspin_60:
    s_nop 4
    s_mov_b32 s46, s66
L_poll_62:
    buffer_load_dword v13, v104, s[36:39], s71 offen sc1
    s_waitcnt vmcnt(0)
    v_subrev_u32 v13, s47, v13
    v_cmp_lt_u32 vcc, 3, v13
    s_cbranch_vccz L_aback_61
    s_sub_u32 s46, s46, 1
    s_cmp_lg_u32 s46, 0
    s_cbranch_scc1 L_poll_62
    s_mov_b32 s66, 1
    s_branch L_aback_61
L_kvspin_65:
    s_mov_b32 s46, s66
L_kvloop_67:
    s_add_u32 s45, s57, 0
    s_and_b32 s45, s45, 7
    s_lshl_b32 s45, s45, 12
    s_add_u32 s45, s45, s6
    buffer_load_dwordx2 v[96:97], v91, s[32:35], s45 offen sc1
    buffer_load_dwordx2 v[98:99], v91, s[32:35], s45 offen offset:2048 sc1
    s_add_u32 s45, s57, 1
    s_and_b32 s45, s45, 7
    s_lshl_b32 s45, s45, 12
    s_add_u32 s45, s45, s6
    buffer_load_dwordx2 v[100:101], v91, s[32:35], s45 offen sc1
    buffer_load_dwordx2 v[102:103], v91, s[32:35], s45 offen offset:2048 sc1
    s_add_u32 s45, s57, 2
    s_and_b32 s45, s45, 7
    s_lshl_b32 s45, s45, 12
    s_add_u32 s45, s45, s6
    buffer_load_dwordx2 v[104:105], v91, s[32:35], s45 offen sc1
    buffer_load_dwordx2 v[106:107], v91, s[32:35], s45 offen offset:2048 sc1
    s_add_u32 s45, s57, 3
    s_and_b32 s45, s45, 7
    s_lshl_b32 s45, s45, 12
    s_add_u32 s45, s45, s6
    buffer_load_dwordx2 v[108:109], v91, s[32:35], s45 offen sc1
    buffer_load_dwordx2 v[110:111], v91, s[32:35], s45 offen offset:2048 sc1
    s_add_u32 s45, s57, 4
    s_and_b32 s45, s45, 7
    s_lshl_b32 s45, s45, 12
    s_add_u32 s45, s45, s6
    buffer_load_dwordx2 v[112:113], v91, s[32:35], s45 offen sc1
    buffer_load_dwordx2 v[114:115], v91, s[32:35], s45 offen offset:2048 sc1
    s_add_u32 s45, s57, 5
    s_and_b32 s45, s45, 7
    s_lshl_b32 s45, s45, 12
    s_add_u32 s45, s45, s6
    buffer_load_dwordx2 v[116:117], v91, s[32:35], s45 offen sc1
    buffer_load_dwordx2 v[118:119], v91, s[32:35], s45 offen offset:2048 sc1
    s_add_u32 s45, s57, 6
    s_and_b32 s45, s45, 7
    s_lshl_b32 s45, s45, 12
    s_add_u32 s45, s45, s6
    buffer_load_dwordx2 v[120:121], v91, s[32:35], s45 offen sc1
    buffer_load_dwordx2 v[122:123], v91, s[32:35], s45 offen offset:2048 sc1
    s_add_u32 s45, s57, 7
    s_and_b32 s45, s45, 7
    s_lshl_b32 s45, s45, 12
    s_add_u32 s45, s45, s6
    buffer_load_dwordx2 v[124:125], v91, s[32:35], s45 offen sc1
    buffer_load_dwordx2 v[126:127], v91, s[32:35], s45 offen offset:2048 sc1
    s_waitcnt vmcnt(0)
    v_mov_b32 v16, 0
    v_mov_b32 v17, 0
    v_mov_b32 v18, 0
    v_mov_b32 v19, 0
    v_mov_b32 v20, 0
    v_dot2c_f32_bf16 v16, s43, v96
    v_dot2c_f32_bf16 v17, s44, v96
    v_dot2c_f32_bf16 v18, s43, v97
    v_dot2c_f32_bf16 v19, s44, v97
    v_max3_u32 v20, v20, v96, v97
    v_dot2c_f32_bf16 v16, s43, v98
    v_dot2c_f32_bf16 v17, s44, v98
    v_dot2c_f32_bf16 v18, s43, v99
    v_dot2c_f32_bf16 v19, s44, v99
    v_max3_u32 v20, v20, v98, v99
    v_dot2c_f32_bf16 v16, s43, v100
    v_dot2c_f32_bf16 v17, s44, v100
    v_dot2c_f32_bf16 v18, s43, v101
    v_dot2c_f32_bf16 v19, s44, v101
    v_max3_u32 v20, v20, v100, v101
    v_dot2c_f32_bf16 v16, s43, v102
    v_dot2c_f32_bf16 v17, s44, v102
    v_dot2c_f32_bf16 v18, s43, v103
    v_dot2c_f32_bf16 v19, s44, v103
    v_max3_u32 v20, v20, v102, v103
    v_dot2c_f32_bf16 v16, s43, v104
    v_dot2c_f32_bf16 v17, s44, v104
    v_dot2c_f32_bf16 v18, s43, v105
    v_dot2c_f32_bf16 v19, s44, v105
    v_max3_u32 v20, v20, v104, v105
    v_dot2c_f32_bf16 v16, s43, v106
    v_dot2c_f32_bf16 v17, s44, v106
    v_dot2c_f32_bf16 v18, s43, v107
    v_dot2c_f32_bf16 v19, s44, v107
    v_max3_u32 v20, v20, v106, v107
    v_dot2c_f32_bf16 v16, s43, v108
    v_dot2c_f32_bf16 v17, s44, v108
    v_dot2c_f32_bf16 v18, s43, v109
    v_dot2c_f32_bf16 v19, s44, v109
    v_max3_u32 v20, v20, v108, v109
    v_dot2c_f32_bf16 v16, s43, v110
    v_dot2c_f32_bf16 v17, s44, v110
    v_dot2c_f32_bf16 v18, s43, v111
    v_dot2c_f32_bf16 v19, s44, v111
    v_max3_u32 v20, v20, v110, v111
    v_dot2c_f32_bf16 v16, s43, v112
    v_dot2c_f32_bf16 v17, s44, v112
    v_dot2c_f32_bf16 v18, s43, v113
    v_dot2c_f32_bf16 v19, s44, v113
    v_max3_u32 v20, v20, v112, v113
    v_dot2c_f32_bf16 v16, s43, v114
    v_dot2c_f32_bf16 v17, s44, v114
    v_dot2c_f32_bf16 v18, s43, v115
    v_dot2c_f32_bf16 v19, s44, v115
    v_max3_u32 v20, v20, v114, v115
    v_dot2c_f32_bf16 v16, s43, v116
    v_dot2c_f32_bf16 v17, s44, v116
    v_dot2c_f32_bf16 v18, s43, v117
    v_dot2c_f32_bf16 v19, s44, v117
    v_max3_u32 v20, v20, v116, v117
    v_dot2c_f32_bf16 v16, s43, v118
    v_dot2c_f32_bf16 v17, s44, v118
    v_dot2c_f32_bf16 v18, s43, v119
    v_dot2c_f32_bf16 v19, s44, v119
    v_max3_u32 v20, v20, v118, v119
    v_dot2c_f32_bf16 v16, s43, v120
    v_dot2c_f32_bf16 v17, s44, v120
    v_dot2c_f32_bf16 v18, s43, v121
    v_dot2c_f32_bf16 v19, s44, v121
    v_max3_u32 v20, v20, v120, v121
    v_dot2c_f32_bf16 v16, s43, v122
    v_dot2c_f32_bf16 v17, s44, v122
    v_dot2c_f32_bf16 v18, s43, v123
    v_dot2c_f32_bf16 v19, s44, v123
    v_max3_u32 v20, v20, v122, v123
    v_dot2c_f32_bf16 v16, s43, v124
    v_dot2c_f32_bf16 v17, s44, v124
    v_dot2c_f32_bf16 v18, s43, v125
    v_dot2c_f32_bf16 v19, s44, v125
    v_max3_u32 v20, v20, v124, v125
    v_dot2c_f32_bf16 v16, s43, v126
    v_dot2c_f32_bf16 v17, s44, v126
    v_dot2c_f32_bf16 v18, s43, v127
    v_dot2c_f32_bf16 v19, s44, v127
    v_max3_u32 v20, v20, v126, v127
    v_cmp_eq_u32 vcc, -1, v20
    s_cbranch_vccz L_kvback_66
    s_sub_u32 s46, s46, 1
    s_cmp_lg_u32 s46, 0
    s_cbranch_scc1 L_kvloop_67
    s_mov_b32 s66, 1
    s_branch L_kvback_66
L_aspin_72:
    s_nop 4
    s_mov_b32 s46, s66
L_poll_74:
    buffer_load_dword v109, v104, s[36:39], s70 offen sc1
    s_waitcnt vmcnt(0)
    v_subrev_u32 v109, s47, v109
    v_cmp_lt_u32 vcc, 3, v109
    s_cbranch_vccz L_aback_73
    s_sub_u32 s46, s46, 1
    s_cmp_lg_u32 s46, 0
    s_cbranch_scc1 L_poll_74
    s_mov_b32 s66, 1
    s_branch L_aback_73
L_aspin_75:
    s_nop 4
    s_mov_b32 s46, s66
L_poll_77:
    buffer_load_dword v13, v104, s[36:39], s71 offen sc1
    s_waitcnt vmcnt(0)
    v_subrev_u32 v13, s47, v13
    v_cmp_lt_u32 vcc, 3, v13
    s_cbranch_vccz L_aback_76
    s_sub_u32 s46, s46, 1
    s_cmp_lg_u32 s46, 0
    s_cbranch_scc1 L_poll_77
    s_mov_b32 s66, 1
    s_branch L_aback_76
L_aspin_78:
    s_nop 4
    s_mov_b32 s46, s66
L_poll_80:
    buffer_load_dword v109, v104, s[36:39], s70 offen sc1
    s_waitcnt vmcnt(0)
    v_subrev_u32 v109, s47, v109
    v_cmp_lt_u32 vcc, 3, v109
    s_cbranch_vccz L_aback_79
    s_sub_u32 s46, s46, 1
    s_cmp_lg_u32 s46, 0
    s_cbranch_scc1 L_poll_80
    s_mov_b32 s66, 1
    s_branch L_aback_79
L_aspin_81:
    s_nop 4
    s_mov_b32 s46, s66
L_poll_83:
    buffer_load_dword v13, v104, s[36:39], s71 offen sc1
    s_waitcnt vmcnt(0)
    v_subrev_u32 v13, s47, v13
    v_cmp_lt_u32 vcc, 3, v13
    s_cbranch_vccz L_aback_82
    s_sub_u32 s46, s46, 1
    s_cmp_lg_u32 s46, 0
    s_cbranch_scc1 L_poll_83
    s_mov_b32 s66, 1
    s_branch L_aback_82
.section .rodata,"a"
.p2align 6
.amdhsa_kernel interleave_layers__linear_attn_block__dense_activation_silu__prompt_kernel
  .amdhsa_next_free_vgpr 512
  .amdhsa_next_free_sgpr 102
  .amdhsa_accum_offset 256
  .amdhsa_group_segment_fixed_size 0
  .amdhsa_kernarg_size 72
  .amdhsa_user_sgpr_count 2
  .amdhsa_user_sgpr_kernarg_segment_ptr 1
  .amdhsa_system_sgpr_workgroup_id_x 1
.end_amdhsa_kernel
```
